```python
import torch

def _softmax(x, axis=-1):
    return torch.softmax(x, dim=axis)
def _gelu(x):
    return torch.nn.functional.gelu(x, approximate="tanh")
def _silu(x):
    return torch.nn.functional.silu(x)
def _sigmoid(x):
    return torch.sigmoid(x)
def _layernorm(x, axis=-1, eps=1e-5):
    m = x.mean(dim=axis, keepdim=True)
    v = x.var(dim=axis, keepdim=True, unbiased=False)
    return (x - m) / torch.sqrt(v + eps)
def _scatter_add(tgt, idx, src, axis=0):
    return tgt.clone().index_add_(axis, idx, src)
def _segment_sum(src, seg, n):
    out = torch.zeros((n,) + src.shape[1:], dtype=src.dtype)
    return out.index_add_(0, seg, src)
def _pad(x, pw):
    flat = tuple(v for pair in reversed(pw) for v in pair)
    return torch.nn.functional.pad(x, flat)

kernel_name = 'concat_heads__mha_block_cached__gqa_block_cached__near_ridge'

def setup_inputs():

    _w = (lambda a: (lambda t: t.to(torch.bfloat16) if t.is_floating_point() else t)(torch.as_tensor(a)))
    def _A_setup():
        B, Sq, D = 16, 144, 576
        H, Sk, Dh = 32, 512, 128
        return {
            "x": _w((lambda *s: torch.randn(*s, dtype=torch.bfloat16) * 0.8)(B, Sq, D)),
            "k_cache": _w((lambda *s: torch.randn(*s, dtype=torch.bfloat16) * 0.8)(B, H, Sk, Dh)),
            "v_cache": _w((lambda *s: torch.randn(*s, dtype=torch.bfloat16) * 0.05)(B, H, Sk, Dh)),
            "wq": _w((lambda *s: torch.randn(*s, dtype=torch.bfloat16) * 0.8)(D, H * Dh) * (D ** -0.5)),
            "wo": _w((lambda *s: torch.randn(*s, dtype=torch.bfloat16) * 0.05)(H * Dh, D) * ((H * Dh) ** -0.5)),
        }
    _A_in = _A_setup()

    def _B_setup():
        B, Sq, D = 16, 144, 576
        Hq, Hkv, Sk, Dh = 32, 32, 512, 128
        assert Hq % Hkv == 0, (Hq, Hkv)
        return {
            "x": _w((lambda *s: torch.randn(*s, dtype=torch.bfloat16) * 0.8)(B, Sq, D)),
            "k_cache": _w((lambda *s: torch.randn(*s, dtype=torch.bfloat16) * 0.8)(B, Hkv, Sk, Dh)),
            "v_cache": _w((lambda *s: torch.randn(*s, dtype=torch.bfloat16) * 0.05)(B, Hkv, Sk, Dh)),
            "wq": _w((lambda *s: torch.randn(*s, dtype=torch.bfloat16) * 0.8)(D, Hq * Dh) * (D ** -0.5)),
            "wo": _w((lambda *s: torch.randn(*s, dtype=torch.bfloat16) * 0.05)(Hq * Dh, D) * ((Hq * Dh) ** -0.5)),
        }
    _B_in = _B_setup()

    return {
        "A_x": _A_in["x"],
        "A_k_cache": _A_in["k_cache"],
        "A_v_cache": _A_in["v_cache"],
        "A_wq": _A_in["wq"],
        "A_wo": _A_in["wo"],
        "B_x": _B_in["x"],
        "B_k_cache": _B_in["k_cache"],
        "B_v_cache": _B_in["v_cache"],
        "B_wq": _B_in["wq"],
        "B_wo": _B_in["wo"],
    }

def reference(A_x, A_k_cache, A_v_cache, A_wq, A_wo, B_x, B_k_cache, B_v_cache, B_wq, B_wo):
    def _A_ref(x, k_cache, v_cache, wq, wo):
        B, Sq, D = x.shape
        H, Dh = 32, 128
        q = (lambda x, *d: x.permute(*d))((x @ wq).reshape(B, Sq, H, Dh), 0, 2, 1, 3)
        scores = torch.einsum("bhqd,bhkd->bhqk", q, k_cache) * (Dh ** -0.5)
        p = _softmax(scores, axis=-1)
        o = torch.einsum("bhqk,bhkd->bhqd", p, v_cache)
        return (lambda x, *d: x.permute(*d))(o, 0, 2, 1, 3).reshape(B, Sq, H * Dh) @ wo

    def _B_ref(x, k_cache, v_cache, wq, wo):
        B, Sq, D = x.shape
        Hq, Dh = 32, 128
        Hkv = k_cache.shape[1]
        rep = Hq // Hkv
        q = (lambda x, *d: x.permute(*d))((x @ wq).reshape(B, Sq, Hq, Dh), 0, 2, 1, 3)
        k = (lambda x, n, axis: torch.repeat_interleave(x, n, dim=axis))(k_cache, rep, axis=1)
        v = (lambda x, n, axis: torch.repeat_interleave(x, n, dim=axis))(v_cache, rep, axis=1)
        scores = torch.einsum("bhqd,bhkd->bhqk", q, k) * (Dh ** -0.5)
        p = _softmax(scores, axis=-1)
        o = torch.einsum("bhqk,bhkd->bhqd", p, v)
        return (lambda x, *d: x.permute(*d))(o, 0, 2, 1, 3).reshape(B, Sq, Hq * Dh) @ wo

    a = _A_ref(A_x, A_k_cache, A_v_cache, A_wq, A_wo)
    b = _B_ref(B_x, B_k_cache, B_v_cache, B_wq, B_wo)
    return torch.concatenate([a, b], axis=-1)
```

```asm
; @launch grid=(256,1,1) block=(512,1,1) lds=163840
.amdgcn_target "amdgcn-amd-amdhsa--gfx950"
.text
.globl concat_heads__mha_block_cached__gqa_block_cached__near_ridge_kernel
.p2align 8
.type concat_heads__mha_block_cached__gqa_block_cached__near_ridge_kernel,@function
concat_heads__mha_block_cached__gqa_block_cached__near_ridge_kernel:
  s_cmp_ge_u32 s2, 256
  s_cbranch_scc0 L_end1_go
  s_endpgm
L_end1_go:
  s_load_dwordx16 s[68:83], s[0:1], 0
  s_load_dwordx8 s[84:91], s[0:1], 64
  s_load_dwordx2 s[92:93], s[0:1], 96
  v_lshrrev_b32 v1, 6, v0
  s_nop 0
  v_readfirstlane_b32 s32, v1
  v_and_b32 v0, 63, v0
  s_bfe_u32 s38, s2, 0x10002
  s_lshl_b32 s38, s38, 4
  s_lshr_b32 s39, s2, 4
  s_add_u32 s33, s38, s39
  s_and_b32 s38, s2, 3
  s_lshl_b32 s38, s38, 1
  s_bfe_u32 s39, s2, 0x10003
  s_add_u32 s34, s38, s39
  s_and_b32 s35, s33, 15
  s_mul_i32 s57, s34, 4
  s_waitcnt lgkmcnt(0)
  s_cmp_lt_u32 s33, 16
  s_cselect_b32 s68, s68, s78
  s_cselect_b32 s69, s69, s79
  s_cselect_b32 s70, s70, s80
  s_cselect_b32 s71, s71, s81
  s_cselect_b32 s72, s72, s82
  s_cselect_b32 s73, s73, s83
  s_cselect_b32 s74, s74, s84
  s_cselect_b32 s75, s75, s85
  s_cselect_b32 s76, s76, s86
  s_cselect_b32 s77, s77, s87
  s_mov_b32 s16, s68
  s_mov_b32 s17, s69
  s_mov_b32 s18, 0x288000
  s_mov_b32 s19, 0x20000
  s_mov_b32 s4, s70
  s_mov_b32 s5, s71
  s_mov_b32 s6, 0x4000000
  s_mov_b32 s7, 0x20000
  s_mov_b32 s8, s72
  s_mov_b32 s9, s73
  s_mov_b32 s10, 0x4000000
  s_mov_b32 s11, 0x20000
  s_mov_b32 s12, s74
  s_mov_b32 s13, s75
  s_mov_b32 s14, 0x480000
  s_mov_b32 s15, 0x20000
  s_mov_b32 s24, s76
  s_mov_b32 s25, s77
  s_mov_b32 s26, 0x480000
  s_mov_b32 s27, 0x20000
  s_mov_b32 s28, s88
  s_mov_b32 s29, s89
  s_mov_b32 s30, 0x510000
  s_mov_b32 s31, 0x20000
  s_mov_b32 s64, s90
  s_mov_b32 s65, s91
  s_mov_b32 s66, 0x100
  s_mov_b32 s67, 0x20000
  s_mov_b32 s20, s92
  s_mov_b32 s21, s93
  s_mov_b32 s22, 0x11710000
  s_mov_b32 s23, 0x20000
  s_cmp_eq_u32 s32, 7
  s_cbranch_scc1 L_H
  s_cmp_lt_u32 s32, 3
  s_cbranch_scc1 L_Ab
  s_cmp_eq_u32 s32, 3
  s_cbranch_scc1 L_Ac0
  s_cmp_eq_u32 s32, 6
  s_cbranch_scc1 L_Bw
  s_branch L_Bx
L_H:
  s_mul_i32 s38, s35, 2
  s_mul_i32 s39, s34, 1
  s_add_u32 s38, s38, s39
  s_mul_i32 s39, s38, 57
  s_lshr_b32 s39, s39, 9
  s_mul_i32 s39, s39, 9
  s_sub_u32 s91, s38, s39
  s_lshl_b32 s90, s91, 1
  s_lshl_b32 s48, s57, 8
  s_mul_i32 s50, s35, 165888
  v_lshrrev_b32 v12, 4, v0
  v_or_b32 v13, 0, v12
  v_lshlrev_b32 v13, 1, v13
  v_xor_b32 v13, v13, v0
  v_and_b32 v13, 15, v13
  v_lshlrev_b32 v13, 4, v13
  v_mul_u32_u24 v12, 8192, v12
  v_add_u32 v12, v12, v13
  v_add_u32 v16, 0, v12
  v_lshrrev_b32 v12, 4, v0
  v_or_b32 v13, 0, v12
  v_lshlrev_b32 v13, 1, v13
  v_xor_b32 v13, v13, v0
  v_and_b32 v13, 15, v13
  v_lshlrev_b32 v13, 4, v13
  v_mul_u32_u24 v12, 8192, v12
  v_add_u32 v12, v12, v13
  v_add_u32 v17, 31744, v12
  v_lshrrev_b32 v12, 4, v0
  v_or_b32 v13, 4, v12
  v_lshlrev_b32 v13, 1, v13
  v_xor_b32 v13, v13, v0
  v_and_b32 v13, 15, v13
  v_lshlrev_b32 v13, 4, v13
  v_mul_u32_u24 v12, 8192, v12
  v_add_u32 v12, v12, v13
  v_add_u32 v18, 63488, v12
  v_lshrrev_b32 v12, 4, v0
  v_or_b32 v13, 4, v12
  v_lshlrev_b32 v13, 1, v13
  v_xor_b32 v13, v13, v0
  v_and_b32 v13, 15, v13
  v_lshlrev_b32 v13, 4, v13
  v_mul_u32_u24 v12, 8192, v12
  v_add_u32 v12, v12, v13
  v_add_u32 v19, 95232, v12
  v_lshrrev_b32 v12, 4, v0
  v_or_b32 v12, 0, v12
  v_xor_b32 v12, v12, v0
  v_and_b32 v12, 7, v12
  v_lshlrev_b32 v12, 4, v12
  v_lshrrev_b32 v13, 3, v0
  v_mul_u32_u24 v13, 1152, v13
  v_add_u32 v12, v12, v13
  v_add_u32 v20, 0, v12
  v_lshrrev_b32 v12, 4, v0
  v_or_b32 v12, 4, v12
  v_xor_b32 v12, v12, v0
  v_and_b32 v12, 7, v12
  v_lshlrev_b32 v12, 4, v12
  v_lshrrev_b32 v13, 3, v0
  v_mul_u32_u24 v13, 1152, v13
  v_add_u32 v12, v12, v13
  v_add_u32 v21, 8192, v12
  v_lshrrev_b32 v12, 4, v0
  v_or_b32 v12, 0, v12
  v_xor_b32 v12, v12, v0
  v_and_b32 v12, 7, v12
  v_lshlrev_b32 v12, 4, v12
  v_lshrrev_b32 v13, 3, v0
  v_mul_u32_u24 v13, 1152, v13
  v_add_u32 v12, v12, v13
  v_add_u32 v22, 16384, v12
  v_lshrrev_b32 v12, 4, v0
  v_or_b32 v12, 4, v12
  v_xor_b32 v12, v12, v0
  v_and_b32 v12, 7, v12
  v_lshlrev_b32 v12, 4, v12
  v_lshrrev_b32 v13, 3, v0
  v_mul_u32_u24 v13, 1152, v13
  v_add_u32 v12, v12, v13
  v_add_u32 v23, 24576, v12
  s_lshl_b32 s40, s90, 6
  s_add_u32 s40, s40, s50
  s_mov_b32 m0, 0xa000
  s_nop 0
  buffer_load_dwordx4 v20, s[16:19], s40 offen lds
  buffer_load_dwordx4 v21, s[16:19], s40 offen offset:1024 lds
  buffer_load_dwordx4 v22, s[16:19], s40 offen offset:2048 lds
  buffer_load_dwordx4 v23, s[16:19], s40 offen offset:3072 lds
  s_add_u32 s40, s40, 36864
  s_mov_b32 m0, 0xb000
  s_nop 0
  buffer_load_dwordx4 v20, s[16:19], s40 offen lds
  buffer_load_dwordx4 v21, s[16:19], s40 offen offset:1024 lds
  buffer_load_dwordx4 v22, s[16:19], s40 offen offset:2048 lds
  buffer_load_dwordx4 v23, s[16:19], s40 offen offset:3072 lds
  s_add_u32 s40, s40, 36864
  s_mov_b32 m0, 0xc000
  s_nop 0
  buffer_load_dwordx4 v20, s[16:19], s40 offen lds
  buffer_load_dwordx4 v21, s[16:19], s40 offen offset:1024 lds
  buffer_load_dwordx4 v22, s[16:19], s40 offen offset:2048 lds
  buffer_load_dwordx4 v23, s[16:19], s40 offen offset:3072 lds
  s_add_u32 s40, s40, 36864
  s_mov_b32 m0, 0xd000
  s_nop 0
  buffer_load_dwordx4 v20, s[16:19], s40 offen lds
  buffer_load_dwordx4 v21, s[16:19], s40 offen offset:1024 lds
  buffer_load_dwordx4 v22, s[16:19], s40 offen offset:2048 lds
  buffer_load_dwordx4 v23, s[16:19], s40 offen offset:3072 lds
  s_add_u32 s40, s40, 36864
  s_mov_b32 m0, 0xe000
  s_nop 0
  buffer_load_dwordx4 v20, s[16:19], s40 offen lds
  buffer_load_dwordx4 v21, s[16:19], s40 offen offset:1024 lds
  s_lshl_b32 s39, s90, 18
  s_add_u32 s39, s39, s48
  s_mov_b32 m0, 0x0
  s_nop 0
  buffer_load_dwordx4 v16, s[12:15], s39 offen lds
  buffer_load_dwordx4 v17, s[12:15], s39 offen offset:1024 lds
  buffer_load_dwordx4 v18, s[12:15], s39 offen offset:2048 lds
  buffer_load_dwordx4 v19, s[12:15], s39 offen offset:3072 lds
  s_add_u32 s39, s39, 131072
  s_mov_b32 m0, 0x1000
  s_nop 0
  buffer_load_dwordx4 v16, s[12:15], s39 offen lds
  buffer_load_dwordx4 v17, s[12:15], s39 offen offset:1024 lds
  buffer_load_dwordx4 v18, s[12:15], s39 offen offset:2048 lds
  buffer_load_dwordx4 v19, s[12:15], s39 offen offset:3072 lds
  s_add_u32 s90, s90, 1
  s_cmp_eq_u32 s90, 18
  s_cselect_b32 s90, 0, s90
  s_lshl_b32 s39, s90, 18
  s_add_u32 s39, s39, s48
  s_mov_b32 m0, 0x2000
  s_nop 0
  buffer_load_dwordx4 v16, s[12:15], s39 offen lds
  buffer_load_dwordx4 v17, s[12:15], s39 offen offset:1024 lds
  buffer_load_dwordx4 v18, s[12:15], s39 offen offset:2048 lds
  buffer_load_dwordx4 v19, s[12:15], s39 offen offset:3072 lds
  s_add_u32 s39, s39, 131072
  s_mov_b32 m0, 0x3000
  s_nop 0
  buffer_load_dwordx4 v16, s[12:15], s39 offen lds
  buffer_load_dwordx4 v17, s[12:15], s39 offen offset:1024 lds
  buffer_load_dwordx4 v18, s[12:15], s39 offen offset:2048 lds
  buffer_load_dwordx4 v19, s[12:15], s39 offen offset:3072 lds
  s_add_u32 s90, s90, 1
  s_cmp_eq_u32 s90, 18
  s_cselect_b32 s90, 0, s90
  s_mov_b32 s36, 0
  v_lshrrev_b32 v12, 4, v0
  v_bfe_u32 v13, v0, 2, 2
  v_lshl_add_u32 v14, v12, 3, v13
  v_lshlrev_b32 v14, 8, v14
  v_and_b32 v12, 1, v12
  v_lshl_add_u32 v13, v12, 2, v13
  v_and_b32 v12, 3, v0
  v_lshl_add_u32 v14, v12, 3, v14
  v_bfe_u32 v12, v0, 1, 3
  v_lshrrev_b32 v13, 4, v0
  v_xor_b32 v12, v12, v13
  v_lshlrev_b32 v12, 4, v12
  v_and_b32 v13, 15, v0
  v_lshl_add_u32 v4, v13, 7, v12
  v_lshlrev_b32 v6, 4, v0
  v_lshrrev_b32 v12, 5, v0
  v_lshl_add_u32 v12, v12, 4, v13
  v_lshlrev_b32 v12, 4, v12
  v_bfe_u32 v13, v0, 4, 1
  v_lshl_add_u32 v12, v13, 3, v12
  v_add_u32 v7, 0x1e800, v12
  v_xor_b32 v5, 64, v4
  s_lshl_b32 s38, s35, 5
  s_add_u32 s38, s38, s57
  s_lshl_b32 s46, s38, 17
  s_add_u32 s47, s46, 0x20000
  v_lshrrev_b32 v12, 4, v0
  v_or_b32 v13, 0, v12
  v_lshlrev_b32 v13, 1, v13
  v_xor_b32 v13, v13, v0
  v_and_b32 v13, 15, v13
  v_lshlrev_b32 v13, 4, v13
  v_mul_u32_u24 v12, 256, v12
  v_add_u32 v12, v12, v13
  v_add_u32 v10, 0, v12
  v_lshrrev_b32 v12, 4, v0
  v_or_b32 v13, 4, v12
  v_lshlrev_b32 v13, 1, v13
  v_xor_b32 v13, v13, v0
  v_and_b32 v13, 15, v13
  v_lshlrev_b32 v13, 4, v13
  v_mul_u32_u24 v12, 256, v12
  v_add_u32 v12, v12, v13
  v_add_u32 v11, 0, v12
  v_add_u32 v8, 0x24800, v6
  s_lshl_b32 s40, s90, 6
  s_add_u32 s40, s40, s50
  s_mov_b32 m0, 0x10800
  s_nop 0
  buffer_load_dwordx4 v20, s[16:19], s40 offen lds
  buffer_load_dwordx4 v21, s[16:19], s40 offen offset:1024 lds
  buffer_load_dwordx4 v22, s[16:19], s40 offen offset:2048 lds
  buffer_load_dwordx4 v23, s[16:19], s40 offen offset:3072 lds
  s_add_u32 s40, s40, 36864
  s_mov_b32 m0, 0x11800
  s_nop 0
  buffer_load_dwordx4 v20, s[16:19], s40 offen lds
  buffer_load_dwordx4 v21, s[16:19], s40 offen offset:1024 lds
  buffer_load_dwordx4 v22, s[16:19], s40 offen offset:2048 lds
  buffer_load_dwordx4 v23, s[16:19], s40 offen offset:3072 lds
  s_add_u32 s40, s40, 36864
  s_mov_b32 m0, 0x12800
  s_nop 0
  buffer_load_dwordx4 v20, s[16:19], s40 offen lds
  buffer_load_dwordx4 v21, s[16:19], s40 offen offset:1024 lds
  buffer_load_dwordx4 v22, s[16:19], s40 offen offset:2048 lds
  buffer_load_dwordx4 v23, s[16:19], s40 offen offset:3072 lds
  s_add_u32 s40, s40, 36864
  s_mov_b32 m0, 0x13800
  s_nop 0
  buffer_load_dwordx4 v20, s[16:19], s40 offen lds
  buffer_load_dwordx4 v21, s[16:19], s40 offen offset:1024 lds
  buffer_load_dwordx4 v22, s[16:19], s40 offen offset:2048 lds
  buffer_load_dwordx4 v23, s[16:19], s40 offen offset:3072 lds
  s_add_u32 s40, s40, 36864
  s_mov_b32 m0, 0x14800
  s_nop 0
  buffer_load_dwordx4 v20, s[16:19], s40 offen lds
  buffer_load_dwordx4 v21, s[16:19], s40 offen offset:1024 lds
  s_lshl_b32 s39, s90, 18
  s_add_u32 s39, s39, s48
  s_mov_b32 m0, 0x4000
  s_nop 0
  buffer_load_dwordx4 v16, s[12:15], s39 offen lds
  buffer_load_dwordx4 v17, s[12:15], s39 offen offset:1024 lds
  buffer_load_dwordx4 v18, s[12:15], s39 offen offset:2048 lds
  buffer_load_dwordx4 v19, s[12:15], s39 offen offset:3072 lds
  s_add_u32 s39, s39, 131072
  s_mov_b32 m0, 0x5000
  s_nop 0
  buffer_load_dwordx4 v16, s[12:15], s39 offen lds
  buffer_load_dwordx4 v17, s[12:15], s39 offen offset:1024 lds
  buffer_load_dwordx4 v18, s[12:15], s39 offen offset:2048 lds
  buffer_load_dwordx4 v19, s[12:15], s39 offen offset:3072 lds
  s_waitcnt vmcnt(26)
  s_add_u32 s90, s90, 1
  s_cmp_eq_u32 s90, 18
  s_cselect_b32 s90, 0, s90
  s_lshl_b32 s39, s90, 18
  s_add_u32 s39, s39, s48
  s_mov_b32 m0, 0x6000
  s_nop 0
  buffer_load_dwordx4 v16, s[12:15], s39 offen lds
  buffer_load_dwordx4 v17, s[12:15], s39 offen offset:1024 lds
  buffer_load_dwordx4 v18, s[12:15], s39 offen offset:2048 lds
  buffer_load_dwordx4 v19, s[12:15], s39 offen offset:3072 lds
  s_add_u32 s39, s39, 131072
  s_mov_b32 m0, 0x7000
  s_nop 0
  buffer_load_dwordx4 v16, s[12:15], s39 offen lds
  buffer_load_dwordx4 v17, s[12:15], s39 offen offset:1024 lds
  buffer_load_dwordx4 v18, s[12:15], s39 offen offset:2048 lds
  buffer_load_dwordx4 v19, s[12:15], s39 offen offset:3072 lds
  s_add_u32 s90, s90, 1
  s_cmp_eq_u32 s90, 18
  s_cselect_b32 s90, 0, s90
  s_waitcnt lgkmcnt(0)
  s_barrier
  v_add_u32 v4, 0xa000, v4
  v_add_u32 v5, 0xa000, v5
  s_lshl_b32 s40, s90, 6
  s_add_u32 s40, s40, s50
  s_mov_b32 m0, 0x22800
  s_nop 0
  buffer_load_dwordx4 v20, s[16:19], s40 offen lds
  buffer_load_dwordx4 v21, s[16:19], s40 offen offset:1024 lds
  buffer_load_dwordx4 v22, s[16:19], s40 offen offset:2048 lds
  buffer_load_dwordx4 v23, s[16:19], s40 offen offset:3072 lds
  s_add_u32 s40, s40, 36864
  s_mov_b32 m0, 0x23800
  s_nop 0
  buffer_load_dwordx4 v20, s[16:19], s40 offen lds
  buffer_load_dwordx4 v21, s[16:19], s40 offen offset:1024 lds
  buffer_load_dwordx4 v22, s[16:19], s40 offen offset:2048 lds
  buffer_load_dwordx4 v23, s[16:19], s40 offen offset:3072 lds
  s_add_u32 s40, s40, 36864
  s_mov_b32 m0, 0x24800
  s_nop 0
  buffer_load_dwordx4 v20, s[16:19], s40 offen lds
  buffer_load_dwordx4 v21, s[16:19], s40 offen offset:1024 lds
  buffer_load_dwordx4 v22, s[16:19], s40 offen offset:2048 lds
  buffer_load_dwordx4 v23, s[16:19], s40 offen offset:3072 lds
  s_add_u32 s40, s40, 36864
  s_mov_b32 m0, 0x25800
  s_nop 0
  buffer_load_dwordx4 v20, s[16:19], s40 offen lds
  buffer_load_dwordx4 v21, s[16:19], s40 offen offset:1024 lds
  buffer_load_dwordx4 v22, s[16:19], s40 offen offset:2048 lds
  buffer_load_dwordx4 v23, s[16:19], s40 offen offset:3072 lds
  s_add_u32 s40, s40, 36864
  s_mov_b32 m0, 0x26800
  s_nop 0
  buffer_load_dwordx4 v20, s[16:19], s40 offen lds
  buffer_load_dwordx4 v21, s[16:19], s40 offen offset:1024 lds
  s_lshl_b32 s39, s90, 18
  s_add_u32 s39, s39, s48
  s_mov_b32 m0, 0x1e800
  s_nop 0
  buffer_load_dwordx4 v16, s[12:15], s39 offen lds
  buffer_load_dwordx4 v17, s[12:15], s39 offen offset:1024 lds
  buffer_load_dwordx4 v18, s[12:15], s39 offen offset:2048 lds
  buffer_load_dwordx4 v19, s[12:15], s39 offen offset:3072 lds
  s_add_u32 s39, s39, 131072
  s_mov_b32 m0, 0x1f800
  s_nop 0
  buffer_load_dwordx4 v16, s[12:15], s39 offen lds
  buffer_load_dwordx4 v17, s[12:15], s39 offen offset:1024 lds
  buffer_load_dwordx4 v18, s[12:15], s39 offen offset:2048 lds
  buffer_load_dwordx4 v19, s[12:15], s39 offen offset:3072 lds
  s_waitcnt vmcnt(52)
  s_add_u32 s90, s90, 1
  s_cmp_eq_u32 s90, 18
  s_cselect_b32 s90, 0, s90
  s_lshl_b32 s39, s90, 18
  s_add_u32 s39, s39, s48
  s_mov_b32 m0, 0x20800
  s_nop 0
  buffer_load_dwordx4 v16, s[12:15], s39 offen lds
  buffer_load_dwordx4 v17, s[12:15], s39 offen offset:1024 lds
  buffer_load_dwordx4 v18, s[12:15], s39 offen offset:2048 lds
  buffer_load_dwordx4 v19, s[12:15], s39 offen offset:3072 lds
  s_add_u32 s39, s39, 131072
  s_mov_b32 m0, 0x21800
  s_nop 0
  buffer_load_dwordx4 v16, s[12:15], s39 offen lds
  buffer_load_dwordx4 v17, s[12:15], s39 offen offset:1024 lds
  buffer_load_dwordx4 v18, s[12:15], s39 offen offset:2048 lds
  buffer_load_dwordx4 v19, s[12:15], s39 offen offset:3072 lds
  s_add_u32 s90, s90, 1
  s_cmp_eq_u32 s90, 18
  s_cselect_b32 s90, 0, s90
  s_waitcnt vmcnt(34)
  s_waitcnt lgkmcnt(0)
  s_barrier
  s_lshl_b32 s40, s90, 6
  s_add_u32 s40, s40, s50
  s_mov_b32 m0, 0xa000
  s_nop 0
  buffer_load_dwordx4 v20, s[16:19], s40 offen lds
  buffer_load_dwordx4 v21, s[16:19], s40 offen offset:1024 lds
  buffer_load_dwordx4 v22, s[16:19], s40 offen offset:2048 lds
  buffer_load_dwordx4 v23, s[16:19], s40 offen offset:3072 lds
  s_add_u32 s40, s40, 36864
  s_mov_b32 m0, 0xb000
  s_nop 0
  buffer_load_dwordx4 v20, s[16:19], s40 offen lds
  buffer_load_dwordx4 v21, s[16:19], s40 offen offset:1024 lds
  buffer_load_dwordx4 v22, s[16:19], s40 offen offset:2048 lds
  buffer_load_dwordx4 v23, s[16:19], s40 offen offset:3072 lds
  s_add_u32 s40, s40, 36864
  s_mov_b32 m0, 0xc000
  s_nop 0
  buffer_load_dwordx4 v20, s[16:19], s40 offen lds
  buffer_load_dwordx4 v21, s[16:19], s40 offen offset:1024 lds
  buffer_load_dwordx4 v22, s[16:19], s40 offen offset:2048 lds
  buffer_load_dwordx4 v23, s[16:19], s40 offen offset:3072 lds
  s_add_u32 s40, s40, 36864
  s_mov_b32 m0, 0xd000
  s_nop 0
  buffer_load_dwordx4 v20, s[16:19], s40 offen lds
  buffer_load_dwordx4 v21, s[16:19], s40 offen offset:1024 lds
  buffer_load_dwordx4 v22, s[16:19], s40 offen offset:2048 lds
  buffer_load_dwordx4 v23, s[16:19], s40 offen offset:3072 lds
  s_add_u32 s40, s40, 36864
  s_mov_b32 m0, 0xe000
  s_nop 0
  buffer_load_dwordx4 v20, s[16:19], s40 offen lds
  buffer_load_dwordx4 v21, s[16:19], s40 offen offset:1024 lds
  s_lshl_b32 s39, s90, 18
  s_add_u32 s39, s39, s48
  s_mov_b32 m0, 0x0
  s_nop 0
  buffer_load_dwordx4 v16, s[12:15], s39 offen lds
  buffer_load_dwordx4 v17, s[12:15], s39 offen offset:1024 lds
  buffer_load_dwordx4 v18, s[12:15], s39 offen offset:2048 lds
  buffer_load_dwordx4 v19, s[12:15], s39 offen offset:3072 lds
  s_add_u32 s39, s39, 131072
  s_mov_b32 m0, 0x1000
  s_nop 0
  buffer_load_dwordx4 v16, s[12:15], s39 offen lds
  buffer_load_dwordx4 v17, s[12:15], s39 offen offset:1024 lds
  buffer_load_dwordx4 v18, s[12:15], s39 offen offset:2048 lds
  buffer_load_dwordx4 v19, s[12:15], s39 offen offset:3072 lds
  s_waitcnt vmcnt(52)
  s_add_u32 s90, s90, 1
  s_cmp_eq_u32 s90, 18
  s_cselect_b32 s90, 0, s90
  s_lshl_b32 s39, s90, 18
  s_add_u32 s39, s39, s48
  s_mov_b32 m0, 0x2000
  s_nop 0
  buffer_load_dwordx4 v16, s[12:15], s39 offen lds
  buffer_load_dwordx4 v17, s[12:15], s39 offen offset:1024 lds
  buffer_load_dwordx4 v18, s[12:15], s39 offen offset:2048 lds
  buffer_load_dwordx4 v19, s[12:15], s39 offen offset:3072 lds
  s_add_u32 s39, s39, 131072
  s_mov_b32 m0, 0x3000
  s_nop 0
  buffer_load_dwordx4 v16, s[12:15], s39 offen lds
  buffer_load_dwordx4 v17, s[12:15], s39 offen offset:1024 lds
  buffer_load_dwordx4 v18, s[12:15], s39 offen offset:2048 lds
  buffer_load_dwordx4 v19, s[12:15], s39 offen offset:3072 lds
  s_add_u32 s90, s90, 1
  s_cmp_eq_u32 s90, 18
  s_cselect_b32 s90, 0, s90
  s_waitcnt vmcnt(34)
  s_waitcnt lgkmcnt(0)
  s_barrier
  v_add_u32 v4, 0x14800, v4
  v_add_u32 v5, 0x14800, v5
  s_lshl_b32 s40, s90, 6
  s_add_u32 s40, s40, s50
  s_mov_b32 m0, 0x10800
  s_nop 0
  buffer_load_dwordx4 v20, s[16:19], s40 offen lds
  buffer_load_dwordx4 v21, s[16:19], s40 offen offset:1024 lds
  buffer_load_dwordx4 v22, s[16:19], s40 offen offset:2048 lds
  buffer_load_dwordx4 v23, s[16:19], s40 offen offset:3072 lds
  s_add_u32 s40, s40, 36864
  s_mov_b32 m0, 0x11800
  s_nop 0
  buffer_load_dwordx4 v20, s[16:19], s40 offen lds
  buffer_load_dwordx4 v21, s[16:19], s40 offen offset:1024 lds
  buffer_load_dwordx4 v22, s[16:19], s40 offen offset:2048 lds
  buffer_load_dwordx4 v23, s[16:19], s40 offen offset:3072 lds
  s_add_u32 s40, s40, 36864
  s_mov_b32 m0, 0x12800
  s_nop 0
  buffer_load_dwordx4 v20, s[16:19], s40 offen lds
  buffer_load_dwordx4 v21, s[16:19], s40 offen offset:1024 lds
  buffer_load_dwordx4 v22, s[16:19], s40 offen offset:2048 lds
  buffer_load_dwordx4 v23, s[16:19], s40 offen offset:3072 lds
  s_add_u32 s40, s40, 36864
  s_mov_b32 m0, 0x13800
  s_nop 0
  buffer_load_dwordx4 v20, s[16:19], s40 offen lds
  buffer_load_dwordx4 v21, s[16:19], s40 offen offset:1024 lds
  buffer_load_dwordx4 v22, s[16:19], s40 offen offset:2048 lds
  buffer_load_dwordx4 v23, s[16:19], s40 offen offset:3072 lds
  s_add_u32 s40, s40, 36864
  s_mov_b32 m0, 0x14800
  s_nop 0
  buffer_load_dwordx4 v20, s[16:19], s40 offen lds
  buffer_load_dwordx4 v21, s[16:19], s40 offen offset:1024 lds
  s_lshl_b32 s39, s90, 18
  s_add_u32 s39, s39, s48
  s_mov_b32 m0, 0x4000
  s_nop 0
  buffer_load_dwordx4 v16, s[12:15], s39 offen lds
  buffer_load_dwordx4 v17, s[12:15], s39 offen offset:1024 lds
  buffer_load_dwordx4 v18, s[12:15], s39 offen offset:2048 lds
  buffer_load_dwordx4 v19, s[12:15], s39 offen offset:3072 lds
  s_add_u32 s39, s39, 131072
  s_mov_b32 m0, 0x5000
  s_nop 0
  buffer_load_dwordx4 v16, s[12:15], s39 offen lds
  buffer_load_dwordx4 v17, s[12:15], s39 offen offset:1024 lds
  buffer_load_dwordx4 v18, s[12:15], s39 offen offset:2048 lds
  buffer_load_dwordx4 v19, s[12:15], s39 offen offset:3072 lds
  s_waitcnt vmcnt(52)
  s_add_u32 s90, s90, 1
  s_cmp_eq_u32 s90, 18
  s_cselect_b32 s90, 0, s90
  s_lshl_b32 s39, s90, 18
  s_add_u32 s39, s39, s48
  s_mov_b32 m0, 0x6000
  s_nop 0
  buffer_load_dwordx4 v16, s[12:15], s39 offen lds
  buffer_load_dwordx4 v17, s[12:15], s39 offen offset:1024 lds
  buffer_load_dwordx4 v18, s[12:15], s39 offen offset:2048 lds
  buffer_load_dwordx4 v19, s[12:15], s39 offen offset:3072 lds
  s_add_u32 s39, s39, 131072
  s_mov_b32 m0, 0x7000
  s_nop 0
  buffer_load_dwordx4 v16, s[12:15], s39 offen lds
  buffer_load_dwordx4 v17, s[12:15], s39 offen offset:1024 lds
  buffer_load_dwordx4 v18, s[12:15], s39 offen offset:2048 lds
  buffer_load_dwordx4 v19, s[12:15], s39 offen offset:3072 lds
  s_add_u32 s90, s90, 1
  s_cmp_eq_u32 s90, 18
  s_cselect_b32 s90, 0, s90
  s_waitcnt vmcnt(34)
  s_waitcnt lgkmcnt(0)
  s_barrier
  v_subrev_u32 v4, 0x14800, v4
  v_subrev_u32 v5, 0x14800, v5
  s_lshl_b32 s40, s90, 6
  s_add_u32 s40, s40, s50
  s_mov_b32 m0, 0x22800
  s_nop 0
  buffer_load_dwordx4 v20, s[16:19], s40 offen lds
  buffer_load_dwordx4 v21, s[16:19], s40 offen offset:1024 lds
  buffer_load_dwordx4 v22, s[16:19], s40 offen offset:2048 lds
  buffer_load_dwordx4 v23, s[16:19], s40 offen offset:3072 lds
  s_add_u32 s40, s40, 36864
  s_mov_b32 m0, 0x23800
  s_nop 0
  buffer_load_dwordx4 v20, s[16:19], s40 offen lds
  buffer_load_dwordx4 v21, s[16:19], s40 offen offset:1024 lds
  buffer_load_dwordx4 v22, s[16:19], s40 offen offset:2048 lds
  buffer_load_dwordx4 v23, s[16:19], s40 offen offset:3072 lds
  s_add_u32 s40, s40, 36864
  s_mov_b32 m0, 0x24800
  s_nop 0
  buffer_load_dwordx4 v20, s[16:19], s40 offen lds
  buffer_load_dwordx4 v21, s[16:19], s40 offen offset:1024 lds
  buffer_load_dwordx4 v22, s[16:19], s40 offen offset:2048 lds
  buffer_load_dwordx4 v23, s[16:19], s40 offen offset:3072 lds
  s_add_u32 s40, s40, 36864
  s_mov_b32 m0, 0x25800
  s_nop 0
  buffer_load_dwordx4 v20, s[16:19], s40 offen lds
  buffer_load_dwordx4 v21, s[16:19], s40 offen offset:1024 lds
  buffer_load_dwordx4 v22, s[16:19], s40 offen offset:2048 lds
  buffer_load_dwordx4 v23, s[16:19], s40 offen offset:3072 lds
  s_add_u32 s40, s40, 36864
  s_mov_b32 m0, 0x26800
  s_nop 0
  buffer_load_dwordx4 v20, s[16:19], s40 offen lds
  buffer_load_dwordx4 v21, s[16:19], s40 offen offset:1024 lds
  s_lshl_b32 s39, s90, 18
  s_add_u32 s39, s39, s48
  s_mov_b32 m0, 0x1e800
  s_nop 0
  buffer_load_dwordx4 v16, s[12:15], s39 offen lds
  buffer_load_dwordx4 v17, s[12:15], s39 offen offset:1024 lds
  buffer_load_dwordx4 v18, s[12:15], s39 offen offset:2048 lds
  buffer_load_dwordx4 v19, s[12:15], s39 offen offset:3072 lds
  s_add_u32 s39, s39, 131072
  s_mov_b32 m0, 0x1f800
  s_nop 0
  buffer_load_dwordx4 v16, s[12:15], s39 offen lds
  buffer_load_dwordx4 v17, s[12:15], s39 offen offset:1024 lds
  buffer_load_dwordx4 v18, s[12:15], s39 offen offset:2048 lds
  buffer_load_dwordx4 v19, s[12:15], s39 offen offset:3072 lds
  s_waitcnt vmcnt(52)
  s_add_u32 s90, s90, 1
  s_cmp_eq_u32 s90, 18
  s_cselect_b32 s90, 0, s90
  s_lshl_b32 s39, s90, 18
  s_add_u32 s39, s39, s48
  s_mov_b32 m0, 0x20800
  s_nop 0
  buffer_load_dwordx4 v16, s[12:15], s39 offen lds
  buffer_load_dwordx4 v17, s[12:15], s39 offen offset:1024 lds
  buffer_load_dwordx4 v18, s[12:15], s39 offen offset:2048 lds
  buffer_load_dwordx4 v19, s[12:15], s39 offen offset:3072 lds
  s_add_u32 s39, s39, 131072
  s_mov_b32 m0, 0x21800
  s_nop 0
  buffer_load_dwordx4 v16, s[12:15], s39 offen lds
  buffer_load_dwordx4 v17, s[12:15], s39 offen offset:1024 lds
  buffer_load_dwordx4 v18, s[12:15], s39 offen offset:2048 lds
  buffer_load_dwordx4 v19, s[12:15], s39 offen offset:3072 lds
  s_add_u32 s90, s90, 1
  s_cmp_eq_u32 s90, 18
  s_cselect_b32 s90, 0, s90
  s_waitcnt vmcnt(34)
  s_waitcnt lgkmcnt(0)
  s_barrier
  s_lshl_b32 s40, s90, 6
  s_add_u32 s40, s40, s50
  s_mov_b32 m0, 0xa000
  s_nop 0
  buffer_load_dwordx4 v20, s[16:19], s40 offen lds
  buffer_load_dwordx4 v21, s[16:19], s40 offen offset:1024 lds
  buffer_load_dwordx4 v22, s[16:19], s40 offen offset:2048 lds
  buffer_load_dwordx4 v23, s[16:19], s40 offen offset:3072 lds
  s_add_u32 s40, s40, 36864
  s_mov_b32 m0, 0xb000
  s_nop 0
  buffer_load_dwordx4 v20, s[16:19], s40 offen lds
  buffer_load_dwordx4 v21, s[16:19], s40 offen offset:1024 lds
  buffer_load_dwordx4 v22, s[16:19], s40 offen offset:2048 lds
  buffer_load_dwordx4 v23, s[16:19], s40 offen offset:3072 lds
  s_add_u32 s40, s40, 36864
  s_mov_b32 m0, 0xc000
  s_nop 0
  buffer_load_dwordx4 v20, s[16:19], s40 offen lds
  buffer_load_dwordx4 v21, s[16:19], s40 offen offset:1024 lds
  buffer_load_dwordx4 v22, s[16:19], s40 offen offset:2048 lds
  buffer_load_dwordx4 v23, s[16:19], s40 offen offset:3072 lds
  s_add_u32 s40, s40, 36864
  s_mov_b32 m0, 0xd000
  s_nop 0
  buffer_load_dwordx4 v20, s[16:19], s40 offen lds
  buffer_load_dwordx4 v21, s[16:19], s40 offen offset:1024 lds
  buffer_load_dwordx4 v22, s[16:19], s40 offen offset:2048 lds
  buffer_load_dwordx4 v23, s[16:19], s40 offen offset:3072 lds
  s_add_u32 s40, s40, 36864
  s_mov_b32 m0, 0xe000
  s_nop 0
  buffer_load_dwordx4 v20, s[16:19], s40 offen lds
  buffer_load_dwordx4 v21, s[16:19], s40 offen offset:1024 lds
  s_lshl_b32 s39, s90, 18
  s_add_u32 s39, s39, s48
  s_mov_b32 m0, 0x0
  s_nop 0
  buffer_load_dwordx4 v16, s[12:15], s39 offen lds
  buffer_load_dwordx4 v17, s[12:15], s39 offen offset:1024 lds
  buffer_load_dwordx4 v18, s[12:15], s39 offen offset:2048 lds
  buffer_load_dwordx4 v19, s[12:15], s39 offen offset:3072 lds
  s_add_u32 s39, s39, 131072
  s_mov_b32 m0, 0x1000
  s_nop 0
  buffer_load_dwordx4 v16, s[12:15], s39 offen lds
  buffer_load_dwordx4 v17, s[12:15], s39 offen offset:1024 lds
  buffer_load_dwordx4 v18, s[12:15], s39 offen offset:2048 lds
  buffer_load_dwordx4 v19, s[12:15], s39 offen offset:3072 lds
  s_waitcnt vmcnt(52)
  s_add_u32 s90, s90, 1
  s_cmp_eq_u32 s90, 18
  s_cselect_b32 s90, 0, s90
  s_lshl_b32 s39, s90, 18
  s_add_u32 s39, s39, s48
  s_mov_b32 m0, 0x2000
  s_nop 0
  buffer_load_dwordx4 v16, s[12:15], s39 offen lds
  buffer_load_dwordx4 v17, s[12:15], s39 offen offset:1024 lds
  buffer_load_dwordx4 v18, s[12:15], s39 offen offset:2048 lds
  buffer_load_dwordx4 v19, s[12:15], s39 offen offset:3072 lds
  s_add_u32 s39, s39, 131072
  s_mov_b32 m0, 0x3000
  s_nop 0
  buffer_load_dwordx4 v16, s[12:15], s39 offen lds
  buffer_load_dwordx4 v17, s[12:15], s39 offen offset:1024 lds
  buffer_load_dwordx4 v18, s[12:15], s39 offen offset:2048 lds
  buffer_load_dwordx4 v19, s[12:15], s39 offen offset:3072 lds
  s_add_u32 s90, s90, 1
  s_cmp_eq_u32 s90, 18
  s_cselect_b32 s90, 0, s90
  s_waitcnt vmcnt(34)
  s_waitcnt lgkmcnt(0)
  s_barrier
  v_add_u32 v4, 0x14800, v4
  v_add_u32 v5, 0x14800, v5
  s_lshl_b32 s40, s90, 6
  s_add_u32 s40, s40, s50
  s_mov_b32 m0, 0x10800
  s_nop 0
  buffer_load_dwordx4 v20, s[16:19], s40 offen lds
  buffer_load_dwordx4 v21, s[16:19], s40 offen offset:1024 lds
  buffer_load_dwordx4 v22, s[16:19], s40 offen offset:2048 lds
  buffer_load_dwordx4 v23, s[16:19], s40 offen offset:3072 lds
  s_add_u32 s40, s40, 36864
  s_mov_b32 m0, 0x11800
  s_nop 0
  buffer_load_dwordx4 v20, s[16:19], s40 offen lds
  buffer_load_dwordx4 v21, s[16:19], s40 offen offset:1024 lds
  buffer_load_dwordx4 v22, s[16:19], s40 offen offset:2048 lds
  buffer_load_dwordx4 v23, s[16:19], s40 offen offset:3072 lds
  s_add_u32 s40, s40, 36864
  s_mov_b32 m0, 0x12800
  s_nop 0
  buffer_load_dwordx4 v20, s[16:19], s40 offen lds
  buffer_load_dwordx4 v21, s[16:19], s40 offen offset:1024 lds
  buffer_load_dwordx4 v22, s[16:19], s40 offen offset:2048 lds
  buffer_load_dwordx4 v23, s[16:19], s40 offen offset:3072 lds
  s_add_u32 s40, s40, 36864
  s_mov_b32 m0, 0x13800
  s_nop 0
  buffer_load_dwordx4 v20, s[16:19], s40 offen lds
  buffer_load_dwordx4 v21, s[16:19], s40 offen offset:1024 lds
  buffer_load_dwordx4 v22, s[16:19], s40 offen offset:2048 lds
  buffer_load_dwordx4 v23, s[16:19], s40 offen offset:3072 lds
  s_add_u32 s40, s40, 36864
  s_mov_b32 m0, 0x14800
  s_nop 0
  buffer_load_dwordx4 v20, s[16:19], s40 offen lds
  buffer_load_dwordx4 v21, s[16:19], s40 offen offset:1024 lds
  s_lshl_b32 s39, s90, 18
  s_add_u32 s39, s39, s48
  s_mov_b32 m0, 0x4000
  s_nop 0
  buffer_load_dwordx4 v16, s[12:15], s39 offen lds
  buffer_load_dwordx4 v17, s[12:15], s39 offen offset:1024 lds
  buffer_load_dwordx4 v18, s[12:15], s39 offen offset:2048 lds
  buffer_load_dwordx4 v19, s[12:15], s39 offen offset:3072 lds
  s_add_u32 s39, s39, 131072
  s_mov_b32 m0, 0x5000
  s_nop 0
  buffer_load_dwordx4 v16, s[12:15], s39 offen lds
  buffer_load_dwordx4 v17, s[12:15], s39 offen offset:1024 lds
  buffer_load_dwordx4 v18, s[12:15], s39 offen offset:2048 lds
  buffer_load_dwordx4 v19, s[12:15], s39 offen offset:3072 lds
  s_waitcnt vmcnt(52)
  s_add_u32 s90, s90, 1
  s_cmp_eq_u32 s90, 18
  s_cselect_b32 s90, 0, s90
  s_lshl_b32 s39, s90, 18
  s_add_u32 s39, s39, s48
  s_mov_b32 m0, 0x6000
  s_nop 0
  buffer_load_dwordx4 v16, s[12:15], s39 offen lds
  buffer_load_dwordx4 v17, s[12:15], s39 offen offset:1024 lds
  buffer_load_dwordx4 v18, s[12:15], s39 offen offset:2048 lds
  buffer_load_dwordx4 v19, s[12:15], s39 offen offset:3072 lds
  s_add_u32 s39, s39, 131072
  s_mov_b32 m0, 0x7000
  s_nop 0
  buffer_load_dwordx4 v16, s[12:15], s39 offen lds
  buffer_load_dwordx4 v17, s[12:15], s39 offen offset:1024 lds
  buffer_load_dwordx4 v18, s[12:15], s39 offen offset:2048 lds
  buffer_load_dwordx4 v19, s[12:15], s39 offen offset:3072 lds
  s_add_u32 s90, s90, 1
  s_cmp_eq_u32 s90, 18
  s_cselect_b32 s90, 0, s90
  s_waitcnt vmcnt(34)
  s_waitcnt lgkmcnt(0)
  s_barrier
  v_subrev_u32 v4, 0x14800, v4
  v_subrev_u32 v5, 0x14800, v5
  s_lshl_b32 s40, s90, 6
  s_add_u32 s40, s40, s50
  s_mov_b32 m0, 0x22800
  s_nop 0
  buffer_load_dwordx4 v20, s[16:19], s40 offen lds
  buffer_load_dwordx4 v21, s[16:19], s40 offen offset:1024 lds
  buffer_load_dwordx4 v22, s[16:19], s40 offen offset:2048 lds
  buffer_load_dwordx4 v23, s[16:19], s40 offen offset:3072 lds
  s_add_u32 s40, s40, 36864
  s_mov_b32 m0, 0x23800
  s_nop 0
  buffer_load_dwordx4 v20, s[16:19], s40 offen lds
  buffer_load_dwordx4 v21, s[16:19], s40 offen offset:1024 lds
  buffer_load_dwordx4 v22, s[16:19], s40 offen offset:2048 lds
  buffer_load_dwordx4 v23, s[16:19], s40 offen offset:3072 lds
  s_add_u32 s40, s40, 36864
  s_mov_b32 m0, 0x24800
  s_nop 0
  buffer_load_dwordx4 v20, s[16:19], s40 offen lds
  buffer_load_dwordx4 v21, s[16:19], s40 offen offset:1024 lds
  buffer_load_dwordx4 v22, s[16:19], s40 offen offset:2048 lds
  buffer_load_dwordx4 v23, s[16:19], s40 offen offset:3072 lds
  s_add_u32 s40, s40, 36864
  s_mov_b32 m0, 0x25800
  s_nop 0
  buffer_load_dwordx4 v20, s[16:19], s40 offen lds
  buffer_load_dwordx4 v21, s[16:19], s40 offen offset:1024 lds
  buffer_load_dwordx4 v22, s[16:19], s40 offen offset:2048 lds
  buffer_load_dwordx4 v23, s[16:19], s40 offen offset:3072 lds
  s_add_u32 s40, s40, 36864
  s_mov_b32 m0, 0x26800
  s_nop 0
  buffer_load_dwordx4 v20, s[16:19], s40 offen lds
  buffer_load_dwordx4 v21, s[16:19], s40 offen offset:1024 lds
  s_lshl_b32 s39, s90, 18
  s_add_u32 s39, s39, s48
  s_mov_b32 m0, 0x1e800
  s_nop 0
  buffer_load_dwordx4 v16, s[12:15], s39 offen lds
  buffer_load_dwordx4 v17, s[12:15], s39 offen offset:1024 lds
  buffer_load_dwordx4 v18, s[12:15], s39 offen offset:2048 lds
  buffer_load_dwordx4 v19, s[12:15], s39 offen offset:3072 lds
  s_add_u32 s39, s39, 131072
  s_mov_b32 m0, 0x1f800
  s_nop 0
  buffer_load_dwordx4 v16, s[12:15], s39 offen lds
  buffer_load_dwordx4 v17, s[12:15], s39 offen offset:1024 lds
  buffer_load_dwordx4 v18, s[12:15], s39 offen offset:2048 lds
  buffer_load_dwordx4 v19, s[12:15], s39 offen offset:3072 lds
  s_waitcnt vmcnt(52)
  s_add_u32 s90, s90, 1
  s_cmp_eq_u32 s90, 18
  s_cselect_b32 s90, 0, s90
  s_lshl_b32 s39, s90, 18
  s_add_u32 s39, s39, s48
  s_mov_b32 m0, 0x20800
  s_nop 0
  buffer_load_dwordx4 v16, s[12:15], s39 offen lds
  buffer_load_dwordx4 v17, s[12:15], s39 offen offset:1024 lds
  buffer_load_dwordx4 v18, s[12:15], s39 offen offset:2048 lds
  buffer_load_dwordx4 v19, s[12:15], s39 offen offset:3072 lds
  s_add_u32 s39, s39, 131072
  s_mov_b32 m0, 0x21800
  s_nop 0
  buffer_load_dwordx4 v16, s[12:15], s39 offen lds
  buffer_load_dwordx4 v17, s[12:15], s39 offen offset:1024 lds
  buffer_load_dwordx4 v18, s[12:15], s39 offen offset:2048 lds
  buffer_load_dwordx4 v19, s[12:15], s39 offen offset:3072 lds
  s_add_u32 s90, s90, 1
  s_cmp_eq_u32 s90, 18
  s_cselect_b32 s90, 0, s90
  s_waitcnt vmcnt(34)
  s_waitcnt lgkmcnt(0)
  s_barrier
  s_mov_b32 m0, 0xe800
  s_add_u32 s38, s46, 0x0
  buffer_load_dwordx4 v10, s[4:7], s38 offen nt lds
  buffer_load_dwordx4 v10, s[4:7], s38 offen offset:1024 nt lds
  buffer_load_dwordx4 v11, s[4:7], s38 offen offset:2048 nt lds
  buffer_load_dwordx4 v11, s[4:7], s38 offen offset:3072 nt lds
  s_mov_b32 m0, 0xf800
  s_add_u32 s38, s46, 0x1000
  buffer_load_dwordx4 v10, s[4:7], s38 offen nt lds
  buffer_load_dwordx4 v10, s[4:7], s38 offen offset:1024 nt lds
  buffer_load_dwordx4 v11, s[4:7], s38 offen offset:2048 nt lds
  buffer_load_dwordx4 v11, s[4:7], s38 offen offset:3072 nt lds
  s_mov_b32 m0, 0x16800
  s_add_u32 s38, s46, 0x0
  buffer_load_dwordx4 v10, s[8:11], s38 offen nt lds
  buffer_load_dwordx4 v10, s[8:11], s38 offen offset:1024 nt lds
  buffer_load_dwordx4 v11, s[8:11], s38 offen offset:2048 nt lds
  buffer_load_dwordx4 v11, s[8:11], s38 offen offset:3072 nt lds
  s_mov_b32 m0, 0x17800
  s_add_u32 s38, s46, 0x1000
  buffer_load_dwordx4 v10, s[8:11], s38 offen nt lds
  buffer_load_dwordx4 v10, s[8:11], s38 offen offset:1024 nt lds
  buffer_load_dwordx4 v11, s[8:11], s38 offen offset:2048 nt lds
  buffer_load_dwordx4 v11, s[8:11], s38 offen offset:3072 nt lds
  s_waitcnt vmcnt(16)
  s_waitcnt lgkmcnt(0)
  s_barrier
  v_add_u32 v4, 0x14800, v4
  v_add_u32 v5, 0x14800, v5
  s_mov_b32 m0, 0x10800
  s_add_u32 s38, s46, 0x2000
  buffer_load_dwordx4 v10, s[4:7], s38 offen nt lds
  buffer_load_dwordx4 v10, s[4:7], s38 offen offset:1024 nt lds
  buffer_load_dwordx4 v11, s[4:7], s38 offen offset:2048 nt lds
  buffer_load_dwordx4 v11, s[4:7], s38 offen offset:3072 nt lds
  s_mov_b32 m0, 0x11800
  s_add_u32 s38, s46, 0x3000
  buffer_load_dwordx4 v10, s[4:7], s38 offen nt lds
  buffer_load_dwordx4 v10, s[4:7], s38 offen offset:1024 nt lds
  buffer_load_dwordx4 v11, s[4:7], s38 offen offset:2048 nt lds
  buffer_load_dwordx4 v11, s[4:7], s38 offen offset:3072 nt lds
  s_mov_b32 m0, 0x18800
  s_add_u32 s38, s46, 0x2000
  buffer_load_dwordx4 v10, s[8:11], s38 offen nt lds
  buffer_load_dwordx4 v10, s[8:11], s38 offen offset:1024 nt lds
  buffer_load_dwordx4 v11, s[8:11], s38 offen offset:2048 nt lds
  buffer_load_dwordx4 v11, s[8:11], s38 offen offset:3072 nt lds
  s_mov_b32 m0, 0x19800
  s_add_u32 s38, s46, 0x3000
  buffer_load_dwordx4 v10, s[8:11], s38 offen nt lds
  buffer_load_dwordx4 v10, s[8:11], s38 offen offset:1024 nt lds
  buffer_load_dwordx4 v11, s[8:11], s38 offen offset:2048 nt lds
  buffer_load_dwordx4 v11, s[8:11], s38 offen offset:3072 nt lds
  s_waitcnt lgkmcnt(0)
  s_barrier
  s_mov_b32 m0, 0x12800
  s_add_u32 s38, s46, 0x4000
  buffer_load_dwordx4 v10, s[4:7], s38 offen nt lds
  buffer_load_dwordx4 v10, s[4:7], s38 offen offset:1024 nt lds
  buffer_load_dwordx4 v11, s[4:7], s38 offen offset:2048 nt lds
  buffer_load_dwordx4 v11, s[4:7], s38 offen offset:3072 nt lds
  s_mov_b32 m0, 0x13800
  s_add_u32 s38, s46, 0x5000
  buffer_load_dwordx4 v10, s[4:7], s38 offen nt lds
  buffer_load_dwordx4 v10, s[4:7], s38 offen offset:1024 nt lds
  buffer_load_dwordx4 v11, s[4:7], s38 offen offset:2048 nt lds
  buffer_load_dwordx4 v11, s[4:7], s38 offen offset:3072 nt lds
  s_mov_b32 m0, 0x1a800
  s_add_u32 s38, s46, 0x4000
  buffer_load_dwordx4 v10, s[8:11], s38 offen nt lds
  buffer_load_dwordx4 v10, s[8:11], s38 offen offset:1024 nt lds
  buffer_load_dwordx4 v11, s[8:11], s38 offen offset:2048 nt lds
  buffer_load_dwordx4 v11, s[8:11], s38 offen offset:3072 nt lds
  s_mov_b32 m0, 0x1b800
  s_add_u32 s38, s46, 0x5000
  buffer_load_dwordx4 v10, s[8:11], s38 offen nt lds
  buffer_load_dwordx4 v10, s[8:11], s38 offen offset:1024 nt lds
  buffer_load_dwordx4 v11, s[8:11], s38 offen offset:2048 nt lds
  buffer_load_dwordx4 v11, s[8:11], s38 offen offset:3072 nt lds
L_H_loop:
  s_waitcnt vmcnt(32)
  s_waitcnt lgkmcnt(0)
  s_barrier
  s_mov_b32 m0, 0x14800
  s_add_u32 s38, s46, 0x6000
  buffer_load_dwordx4 v10, s[4:7], s38 offen nt lds
  buffer_load_dwordx4 v10, s[4:7], s38 offen offset:1024 nt lds
  buffer_load_dwordx4 v11, s[4:7], s38 offen offset:2048 nt lds
  buffer_load_dwordx4 v11, s[4:7], s38 offen offset:3072 nt lds
  s_mov_b32 m0, 0x15800
  s_add_u32 s38, s46, 0x7000
  buffer_load_dwordx4 v10, s[4:7], s38 offen nt lds
  buffer_load_dwordx4 v10, s[4:7], s38 offen offset:1024 nt lds
  buffer_load_dwordx4 v11, s[4:7], s38 offen offset:2048 nt lds
  buffer_load_dwordx4 v11, s[4:7], s38 offen offset:3072 nt lds
  s_mov_b32 m0, 0x1c800
  s_add_u32 s38, s46, 0x6000
  buffer_load_dwordx4 v10, s[8:11], s38 offen nt lds
  buffer_load_dwordx4 v10, s[8:11], s38 offen offset:1024 nt lds
  buffer_load_dwordx4 v11, s[8:11], s38 offen offset:2048 nt lds
  buffer_load_dwordx4 v11, s[8:11], s38 offen offset:3072 nt lds
  s_mov_b32 m0, 0x1d800
  s_add_u32 s38, s46, 0x7000
  buffer_load_dwordx4 v10, s[8:11], s38 offen nt lds
  buffer_load_dwordx4 v10, s[8:11], s38 offen offset:1024 nt lds
  buffer_load_dwordx4 v11, s[8:11], s38 offen offset:2048 nt lds
  buffer_load_dwordx4 v11, s[8:11], s38 offen offset:3072 nt lds
  s_waitcnt lgkmcnt(0)
  s_barrier
  s_waitcnt lgkmcnt(0)
  s_barrier
  s_waitcnt lgkmcnt(0)
  s_cmp_eq_u32 s36, 0
  s_cbranch_scc1 L_H_dr_end
  s_cmp_eq_u32 s36, 2
  s_cbranch_scc1 L_H_dr_1
  ds_read_b128 v[160:163], v8
  ds_read_b128 v[164:167], v8 offset:4096
  ds_read_b128 v[168:171], v8 offset:8192
  ds_read_b128 v[172:175], v8 offset:1024
  ds_read_b128 v[176:179], v8 offset:5120
  ds_read_b128 v[180:183], v8 offset:9216
  ds_read_b128 v[184:187], v8 offset:2048
  ds_read_b128 v[188:191], v8 offset:6144
  ds_read_b128 v[192:195], v8 offset:10240
  ds_read_b128 v[196:199], v8 offset:3072
  ds_read_b128 v[200:203], v8 offset:7168
  ds_read_b128 v[204:207], v8 offset:11264
  s_waitcnt lgkmcnt(0)
  s_branch L_H_dr_end
L_H_dr_1:
  ds_read_b128 v[208:211], v8
  ds_read_b128 v[212:215], v8 offset:4096
  ds_read_b128 v[216:219], v8 offset:8192
  ds_read_b128 v[220:223], v8 offset:1024
  ds_read_b128 v[224:227], v8 offset:5120
  ds_read_b128 v[228:231], v8 offset:9216
  ds_read_b128 v[232:235], v8 offset:2048
  ds_read_b128 v[236:239], v8 offset:6144
  ds_read_b128 v[240:243], v8 offset:10240
  ds_read_b128 v[244:247], v8 offset:3072
  ds_read_b128 v[248:251], v8 offset:7168
  ds_read_b128 v[252:255], v8 offset:11264
  s_waitcnt lgkmcnt(0)
L_H_dr_end:
  s_waitcnt vmcnt(32)
  s_waitcnt lgkmcnt(0)
  s_barrier
  s_mov_b32 m0, 0xe800
  s_add_u32 s38, s46, 0x8000
  buffer_load_dwordx4 v10, s[4:7], s38 offen nt lds
  buffer_load_dwordx4 v10, s[4:7], s38 offen offset:1024 nt lds
  buffer_load_dwordx4 v11, s[4:7], s38 offen offset:2048 nt lds
  buffer_load_dwordx4 v11, s[4:7], s38 offen offset:3072 nt lds
  s_mov_b32 m0, 0xf800
  s_add_u32 s38, s46, 0x9000
  buffer_load_dwordx4 v10, s[4:7], s38 offen nt lds
  buffer_load_dwordx4 v10, s[4:7], s38 offen offset:1024 nt lds
  buffer_load_dwordx4 v11, s[4:7], s38 offen offset:2048 nt lds
  buffer_load_dwordx4 v11, s[4:7], s38 offen offset:3072 nt lds
  s_mov_b32 m0, 0x16800
  s_add_u32 s38, s46, 0x8000
  buffer_load_dwordx4 v10, s[8:11], s38 offen nt lds
  buffer_load_dwordx4 v10, s[8:11], s38 offen offset:1024 nt lds
  buffer_load_dwordx4 v11, s[8:11], s38 offen offset:2048 nt lds
  buffer_load_dwordx4 v11, s[8:11], s38 offen offset:3072 nt lds
  s_mov_b32 m0, 0x17800
  s_add_u32 s38, s46, 0x9000
  buffer_load_dwordx4 v10, s[8:11], s38 offen nt lds
  buffer_load_dwordx4 v10, s[8:11], s38 offen offset:1024 nt lds
  buffer_load_dwordx4 v11, s[8:11], s38 offen offset:2048 nt lds
  buffer_load_dwordx4 v11, s[8:11], s38 offen offset:3072 nt lds
  s_waitcnt vmcnt(32)
  s_waitcnt lgkmcnt(0)
  s_barrier
  s_mov_b32 m0, 0x10800
  s_add_u32 s38, s46, 0xa000
  buffer_load_dwordx4 v10, s[4:7], s38 offen nt lds
  buffer_load_dwordx4 v10, s[4:7], s38 offen offset:1024 nt lds
  buffer_load_dwordx4 v11, s[4:7], s38 offen offset:2048 nt lds
  buffer_load_dwordx4 v11, s[4:7], s38 offen offset:3072 nt lds
  s_mov_b32 m0, 0x11800
  s_add_u32 s38, s46, 0xb000
  buffer_load_dwordx4 v10, s[4:7], s38 offen nt lds
  buffer_load_dwordx4 v10, s[4:7], s38 offen offset:1024 nt lds
  buffer_load_dwordx4 v11, s[4:7], s38 offen offset:2048 nt lds
  buffer_load_dwordx4 v11, s[4:7], s38 offen offset:3072 nt lds
  s_mov_b32 m0, 0x18800
  s_add_u32 s38, s46, 0xa000
  buffer_load_dwordx4 v10, s[8:11], s38 offen nt lds
  buffer_load_dwordx4 v10, s[8:11], s38 offen offset:1024 nt lds
  buffer_load_dwordx4 v11, s[8:11], s38 offen offset:2048 nt lds
  buffer_load_dwordx4 v11, s[8:11], s38 offen offset:3072 nt lds
  s_mov_b32 m0, 0x19800
  s_add_u32 s38, s46, 0xb000
  buffer_load_dwordx4 v10, s[8:11], s38 offen nt lds
  buffer_load_dwordx4 v10, s[8:11], s38 offen offset:1024 nt lds
  buffer_load_dwordx4 v11, s[8:11], s38 offen offset:2048 nt lds
  buffer_load_dwordx4 v11, s[8:11], s38 offen offset:3072 nt lds
  s_waitcnt vmcnt(32)
  s_waitcnt lgkmcnt(0)
  s_barrier
  s_mov_b32 m0, 0x12800
  s_add_u32 s38, s46, 0xc000
  buffer_load_dwordx4 v10, s[4:7], s38 offen nt lds
  buffer_load_dwordx4 v10, s[4:7], s38 offen offset:1024 nt lds
  buffer_load_dwordx4 v11, s[4:7], s38 offen offset:2048 nt lds
  buffer_load_dwordx4 v11, s[4:7], s38 offen offset:3072 nt lds
  s_mov_b32 m0, 0x13800
  s_add_u32 s38, s46, 0xd000
  buffer_load_dwordx4 v10, s[4:7], s38 offen nt lds
  buffer_load_dwordx4 v10, s[4:7], s38 offen offset:1024 nt lds
  buffer_load_dwordx4 v11, s[4:7], s38 offen offset:2048 nt lds
  buffer_load_dwordx4 v11, s[4:7], s38 offen offset:3072 nt lds
  s_mov_b32 m0, 0x1a800
  s_add_u32 s38, s46, 0xc000
  buffer_load_dwordx4 v10, s[8:11], s38 offen nt lds
  buffer_load_dwordx4 v10, s[8:11], s38 offen offset:1024 nt lds
  buffer_load_dwordx4 v11, s[8:11], s38 offen offset:2048 nt lds
  buffer_load_dwordx4 v11, s[8:11], s38 offen offset:3072 nt lds
  s_mov_b32 m0, 0x1b800
  s_add_u32 s38, s46, 0xd000
  buffer_load_dwordx4 v10, s[8:11], s38 offen nt lds
  buffer_load_dwordx4 v10, s[8:11], s38 offen offset:1024 nt lds
  buffer_load_dwordx4 v11, s[8:11], s38 offen offset:2048 nt lds
  buffer_load_dwordx4 v11, s[8:11], s38 offen offset:3072 nt lds
  s_waitcnt vmcnt(32)
  s_waitcnt lgkmcnt(0)
  s_barrier
  s_mov_b32 m0, 0x14800
  s_add_u32 s38, s46, 0xe000
  buffer_load_dwordx4 v10, s[4:7], s38 offen nt lds
  buffer_load_dwordx4 v10, s[4:7], s38 offen offset:1024 nt lds
  buffer_load_dwordx4 v11, s[4:7], s38 offen offset:2048 nt lds
  buffer_load_dwordx4 v11, s[4:7], s38 offen offset:3072 nt lds
  s_mov_b32 m0, 0x15800
  s_add_u32 s38, s46, 0xf000
  buffer_load_dwordx4 v10, s[4:7], s38 offen nt lds
  buffer_load_dwordx4 v10, s[4:7], s38 offen offset:1024 nt lds
  buffer_load_dwordx4 v11, s[4:7], s38 offen offset:2048 nt lds
  buffer_load_dwordx4 v11, s[4:7], s38 offen offset:3072 nt lds
  s_mov_b32 m0, 0x1c800
  s_add_u32 s38, s46, 0xe000
  buffer_load_dwordx4 v10, s[8:11], s38 offen nt lds
  buffer_load_dwordx4 v10, s[8:11], s38 offen offset:1024 nt lds
  buffer_load_dwordx4 v11, s[8:11], s38 offen offset:2048 nt lds
  buffer_load_dwordx4 v11, s[8:11], s38 offen offset:3072 nt lds
  s_mov_b32 m0, 0x1d800
  s_add_u32 s38, s46, 0xf000
  buffer_load_dwordx4 v10, s[8:11], s38 offen nt lds
  buffer_load_dwordx4 v10, s[8:11], s38 offen offset:1024 nt lds
  buffer_load_dwordx4 v11, s[8:11], s38 offen offset:2048 nt lds
  buffer_load_dwordx4 v11, s[8:11], s38 offen offset:3072 nt lds
  s_waitcnt vmcnt(32)
  s_waitcnt lgkmcnt(0)
  s_barrier
  s_mov_b32 m0, 0xe800
  s_add_u32 s38, s46, 0x10000
  buffer_load_dwordx4 v10, s[4:7], s38 offen nt lds
  buffer_load_dwordx4 v10, s[4:7], s38 offen offset:1024 nt lds
  buffer_load_dwordx4 v11, s[4:7], s38 offen offset:2048 nt lds
  buffer_load_dwordx4 v11, s[4:7], s38 offen offset:3072 nt lds
  s_mov_b32 m0, 0xf800
  s_add_u32 s38, s46, 0x11000
  buffer_load_dwordx4 v10, s[4:7], s38 offen nt lds
  buffer_load_dwordx4 v10, s[4:7], s38 offen offset:1024 nt lds
  buffer_load_dwordx4 v11, s[4:7], s38 offen offset:2048 nt lds
  buffer_load_dwordx4 v11, s[4:7], s38 offen offset:3072 nt lds
  s_mov_b32 m0, 0x16800
  s_add_u32 s38, s46, 0x10000
  buffer_load_dwordx4 v10, s[8:11], s38 offen nt lds
  buffer_load_dwordx4 v10, s[8:11], s38 offen offset:1024 nt lds
  buffer_load_dwordx4 v11, s[8:11], s38 offen offset:2048 nt lds
  buffer_load_dwordx4 v11, s[8:11], s38 offen offset:3072 nt lds
  s_mov_b32 m0, 0x17800
  s_add_u32 s38, s46, 0x11000
  buffer_load_dwordx4 v10, s[8:11], s38 offen nt lds
  buffer_load_dwordx4 v10, s[8:11], s38 offen offset:1024 nt lds
  buffer_load_dwordx4 v11, s[8:11], s38 offen offset:2048 nt lds
  buffer_load_dwordx4 v11, s[8:11], s38 offen offset:3072 nt lds
  s_waitcnt vmcnt(32)
  s_waitcnt lgkmcnt(0)
  s_barrier
  s_mov_b32 m0, 0x10800
  s_add_u32 s38, s46, 0x12000
  buffer_load_dwordx4 v10, s[4:7], s38 offen nt lds
  buffer_load_dwordx4 v10, s[4:7], s38 offen offset:1024 nt lds
  buffer_load_dwordx4 v11, s[4:7], s38 offen offset:2048 nt lds
  buffer_load_dwordx4 v11, s[4:7], s38 offen offset:3072 nt lds
  s_mov_b32 m0, 0x11800
  s_add_u32 s38, s46, 0x13000
  buffer_load_dwordx4 v10, s[4:7], s38 offen nt lds
  buffer_load_dwordx4 v10, s[4:7], s38 offen offset:1024 nt lds
  buffer_load_dwordx4 v11, s[4:7], s38 offen offset:2048 nt lds
  buffer_load_dwordx4 v11, s[4:7], s38 offen offset:3072 nt lds
  s_mov_b32 m0, 0x18800
  s_add_u32 s38, s46, 0x12000
  buffer_load_dwordx4 v10, s[8:11], s38 offen nt lds
  buffer_load_dwordx4 v10, s[8:11], s38 offen offset:1024 nt lds
  buffer_load_dwordx4 v11, s[8:11], s38 offen offset:2048 nt lds
  buffer_load_dwordx4 v11, s[8:11], s38 offen offset:3072 nt lds
  s_mov_b32 m0, 0x19800
  s_add_u32 s38, s46, 0x13000
  buffer_load_dwordx4 v10, s[8:11], s38 offen nt lds
  buffer_load_dwordx4 v10, s[8:11], s38 offen offset:1024 nt lds
  buffer_load_dwordx4 v11, s[8:11], s38 offen offset:2048 nt lds
  buffer_load_dwordx4 v11, s[8:11], s38 offen offset:3072 nt lds
  s_waitcnt vmcnt(32)
  s_waitcnt lgkmcnt(0)
  s_barrier
  s_mov_b32 m0, 0x12800
  s_add_u32 s38, s46, 0x14000
  buffer_load_dwordx4 v10, s[4:7], s38 offen nt lds
  buffer_load_dwordx4 v10, s[4:7], s38 offen offset:1024 nt lds
  buffer_load_dwordx4 v11, s[4:7], s38 offen offset:2048 nt lds
  buffer_load_dwordx4 v11, s[4:7], s38 offen offset:3072 nt lds
  s_mov_b32 m0, 0x13800
  s_add_u32 s38, s46, 0x15000
  buffer_load_dwordx4 v10, s[4:7], s38 offen nt lds
  buffer_load_dwordx4 v10, s[4:7], s38 offen offset:1024 nt lds
  buffer_load_dwordx4 v11, s[4:7], s38 offen offset:2048 nt lds
  buffer_load_dwordx4 v11, s[4:7], s38 offen offset:3072 nt lds
  s_mov_b32 m0, 0x1a800
  s_add_u32 s38, s46, 0x14000
  buffer_load_dwordx4 v10, s[8:11], s38 offen nt lds
  buffer_load_dwordx4 v10, s[8:11], s38 offen offset:1024 nt lds
  buffer_load_dwordx4 v11, s[8:11], s38 offen offset:2048 nt lds
  buffer_load_dwordx4 v11, s[8:11], s38 offen offset:3072 nt lds
  s_mov_b32 m0, 0x1b800
  s_add_u32 s38, s46, 0x15000
  buffer_load_dwordx4 v10, s[8:11], s38 offen nt lds
  buffer_load_dwordx4 v10, s[8:11], s38 offen offset:1024 nt lds
  buffer_load_dwordx4 v11, s[8:11], s38 offen offset:2048 nt lds
  buffer_load_dwordx4 v11, s[8:11], s38 offen offset:3072 nt lds
  s_waitcnt vmcnt(32)
  s_waitcnt lgkmcnt(0)
  s_barrier
  s_mov_b32 m0, 0x14800
  s_add_u32 s38, s46, 0x16000
  buffer_load_dwordx4 v10, s[4:7], s38 offen nt lds
  buffer_load_dwordx4 v10, s[4:7], s38 offen offset:1024 nt lds
  buffer_load_dwordx4 v11, s[4:7], s38 offen offset:2048 nt lds
  buffer_load_dwordx4 v11, s[4:7], s38 offen offset:3072 nt lds
  s_mov_b32 m0, 0x15800
  s_add_u32 s38, s46, 0x17000
  buffer_load_dwordx4 v10, s[4:7], s38 offen nt lds
  buffer_load_dwordx4 v10, s[4:7], s38 offen offset:1024 nt lds
  buffer_load_dwordx4 v11, s[4:7], s38 offen offset:2048 nt lds
  buffer_load_dwordx4 v11, s[4:7], s38 offen offset:3072 nt lds
  s_mov_b32 m0, 0x1c800
  s_add_u32 s38, s46, 0x16000
  buffer_load_dwordx4 v10, s[8:11], s38 offen nt lds
  buffer_load_dwordx4 v10, s[8:11], s38 offen offset:1024 nt lds
  buffer_load_dwordx4 v11, s[8:11], s38 offen offset:2048 nt lds
  buffer_load_dwordx4 v11, s[8:11], s38 offen offset:3072 nt lds
  s_mov_b32 m0, 0x1d800
  s_add_u32 s38, s46, 0x17000
  buffer_load_dwordx4 v10, s[8:11], s38 offen nt lds
  buffer_load_dwordx4 v10, s[8:11], s38 offen offset:1024 nt lds
  buffer_load_dwordx4 v11, s[8:11], s38 offen offset:2048 nt lds
  buffer_load_dwordx4 v11, s[8:11], s38 offen offset:3072 nt lds
  s_waitcnt vmcnt(32)
  s_waitcnt lgkmcnt(0)
  s_barrier
  s_mov_b32 m0, 0xe800
  s_add_u32 s38, s46, 0x18000
  buffer_load_dwordx4 v10, s[4:7], s38 offen nt lds
  buffer_load_dwordx4 v10, s[4:7], s38 offen offset:1024 nt lds
  buffer_load_dwordx4 v11, s[4:7], s38 offen offset:2048 nt lds
  buffer_load_dwordx4 v11, s[4:7], s38 offen offset:3072 nt lds
  s_mov_b32 m0, 0xf800
  s_add_u32 s38, s46, 0x19000
  buffer_load_dwordx4 v10, s[4:7], s38 offen nt lds
  buffer_load_dwordx4 v10, s[4:7], s38 offen offset:1024 nt lds
  buffer_load_dwordx4 v11, s[4:7], s38 offen offset:2048 nt lds
  buffer_load_dwordx4 v11, s[4:7], s38 offen offset:3072 nt lds
  s_mov_b32 m0, 0x16800
  s_add_u32 s38, s46, 0x18000
  buffer_load_dwordx4 v10, s[8:11], s38 offen nt lds
  buffer_load_dwordx4 v10, s[8:11], s38 offen offset:1024 nt lds
  buffer_load_dwordx4 v11, s[8:11], s38 offen offset:2048 nt lds
  buffer_load_dwordx4 v11, s[8:11], s38 offen offset:3072 nt lds
  s_mov_b32 m0, 0x17800
  s_add_u32 s38, s46, 0x19000
  buffer_load_dwordx4 v10, s[8:11], s38 offen nt lds
  buffer_load_dwordx4 v10, s[8:11], s38 offen offset:1024 nt lds
  buffer_load_dwordx4 v11, s[8:11], s38 offen offset:2048 nt lds
  buffer_load_dwordx4 v11, s[8:11], s38 offen offset:3072 nt lds
  s_waitcnt vmcnt(32)
  s_waitcnt lgkmcnt(0)
  s_barrier
  s_mov_b32 m0, 0x10800
  s_add_u32 s38, s46, 0x1a000
  buffer_load_dwordx4 v10, s[4:7], s38 offen nt lds
  buffer_load_dwordx4 v10, s[4:7], s38 offen offset:1024 nt lds
  buffer_load_dwordx4 v11, s[4:7], s38 offen offset:2048 nt lds
  buffer_load_dwordx4 v11, s[4:7], s38 offen offset:3072 nt lds
  s_mov_b32 m0, 0x11800
  s_add_u32 s38, s46, 0x1b000
  buffer_load_dwordx4 v10, s[4:7], s38 offen nt lds
  buffer_load_dwordx4 v10, s[4:7], s38 offen offset:1024 nt lds
  buffer_load_dwordx4 v11, s[4:7], s38 offen offset:2048 nt lds
  buffer_load_dwordx4 v11, s[4:7], s38 offen offset:3072 nt lds
  s_mov_b32 m0, 0x18800
  s_add_u32 s38, s46, 0x1a000
  buffer_load_dwordx4 v10, s[8:11], s38 offen nt lds
  buffer_load_dwordx4 v10, s[8:11], s38 offen offset:1024 nt lds
  buffer_load_dwordx4 v11, s[8:11], s38 offen offset:2048 nt lds
  buffer_load_dwordx4 v11, s[8:11], s38 offen offset:3072 nt lds
  s_mov_b32 m0, 0x19800
  s_add_u32 s38, s46, 0x1b000
  buffer_load_dwordx4 v10, s[8:11], s38 offen nt lds
  buffer_load_dwordx4 v10, s[8:11], s38 offen offset:1024 nt lds
  buffer_load_dwordx4 v11, s[8:11], s38 offen offset:2048 nt lds
  buffer_load_dwordx4 v11, s[8:11], s38 offen offset:3072 nt lds
  s_waitcnt vmcnt(32)
  s_waitcnt lgkmcnt(0)
  s_barrier
  s_mov_b32 m0, 0x12800
  s_add_u32 s38, s46, 0x1c000
  buffer_load_dwordx4 v10, s[4:7], s38 offen nt lds
  buffer_load_dwordx4 v10, s[4:7], s38 offen offset:1024 nt lds
  buffer_load_dwordx4 v11, s[4:7], s38 offen offset:2048 nt lds
  buffer_load_dwordx4 v11, s[4:7], s38 offen offset:3072 nt lds
  s_mov_b32 m0, 0x13800
  s_add_u32 s38, s46, 0x1d000
  buffer_load_dwordx4 v10, s[4:7], s38 offen nt lds
  buffer_load_dwordx4 v10, s[4:7], s38 offen offset:1024 nt lds
  buffer_load_dwordx4 v11, s[4:7], s38 offen offset:2048 nt lds
  buffer_load_dwordx4 v11, s[4:7], s38 offen offset:3072 nt lds
  s_mov_b32 m0, 0x1a800
  s_add_u32 s38, s46, 0x1c000
  buffer_load_dwordx4 v10, s[8:11], s38 offen nt lds
  buffer_load_dwordx4 v10, s[8:11], s38 offen offset:1024 nt lds
  buffer_load_dwordx4 v11, s[8:11], s38 offen offset:2048 nt lds
  buffer_load_dwordx4 v11, s[8:11], s38 offen offset:3072 nt lds
  s_mov_b32 m0, 0x1b800
  s_add_u32 s38, s46, 0x1d000
  buffer_load_dwordx4 v10, s[8:11], s38 offen nt lds
  buffer_load_dwordx4 v10, s[8:11], s38 offen offset:1024 nt lds
  buffer_load_dwordx4 v11, s[8:11], s38 offen offset:2048 nt lds
  buffer_load_dwordx4 v11, s[8:11], s38 offen offset:3072 nt lds
  s_waitcnt vmcnt(32)
  s_waitcnt lgkmcnt(0)
  s_barrier
  s_mov_b32 m0, 0x14800
  s_add_u32 s38, s46, 0x1e000
  buffer_load_dwordx4 v10, s[4:7], s38 offen nt lds
  buffer_load_dwordx4 v10, s[4:7], s38 offen offset:1024 nt lds
  buffer_load_dwordx4 v11, s[4:7], s38 offen offset:2048 nt lds
  buffer_load_dwordx4 v11, s[4:7], s38 offen offset:3072 nt lds
  s_mov_b32 m0, 0x15800
  s_add_u32 s38, s46, 0x1f000
  buffer_load_dwordx4 v10, s[4:7], s38 offen nt lds
  buffer_load_dwordx4 v10, s[4:7], s38 offen offset:1024 nt lds
  buffer_load_dwordx4 v11, s[4:7], s38 offen offset:2048 nt lds
  buffer_load_dwordx4 v11, s[4:7], s38 offen offset:3072 nt lds
  s_mov_b32 m0, 0x1c800
  s_add_u32 s38, s46, 0x1e000
  buffer_load_dwordx4 v10, s[8:11], s38 offen nt lds
  buffer_load_dwordx4 v10, s[8:11], s38 offen offset:1024 nt lds
  buffer_load_dwordx4 v11, s[8:11], s38 offen offset:2048 nt lds
  buffer_load_dwordx4 v11, s[8:11], s38 offen offset:3072 nt lds
  s_mov_b32 m0, 0x1d800
  s_add_u32 s38, s46, 0x1f000
  buffer_load_dwordx4 v10, s[8:11], s38 offen nt lds
  buffer_load_dwordx4 v10, s[8:11], s38 offen offset:1024 nt lds
  buffer_load_dwordx4 v11, s[8:11], s38 offen offset:2048 nt lds
  buffer_load_dwordx4 v11, s[8:11], s38 offen offset:3072 nt lds
  s_waitcnt vmcnt(32)
  s_waitcnt lgkmcnt(0)
  s_barrier
  s_mov_b32 m0, 0xe800
  s_add_u32 s38, s47, 0x0
  buffer_load_dwordx4 v10, s[4:7], s38 offen nt lds
  buffer_load_dwordx4 v10, s[4:7], s38 offen offset:1024 nt lds
  buffer_load_dwordx4 v11, s[4:7], s38 offen offset:2048 nt lds
  buffer_load_dwordx4 v11, s[4:7], s38 offen offset:3072 nt lds
  s_mov_b32 m0, 0xf800
  s_add_u32 s38, s47, 0x1000
  buffer_load_dwordx4 v10, s[4:7], s38 offen nt lds
  buffer_load_dwordx4 v10, s[4:7], s38 offen offset:1024 nt lds
  buffer_load_dwordx4 v11, s[4:7], s38 offen offset:2048 nt lds
  buffer_load_dwordx4 v11, s[4:7], s38 offen offset:3072 nt lds
  s_mov_b32 m0, 0x16800
  s_add_u32 s38, s47, 0x0
  buffer_load_dwordx4 v10, s[8:11], s38 offen nt lds
  buffer_load_dwordx4 v10, s[8:11], s38 offen offset:1024 nt lds
  buffer_load_dwordx4 v11, s[8:11], s38 offen offset:2048 nt lds
  buffer_load_dwordx4 v11, s[8:11], s38 offen offset:3072 nt lds
  s_mov_b32 m0, 0x17800
  s_add_u32 s38, s47, 0x1000
  buffer_load_dwordx4 v10, s[8:11], s38 offen nt lds
  buffer_load_dwordx4 v10, s[8:11], s38 offen offset:1024 nt lds
  buffer_load_dwordx4 v11, s[8:11], s38 offen offset:2048 nt lds
  buffer_load_dwordx4 v11, s[8:11], s38 offen offset:3072 nt lds
  s_waitcnt vmcnt(32)
  s_waitcnt lgkmcnt(0)
  s_barrier
  s_mov_b32 m0, 0x10800
  s_add_u32 s38, s47, 0x2000
  buffer_load_dwordx4 v10, s[4:7], s38 offen nt lds
  buffer_load_dwordx4 v10, s[4:7], s38 offen offset:1024 nt lds
  buffer_load_dwordx4 v11, s[4:7], s38 offen offset:2048 nt lds
  buffer_load_dwordx4 v11, s[4:7], s38 offen offset:3072 nt lds
  s_mov_b32 m0, 0x11800
  s_add_u32 s38, s47, 0x3000
  buffer_load_dwordx4 v10, s[4:7], s38 offen nt lds
  buffer_load_dwordx4 v10, s[4:7], s38 offen offset:1024 nt lds
  buffer_load_dwordx4 v11, s[4:7], s38 offen offset:2048 nt lds
  buffer_load_dwordx4 v11, s[4:7], s38 offen offset:3072 nt lds
  s_mov_b32 m0, 0x18800
  s_add_u32 s38, s47, 0x2000
  buffer_load_dwordx4 v10, s[8:11], s38 offen nt lds
  buffer_load_dwordx4 v10, s[8:11], s38 offen offset:1024 nt lds
  buffer_load_dwordx4 v11, s[8:11], s38 offen offset:2048 nt lds
  buffer_load_dwordx4 v11, s[8:11], s38 offen offset:3072 nt lds
  s_mov_b32 m0, 0x19800
  s_add_u32 s38, s47, 0x3000
  buffer_load_dwordx4 v10, s[8:11], s38 offen nt lds
  buffer_load_dwordx4 v10, s[8:11], s38 offen offset:1024 nt lds
  buffer_load_dwordx4 v11, s[8:11], s38 offen offset:2048 nt lds
  buffer_load_dwordx4 v11, s[8:11], s38 offen offset:3072 nt lds
  s_waitcnt vmcnt(32)
  s_waitcnt lgkmcnt(0)
  s_barrier
  s_mov_b32 m0, 0x12800
  s_add_u32 s38, s47, 0x4000
  buffer_load_dwordx4 v10, s[4:7], s38 offen nt lds
  buffer_load_dwordx4 v10, s[4:7], s38 offen offset:1024 nt lds
  buffer_load_dwordx4 v11, s[4:7], s38 offen offset:2048 nt lds
  buffer_load_dwordx4 v11, s[4:7], s38 offen offset:3072 nt lds
  s_mov_b32 m0, 0x13800
  s_add_u32 s38, s47, 0x5000
  buffer_load_dwordx4 v10, s[4:7], s38 offen nt lds
  buffer_load_dwordx4 v10, s[4:7], s38 offen offset:1024 nt lds
  buffer_load_dwordx4 v11, s[4:7], s38 offen offset:2048 nt lds
  buffer_load_dwordx4 v11, s[4:7], s38 offen offset:3072 nt lds
  s_mov_b32 m0, 0x1a800
  s_add_u32 s38, s47, 0x4000
  buffer_load_dwordx4 v10, s[8:11], s38 offen nt lds
  buffer_load_dwordx4 v10, s[8:11], s38 offen offset:1024 nt lds
  buffer_load_dwordx4 v11, s[8:11], s38 offen offset:2048 nt lds
  buffer_load_dwordx4 v11, s[8:11], s38 offen offset:3072 nt lds
  s_mov_b32 m0, 0x1b800
  s_add_u32 s38, s47, 0x5000
  buffer_load_dwordx4 v10, s[8:11], s38 offen nt lds
  buffer_load_dwordx4 v10, s[8:11], s38 offen offset:1024 nt lds
  buffer_load_dwordx4 v11, s[8:11], s38 offen offset:2048 nt lds
  buffer_load_dwordx4 v11, s[8:11], s38 offen offset:3072 nt lds
  s_add_u32 s36, s36, 1
  s_mov_b32 s46, s47
  s_add_u32 s47, s46, 0x20000
  s_cmp_lt_u32 s36, 3
  s_cbranch_scc1 L_H_loop
L_r3_7:
  s_waitcnt lgkmcnt(0)
  s_setprio 0
  v_lshlrev_b32 v2, 4, v0
  v_lshrrev_b32 v14, 2, v0
  v_bfe_u32 v15, v0, 3, 2
  v_lshlrev_b32 v14, 7, v14
  v_and_b32 v9, 3, v0
  v_lshl_add_u32 v14, v9, 3, v14
  v_xor_b32 v9, 2, v15
  v_lshl_add_u32 v3, v9, 5, v14
  v_add_u32 v5, 100352, v3
  v_xor_b32 v9, 3, v15
  v_lshl_add_u32 v4, v9, 5, v14
  v_add_u32 v6, 100352, v4
  v_lshrrev_b32 v14, 4, v0
  v_lshlrev_b32 v14, 1, v14
  v_xor_b32 v14, v14, v0
  v_and_b32 v14, 7, v14
  v_lshlrev_b32 v14, 4, v14
  v_lshrrev_b32 v15, 3, v0
  v_mul_u32_u24 v15, 1152, v15
  v_add_u32 v7, v14, v15
  v_add_u32 v8, 8192, v7
  v_add_u32 v9, 59392, v2
  s_mul_i32 s72, s57, 147456
  s_lshl_b32 s73, s33, 3
  s_add_u32 s73, s73, s34
  s_mul_i32 s73, s73, 165888
  s_add_u32 s73, s73, 0x5000000
  s_lshl_b32 s75, s33, 5
  s_add_u32 s75, s75, s34
  s_mul_i32 s75, s75, 36864
  s_waitcnt vmcnt(32)
  s_waitcnt lgkmcnt(0)
  s_barrier
  s_mov_b32 m0, 0x14800
  s_add_u32 s38, s46, 0x6000
  buffer_load_dwordx4 v10, s[4:7], s38 offen nt lds
  buffer_load_dwordx4 v10, s[4:7], s38 offen offset:1024 nt lds
  buffer_load_dwordx4 v11, s[4:7], s38 offen offset:2048 nt lds
  buffer_load_dwordx4 v11, s[4:7], s38 offen offset:3072 nt lds
  s_mov_b32 m0, 0x15800
  s_add_u32 s38, s46, 0x7000
  buffer_load_dwordx4 v10, s[4:7], s38 offen nt lds
  buffer_load_dwordx4 v10, s[4:7], s38 offen offset:1024 nt lds
  buffer_load_dwordx4 v11, s[4:7], s38 offen offset:2048 nt lds
  buffer_load_dwordx4 v11, s[4:7], s38 offen offset:3072 nt lds
  s_mov_b32 m0, 0x1c800
  s_add_u32 s38, s46, 0x6000
  buffer_load_dwordx4 v10, s[8:11], s38 offen nt lds
  buffer_load_dwordx4 v10, s[8:11], s38 offen offset:1024 nt lds
  buffer_load_dwordx4 v11, s[8:11], s38 offen offset:2048 nt lds
  buffer_load_dwordx4 v11, s[8:11], s38 offen offset:3072 nt lds
  s_mov_b32 m0, 0x1d800
  s_add_u32 s38, s46, 0x7000
  buffer_load_dwordx4 v10, s[8:11], s38 offen nt lds
  buffer_load_dwordx4 v10, s[8:11], s38 offen offset:1024 nt lds
  buffer_load_dwordx4 v11, s[8:11], s38 offen offset:2048 nt lds
  buffer_load_dwordx4 v11, s[8:11], s38 offen offset:3072 nt lds
  s_waitcnt lgkmcnt(0)
  s_barrier
  s_waitcnt lgkmcnt(0)
  s_barrier
  s_waitcnt vmcnt(32)
  s_waitcnt lgkmcnt(0)
  s_barrier
  s_mov_b32 m0, 0xe800
  s_add_u32 s38, s46, 0x8000
  buffer_load_dwordx4 v10, s[4:7], s38 offen nt lds
  buffer_load_dwordx4 v10, s[4:7], s38 offen offset:1024 nt lds
  buffer_load_dwordx4 v11, s[4:7], s38 offen offset:2048 nt lds
  buffer_load_dwordx4 v11, s[4:7], s38 offen offset:3072 nt lds
  s_mov_b32 m0, 0xf800
  s_add_u32 s38, s46, 0x9000
  buffer_load_dwordx4 v10, s[4:7], s38 offen nt lds
  buffer_load_dwordx4 v10, s[4:7], s38 offen offset:1024 nt lds
  buffer_load_dwordx4 v11, s[4:7], s38 offen offset:2048 nt lds
  buffer_load_dwordx4 v11, s[4:7], s38 offen offset:3072 nt lds
  s_mov_b32 m0, 0x16800
  s_add_u32 s38, s46, 0x8000
  buffer_load_dwordx4 v10, s[8:11], s38 offen nt lds
  buffer_load_dwordx4 v10, s[8:11], s38 offen offset:1024 nt lds
  buffer_load_dwordx4 v11, s[8:11], s38 offen offset:2048 nt lds
  buffer_load_dwordx4 v11, s[8:11], s38 offen offset:3072 nt lds
  s_mov_b32 m0, 0x17800
  s_add_u32 s38, s46, 0x9000
  buffer_load_dwordx4 v10, s[8:11], s38 offen nt lds
  buffer_load_dwordx4 v10, s[8:11], s38 offen offset:1024 nt lds
  buffer_load_dwordx4 v11, s[8:11], s38 offen offset:2048 nt lds
  buffer_load_dwordx4 v11, s[8:11], s38 offen offset:3072 nt lds
  ds_write_b128 v2, v[160:163] offset:16384
  ds_write_b128 v2, v[172:175] offset:17408
  ds_write_b128 v2, v[184:187] offset:18432
  ds_write_b128 v2, v[196:199] offset:19456
  ds_write_b128 v2, v[164:167] offset:20480
  ds_write_b128 v2, v[176:179] offset:21504
  ds_write_b128 v2, v[188:191] offset:22528
  ds_write_b128 v2, v[200:203] offset:23552
  ds_write_b128 v2, v[168:171] offset:24576
  ds_write_b128 v2, v[180:183] offset:25600
  ds_write_b128 v2, v[192:195] offset:26624
  ds_write_b128 v2, v[204:207] offset:27648
  ds_write_b128 v2, v[208:211] offset:28672
  ds_write_b128 v2, v[220:223] offset:29696
  ds_write_b128 v2, v[232:235] offset:30720
  s_waitcnt lgkmcnt(14)
  ds_write_b128 v2, v[244:247] offset:31744
  s_waitcnt lgkmcnt(14)
  ds_write_b128 v2, v[212:215] offset:32768
  s_waitcnt lgkmcnt(14)
  ds_write_b128 v2, v[224:227] offset:33792
  s_waitcnt lgkmcnt(14)
  ds_write_b128 v2, v[236:239] offset:34816
  s_waitcnt lgkmcnt(14)
  ds_write_b128 v2, v[248:251] offset:35840
  s_waitcnt lgkmcnt(14)
  ds_write_b128 v2, v[216:219] offset:36864
  s_waitcnt lgkmcnt(14)
  ds_write_b128 v2, v[228:231] offset:37888
  s_waitcnt lgkmcnt(14)
  ds_write_b128 v2, v[240:243] offset:38912
  s_waitcnt lgkmcnt(14)
  ds_write_b128 v2, v[252:255] offset:39936
  s_waitcnt vmcnt(32)
  s_waitcnt lgkmcnt(0)
  s_barrier
  s_mov_b32 m0, 0x10800
  s_add_u32 s38, s46, 0xa000
  buffer_load_dwordx4 v10, s[4:7], s38 offen nt lds
  buffer_load_dwordx4 v10, s[4:7], s38 offen offset:1024 nt lds
  buffer_load_dwordx4 v11, s[4:7], s38 offen offset:2048 nt lds
  buffer_load_dwordx4 v11, s[4:7], s38 offen offset:3072 nt lds
  s_mov_b32 m0, 0x11800
  s_add_u32 s38, s46, 0xb000
  buffer_load_dwordx4 v10, s[4:7], s38 offen nt lds
  buffer_load_dwordx4 v10, s[4:7], s38 offen offset:1024 nt lds
  buffer_load_dwordx4 v11, s[4:7], s38 offen offset:2048 nt lds
  buffer_load_dwordx4 v11, s[4:7], s38 offen offset:3072 nt lds
  s_mov_b32 m0, 0x18800
  s_add_u32 s38, s46, 0xa000
  buffer_load_dwordx4 v10, s[8:11], s38 offen nt lds
  buffer_load_dwordx4 v10, s[8:11], s38 offen offset:1024 nt lds
  buffer_load_dwordx4 v11, s[8:11], s38 offen offset:2048 nt lds
  buffer_load_dwordx4 v11, s[8:11], s38 offen offset:3072 nt lds
  s_mov_b32 m0, 0x19800
  s_add_u32 s38, s46, 0xb000
  buffer_load_dwordx4 v10, s[8:11], s38 offen nt lds
  buffer_load_dwordx4 v10, s[8:11], s38 offen offset:1024 nt lds
  buffer_load_dwordx4 v11, s[8:11], s38 offen offset:2048 nt lds
  buffer_load_dwordx4 v11, s[8:11], s38 offen offset:3072 nt lds
  ds_read_b128 v[128:131], v2
  ds_read_b128 v[132:135], v2 offset:4096
  ds_read_b128 v[136:139], v2 offset:1024
  ds_read_b128 v[140:143], v2 offset:5120
  ds_read_b128 v[144:147], v2 offset:2048
  ds_read_b128 v[148:151], v2 offset:6144
  ds_read_b128 v[152:155], v2 offset:3072
  ds_read_b128 v[156:159], v2 offset:7168
  ds_read_b128 v[160:163], v2 offset:8192
  ds_read_b128 v[164:167], v2 offset:12288
  ds_read_b128 v[168:171], v2 offset:9216
  ds_read_b128 v[172:175], v2 offset:13312
  ds_read_b128 v[176:179], v2 offset:10240
  ds_read_b128 v[180:183], v2 offset:14336
  ds_read_b128 v[184:187], v2 offset:11264
  s_waitcnt lgkmcnt(14)
  ds_read_b128 v[188:191], v2 offset:15360
  s_waitcnt vmcnt(32)
  s_waitcnt lgkmcnt(0)
  s_barrier
  s_mov_b32 m0, 0x12800
  s_add_u32 s38, s46, 0xc000
  buffer_load_dwordx4 v10, s[4:7], s38 offen nt lds
  buffer_load_dwordx4 v10, s[4:7], s38 offen offset:1024 nt lds
  buffer_load_dwordx4 v11, s[4:7], s38 offen offset:2048 nt lds
  buffer_load_dwordx4 v11, s[4:7], s38 offen offset:3072 nt lds
  s_mov_b32 m0, 0x13800
  s_add_u32 s38, s46, 0xd000
  buffer_load_dwordx4 v10, s[4:7], s38 offen nt lds
  buffer_load_dwordx4 v10, s[4:7], s38 offen offset:1024 nt lds
  buffer_load_dwordx4 v11, s[4:7], s38 offen offset:2048 nt lds
  buffer_load_dwordx4 v11, s[4:7], s38 offen offset:3072 nt lds
  s_mov_b32 m0, 0x1a800
  s_add_u32 s38, s46, 0xc000
  buffer_load_dwordx4 v10, s[8:11], s38 offen nt lds
  buffer_load_dwordx4 v10, s[8:11], s38 offen offset:1024 nt lds
  buffer_load_dwordx4 v11, s[8:11], s38 offen offset:2048 nt lds
  buffer_load_dwordx4 v11, s[8:11], s38 offen offset:3072 nt lds
  s_mov_b32 m0, 0x1b800
  s_add_u32 s38, s46, 0xd000
  buffer_load_dwordx4 v10, s[8:11], s38 offen nt lds
  buffer_load_dwordx4 v10, s[8:11], s38 offen offset:1024 nt lds
  buffer_load_dwordx4 v11, s[8:11], s38 offen offset:2048 nt lds
  buffer_load_dwordx4 v11, s[8:11], s38 offen offset:3072 nt lds
  v_add_u32 v14, 124928, v2
  ds_read_b128 v[64:67], v14
  ds_read_b128 v[68:71], v14 offset:4096
  ds_read_b128 v[72:75], v14 offset:1024
  ds_read_b128 v[76:79], v14 offset:5120
  ds_read_b128 v[80:83], v14 offset:2048
  ds_read_b128 v[84:87], v14 offset:6144
  ds_read_b128 v[88:91], v14 offset:3072
  ds_read_b128 v[92:95], v14 offset:7168
  s_waitcnt vmcnt(32)
  s_waitcnt lgkmcnt(0)
  s_barrier
  s_mov_b32 m0, 0x14800
  s_add_u32 s38, s46, 0xe000
  buffer_load_dwordx4 v10, s[4:7], s38 offen nt lds
  buffer_load_dwordx4 v10, s[4:7], s38 offen offset:1024 nt lds
  buffer_load_dwordx4 v11, s[4:7], s38 offen offset:2048 nt lds
  buffer_load_dwordx4 v11, s[4:7], s38 offen offset:3072 nt lds
  s_mov_b32 m0, 0x15800
  s_add_u32 s38, s46, 0xf000
  buffer_load_dwordx4 v10, s[4:7], s38 offen nt lds
  buffer_load_dwordx4 v10, s[4:7], s38 offen offset:1024 nt lds
  buffer_load_dwordx4 v11, s[4:7], s38 offen offset:2048 nt lds
  buffer_load_dwordx4 v11, s[4:7], s38 offen offset:3072 nt lds
  s_mov_b32 m0, 0x1c800
  s_add_u32 s38, s46, 0xe000
  buffer_load_dwordx4 v10, s[8:11], s38 offen nt lds
  buffer_load_dwordx4 v10, s[8:11], s38 offen offset:1024 nt lds
  buffer_load_dwordx4 v11, s[8:11], s38 offen offset:2048 nt lds
  buffer_load_dwordx4 v11, s[8:11], s38 offen offset:3072 nt lds
  s_mov_b32 m0, 0x1d800
  s_add_u32 s38, s46, 0xf000
  buffer_load_dwordx4 v10, s[8:11], s38 offen nt lds
  buffer_load_dwordx4 v10, s[8:11], s38 offen offset:1024 nt lds
  buffer_load_dwordx4 v11, s[8:11], s38 offen offset:2048 nt lds
  buffer_load_dwordx4 v11, s[8:11], s38 offen offset:3072 nt lds
  s_waitcnt vmcnt(32)
  s_waitcnt lgkmcnt(0)
  s_barrier
  s_mov_b32 m0, 0xe800
  s_add_u32 s38, s46, 0x10000
  buffer_load_dwordx4 v10, s[4:7], s38 offen nt lds
  buffer_load_dwordx4 v10, s[4:7], s38 offen offset:1024 nt lds
  buffer_load_dwordx4 v11, s[4:7], s38 offen offset:2048 nt lds
  buffer_load_dwordx4 v11, s[4:7], s38 offen offset:3072 nt lds
  s_mov_b32 m0, 0xf800
  s_add_u32 s38, s46, 0x11000
  buffer_load_dwordx4 v10, s[4:7], s38 offen nt lds
  buffer_load_dwordx4 v10, s[4:7], s38 offen offset:1024 nt lds
  buffer_load_dwordx4 v11, s[4:7], s38 offen offset:2048 nt lds
  buffer_load_dwordx4 v11, s[4:7], s38 offen offset:3072 nt lds
  s_mov_b32 m0, 0x16800
  s_add_u32 s38, s46, 0x10000
  buffer_load_dwordx4 v10, s[8:11], s38 offen nt lds
  buffer_load_dwordx4 v10, s[8:11], s38 offen offset:1024 nt lds
  buffer_load_dwordx4 v11, s[8:11], s38 offen offset:2048 nt lds
  buffer_load_dwordx4 v11, s[8:11], s38 offen offset:3072 nt lds
  s_mov_b32 m0, 0x17800
  s_add_u32 s38, s46, 0x11000
  buffer_load_dwordx4 v10, s[8:11], s38 offen nt lds
  buffer_load_dwordx4 v10, s[8:11], s38 offen offset:1024 nt lds
  buffer_load_dwordx4 v11, s[8:11], s38 offen offset:2048 nt lds
  buffer_load_dwordx4 v11, s[8:11], s38 offen offset:3072 nt lds
  s_waitcnt vmcnt(32)
  s_waitcnt lgkmcnt(0)
  s_barrier
  s_mov_b32 m0, 0x10800
  s_add_u32 s38, s46, 0x12000
  buffer_load_dwordx4 v10, s[4:7], s38 offen nt lds
  buffer_load_dwordx4 v10, s[4:7], s38 offen offset:1024 nt lds
  buffer_load_dwordx4 v11, s[4:7], s38 offen offset:2048 nt lds
  buffer_load_dwordx4 v11, s[4:7], s38 offen offset:3072 nt lds
  s_mov_b32 m0, 0x11800
  s_add_u32 s38, s46, 0x13000
  buffer_load_dwordx4 v10, s[4:7], s38 offen nt lds
  buffer_load_dwordx4 v10, s[4:7], s38 offen offset:1024 nt lds
  buffer_load_dwordx4 v11, s[4:7], s38 offen offset:2048 nt lds
  buffer_load_dwordx4 v11, s[4:7], s38 offen offset:3072 nt lds
  s_mov_b32 m0, 0x18800
  s_add_u32 s38, s46, 0x12000
  buffer_load_dwordx4 v10, s[8:11], s38 offen nt lds
  buffer_load_dwordx4 v10, s[8:11], s38 offen offset:1024 nt lds
  buffer_load_dwordx4 v11, s[8:11], s38 offen offset:2048 nt lds
  buffer_load_dwordx4 v11, s[8:11], s38 offen offset:3072 nt lds
  s_mov_b32 m0, 0x19800
  s_add_u32 s38, s46, 0x13000
  buffer_load_dwordx4 v10, s[8:11], s38 offen nt lds
  buffer_load_dwordx4 v10, s[8:11], s38 offen offset:1024 nt lds
  buffer_load_dwordx4 v11, s[8:11], s38 offen offset:2048 nt lds
  buffer_load_dwordx4 v11, s[8:11], s38 offen offset:3072 nt lds
  s_waitcnt vmcnt(32)
  s_waitcnt lgkmcnt(0)
  s_barrier
  s_mov_b32 m0, 0x12800
  s_add_u32 s38, s46, 0x14000
  buffer_load_dwordx4 v10, s[4:7], s38 offen nt lds
  buffer_load_dwordx4 v10, s[4:7], s38 offen offset:1024 nt lds
  buffer_load_dwordx4 v11, s[4:7], s38 offen offset:2048 nt lds
  buffer_load_dwordx4 v11, s[4:7], s38 offen offset:3072 nt lds
  s_mov_b32 m0, 0x13800
  s_add_u32 s38, s46, 0x15000
  buffer_load_dwordx4 v10, s[4:7], s38 offen nt lds
  buffer_load_dwordx4 v10, s[4:7], s38 offen offset:1024 nt lds
  buffer_load_dwordx4 v11, s[4:7], s38 offen offset:2048 nt lds
  buffer_load_dwordx4 v11, s[4:7], s38 offen offset:3072 nt lds
  s_mov_b32 m0, 0x1a800
  s_add_u32 s38, s46, 0x14000
  buffer_load_dwordx4 v10, s[8:11], s38 offen nt lds
  buffer_load_dwordx4 v10, s[8:11], s38 offen offset:1024 nt lds
  buffer_load_dwordx4 v11, s[8:11], s38 offen offset:2048 nt lds
  buffer_load_dwordx4 v11, s[8:11], s38 offen offset:3072 nt lds
  s_mov_b32 m0, 0x1b800
  s_add_u32 s38, s46, 0x15000
  buffer_load_dwordx4 v10, s[8:11], s38 offen nt lds
  buffer_load_dwordx4 v10, s[8:11], s38 offen offset:1024 nt lds
  buffer_load_dwordx4 v11, s[8:11], s38 offen offset:2048 nt lds
  buffer_load_dwordx4 v11, s[8:11], s38 offen offset:3072 nt lds
  s_waitcnt vmcnt(32)
  s_waitcnt lgkmcnt(0)
  s_barrier
  s_mov_b32 m0, 0x14800
  s_add_u32 s38, s46, 0x16000
  buffer_load_dwordx4 v10, s[4:7], s38 offen nt lds
  buffer_load_dwordx4 v10, s[4:7], s38 offen offset:1024 nt lds
  buffer_load_dwordx4 v11, s[4:7], s38 offen offset:2048 nt lds
  buffer_load_dwordx4 v11, s[4:7], s38 offen offset:3072 nt lds
  s_mov_b32 m0, 0x15800
  s_add_u32 s38, s46, 0x17000
  buffer_load_dwordx4 v10, s[4:7], s38 offen nt lds
  buffer_load_dwordx4 v10, s[4:7], s38 offen offset:1024 nt lds
  buffer_load_dwordx4 v11, s[4:7], s38 offen offset:2048 nt lds
  buffer_load_dwordx4 v11, s[4:7], s38 offen offset:3072 nt lds
  s_mov_b32 m0, 0x1c800
  s_add_u32 s38, s46, 0x16000
  buffer_load_dwordx4 v10, s[8:11], s38 offen nt lds
  buffer_load_dwordx4 v10, s[8:11], s38 offen offset:1024 nt lds
  buffer_load_dwordx4 v11, s[8:11], s38 offen offset:2048 nt lds
  buffer_load_dwordx4 v11, s[8:11], s38 offen offset:3072 nt lds
  s_mov_b32 m0, 0x1d800
  s_add_u32 s38, s46, 0x17000
  buffer_load_dwordx4 v10, s[8:11], s38 offen nt lds
  buffer_load_dwordx4 v10, s[8:11], s38 offen offset:1024 nt lds
  buffer_load_dwordx4 v11, s[8:11], s38 offen offset:2048 nt lds
  buffer_load_dwordx4 v11, s[8:11], s38 offen offset:3072 nt lds
  s_waitcnt vmcnt(32)
  s_waitcnt lgkmcnt(0)
  s_barrier
  s_mov_b32 m0, 0xe800
  s_add_u32 s38, s46, 0x18000
  buffer_load_dwordx4 v10, s[4:7], s38 offen nt lds
  buffer_load_dwordx4 v10, s[4:7], s38 offen offset:1024 nt lds
  buffer_load_dwordx4 v11, s[4:7], s38 offen offset:2048 nt lds
  buffer_load_dwordx4 v11, s[4:7], s38 offen offset:3072 nt lds
  s_mov_b32 m0, 0xf800
  s_add_u32 s38, s46, 0x19000
  buffer_load_dwordx4 v10, s[4:7], s38 offen nt lds
  buffer_load_dwordx4 v10, s[4:7], s38 offen offset:1024 nt lds
  buffer_load_dwordx4 v11, s[4:7], s38 offen offset:2048 nt lds
  buffer_load_dwordx4 v11, s[4:7], s38 offen offset:3072 nt lds
  s_mov_b32 m0, 0x16800
  s_add_u32 s38, s46, 0x18000
  buffer_load_dwordx4 v10, s[8:11], s38 offen nt lds
  buffer_load_dwordx4 v10, s[8:11], s38 offen offset:1024 nt lds
  buffer_load_dwordx4 v11, s[8:11], s38 offen offset:2048 nt lds
  buffer_load_dwordx4 v11, s[8:11], s38 offen offset:3072 nt lds
  s_mov_b32 m0, 0x17800
  s_add_u32 s38, s46, 0x19000
  buffer_load_dwordx4 v10, s[8:11], s38 offen nt lds
  buffer_load_dwordx4 v10, s[8:11], s38 offen offset:1024 nt lds
  buffer_load_dwordx4 v11, s[8:11], s38 offen offset:2048 nt lds
  buffer_load_dwordx4 v11, s[8:11], s38 offen offset:3072 nt lds
  s_waitcnt vmcnt(32)
  s_waitcnt lgkmcnt(0)
  s_barrier
  s_mov_b32 m0, 0x10800
  s_add_u32 s38, s46, 0x1a000
  buffer_load_dwordx4 v10, s[4:7], s38 offen nt lds
  buffer_load_dwordx4 v10, s[4:7], s38 offen offset:1024 nt lds
  buffer_load_dwordx4 v11, s[4:7], s38 offen offset:2048 nt lds
  buffer_load_dwordx4 v11, s[4:7], s38 offen offset:3072 nt lds
  s_mov_b32 m0, 0x11800
  s_add_u32 s38, s46, 0x1b000
  buffer_load_dwordx4 v10, s[4:7], s38 offen nt lds
  buffer_load_dwordx4 v10, s[4:7], s38 offen offset:1024 nt lds
  buffer_load_dwordx4 v11, s[4:7], s38 offen offset:2048 nt lds
  buffer_load_dwordx4 v11, s[4:7], s38 offen offset:3072 nt lds
  s_mov_b32 m0, 0x18800
  s_add_u32 s38, s46, 0x1a000
  buffer_load_dwordx4 v10, s[8:11], s38 offen nt lds
  buffer_load_dwordx4 v10, s[8:11], s38 offen offset:1024 nt lds
  buffer_load_dwordx4 v11, s[8:11], s38 offen offset:2048 nt lds
  buffer_load_dwordx4 v11, s[8:11], s38 offen offset:3072 nt lds
  s_mov_b32 m0, 0x19800
  s_add_u32 s38, s46, 0x1b000
  buffer_load_dwordx4 v10, s[8:11], s38 offen nt lds
  buffer_load_dwordx4 v10, s[8:11], s38 offen offset:1024 nt lds
  buffer_load_dwordx4 v11, s[8:11], s38 offen offset:2048 nt lds
  buffer_load_dwordx4 v11, s[8:11], s38 offen offset:3072 nt lds
  s_waitcnt vmcnt(32)
  s_waitcnt lgkmcnt(0)
  s_barrier
  s_mov_b32 m0, 0x12800
  s_add_u32 s38, s46, 0x1c000
  buffer_load_dwordx4 v10, s[4:7], s38 offen nt lds
  buffer_load_dwordx4 v10, s[4:7], s38 offen offset:1024 nt lds
  buffer_load_dwordx4 v11, s[4:7], s38 offen offset:2048 nt lds
  buffer_load_dwordx4 v11, s[4:7], s38 offen offset:3072 nt lds
  s_mov_b32 m0, 0x13800
  s_add_u32 s38, s46, 0x1d000
  buffer_load_dwordx4 v10, s[4:7], s38 offen nt lds
  buffer_load_dwordx4 v10, s[4:7], s38 offen offset:1024 nt lds
  buffer_load_dwordx4 v11, s[4:7], s38 offen offset:2048 nt lds
  buffer_load_dwordx4 v11, s[4:7], s38 offen offset:3072 nt lds
  s_mov_b32 m0, 0x1a800
  s_add_u32 s38, s46, 0x1c000
  buffer_load_dwordx4 v10, s[8:11], s38 offen nt lds
  buffer_load_dwordx4 v10, s[8:11], s38 offen offset:1024 nt lds
  buffer_load_dwordx4 v11, s[8:11], s38 offen offset:2048 nt lds
  buffer_load_dwordx4 v11, s[8:11], s38 offen offset:3072 nt lds
  s_mov_b32 m0, 0x1b800
  s_add_u32 s38, s46, 0x1d000
  buffer_load_dwordx4 v10, s[8:11], s38 offen nt lds
  buffer_load_dwordx4 v10, s[8:11], s38 offen offset:1024 nt lds
  buffer_load_dwordx4 v11, s[8:11], s38 offen offset:2048 nt lds
  buffer_load_dwordx4 v11, s[8:11], s38 offen offset:3072 nt lds
  s_waitcnt vmcnt(32)
  s_waitcnt lgkmcnt(0)
  s_barrier
  s_mov_b32 m0, 0x14800
  s_add_u32 s38, s46, 0x1e000
  buffer_load_dwordx4 v10, s[4:7], s38 offen nt lds
  buffer_load_dwordx4 v10, s[4:7], s38 offen offset:1024 nt lds
  buffer_load_dwordx4 v11, s[4:7], s38 offen offset:2048 nt lds
  buffer_load_dwordx4 v11, s[4:7], s38 offen offset:3072 nt lds
  s_mov_b32 m0, 0x15800
  s_add_u32 s38, s46, 0x1f000
  buffer_load_dwordx4 v10, s[4:7], s38 offen nt lds
  buffer_load_dwordx4 v10, s[4:7], s38 offen offset:1024 nt lds
  buffer_load_dwordx4 v11, s[4:7], s38 offen offset:2048 nt lds
  buffer_load_dwordx4 v11, s[4:7], s38 offen offset:3072 nt lds
  s_mov_b32 m0, 0x1c800
  s_add_u32 s38, s46, 0x1e000
  buffer_load_dwordx4 v10, s[8:11], s38 offen nt lds
  buffer_load_dwordx4 v10, s[8:11], s38 offen offset:1024 nt lds
  buffer_load_dwordx4 v11, s[8:11], s38 offen offset:2048 nt lds
  buffer_load_dwordx4 v11, s[8:11], s38 offen offset:3072 nt lds
  s_mov_b32 m0, 0x1d800
  s_add_u32 s38, s46, 0x1f000
  buffer_load_dwordx4 v10, s[8:11], s38 offen nt lds
  buffer_load_dwordx4 v10, s[8:11], s38 offen offset:1024 nt lds
  buffer_load_dwordx4 v11, s[8:11], s38 offen offset:2048 nt lds
  buffer_load_dwordx4 v11, s[8:11], s38 offen offset:3072 nt lds
  s_waitcnt vmcnt(32)
  s_waitcnt lgkmcnt(0)
  s_barrier
  s_waitcnt vmcnt(16)
  s_waitcnt lgkmcnt(0)
  s_barrier
  s_waitcnt vmcnt(0)
  s_waitcnt lgkmcnt(0)
  s_barrier
  s_waitcnt lgkmcnt(0)
  s_barrier
  s_waitcnt lgkmcnt(0)
  s_barrier
  s_waitcnt vmcnt(0)
  s_waitcnt lgkmcnt(0)
  s_barrier
  ds_read_b128 v[96:99], v9
  ds_read_b128 v[100:103], v9 offset:4096
  ds_read_b128 v[104:107], v9 offset:1024
  ds_read_b128 v[108:111], v9 offset:5120
  ds_read_b128 v[112:115], v9 offset:2048
  ds_read_b128 v[116:119], v9 offset:6144
  ds_read_b128 v[120:123], v9 offset:3072
  ds_read_b128 v[124:127], v9 offset:7168
  s_mov_b32 m0, 0x3800
  s_add_u32 s39, s72, 0x1f800
  buffer_load_dwordx4 v7, s[24:27], s39 offen lds
  buffer_load_dwordx4 v8, s[24:27], s39 offen offset:1024 lds
  s_mov_b32 m0, 0x7800
  s_add_u32 s39, s72, 0x43800
  buffer_load_dwordx4 v7, s[24:27], s39 offen lds
  buffer_load_dwordx4 v8, s[24:27], s39 offen offset:1024 lds
  ds_read_b64_tr_b16 v[16:17], v3 offset:40960
  ds_read_b64_tr_b16 v[18:19], v3 offset:43008
  ds_read_b64_tr_b16 v[20:21], v4 offset:40960
  ds_read_b64_tr_b16 v[22:23], v4 offset:43008
  ds_read_b64_tr_b16 v[24:25], v3 offset:45056
  ds_read_b64_tr_b16 v[26:27], v3 offset:47104
  ds_read_b64_tr_b16 v[28:29], v4 offset:45056
  s_waitcnt lgkmcnt(14)
  ds_read_b64_tr_b16 v[30:31], v4 offset:47104
  s_add_u32 s76, s34, 24
  s_mov_b32 s77, 0
  s_mov_b32 s78, 0
  s_mov_b32 s80, 0x7ff00000
  s_waitcnt lgkmcnt(14)
  ds_read_b64_tr_b16 v[48:49], v3 offset:49152
  s_waitcnt lgkmcnt(13)
  ds_read_b64_tr_b16 v[50:51], v3 offset:51200
  s_waitcnt lgkmcnt(8)
  v_mfma_f32_16x16x32_bf16 v[32:35], v[16:19], v[64:67], 0
  v_mfma_f32_16x16x32_bf16 v[40:43], v[16:19], v[68:71], 0
  ds_read_b64_tr_b16 v[52:53], v4 offset:49152
  ds_read_b64_tr_b16 v[54:55], v4 offset:51200
  s_waitcnt lgkmcnt(8)
  v_mfma_f32_16x16x32_bf16 v[36:39], v[20:23], v[64:67], 0
  v_mfma_f32_16x16x32_bf16 v[44:47], v[20:23], v[68:71], 0
  ds_read_b64_tr_b16 v[56:57], v3 offset:53248
  ds_read_b64_tr_b16 v[58:59], v3 offset:55296
  s_waitcnt lgkmcnt(8)
  v_mfma_f32_16x16x32_bf16 v[32:35], v[24:27], v[72:75], v[32:35]
  v_mfma_f32_16x16x32_bf16 v[40:43], v[24:27], v[76:79], v[40:43]
  ds_read_b64_tr_b16 v[60:61], v4 offset:53248
  ds_read_b64_tr_b16 v[62:63], v4 offset:55296
  s_waitcnt lgkmcnt(8)
  v_mfma_f32_16x16x32_bf16 v[36:39], v[28:31], v[72:75], v[36:39]
  v_mfma_f32_16x16x32_bf16 v[44:47], v[28:31], v[76:79], v[44:47]
  s_waitcnt lgkmcnt(0)
  s_barrier
  ds_read_b64_tr_b16 v[16:17], v5
  ds_read_b64_tr_b16 v[18:19], v5 offset:2048
  v_mfma_f32_16x16x32_bf16 v[32:35], v[48:51], v[80:83], v[32:35]
  v_mfma_f32_16x16x32_bf16 v[40:43], v[48:51], v[84:87], v[40:43]
  ds_read_b64_tr_b16 v[20:21], v6
  ds_read_b64_tr_b16 v[22:23], v6 offset:2048
  s_mov_b32 m0, 0xd800
  s_add_u32 s39, s72, 0x67880
  buffer_load_dwordx4 v7, s[24:27], s39 offen lds
  buffer_load_dwordx4 v8, s[24:27], s39 offen offset:1024 lds
  v_mfma_f32_16x16x32_bf16 v[36:39], v[52:55], v[80:83], v[36:39]
  v_mfma_f32_16x16x32_bf16 v[44:47], v[52:55], v[84:87], v[44:47]
  ds_read_b64_tr_b16 v[24:25], v5 offset:4096
  ds_read_b64_tr_b16 v[26:27], v5 offset:6144
  v_mfma_f32_16x16x32_bf16 v[32:35], v[56:59], v[88:91], v[32:35]
  v_mfma_f32_16x16x32_bf16 v[40:43], v[56:59], v[92:95], v[40:43]
  ds_read_b64_tr_b16 v[28:29], v6 offset:4096
  ds_read_b64_tr_b16 v[30:31], v6 offset:6144
  v_mfma_f32_16x16x32_bf16 v[36:39], v[60:63], v[88:91], v[36:39]
  v_mfma_f32_16x16x32_bf16 v[44:47], v[60:63], v[92:95], v[44:47]
  ds_read_b64_tr_b16 v[48:49], v5 offset:8192
  ds_read_b64_tr_b16 v[50:51], v5 offset:10240
  s_waitcnt lgkmcnt(8)
  v_mfma_f32_16x16x32_bf16 v[32:35], v[16:19], v[96:99], v[32:35]
  v_mfma_f32_16x16x32_bf16 v[40:43], v[16:19], v[100:103], v[40:43]
  ds_read_b64_tr_b16 v[52:53], v6 offset:8192
  ds_read_b64_tr_b16 v[54:55], v6 offset:10240
  s_waitcnt lgkmcnt(8)
  v_mfma_f32_16x16x32_bf16 v[36:39], v[20:23], v[96:99], v[36:39]
  v_mfma_f32_16x16x32_bf16 v[44:47], v[20:23], v[100:103], v[44:47]
  ds_read_b64_tr_b16 v[56:57], v5 offset:12288
  ds_read_b64_tr_b16 v[58:59], v5 offset:14336
  s_waitcnt lgkmcnt(8)
  v_mfma_f32_16x16x32_bf16 v[32:35], v[24:27], v[104:107], v[32:35]
  v_mfma_f32_16x16x32_bf16 v[40:43], v[24:27], v[108:111], v[40:43]
  ds_read_b64_tr_b16 v[60:61], v6 offset:12288
  ds_read_b64_tr_b16 v[62:63], v6 offset:14336
  s_waitcnt lgkmcnt(8)
  v_mfma_f32_16x16x32_bf16 v[36:39], v[28:31], v[104:107], v[36:39]
  v_mfma_f32_16x16x32_bf16 v[44:47], v[28:31], v[108:111], v[44:47]
  s_waitcnt vmcnt(4)
  s_waitcnt lgkmcnt(0)
  s_barrier
  ds_read_b64_tr_b16 v[16:17], v3
  ds_read_b64_tr_b16 v[18:19], v3 offset:2048
  v_mfma_f32_16x16x32_bf16 v[32:35], v[48:51], v[112:115], v[32:35]
  v_mfma_f32_16x16x32_bf16 v[40:43], v[48:51], v[116:119], v[40:43]
  ds_read_b64_tr_b16 v[20:21], v4
  ds_read_b64_tr_b16 v[22:23], v4 offset:2048
  s_mov_b32 m0, 0x1c000
  s_add_u32 s39, s72, 0x8b880
  buffer_load_dwordx4 v7, s[24:27], s39 offen lds
  buffer_load_dwordx4 v8, s[24:27], s39 offen offset:1024 lds
  v_mfma_f32_16x16x32_bf16 v[36:39], v[52:55], v[112:115], v[36:39]
  v_mfma_f32_16x16x32_bf16 v[44:47], v[52:55], v[116:119], v[44:47]
  ds_read_b64_tr_b16 v[24:25], v3 offset:4096
  ds_read_b64_tr_b16 v[26:27], v3 offset:6144
  v_mfma_f32_16x16x32_bf16 v[32:35], v[56:59], v[120:123], v[32:35]
  v_mfma_f32_16x16x32_bf16 v[40:43], v[56:59], v[124:127], v[40:43]
  ds_read_b64_tr_b16 v[28:29], v4 offset:4096
  ds_read_b64_tr_b16 v[30:31], v4 offset:6144
  v_mfma_f32_16x16x32_bf16 v[36:39], v[60:63], v[120:123], v[36:39]
  v_mfma_f32_16x16x32_bf16 v[44:47], v[60:63], v[124:127], v[44:47]
  ds_read_b64_tr_b16 v[48:49], v3 offset:8192
  ds_read_b64_tr_b16 v[50:51], v3 offset:10240
  s_waitcnt lgkmcnt(8)
  v_mfma_f32_16x16x32_bf16 v[32:35], v[16:19], v[128:131], v[32:35]
  v_mfma_f32_16x16x32_bf16 v[40:43], v[16:19], v[132:135], v[40:43]
  ds_read_b64_tr_b16 v[52:53], v4 offset:8192
  ds_read_b64_tr_b16 v[54:55], v4 offset:10240
  s_waitcnt lgkmcnt(8)
  v_mfma_f32_16x16x32_bf16 v[36:39], v[20:23], v[128:131], v[36:39]
  v_mfma_f32_16x16x32_bf16 v[44:47], v[20:23], v[132:135], v[44:47]
  ds_read_b64_tr_b16 v[56:57], v3 offset:12288
  ds_read_b64_tr_b16 v[58:59], v3 offset:14336
  s_waitcnt lgkmcnt(8)
  v_mfma_f32_16x16x32_bf16 v[32:35], v[24:27], v[136:139], v[32:35]
  v_mfma_f32_16x16x32_bf16 v[40:43], v[24:27], v[140:143], v[40:43]
  ds_read_b64_tr_b16 v[60:61], v4 offset:12288
  ds_read_b64_tr_b16 v[62:63], v4 offset:14336
  s_waitcnt lgkmcnt(8)
  v_mfma_f32_16x16x32_bf16 v[36:39], v[28:31], v[136:139], v[36:39]
  v_mfma_f32_16x16x32_bf16 v[44:47], v[28:31], v[140:143], v[44:47]
  s_waitcnt vmcnt(4)
  s_waitcnt lgkmcnt(0)
  s_barrier
  ds_read_b64_tr_b16 v[16:17], v3 offset:16384
  ds_read_b64_tr_b16 v[18:19], v3 offset:18432
  v_mfma_f32_16x16x32_bf16 v[32:35], v[48:51], v[144:147], v[32:35]
  v_mfma_f32_16x16x32_bf16 v[40:43], v[48:51], v[148:151], v[40:43]
  ds_read_b64_tr_b16 v[20:21], v4 offset:16384
  ds_read_b64_tr_b16 v[22:23], v4 offset:18432
  s_mov_b32 m0, 0x3800
  s_add_u32 s39, s72, 0x1f880
  buffer_load_dwordx4 v7, s[24:27], s39 offen lds
  buffer_load_dwordx4 v8, s[24:27], s39 offen offset:1024 lds
  v_mfma_f32_16x16x32_bf16 v[36:39], v[52:55], v[144:147], v[36:39]
  v_mfma_f32_16x16x32_bf16 v[44:47], v[52:55], v[148:151], v[44:47]
  ds_read_b64_tr_b16 v[24:25], v3 offset:20480
  ds_read_b64_tr_b16 v[26:27], v3 offset:22528
  v_mfma_f32_16x16x32_bf16 v[32:35], v[56:59], v[152:155], v[32:35]
  v_mfma_f32_16x16x32_bf16 v[40:43], v[56:59], v[156:159], v[40:43]
  ds_read_b64_tr_b16 v[28:29], v4 offset:20480
  ds_read_b64_tr_b16 v[30:31], v4 offset:22528
  v_mfma_f32_16x16x32_bf16 v[36:39], v[60:63], v[152:155], v[36:39]
  v_mfma_f32_16x16x32_bf16 v[44:47], v[60:63], v[156:159], v[44:47]
  ds_read_b64_tr_b16 v[48:49], v3 offset:24576
  ds_read_b64_tr_b16 v[50:51], v3 offset:26624
  s_waitcnt lgkmcnt(8)
  v_mfma_f32_16x16x32_bf16 v[32:35], v[16:19], v[160:163], v[32:35]
  v_mfma_f32_16x16x32_bf16 v[40:43], v[16:19], v[164:167], v[40:43]
  ds_read_b64_tr_b16 v[52:53], v4 offset:24576
  ds_read_b64_tr_b16 v[54:55], v4 offset:26624
  s_waitcnt lgkmcnt(8)
  v_mfma_f32_16x16x32_bf16 v[36:39], v[20:23], v[160:163], v[36:39]
  v_mfma_f32_16x16x32_bf16 v[44:47], v[20:23], v[164:167], v[44:47]
  ds_read_b64_tr_b16 v[56:57], v3 offset:28672
  ds_read_b64_tr_b16 v[58:59], v3 offset:30720
  s_waitcnt lgkmcnt(8)
  v_mfma_f32_16x16x32_bf16 v[32:35], v[24:27], v[168:171], v[32:35]
  v_mfma_f32_16x16x32_bf16 v[40:43], v[24:27], v[172:175], v[40:43]
  ds_read_b64_tr_b16 v[60:61], v4 offset:28672
  ds_read_b64_tr_b16 v[62:63], v4 offset:30720
  s_waitcnt lgkmcnt(8)
  v_mfma_f32_16x16x32_bf16 v[36:39], v[28:31], v[168:171], v[36:39]
  v_mfma_f32_16x16x32_bf16 v[44:47], v[28:31], v[172:175], v[44:47]
  s_waitcnt vmcnt(4)
  s_waitcnt lgkmcnt(0)
  s_barrier
  ds_read_b64_tr_b16 v[16:17], v3 offset:40960
  ds_read_b64_tr_b16 v[18:19], v3 offset:43008
  v_mfma_f32_16x16x32_bf16 v[32:35], v[48:51], v[176:179], v[32:35]
  v_mfma_f32_16x16x32_bf16 v[40:43], v[48:51], v[180:183], v[40:43]
  ds_read_b64_tr_b16 v[20:21], v4 offset:40960
  ds_read_b64_tr_b16 v[22:23], v4 offset:43008
  s_mov_b32 m0, 0x7800
  s_add_u32 s39, s72, 0x43880
  buffer_load_dwordx4 v7, s[24:27], s39 offen lds
  buffer_load_dwordx4 v8, s[24:27], s39 offen offset:1024 lds
  v_mfma_f32_16x16x32_bf16 v[36:39], v[52:55], v[176:179], v[36:39]
  v_mfma_f32_16x16x32_bf16 v[44:47], v[52:55], v[180:183], v[44:47]
  ds_read_b64_tr_b16 v[24:25], v3 offset:45056
  ds_read_b64_tr_b16 v[26:27], v3 offset:47104
  v_mfma_f32_16x16x32_bf16 v[32:35], v[56:59], v[184:187], v[32:35]
  v_mfma_f32_16x16x32_bf16 v[40:43], v[56:59], v[188:191], v[40:43]
  ds_read_b64_tr_b16 v[28:29], v4 offset:45056
  ds_read_b64_tr_b16 v[30:31], v4 offset:47104
  v_mfma_f32_16x16x32_bf16 v[36:39], v[60:63], v[184:187], v[36:39]
  v_mfma_f32_16x16x32_bf16 v[44:47], v[60:63], v[188:191], v[44:47]
  s_add_u32 s72, s72, 128
  s_mov_b32 s74, 7
L_op7_loop:
  ds_read_b64_tr_b16 v[48:49], v3 offset:49152
  ds_read_b64_tr_b16 v[50:51], v3 offset:51200
  v_cvt_pk_bf16_f32 v10, v32, v33
  v_cvt_pk_bf16_f32 v11, v34, v35
  s_nop 0
  v_cvt_pk_bf16_f32 v12, v36, v37
  v_cvt_pk_bf16_f32 v13, v38, v39
  s_add_u32 s40, s73, 0x400
  buffer_store_dwordx4 v[10:13], v2, s[20:23], s40 offen sc1
  s_waitcnt lgkmcnt(8)
  v_mfma_f32_16x16x32_bf16 v[32:35], v[16:19], v[64:67], 0
  v_cvt_pk_bf16_f32 v10, v40, v41
  v_cvt_pk_bf16_f32 v11, v42, v43
  v_cvt_pk_bf16_f32 v12, v44, v45
  v_cvt_pk_bf16_f32 v13, v46, v47
  s_add_u32 s40, s73, 0xc00
  buffer_store_dwordx4 v[10:13], v2, s[20:23], s40 offen sc1
  v_mfma_f32_16x16x32_bf16 v[40:43], v[16:19], v[68:71], 0
  ds_read_b64_tr_b16 v[52:53], v4 offset:49152
  ds_read_b64_tr_b16 v[54:55], v4 offset:51200
  s_waitcnt lgkmcnt(6)
  v_mfma_f32_16x16x32_bf16 v[36:39], v[20:23], v[64:67], 0
  v_mfma_f32_16x16x32_bf16 v[44:47], v[20:23], v[68:71], 0
  ds_read_b64_tr_b16 v[56:57], v3 offset:53248
  ds_read_b64_tr_b16 v[58:59], v3 offset:55296
  v_mfma_f32_16x16x32_bf16 v[32:35], v[24:27], v[72:75], v[32:35]
  v_mfma_f32_16x16x32_bf16 v[40:43], v[24:27], v[76:79], v[40:43]
  ds_read_b64_tr_b16 v[60:61], v4 offset:53248
  ds_read_b64_tr_b16 v[62:63], v4 offset:55296
  s_waitcnt lgkmcnt(7)
  v_mfma_f32_16x16x32_bf16 v[36:39], v[28:31], v[72:75], v[36:39]
  v_mfma_f32_16x16x32_bf16 v[44:47], v[28:31], v[76:79], v[44:47]
  s_waitcnt vmcnt(6)
  s_waitcnt lgkmcnt(0)
  s_barrier
  ds_read_b64_tr_b16 v[16:17], v5
  ds_read_b64_tr_b16 v[18:19], v5 offset:2048
  v_mfma_f32_16x16x32_bf16 v[32:35], v[48:51], v[80:83], v[32:35]
  v_mfma_f32_16x16x32_bf16 v[40:43], v[48:51], v[84:87], v[40:43]
  ds_read_b64_tr_b16 v[20:21], v6
  ds_read_b64_tr_b16 v[22:23], v6 offset:2048
  s_mov_b32 m0, 0xd800
  s_add_u32 s39, s72, 0x67880
  buffer_load_dwordx4 v7, s[24:27], s39 offen lds
  buffer_load_dwordx4 v8, s[24:27], s39 offen offset:1024 lds
  v_mfma_f32_16x16x32_bf16 v[36:39], v[52:55], v[80:83], v[36:39]
  v_mfma_f32_16x16x32_bf16 v[44:47], v[52:55], v[84:87], v[44:47]
  ds_read_b64_tr_b16 v[24:25], v5 offset:4096
  ds_read_b64_tr_b16 v[26:27], v5 offset:6144
  v_mfma_f32_16x16x32_bf16 v[32:35], v[56:59], v[88:91], v[32:35]
  v_mfma_f32_16x16x32_bf16 v[40:43], v[56:59], v[92:95], v[40:43]
  ds_read_b64_tr_b16 v[28:29], v6 offset:4096
  ds_read_b64_tr_b16 v[30:31], v6 offset:6144
  v_mfma_f32_16x16x32_bf16 v[36:39], v[60:63], v[88:91], v[36:39]
  v_mfma_f32_16x16x32_bf16 v[44:47], v[60:63], v[92:95], v[44:47]
  ds_read_b64_tr_b16 v[48:49], v5 offset:8192
  ds_read_b64_tr_b16 v[50:51], v5 offset:10240
  s_waitcnt lgkmcnt(8)
  v_mfma_f32_16x16x32_bf16 v[32:35], v[16:19], v[96:99], v[32:35]
  v_mfma_f32_16x16x32_bf16 v[40:43], v[16:19], v[100:103], v[40:43]
  ds_read_b64_tr_b16 v[52:53], v6 offset:8192
  ds_read_b64_tr_b16 v[54:55], v6 offset:10240
  s_waitcnt lgkmcnt(8)
  v_mfma_f32_16x16x32_bf16 v[36:39], v[20:23], v[96:99], v[36:39]
  v_mfma_f32_16x16x32_bf16 v[44:47], v[20:23], v[100:103], v[44:47]
  ds_read_b64_tr_b16 v[56:57], v5 offset:12288
  ds_read_b64_tr_b16 v[58:59], v5 offset:14336
  s_waitcnt lgkmcnt(8)
  v_mfma_f32_16x16x32_bf16 v[32:35], v[24:27], v[104:107], v[32:35]
  v_mfma_f32_16x16x32_bf16 v[40:43], v[24:27], v[108:111], v[40:43]
  ds_read_b64_tr_b16 v[60:61], v6 offset:12288
  ds_read_b64_tr_b16 v[62:63], v6 offset:14336
  s_waitcnt lgkmcnt(8)
  v_mfma_f32_16x16x32_bf16 v[36:39], v[28:31], v[104:107], v[36:39]
  v_mfma_f32_16x16x32_bf16 v[44:47], v[28:31], v[108:111], v[44:47]
  s_waitcnt vmcnt(6)
  s_waitcnt lgkmcnt(0)
  s_barrier
  ds_read_b64_tr_b16 v[16:17], v3
  ds_read_b64_tr_b16 v[18:19], v3 offset:2048
  v_mfma_f32_16x16x32_bf16 v[32:35], v[48:51], v[112:115], v[32:35]
  v_mfma_f32_16x16x32_bf16 v[40:43], v[48:51], v[116:119], v[40:43]
  ds_read_b64_tr_b16 v[20:21], v4
  ds_read_b64_tr_b16 v[22:23], v4 offset:2048
  s_mov_b32 m0, 0x1c000
  s_add_u32 s39, s72, 0x8b880
  buffer_load_dwordx4 v7, s[24:27], s39 offen lds
  buffer_load_dwordx4 v8, s[24:27], s39 offen offset:1024 lds
  v_mfma_f32_16x16x32_bf16 v[36:39], v[52:55], v[112:115], v[36:39]
  v_mfma_f32_16x16x32_bf16 v[44:47], v[52:55], v[116:119], v[44:47]
  ds_read_b64_tr_b16 v[24:25], v3 offset:4096
  ds_read_b64_tr_b16 v[26:27], v3 offset:6144
  v_mfma_f32_16x16x32_bf16 v[32:35], v[56:59], v[120:123], v[32:35]
  v_mfma_f32_16x16x32_bf16 v[40:43], v[56:59], v[124:127], v[40:43]
  ds_read_b64_tr_b16 v[28:29], v4 offset:4096
  ds_read_b64_tr_b16 v[30:31], v4 offset:6144
  v_mfma_f32_16x16x32_bf16 v[36:39], v[60:63], v[120:123], v[36:39]
  v_mfma_f32_16x16x32_bf16 v[44:47], v[60:63], v[124:127], v[44:47]
  ds_read_b64_tr_b16 v[48:49], v3 offset:8192
  ds_read_b64_tr_b16 v[50:51], v3 offset:10240
  s_waitcnt lgkmcnt(8)
  v_mfma_f32_16x16x32_bf16 v[32:35], v[16:19], v[128:131], v[32:35]
  v_mfma_f32_16x16x32_bf16 v[40:43], v[16:19], v[132:135], v[40:43]
  ds_read_b64_tr_b16 v[52:53], v4 offset:8192
  ds_read_b64_tr_b16 v[54:55], v4 offset:10240
  s_waitcnt lgkmcnt(8)
  v_mfma_f32_16x16x32_bf16 v[36:39], v[20:23], v[128:131], v[36:39]
  v_mfma_f32_16x16x32_bf16 v[44:47], v[20:23], v[132:135], v[44:47]
  ds_read_b64_tr_b16 v[56:57], v3 offset:12288
  ds_read_b64_tr_b16 v[58:59], v3 offset:14336
  s_waitcnt lgkmcnt(8)
  v_mfma_f32_16x16x32_bf16 v[32:35], v[24:27], v[136:139], v[32:35]
  v_mfma_f32_16x16x32_bf16 v[40:43], v[24:27], v[140:143], v[40:43]
  ds_read_b64_tr_b16 v[60:61], v4 offset:12288
  ds_read_b64_tr_b16 v[62:63], v4 offset:14336
  s_waitcnt lgkmcnt(8)
  v_mfma_f32_16x16x32_bf16 v[36:39], v[28:31], v[136:139], v[36:39]
  v_mfma_f32_16x16x32_bf16 v[44:47], v[28:31], v[140:143], v[44:47]
  s_waitcnt vmcnt(6)
  s_waitcnt lgkmcnt(0)
  s_barrier
  ds_read_b64_tr_b16 v[16:17], v3 offset:16384
  ds_read_b64_tr_b16 v[18:19], v3 offset:18432
  v_mfma_f32_16x16x32_bf16 v[32:35], v[48:51], v[144:147], v[32:35]
  v_mfma_f32_16x16x32_bf16 v[40:43], v[48:51], v[148:151], v[40:43]
  ds_read_b64_tr_b16 v[20:21], v4 offset:16384
  ds_read_b64_tr_b16 v[22:23], v4 offset:18432
  s_mov_b32 m0, 0x3800
  s_add_u32 s39, s72, 0x1f880
  buffer_load_dwordx4 v7, s[24:27], s39 offen lds
  buffer_load_dwordx4 v8, s[24:27], s39 offen offset:1024 lds
  v_mfma_f32_16x16x32_bf16 v[36:39], v[52:55], v[144:147], v[36:39]
  v_mfma_f32_16x16x32_bf16 v[44:47], v[52:55], v[148:151], v[44:47]
  ds_read_b64_tr_b16 v[24:25], v3 offset:20480
  ds_read_b64_tr_b16 v[26:27], v3 offset:22528
  v_mfma_f32_16x16x32_bf16 v[32:35], v[56:59], v[152:155], v[32:35]
  v_mfma_f32_16x16x32_bf16 v[40:43], v[56:59], v[156:159], v[40:43]
  ds_read_b64_tr_b16 v[28:29], v4 offset:20480
  ds_read_b64_tr_b16 v[30:31], v4 offset:22528
  v_mfma_f32_16x16x32_bf16 v[36:39], v[60:63], v[152:155], v[36:39]
  v_mfma_f32_16x16x32_bf16 v[44:47], v[60:63], v[156:159], v[44:47]
  ds_read_b64_tr_b16 v[48:49], v3 offset:24576
  ds_read_b64_tr_b16 v[50:51], v3 offset:26624
  s_waitcnt lgkmcnt(8)
  v_mfma_f32_16x16x32_bf16 v[32:35], v[16:19], v[160:163], v[32:35]
  v_mfma_f32_16x16x32_bf16 v[40:43], v[16:19], v[164:167], v[40:43]
  ds_read_b64_tr_b16 v[52:53], v4 offset:24576
  ds_read_b64_tr_b16 v[54:55], v4 offset:26624
  s_waitcnt lgkmcnt(8)
  v_mfma_f32_16x16x32_bf16 v[36:39], v[20:23], v[160:163], v[36:39]
  v_mfma_f32_16x16x32_bf16 v[44:47], v[20:23], v[164:167], v[44:47]
  ds_read_b64_tr_b16 v[56:57], v3 offset:28672
  ds_read_b64_tr_b16 v[58:59], v3 offset:30720
  s_waitcnt lgkmcnt(8)
  v_mfma_f32_16x16x32_bf16 v[32:35], v[24:27], v[168:171], v[32:35]
  v_mfma_f32_16x16x32_bf16 v[40:43], v[24:27], v[172:175], v[40:43]
  ds_read_b64_tr_b16 v[60:61], v4 offset:28672
  ds_read_b64_tr_b16 v[62:63], v4 offset:30720
  s_waitcnt lgkmcnt(8)
  v_mfma_f32_16x16x32_bf16 v[36:39], v[28:31], v[168:171], v[36:39]
  v_mfma_f32_16x16x32_bf16 v[44:47], v[28:31], v[172:175], v[44:47]
  s_waitcnt vmcnt(4)
  s_waitcnt lgkmcnt(0)
  s_barrier
  ds_read_b64_tr_b16 v[16:17], v3 offset:40960
  ds_read_b64_tr_b16 v[18:19], v3 offset:43008
  v_mfma_f32_16x16x32_bf16 v[32:35], v[48:51], v[176:179], v[32:35]
  v_mfma_f32_16x16x32_bf16 v[40:43], v[48:51], v[180:183], v[40:43]
  ds_read_b64_tr_b16 v[20:21], v4 offset:40960
  ds_read_b64_tr_b16 v[22:23], v4 offset:43008
  s_mov_b32 m0, 0x7800
  s_add_u32 s39, s72, 0x43880
  buffer_load_dwordx4 v7, s[24:27], s39 offen lds
  buffer_load_dwordx4 v8, s[24:27], s39 offen offset:1024 lds
  v_mfma_f32_16x16x32_bf16 v[36:39], v[52:55], v[176:179], v[36:39]
  v_mfma_f32_16x16x32_bf16 v[44:47], v[52:55], v[180:183], v[44:47]
  ds_read_b64_tr_b16 v[24:25], v3 offset:45056
  ds_read_b64_tr_b16 v[26:27], v3 offset:47104
  v_mfma_f32_16x16x32_bf16 v[32:35], v[56:59], v[184:187], v[32:35]
  v_mfma_f32_16x16x32_bf16 v[40:43], v[56:59], v[188:191], v[40:43]
  ds_read_b64_tr_b16 v[28:29], v4 offset:45056
  ds_read_b64_tr_b16 v[30:31], v4 offset:47104
  v_mfma_f32_16x16x32_bf16 v[36:39], v[60:63], v[184:187], v[36:39]
  v_mfma_f32_16x16x32_bf16 v[44:47], v[60:63], v[188:191], v[44:47]
  s_add_u32 s72, s72, 128
  s_add_u32 s73, s73, 0x4800
  s_add_u32 s78, s78, 1
  s_sub_u32 s74, s74, 1
  s_cmp_lg_u32 s74, 0
  s_cbranch_scc1 L_op7_loop
  ds_read_b64_tr_b16 v[48:49], v3 offset:49152
  ds_read_b64_tr_b16 v[50:51], v3 offset:51200
  v_cvt_pk_bf16_f32 v10, v32, v33
  v_cvt_pk_bf16_f32 v11, v34, v35
  v_cvt_pk_bf16_f32 v12, v36, v37
  v_cvt_pk_bf16_f32 v13, v38, v39
  s_add_u32 s40, s73, 0x400
  buffer_store_dwordx4 v[10:13], v2, s[20:23], s40 offen sc1
  s_waitcnt lgkmcnt(6)
  v_mfma_f32_16x16x32_bf16 v[32:35], v[16:19], v[64:67], 0
  v_cvt_pk_bf16_f32 v10, v40, v41
  v_cvt_pk_bf16_f32 v11, v42, v43
  v_cvt_pk_bf16_f32 v12, v44, v45
  v_cvt_pk_bf16_f32 v13, v46, v47
  s_add_u32 s40, s73, 0xc00
  buffer_store_dwordx4 v[10:13], v2, s[20:23], s40 offen sc1
  v_mfma_f32_16x16x32_bf16 v[40:43], v[16:19], v[68:71], 0
  ds_read_b64_tr_b16 v[52:53], v4 offset:49152
  ds_read_b64_tr_b16 v[54:55], v4 offset:51200
  v_mfma_f32_16x16x32_bf16 v[36:39], v[20:23], v[64:67], 0
  v_mfma_f32_16x16x32_bf16 v[44:47], v[20:23], v[68:71], 0
  ds_read_b64_tr_b16 v[56:57], v3 offset:53248
  ds_read_b64_tr_b16 v[58:59], v3 offset:55296
  s_waitcnt lgkmcnt(6)
  v_mfma_f32_16x16x32_bf16 v[32:35], v[24:27], v[72:75], v[32:35]
  v_mfma_f32_16x16x32_bf16 v[40:43], v[24:27], v[76:79], v[40:43]
  ds_read_b64_tr_b16 v[60:61], v4 offset:53248
  ds_read_b64_tr_b16 v[62:63], v4 offset:55296
  v_mfma_f32_16x16x32_bf16 v[36:39], v[28:31], v[72:75], v[36:39]
  v_mfma_f32_16x16x32_bf16 v[44:47], v[28:31], v[76:79], v[44:47]
  s_waitcnt vmcnt(6)
  s_waitcnt lgkmcnt(0)
  s_barrier
  ds_read_b64_tr_b16 v[16:17], v5
  ds_read_b64_tr_b16 v[18:19], v5 offset:2048
  v_mfma_f32_16x16x32_bf16 v[32:35], v[48:51], v[80:83], v[32:35]
  v_mfma_f32_16x16x32_bf16 v[40:43], v[48:51], v[84:87], v[40:43]
  ds_read_b64_tr_b16 v[20:21], v6
  ds_read_b64_tr_b16 v[22:23], v6 offset:2048
  v_mfma_f32_16x16x32_bf16 v[36:39], v[52:55], v[80:83], v[36:39]
  v_mfma_f32_16x16x32_bf16 v[44:47], v[52:55], v[84:87], v[44:47]
  ds_read_b64_tr_b16 v[24:25], v5 offset:4096
  ds_read_b64_tr_b16 v[26:27], v5 offset:6144
  v_mfma_f32_16x16x32_bf16 v[32:35], v[56:59], v[88:91], v[32:35]
  v_mfma_f32_16x16x32_bf16 v[40:43], v[56:59], v[92:95], v[40:43]
  ds_read_b64_tr_b16 v[28:29], v6 offset:4096
  ds_read_b64_tr_b16 v[30:31], v6 offset:6144
  v_mfma_f32_16x16x32_bf16 v[36:39], v[60:63], v[88:91], v[36:39]
  v_mfma_f32_16x16x32_bf16 v[44:47], v[60:63], v[92:95], v[44:47]
  ds_read_b64_tr_b16 v[48:49], v5 offset:8192
  ds_read_b64_tr_b16 v[50:51], v5 offset:10240
  s_waitcnt lgkmcnt(8)
  v_mfma_f32_16x16x32_bf16 v[32:35], v[16:19], v[96:99], v[32:35]
  v_mfma_f32_16x16x32_bf16 v[40:43], v[16:19], v[100:103], v[40:43]
  ds_read_b64_tr_b16 v[52:53], v6 offset:8192
  ds_read_b64_tr_b16 v[54:55], v6 offset:10240
  s_waitcnt lgkmcnt(8)
  v_mfma_f32_16x16x32_bf16 v[36:39], v[20:23], v[96:99], v[36:39]
  v_mfma_f32_16x16x32_bf16 v[44:47], v[20:23], v[100:103], v[44:47]
  ds_read_b64_tr_b16 v[56:57], v5 offset:12288
  ds_read_b64_tr_b16 v[58:59], v5 offset:14336
  s_waitcnt lgkmcnt(8)
  v_mfma_f32_16x16x32_bf16 v[32:35], v[24:27], v[104:107], v[32:35]
  v_mfma_f32_16x16x32_bf16 v[40:43], v[24:27], v[108:111], v[40:43]
  ds_read_b64_tr_b16 v[60:61], v6 offset:12288
  ds_read_b64_tr_b16 v[62:63], v6 offset:14336
  s_waitcnt lgkmcnt(8)
  v_mfma_f32_16x16x32_bf16 v[36:39], v[28:31], v[104:107], v[36:39]
  v_mfma_f32_16x16x32_bf16 v[44:47], v[28:31], v[108:111], v[44:47]
  s_waitcnt vmcnt(4)
  s_waitcnt lgkmcnt(0)
  s_barrier
  ds_read_b64_tr_b16 v[16:17], v3
  ds_read_b64_tr_b16 v[18:19], v3 offset:2048
  v_mfma_f32_16x16x32_bf16 v[32:35], v[48:51], v[112:115], v[32:35]
  v_mfma_f32_16x16x32_bf16 v[40:43], v[48:51], v[116:119], v[40:43]
  ds_read_b64_tr_b16 v[20:21], v4
  ds_read_b64_tr_b16 v[22:23], v4 offset:2048
  v_mfma_f32_16x16x32_bf16 v[36:39], v[52:55], v[112:115], v[36:39]
  v_mfma_f32_16x16x32_bf16 v[44:47], v[52:55], v[116:119], v[44:47]
  ds_read_b64_tr_b16 v[24:25], v3 offset:4096
  ds_read_b64_tr_b16 v[26:27], v3 offset:6144
  v_mfma_f32_16x16x32_bf16 v[32:35], v[56:59], v[120:123], v[32:35]
  v_mfma_f32_16x16x32_bf16 v[40:43], v[56:59], v[124:127], v[40:43]
  ds_read_b64_tr_b16 v[28:29], v4 offset:4096
  ds_read_b64_tr_b16 v[30:31], v4 offset:6144
  v_mfma_f32_16x16x32_bf16 v[36:39], v[60:63], v[120:123], v[36:39]
  v_mfma_f32_16x16x32_bf16 v[44:47], v[60:63], v[124:127], v[44:47]
  ds_read_b64_tr_b16 v[48:49], v3 offset:8192
  ds_read_b64_tr_b16 v[50:51], v3 offset:10240
  s_waitcnt lgkmcnt(8)
  v_mfma_f32_16x16x32_bf16 v[32:35], v[16:19], v[128:131], v[32:35]
  v_mfma_f32_16x16x32_bf16 v[40:43], v[16:19], v[132:135], v[40:43]
  ds_read_b64_tr_b16 v[52:53], v4 offset:8192
  ds_read_b64_tr_b16 v[54:55], v4 offset:10240
  s_waitcnt lgkmcnt(8)
  v_mfma_f32_16x16x32_bf16 v[36:39], v[20:23], v[128:131], v[36:39]
  v_mfma_f32_16x16x32_bf16 v[44:47], v[20:23], v[132:135], v[44:47]
  ds_read_b64_tr_b16 v[56:57], v3 offset:12288
  ds_read_b64_tr_b16 v[58:59], v3 offset:14336
  s_waitcnt lgkmcnt(8)
  v_mfma_f32_16x16x32_bf16 v[32:35], v[24:27], v[136:139], v[32:35]
  v_mfma_f32_16x16x32_bf16 v[40:43], v[24:27], v[140:143], v[40:43]
  ds_read_b64_tr_b16 v[60:61], v4 offset:12288
  ds_read_b64_tr_b16 v[62:63], v4 offset:14336
  s_waitcnt lgkmcnt(8)
  v_mfma_f32_16x16x32_bf16 v[36:39], v[28:31], v[136:139], v[36:39]
  v_mfma_f32_16x16x32_bf16 v[44:47], v[28:31], v[140:143], v[44:47]
  s_waitcnt vmcnt(0)
  s_waitcnt lgkmcnt(0)
  s_barrier
  ds_read_b64_tr_b16 v[16:17], v3 offset:16384
  ds_read_b64_tr_b16 v[18:19], v3 offset:18432
  v_mfma_f32_16x16x32_bf16 v[32:35], v[48:51], v[144:147], v[32:35]
  s_lshl_b32 s41, s33, 8
  s_add_u32 s41, s41, s34
  s_add_u32 s41, s41, 0x4000000
  s_add_u32 s42, s78, 1
  v_mov_b32 v240, s41
  v_mov_b32 v241, s42
  s_mov_b64 exec, 1
  buffer_store_byte v241, v240, s[20:23], 0 offen sc1
  s_mov_b64 exec, -1
  v_mfma_f32_16x16x32_bf16 v[40:43], v[48:51], v[148:151], v[40:43]
  ds_read_b64_tr_b16 v[20:21], v4 offset:16384
  ds_read_b64_tr_b16 v[22:23], v4 offset:18432
  v_mfma_f32_16x16x32_bf16 v[36:39], v[52:55], v[144:147], v[36:39]
  v_mfma_f32_16x16x32_bf16 v[44:47], v[52:55], v[148:151], v[44:47]
  ds_read_b64_tr_b16 v[24:25], v3 offset:20480
  ds_read_b64_tr_b16 v[26:27], v3 offset:22528
  v_mfma_f32_16x16x32_bf16 v[32:35], v[56:59], v[152:155], v[32:35]
  v_mfma_f32_16x16x32_bf16 v[40:43], v[56:59], v[156:159], v[40:43]
  ds_read_b64_tr_b16 v[28:29], v4 offset:20480
  ds_read_b64_tr_b16 v[30:31], v4 offset:22528
  v_mfma_f32_16x16x32_bf16 v[36:39], v[60:63], v[152:155], v[36:39]
  v_mfma_f32_16x16x32_bf16 v[44:47], v[60:63], v[156:159], v[44:47]
  ds_read_b64_tr_b16 v[48:49], v3 offset:24576
  ds_read_b64_tr_b16 v[50:51], v3 offset:26624
  s_waitcnt lgkmcnt(8)
  v_mfma_f32_16x16x32_bf16 v[32:35], v[16:19], v[160:163], v[32:35]
  v_mfma_f32_16x16x32_bf16 v[40:43], v[16:19], v[164:167], v[40:43]
  ds_read_b64_tr_b16 v[52:53], v4 offset:24576
  ds_read_b64_tr_b16 v[54:55], v4 offset:26624
  s_waitcnt lgkmcnt(8)
  v_mfma_f32_16x16x32_bf16 v[36:39], v[20:23], v[160:163], v[36:39]
  v_mfma_f32_16x16x32_bf16 v[44:47], v[20:23], v[164:167], v[44:47]
  ds_read_b64_tr_b16 v[56:57], v3 offset:28672
  ds_read_b64_tr_b16 v[58:59], v3 offset:30720
  s_waitcnt lgkmcnt(8)
  v_mfma_f32_16x16x32_bf16 v[32:35], v[24:27], v[168:171], v[32:35]
  v_mfma_f32_16x16x32_bf16 v[40:43], v[24:27], v[172:175], v[40:43]
  ds_read_b64_tr_b16 v[60:61], v4 offset:28672
  ds_read_b64_tr_b16 v[62:63], v4 offset:30720
  s_waitcnt lgkmcnt(8)
  v_mfma_f32_16x16x32_bf16 v[36:39], v[28:31], v[168:171], v[36:39]
  v_mfma_f32_16x16x32_bf16 v[44:47], v[28:31], v[172:175], v[44:47]
  s_waitcnt lgkmcnt(6)
  v_mfma_f32_16x16x32_bf16 v[32:35], v[48:51], v[176:179], v[32:35]
  v_mfma_f32_16x16x32_bf16 v[40:43], v[48:51], v[180:183], v[40:43]
  s_waitcnt lgkmcnt(4)
  v_mfma_f32_16x16x32_bf16 v[36:39], v[52:55], v[176:179], v[36:39]
  v_mfma_f32_16x16x32_bf16 v[44:47], v[52:55], v[180:183], v[44:47]
  s_waitcnt lgkmcnt(2)
  v_mfma_f32_16x16x32_bf16 v[32:35], v[56:59], v[184:187], v[32:35]
  v_mfma_f32_16x16x32_bf16 v[40:43], v[56:59], v[188:191], v[40:43]
  s_waitcnt lgkmcnt(0)
  v_mfma_f32_16x16x32_bf16 v[36:39], v[60:63], v[184:187], v[36:39]
  v_mfma_f32_16x16x32_bf16 v[44:47], v[60:63], v[188:191], v[44:47]
  s_nop 3
  v_cvt_pk_bf16_f32 v10, v32, v33
  v_cvt_pk_bf16_f32 v11, v34, v35
  s_nop 0
  v_cvt_pk_bf16_f32 v12, v36, v37
  v_cvt_pk_bf16_f32 v13, v38, v39
  s_add_u32 s40, s73, 0x4c00
  buffer_store_dwordx4 v[10:13], v2, s[20:23], s40 offen sc1
  s_nop 1
  v_cvt_pk_bf16_f32 v10, v40, v41
  v_cvt_pk_bf16_f32 v11, v42, v43
  v_cvt_pk_bf16_f32 v12, v44, v45
  v_cvt_pk_bf16_f32 v13, v46, v47
  s_add_u32 s40, s73, 0x5400
  buffer_store_dwordx4 v[10:13], v2, s[20:23], s40 offen sc1
  s_lshl_b32 s41, s33, 8
  s_add_u32 s41, s41, 0x4000000
  v_mov_b32 v238, s41
  v_and_b32 v239, 15, v0
  v_mul_u32_u24 v239, 2304, v239
  v_lshrrev_b32 v232, 4, v0
  v_lshl_add_u32 v239, v232, 4, v239
  buffer_load_dwordx2 v[236:237], v238, s[20:23], 0 offen sc1
  s_waitcnt vmcnt(0)
  s_barrier
  s_lshl_b32 s41, s33, 8
  s_add_u32 s41, s41, s34
  s_add_u32 s41, s41, 0x4000000
  s_add_u32 s42, s78, 2
  v_mov_b32 v240, s41
  v_mov_b32 v241, s42
  s_mov_b64 exec, 1
  buffer_store_byte v241, v240, s[20:23], 0 offen sc1
  s_mov_b64 exec, -1
  s_branch L_tail
L_Ab:
  s_mov_b32 s37, s32
  s_mov_b32 s36, 0
  s_mov_b32 s88, 0x3e0293ee
  s_mov_b32 s89, 0x3e0293ee
  v_lshrrev_b32 v19, 4, v0
  v_bfe_u32 v20, v0, 2, 2
  v_lshl_add_u32 v21, v19, 3, v20
  v_lshlrev_b32 v21, 8, v21
  v_and_b32 v19, 1, v19
  v_lshl_add_u32 v20, v19, 2, v20
  v_and_b32 v19, 3, v0
  v_lshl_add_u32 v21, v19, 3, v21
  v_xor_b32 v19, 4, v20
  v_lshl_add_u32 v40, v19, 5, v21
  v_xor_b32 v19, 5, v20
  v_lshl_add_u32 v41, v19, 5, v21
  v_bfe_u32 v19, v0, 1, 3
  v_lshrrev_b32 v20, 4, v0
  v_xor_b32 v19, v19, v20
  v_lshlrev_b32 v19, 4, v19
  v_and_b32 v20, 15, v0
  v_lshl_add_u32 v44, v20, 7, v19
  v_lshlrev_b32 v46, 4, v0
  v_lshrrev_b32 v19, 5, v0
  v_lshl_add_u32 v19, v19, 4, v20
  v_lshlrev_b32 v19, 4, v19
  v_bfe_u32 v20, v0, 4, 1
  v_lshl_add_u32 v19, v20, 3, v19
  v_add_u32 v47, 0x1e800, v19
  s_mul_i32 s38, s37, 3072
  s_mul_i32 s39, s37, 12288
  s_mul_i32 s40, s37, 6144
  v_add_u32 v44, s40, v44
  v_add_u32 v46, s38, v46
  v_add_u32 v47, s39, v47
  v_xor_b32 v45, 64, v44
  v_lshrrev_b32 v19, 4, v0
  v_bfe_u32 v20, v0, 2, 2
  v_lshl_add_u32 v21, v19, 3, v20
  v_lshlrev_b32 v21, 8, v21
  v_and_b32 v19, 1, v19
  v_lshl_add_u32 v20, v19, 2, v20
  v_and_b32 v19, 3, v0
  v_lshl_add_u32 v21, v19, 3, v21
  v_add_u32 v21, 92160, v21
  v_xor_b32 v19, 0, v20
  v_lshl_add_u32 v2, v19, 5, v21
  v_xor_b32 v19, 1, v20
  v_lshl_add_u32 v3, v19, 5, v21
  v_xor_b32 v19, 2, v20
  v_lshl_add_u32 v4, v19, 5, v21
  v_xor_b32 v19, 3, v20
  v_lshl_add_u32 v5, v19, 5, v21
  v_xor_b32 v19, 4, v20
  v_lshl_add_u32 v6, v19, 5, v21
  v_xor_b32 v19, 5, v20
  v_lshl_add_u32 v7, v19, 5, v21
  v_xor_b32 v19, 6, v20
  v_lshl_add_u32 v8, v19, 5, v21
  v_xor_b32 v19, 7, v20
  v_lshl_add_u32 v9, v19, 5, v21
  v_bfe_u32 v19, v0, 2, 2
  v_and_b32 v20, 3, v0
  v_lshl_add_u32 v21, v19, 3, v20
  v_lshlrev_b32 v21, 8, v21
  v_add_u32 v21, 59392, v21
  v_and_b32 v19, 7, v0
  v_lshlrev_b32 v19, 1, v19
  v_lshrrev_b32 v20, 4, v0
  v_xor_b32 v19, v19, v20
  v_xor_b32 v20, 0, v19
  v_lshl_add_u32 v10, v20, 4, v21
  v_xor_b32 v20, 4, v19
  v_lshl_add_u32 v11, v20, 4, v21
  v_xor_b32 v20, 8, v19
  v_lshl_add_u32 v12, v20, 4, v21
  v_xor_b32 v20, 12, v19
  v_lshl_add_u32 v13, v20, 4, v21
  v_lshlrev_b32 v14, 4, v0
  s_lshl_b32 s38, s37, 13
  s_add_u32 s38, s38, 0x1e800
  v_add_u32 v18, s38, v14
  v_mov_b32 v15, 0
  v_mov_b32 v16, 0
  s_waitcnt lgkmcnt(0)
  s_barrier
  v_add_u32 v44, 0xa000, v44
  v_add_u32 v45, 0xa000, v45
  ds_read_b64_tr_b16 v[56:57], v40
  ds_read_b64_tr_b16 v[58:59], v40 offset:1024
  ds_read_b64_tr_b16 v[60:61], v41
  ds_read_b64_tr_b16 v[62:63], v41 offset:1024
  ds_read_b128 v[72:75], v44
  ds_read_b128 v[76:79], v44 offset:2048
  ds_read_b128 v[80:83], v44 offset:4096
  s_waitcnt lgkmcnt(2)
  v_mfma_f32_16x16x32_bf16 v[192:195], v[56:59], v[72:75], 0
  ds_read_b64_tr_b16 v[108:109], v40 offset:8192
  ds_read_b64_tr_b16 v[110:111], v40 offset:9216
  v_mfma_f32_16x16x32_bf16 v[204:207], v[60:63], v[72:75], 0
  ds_read_b64_tr_b16 v[112:113], v41 offset:8192
  ds_read_b64_tr_b16 v[114:115], v41 offset:9216
  s_waitcnt lgkmcnt(5)
  v_mfma_f32_16x16x32_bf16 v[196:199], v[56:59], v[76:79], 0
  ds_read_b128 v[96:99], v45
  ds_read_b128 v[100:103], v45 offset:2048
  v_mfma_f32_16x16x32_bf16 v[208:211], v[60:63], v[76:79], 0
  ds_read_b128 v[104:107], v45 offset:4096
  s_waitcnt lgkmcnt(7)
  v_mfma_f32_16x16x32_bf16 v[200:203], v[56:59], v[80:83], 0
  v_mfma_f32_16x16x32_bf16 v[212:215], v[60:63], v[80:83], 0
  s_waitcnt lgkmcnt(2)
  v_mfma_f32_16x16x32_bf16 v[192:195], v[108:111], v[96:99], v[192:195]
  v_mfma_f32_16x16x32_bf16 v[204:207], v[112:115], v[96:99], v[204:207]
  s_waitcnt lgkmcnt(1)
  v_mfma_f32_16x16x32_bf16 v[196:199], v[108:111], v[100:103], v[196:199]
  v_mfma_f32_16x16x32_bf16 v[208:211], v[112:115], v[100:103], v[208:211]
  s_waitcnt lgkmcnt(0)
  v_mfma_f32_16x16x32_bf16 v[200:203], v[108:111], v[104:107], v[200:203]
  v_mfma_f32_16x16x32_bf16 v[212:215], v[112:115], v[104:107], v[212:215]
  s_waitcnt lgkmcnt(0)
  s_barrier
  ds_read_b64_tr_b16 v[56:57], v40 offset:16384
  ds_read_b64_tr_b16 v[58:59], v40 offset:17408
  ds_read_b64_tr_b16 v[60:61], v41 offset:16384
  ds_read_b64_tr_b16 v[62:63], v41 offset:17408
  ds_read_b128 v[72:75], v44 offset:26624
  ds_read_b128 v[76:79], v44 offset:28672
  ds_read_b128 v[80:83], v44 offset:30720
  s_waitcnt lgkmcnt(2)
  v_mfma_f32_16x16x32_bf16 v[192:195], v[56:59], v[72:75], v[192:195]
  ds_read_b64_tr_b16 v[108:109], v40 offset:24576
  ds_read_b64_tr_b16 v[110:111], v40 offset:25600
  v_mfma_f32_16x16x32_bf16 v[204:207], v[60:63], v[72:75], v[204:207]
  ds_read_b64_tr_b16 v[112:113], v41 offset:24576
  ds_read_b64_tr_b16 v[114:115], v41 offset:25600
  s_waitcnt lgkmcnt(5)
  v_mfma_f32_16x16x32_bf16 v[196:199], v[56:59], v[76:79], v[196:199]
  ds_read_b128 v[96:99], v45 offset:26624
  ds_read_b128 v[100:103], v45 offset:28672
  v_mfma_f32_16x16x32_bf16 v[208:211], v[60:63], v[76:79], v[208:211]
  ds_read_b128 v[104:107], v45 offset:30720
  s_waitcnt lgkmcnt(7)
  v_mfma_f32_16x16x32_bf16 v[200:203], v[56:59], v[80:83], v[200:203]
  v_mfma_f32_16x16x32_bf16 v[212:215], v[60:63], v[80:83], v[212:215]
  s_waitcnt lgkmcnt(2)
  v_mfma_f32_16x16x32_bf16 v[192:195], v[108:111], v[96:99], v[192:195]
  v_mfma_f32_16x16x32_bf16 v[204:207], v[112:115], v[96:99], v[204:207]
  s_waitcnt lgkmcnt(1)
  v_mfma_f32_16x16x32_bf16 v[196:199], v[108:111], v[100:103], v[196:199]
  v_mfma_f32_16x16x32_bf16 v[208:211], v[112:115], v[100:103], v[208:211]
  s_waitcnt lgkmcnt(0)
  v_mfma_f32_16x16x32_bf16 v[200:203], v[108:111], v[104:107], v[200:203]
  v_mfma_f32_16x16x32_bf16 v[212:215], v[112:115], v[104:107], v[212:215]
  s_waitcnt lgkmcnt(0)
  s_barrier
  v_add_u32 v40, 0x1e800, v40
  v_add_u32 v41, 0x1e800, v41
  v_add_u32 v44, 0x14800, v44
  v_add_u32 v45, 0x14800, v45
  ds_read_b64_tr_b16 v[56:57], v40
  ds_read_b64_tr_b16 v[58:59], v40 offset:1024
  ds_read_b64_tr_b16 v[60:61], v41
  ds_read_b64_tr_b16 v[62:63], v41 offset:1024
  ds_read_b128 v[72:75], v44 offset:16384
  ds_read_b128 v[76:79], v44 offset:18432
  ds_read_b128 v[80:83], v44 offset:20480
  s_waitcnt lgkmcnt(2)
  v_mfma_f32_16x16x32_bf16 v[192:195], v[56:59], v[72:75], v[192:195]
  ds_read_b64_tr_b16 v[108:109], v40 offset:8192
  ds_read_b64_tr_b16 v[110:111], v40 offset:9216
  v_mfma_f32_16x16x32_bf16 v[204:207], v[60:63], v[72:75], v[204:207]
  ds_read_b64_tr_b16 v[112:113], v41 offset:8192
  ds_read_b64_tr_b16 v[114:115], v41 offset:9216
  s_waitcnt lgkmcnt(5)
  v_mfma_f32_16x16x32_bf16 v[196:199], v[56:59], v[76:79], v[196:199]
  ds_read_b128 v[96:99], v45 offset:16384
  ds_read_b128 v[100:103], v45 offset:18432
  v_mfma_f32_16x16x32_bf16 v[208:211], v[60:63], v[76:79], v[208:211]
  ds_read_b128 v[104:107], v45 offset:20480
  s_waitcnt lgkmcnt(7)
  v_mfma_f32_16x16x32_bf16 v[200:203], v[56:59], v[80:83], v[200:203]
  v_mfma_f32_16x16x32_bf16 v[212:215], v[60:63], v[80:83], v[212:215]
  s_waitcnt lgkmcnt(2)
  v_mfma_f32_16x16x32_bf16 v[192:195], v[108:111], v[96:99], v[192:195]
  v_mfma_f32_16x16x32_bf16 v[204:207], v[112:115], v[96:99], v[204:207]
  s_waitcnt lgkmcnt(1)
  v_mfma_f32_16x16x32_bf16 v[196:199], v[108:111], v[100:103], v[196:199]
  v_mfma_f32_16x16x32_bf16 v[208:211], v[112:115], v[100:103], v[208:211]
  s_waitcnt lgkmcnt(0)
  v_mfma_f32_16x16x32_bf16 v[200:203], v[108:111], v[104:107], v[200:203]
  v_mfma_f32_16x16x32_bf16 v[212:215], v[112:115], v[104:107], v[212:215]
  s_waitcnt lgkmcnt(0)
  s_barrier
  v_subrev_u32 v40, 0x1e800, v40
  v_subrev_u32 v41, 0x1e800, v41
  v_subrev_u32 v44, 0x14800, v44
  v_subrev_u32 v45, 0x14800, v45
  ds_read_b64_tr_b16 v[56:57], v40
  ds_read_b64_tr_b16 v[58:59], v40 offset:1024
  ds_read_b64_tr_b16 v[60:61], v41
  ds_read_b64_tr_b16 v[62:63], v41 offset:1024
  ds_read_b128 v[72:75], v44
  ds_read_b128 v[76:79], v44 offset:2048
  ds_read_b128 v[80:83], v44 offset:4096
  s_waitcnt lgkmcnt(2)
  v_mfma_f32_16x16x32_bf16 v[192:195], v[56:59], v[72:75], v[192:195]
  ds_read_b64_tr_b16 v[108:109], v40 offset:8192
  ds_read_b64_tr_b16 v[110:111], v40 offset:9216
  v_mfma_f32_16x16x32_bf16 v[204:207], v[60:63], v[72:75], v[204:207]
  ds_read_b64_tr_b16 v[112:113], v41 offset:8192
  ds_read_b64_tr_b16 v[114:115], v41 offset:9216
  s_waitcnt lgkmcnt(5)
  v_mfma_f32_16x16x32_bf16 v[196:199], v[56:59], v[76:79], v[196:199]
  ds_read_b128 v[96:99], v45
  ds_read_b128 v[100:103], v45 offset:2048
  v_mfma_f32_16x16x32_bf16 v[208:211], v[60:63], v[76:79], v[208:211]
  ds_read_b128 v[104:107], v45 offset:4096
  s_waitcnt lgkmcnt(7)
  v_mfma_f32_16x16x32_bf16 v[200:203], v[56:59], v[80:83], v[200:203]
  v_mfma_f32_16x16x32_bf16 v[212:215], v[60:63], v[80:83], v[212:215]
  s_waitcnt lgkmcnt(2)
  v_mfma_f32_16x16x32_bf16 v[192:195], v[108:111], v[96:99], v[192:195]
  v_mfma_f32_16x16x32_bf16 v[204:207], v[112:115], v[96:99], v[204:207]
  s_waitcnt lgkmcnt(1)
  v_mfma_f32_16x16x32_bf16 v[196:199], v[108:111], v[100:103], v[196:199]
  v_mfma_f32_16x16x32_bf16 v[208:211], v[112:115], v[100:103], v[208:211]
  s_waitcnt lgkmcnt(0)
  v_mfma_f32_16x16x32_bf16 v[200:203], v[108:111], v[104:107], v[200:203]
  v_mfma_f32_16x16x32_bf16 v[212:215], v[112:115], v[104:107], v[212:215]
  s_waitcnt lgkmcnt(0)
  s_barrier
  ds_read_b64_tr_b16 v[56:57], v40 offset:16384
  ds_read_b64_tr_b16 v[58:59], v40 offset:17408
  ds_read_b64_tr_b16 v[60:61], v41 offset:16384
  ds_read_b64_tr_b16 v[62:63], v41 offset:17408
  ds_read_b128 v[72:75], v44 offset:26624
  ds_read_b128 v[76:79], v44 offset:28672
  ds_read_b128 v[80:83], v44 offset:30720
  s_waitcnt lgkmcnt(2)
  v_mfma_f32_16x16x32_bf16 v[192:195], v[56:59], v[72:75], v[192:195]
  ds_read_b64_tr_b16 v[108:109], v40 offset:24576
  ds_read_b64_tr_b16 v[110:111], v40 offset:25600
  v_mfma_f32_16x16x32_bf16 v[204:207], v[60:63], v[72:75], v[204:207]
  ds_read_b64_tr_b16 v[112:113], v41 offset:24576
  ds_read_b64_tr_b16 v[114:115], v41 offset:25600
  s_waitcnt lgkmcnt(5)
  v_mfma_f32_16x16x32_bf16 v[196:199], v[56:59], v[76:79], v[196:199]
  ds_read_b128 v[96:99], v45 offset:26624
  ds_read_b128 v[100:103], v45 offset:28672
  v_mfma_f32_16x16x32_bf16 v[208:211], v[60:63], v[76:79], v[208:211]
  ds_read_b128 v[104:107], v45 offset:30720
  s_waitcnt lgkmcnt(7)
  v_mfma_f32_16x16x32_bf16 v[200:203], v[56:59], v[80:83], v[200:203]
  v_mfma_f32_16x16x32_bf16 v[212:215], v[60:63], v[80:83], v[212:215]
  s_waitcnt lgkmcnt(2)
  v_mfma_f32_16x16x32_bf16 v[192:195], v[108:111], v[96:99], v[192:195]
  v_mfma_f32_16x16x32_bf16 v[204:207], v[112:115], v[96:99], v[204:207]
  s_waitcnt lgkmcnt(1)
  v_mfma_f32_16x16x32_bf16 v[196:199], v[108:111], v[100:103], v[196:199]
  v_mfma_f32_16x16x32_bf16 v[208:211], v[112:115], v[100:103], v[208:211]
  s_waitcnt lgkmcnt(0)
  v_mfma_f32_16x16x32_bf16 v[200:203], v[108:111], v[104:107], v[200:203]
  v_mfma_f32_16x16x32_bf16 v[212:215], v[112:115], v[104:107], v[212:215]
  s_waitcnt lgkmcnt(0)
  s_barrier
  v_add_u32 v40, 0x1e800, v40
  v_add_u32 v41, 0x1e800, v41
  v_add_u32 v44, 0x14800, v44
  v_add_u32 v45, 0x14800, v45
  ds_read_b64_tr_b16 v[56:57], v40
  ds_read_b64_tr_b16 v[58:59], v40 offset:1024
  ds_read_b64_tr_b16 v[60:61], v41
  ds_read_b64_tr_b16 v[62:63], v41 offset:1024
  ds_read_b128 v[72:75], v44 offset:16384
  ds_read_b128 v[76:79], v44 offset:18432
  ds_read_b128 v[80:83], v44 offset:20480
  s_waitcnt lgkmcnt(2)
  v_mfma_f32_16x16x32_bf16 v[192:195], v[56:59], v[72:75], v[192:195]
  ds_read_b64_tr_b16 v[108:109], v40 offset:8192
  ds_read_b64_tr_b16 v[110:111], v40 offset:9216
  v_mfma_f32_16x16x32_bf16 v[204:207], v[60:63], v[72:75], v[204:207]
  ds_read_b64_tr_b16 v[112:113], v41 offset:8192
  ds_read_b64_tr_b16 v[114:115], v41 offset:9216
  s_waitcnt lgkmcnt(5)
  v_mfma_f32_16x16x32_bf16 v[196:199], v[56:59], v[76:79], v[196:199]
  ds_read_b128 v[96:99], v45 offset:16384
  ds_read_b128 v[100:103], v45 offset:18432
  v_mfma_f32_16x16x32_bf16 v[208:211], v[60:63], v[76:79], v[208:211]
  ds_read_b128 v[104:107], v45 offset:20480
  s_waitcnt lgkmcnt(7)
  v_mfma_f32_16x16x32_bf16 v[200:203], v[56:59], v[80:83], v[200:203]
  v_mfma_f32_16x16x32_bf16 v[212:215], v[60:63], v[80:83], v[212:215]
  s_waitcnt lgkmcnt(2)
  v_mfma_f32_16x16x32_bf16 v[192:195], v[108:111], v[96:99], v[192:195]
  v_mfma_f32_16x16x32_bf16 v[204:207], v[112:115], v[96:99], v[204:207]
  s_waitcnt lgkmcnt(1)
  v_mfma_f32_16x16x32_bf16 v[196:199], v[108:111], v[100:103], v[196:199]
  v_mfma_f32_16x16x32_bf16 v[208:211], v[112:115], v[100:103], v[208:211]
  s_waitcnt lgkmcnt(0)
  v_mfma_f32_16x16x32_bf16 v[200:203], v[108:111], v[104:107], v[200:203]
  v_mfma_f32_16x16x32_bf16 v[212:215], v[112:115], v[104:107], v[212:215]
  s_waitcnt lgkmcnt(0)
  s_barrier
  v_subrev_u32 v40, 0x1e800, v40
  v_subrev_u32 v41, 0x1e800, v41
  v_subrev_u32 v44, 0x14800, v44
  v_subrev_u32 v45, 0x14800, v45
  ds_read_b64_tr_b16 v[56:57], v40
  ds_read_b64_tr_b16 v[58:59], v40 offset:1024
  ds_read_b64_tr_b16 v[60:61], v41
  ds_read_b64_tr_b16 v[62:63], v41 offset:1024
  ds_read_b128 v[72:75], v44
  ds_read_b128 v[76:79], v44 offset:2048
  ds_read_b128 v[80:83], v44 offset:4096
  s_waitcnt lgkmcnt(2)
  v_mfma_f32_16x16x32_bf16 v[192:195], v[56:59], v[72:75], v[192:195]
  ds_read_b64_tr_b16 v[108:109], v40 offset:8192
  ds_read_b64_tr_b16 v[110:111], v40 offset:9216
  v_mfma_f32_16x16x32_bf16 v[204:207], v[60:63], v[72:75], v[204:207]
  ds_read_b64_tr_b16 v[112:113], v41 offset:8192
  ds_read_b64_tr_b16 v[114:115], v41 offset:9216
  s_waitcnt lgkmcnt(5)
  v_mfma_f32_16x16x32_bf16 v[196:199], v[56:59], v[76:79], v[196:199]
  ds_read_b128 v[96:99], v45
  ds_read_b128 v[100:103], v45 offset:2048
  v_mfma_f32_16x16x32_bf16 v[208:211], v[60:63], v[76:79], v[208:211]
  ds_read_b128 v[104:107], v45 offset:4096
  s_waitcnt lgkmcnt(7)
  v_mfma_f32_16x16x32_bf16 v[200:203], v[56:59], v[80:83], v[200:203]
  v_mfma_f32_16x16x32_bf16 v[212:215], v[60:63], v[80:83], v[212:215]
  s_waitcnt lgkmcnt(2)
  v_mfma_f32_16x16x32_bf16 v[192:195], v[108:111], v[96:99], v[192:195]
  v_mfma_f32_16x16x32_bf16 v[204:207], v[112:115], v[96:99], v[204:207]
  s_waitcnt lgkmcnt(1)
  v_mfma_f32_16x16x32_bf16 v[196:199], v[108:111], v[100:103], v[196:199]
  v_mfma_f32_16x16x32_bf16 v[208:211], v[112:115], v[100:103], v[208:211]
  s_waitcnt lgkmcnt(0)
  v_mfma_f32_16x16x32_bf16 v[200:203], v[108:111], v[104:107], v[200:203]
  v_mfma_f32_16x16x32_bf16 v[212:215], v[112:115], v[104:107], v[212:215]
  s_waitcnt lgkmcnt(0)
  s_barrier
  ds_read_b64_tr_b16 v[56:57], v40 offset:16384
  ds_read_b64_tr_b16 v[58:59], v40 offset:17408
  ds_read_b64_tr_b16 v[60:61], v41 offset:16384
  ds_read_b64_tr_b16 v[62:63], v41 offset:17408
  ds_read_b128 v[72:75], v44 offset:26624
  ds_read_b128 v[76:79], v44 offset:28672
  ds_read_b128 v[80:83], v44 offset:30720
  s_waitcnt lgkmcnt(2)
  v_mfma_f32_16x16x32_bf16 v[192:195], v[56:59], v[72:75], v[192:195]
  ds_read_b64_tr_b16 v[108:109], v40 offset:24576
  ds_read_b64_tr_b16 v[110:111], v40 offset:25600
  v_mfma_f32_16x16x32_bf16 v[204:207], v[60:63], v[72:75], v[204:207]
  ds_read_b64_tr_b16 v[112:113], v41 offset:24576
  ds_read_b64_tr_b16 v[114:115], v41 offset:25600
  s_waitcnt lgkmcnt(5)
  v_mfma_f32_16x16x32_bf16 v[196:199], v[56:59], v[76:79], v[196:199]
  ds_read_b128 v[96:99], v45 offset:26624
  ds_read_b128 v[100:103], v45 offset:28672
  v_mfma_f32_16x16x32_bf16 v[208:211], v[60:63], v[76:79], v[208:211]
  ds_read_b128 v[104:107], v45 offset:30720
  s_waitcnt lgkmcnt(7)
  v_mfma_f32_16x16x32_bf16 v[200:203], v[56:59], v[80:83], v[200:203]
  v_mfma_f32_16x16x32_bf16 v[212:215], v[60:63], v[80:83], v[212:215]
  s_waitcnt lgkmcnt(2)
  v_mfma_f32_16x16x32_bf16 v[192:195], v[108:111], v[96:99], v[192:195]
  v_mfma_f32_16x16x32_bf16 v[204:207], v[112:115], v[96:99], v[204:207]
  s_waitcnt lgkmcnt(1)
  v_mfma_f32_16x16x32_bf16 v[196:199], v[108:111], v[100:103], v[196:199]
  v_mfma_f32_16x16x32_bf16 v[208:211], v[112:115], v[100:103], v[208:211]
  s_waitcnt lgkmcnt(0)
  v_mfma_f32_16x16x32_bf16 v[200:203], v[108:111], v[104:107], v[200:203]
  v_mfma_f32_16x16x32_bf16 v[212:215], v[112:115], v[104:107], v[212:215]
  s_waitcnt lgkmcnt(0)
  s_barrier
  v_add_u32 v40, 0x1e800, v40
  v_add_u32 v41, 0x1e800, v41
  v_add_u32 v44, 0x14800, v44
  v_add_u32 v45, 0x14800, v45
  ds_read_b64_tr_b16 v[56:57], v40
  ds_read_b64_tr_b16 v[58:59], v40 offset:1024
  ds_read_b64_tr_b16 v[60:61], v41
  ds_read_b64_tr_b16 v[62:63], v41 offset:1024
  ds_read_b128 v[72:75], v44 offset:16384
  ds_read_b128 v[76:79], v44 offset:18432
  ds_read_b128 v[80:83], v44 offset:20480
  s_waitcnt lgkmcnt(2)
  v_mfma_f32_16x16x32_bf16 v[192:195], v[56:59], v[72:75], v[192:195]
  ds_read_b64_tr_b16 v[108:109], v40 offset:8192
  ds_read_b64_tr_b16 v[110:111], v40 offset:9216
  v_mfma_f32_16x16x32_bf16 v[204:207], v[60:63], v[72:75], v[204:207]
  ds_read_b64_tr_b16 v[112:113], v41 offset:8192
  ds_read_b64_tr_b16 v[114:115], v41 offset:9216
  s_waitcnt lgkmcnt(5)
  v_mfma_f32_16x16x32_bf16 v[196:199], v[56:59], v[76:79], v[196:199]
  ds_read_b128 v[96:99], v45 offset:16384
  ds_read_b128 v[100:103], v45 offset:18432
  v_mfma_f32_16x16x32_bf16 v[208:211], v[60:63], v[76:79], v[208:211]
  ds_read_b128 v[104:107], v45 offset:20480
  s_waitcnt lgkmcnt(7)
  v_mfma_f32_16x16x32_bf16 v[200:203], v[56:59], v[80:83], v[200:203]
  v_mfma_f32_16x16x32_bf16 v[212:215], v[60:63], v[80:83], v[212:215]
  s_waitcnt lgkmcnt(2)
  v_mfma_f32_16x16x32_bf16 v[192:195], v[108:111], v[96:99], v[192:195]
  v_mfma_f32_16x16x32_bf16 v[204:207], v[112:115], v[96:99], v[204:207]
  s_waitcnt lgkmcnt(1)
  v_mfma_f32_16x16x32_bf16 v[196:199], v[108:111], v[100:103], v[196:199]
  v_mfma_f32_16x16x32_bf16 v[208:211], v[112:115], v[100:103], v[208:211]
  s_waitcnt lgkmcnt(0)
  v_mfma_f32_16x16x32_bf16 v[200:203], v[108:111], v[104:107], v[200:203]
  v_mfma_f32_16x16x32_bf16 v[212:215], v[112:115], v[104:107], v[212:215]
  s_waitcnt lgkmcnt(0)
  s_barrier
  v_subrev_u32 v40, 0x1e800, v40
  v_subrev_u32 v41, 0x1e800, v41
  v_pk_mul_f32 v[192:193], v[192:193], s[88:89]
  v_pk_mul_f32 v[194:195], v[194:195], s[88:89]
  v_cvt_pk_bf16_f32 v88, v192, v193
  v_cvt_pk_bf16_f32 v89, v194, v195
  ds_write_b64 v47, v[88:89] offset:2048
  v_pk_mul_f32 v[204:205], v[204:205], s[88:89]
  v_pk_mul_f32 v[206:207], v[206:207], s[88:89]
  v_cvt_pk_bf16_f32 v90, v204, v205
  v_cvt_pk_bf16_f32 v91, v206, v207
  ds_write_b64 v47, v[90:91] offset:2560
  v_pk_mul_f32 v[196:197], v[196:197], s[88:89]
  v_pk_mul_f32 v[198:199], v[198:199], s[88:89]
  v_cvt_pk_bf16_f32 v92, v196, v197
  v_cvt_pk_bf16_f32 v93, v198, v199
  ds_write_b64 v47, v[92:93] offset:6144
  v_pk_mul_f32 v[208:209], v[208:209], s[88:89]
  v_pk_mul_f32 v[210:211], v[210:211], s[88:89]
  v_cvt_pk_bf16_f32 v94, v208, v209
  v_cvt_pk_bf16_f32 v95, v210, v211
  ds_write_b64 v47, v[94:95] offset:6656
  v_pk_mul_f32 v[200:201], v[200:201], s[88:89]
  v_pk_mul_f32 v[202:203], v[202:203], s[88:89]
  v_cvt_pk_bf16_f32 v88, v200, v201
  v_cvt_pk_bf16_f32 v89, v202, v203
  ds_write_b64 v47, v[88:89] offset:10240
  v_pk_mul_f32 v[212:213], v[212:213], s[88:89]
  v_pk_mul_f32 v[214:215], v[214:215], s[88:89]
  v_cvt_pk_bf16_f32 v90, v212, v213
  v_cvt_pk_bf16_f32 v91, v214, v215
  ds_write_b64 v47, v[90:91] offset:10752
  s_setprio 2
  s_waitcnt lgkmcnt(0)
  s_barrier
L_Ab_go:
  ds_read_b128 v[96:99], v18
  ds_read_b128 v[100:103], v18 offset:1024
  ds_read_b128 v[104:107], v18 offset:2048
  ds_read_b128 v[108:111], v18 offset:3072
  ds_read_b128 v[56:59], v10
  ds_read_b128 v[60:63], v10 offset:1024
  ds_read_b128 v[64:67], v11
  ds_read_b128 v[68:71], v11 offset:1024
  ds_read_b128 v[72:75], v12
  ds_read_b128 v[76:79], v12 offset:1024
  ds_read_b128 v[80:83], v13
  ds_read_b128 v[84:87], v13 offset:1024
  ds_read_b128 v[112:115], v18 offset:4096
  ds_read_b128 v[116:119], v18 offset:5120
  ds_read_b128 v[120:123], v18 offset:6144
  s_waitcnt lgkmcnt(14)
  ds_read_b128 v[124:127], v18 offset:7168
  s_mov_b32 s61, 4
  s_waitcnt lgkmcnt(11)
  v_mfma_f32_16x16x32_bf16 v[40:43], v[56:59], v[96:99], 0
  s_waitcnt lgkmcnt(10)
  v_mfma_f32_16x16x32_bf16 v[48:51], v[60:63], v[96:99], 0
  s_waitcnt lgkmcnt(0)
  ds_write_b128 v18, v[192:195]
  ds_write_b128 v18, v[200:203] offset:1024
  v_mfma_f32_16x16x32_bf16 v[40:43], v[64:67], v[100:103], v[40:43]
  ds_write_b128 v18, v[208:211] offset:2048
  v_mfma_f32_16x16x32_bf16 v[48:51], v[68:71], v[100:103], v[48:51]
  ds_write_b128 v18, v[216:219] offset:3072
  v_mfma_f32_16x16x32_bf16 v[40:43], v[72:75], v[104:107], v[40:43]
  ds_write_b128 v18, v[224:227] offset:4096
  v_mfma_f32_16x16x32_bf16 v[48:51], v[76:79], v[104:107], v[48:51]
  ds_write_b128 v18, v[232:235] offset:5120
  v_mfma_f32_16x16x32_bf16 v[40:43], v[80:83], v[108:111], v[40:43]
  ds_write_b128 v18, v[240:243] offset:6144
  v_mfma_f32_16x16x32_bf16 v[48:51], v[84:87], v[108:111], v[48:51]
  ds_write_b128 v18, v[248:251] offset:7168
  v_mfma_f32_16x16x32_bf16 v[44:47], v[56:59], v[112:115], 0
  ds_read_b64_tr_b16 v[88:89], v2
  ds_read_b64_tr_b16 v[90:91], v2 offset:1024
  s_barrier
  v_mfma_f32_16x16x32_bf16 v[52:55], v[60:63], v[112:115], 0
  ds_read_b64_tr_b16 v[92:93], v3
  ds_read_b64_tr_b16 v[94:95], v3 offset:1024
  v_mfma_f32_16x16x32_bf16 v[44:47], v[64:67], v[116:119], v[44:47]
  ds_read_b64_tr_b16 v[64:65], v4
  ds_read_b64_tr_b16 v[66:67], v4 offset:1024
  v_max3_f32 v19, v40, v41, v42
  v_max3_f32 v19, v19, v43, v48
  v_max3_f32 v19, v19, v49, v50
  v_max_f32 v19, v19, v51
  v_mov_b32 v22, v19
  s_nop 1
  v_permlane32_swap_b32 v19, v22
  v_max_f32 v19, v19, v22
  v_mov_b32 v22, v19
  s_nop 1
  v_permlane16_swap_b32 v19, v22
  v_max_f32 v19, v19, v22
  v_sub_f32 v40, v40, v19
  v_sub_f32 v41, v41, v19
  v_sub_f32 v42, v42, v19
  v_sub_f32 v43, v43, v19
  v_sub_f32 v48, v48, v19
  v_sub_f32 v49, v49, v19
  v_sub_f32 v50, v50, v19
  v_sub_f32 v51, v51, v19
  v_sub_f32 v24, 0, v19
  v_sub_f32 v25, 0, v19
  v_sub_f32 v26, 0, v19
  v_sub_f32 v27, 0, v19
  v_exp_f32 v40, v40
  v_exp_f32 v41, v41
  v_exp_f32 v42, v42
  v_cvt_pk_bf16_f32 v32, v40, v41
  v_exp_f32 v43, v43
  v_exp_f32 v48, v48
  v_cvt_pk_bf16_f32 v33, v42, v43
  v_exp_f32 v49, v49
  v_exp_f32 v50, v50
  v_cvt_pk_bf16_f32 v34, v48, v49
  v_exp_f32 v51, v51
  v_mfma_f32_16x16x32_bf16 v[52:55], v[68:71], v[116:119], v[52:55]
  ds_read_b64_tr_b16 v[68:69], v5
  s_waitcnt lgkmcnt(4)
  ds_read_b64_tr_b16 v[70:71], v5 offset:1024
  v_cvt_pk_bf16_f32 v35, v50, v51
  v_mfma_f32_16x16x32_bf16 v[44:47], v[72:75], v[120:123], v[44:47]
  ds_read_b64_tr_b16 v[72:73], v6
  ds_read_b64_tr_b16 v[74:75], v6 offset:1024
  v_mfma_f32_16x16x32_bf16 v[52:55], v[76:79], v[120:123], v[52:55]
  ds_read_b64_tr_b16 v[76:77], v7
  ds_read_b64_tr_b16 v[78:79], v7 offset:1024
  v_mfma_f32_16x16x32_bf16 v[44:47], v[80:83], v[124:127], v[44:47]
  ds_read_b64_tr_b16 v[80:81], v8
  ds_read_b64_tr_b16 v[82:83], v8 offset:1024
  v_mfma_f32_16x16x32_bf16 v[52:55], v[84:87], v[124:127], v[52:55]
  ds_read_b64_tr_b16 v[84:85], v9
  ds_read_b64_tr_b16 v[86:87], v9 offset:1024
  v_mfma_f32_16x16x32_bf16 v[192:195], v[88:91], v[32:35], 0
  v_add_f32 v15, v15, v40
  s_waitcnt lgkmcnt(10)
  v_mfma_f32_16x16x32_bf16 v[196:199], v[92:95], v[32:35], 0
  v_add_f32 v15, v15, v41
  v_add_f32 v15, v15, v42
  v_mfma_f32_16x16x32_bf16 v[200:203], v[64:67], v[32:35], 0
  s_waitcnt lgkmcnt(0)
  s_barrier
  v_max3_f32 v20, v44, v45, v46
  v_max3_f32 v20, v20, v47, v52
  v_max3_f32 v20, v20, v53, v54
  v_max_f32 v20, v20, v55
  v_mov_b32 v22, v20
  s_nop 1
  v_permlane32_swap_b32 v20, v22
  v_max_f32 v20, v20, v22
  v_mov_b32 v22, v20
  s_nop 1
  v_permlane16_swap_b32 v20, v22
  v_max_f32 v20, v20, v22
  v_sub_f32 v44, v44, v20
  v_sub_f32 v45, v45, v20
  v_sub_f32 v46, v46, v20
  v_sub_f32 v47, v47, v20
  v_sub_f32 v52, v52, v20
  v_sub_f32 v53, v53, v20
  v_sub_f32 v54, v54, v20
  v_sub_f32 v55, v55, v20
  v_sub_f32 v28, 0, v20
  v_sub_f32 v29, 0, v20
  v_sub_f32 v30, 0, v20
  v_sub_f32 v31, 0, v20
  v_exp_f32 v44, v44
  v_exp_f32 v45, v45
  v_exp_f32 v46, v46
  v_cvt_pk_bf16_f32 v36, v44, v45
  v_exp_f32 v47, v47
  v_exp_f32 v52, v52
  v_cvt_pk_bf16_f32 v37, v46, v47
  v_exp_f32 v53, v53
  v_exp_f32 v54, v54
  v_cvt_pk_bf16_f32 v38, v52, v53
  v_exp_f32 v55, v55
  v_mfma_f32_16x16x32_bf16 v[204:207], v[68:71], v[32:35], 0
  v_cvt_pk_bf16_f32 v39, v54, v55
  v_mfma_f32_16x16x32_bf16 v[208:211], v[72:75], v[32:35], 0
  s_waitcnt lgkmcnt(0)
  s_barrier
  v_mfma_f32_16x16x32_bf16 v[212:215], v[76:79], v[32:35], 0
  ds_read_b128 v[56:59], v10 offset:8192
  v_add_f32 v15, v15, v43
  v_mfma_f32_16x16x32_bf16 v[216:219], v[80:83], v[32:35], 0
  ds_read_b128 v[60:63], v10 offset:9216
  v_mfma_f32_16x16x32_bf16 v[220:223], v[84:87], v[32:35], 0
  v_add_f32 v15, v15, v48
  v_add_f32 v15, v15, v49
  v_mfma_f32_16x16x32_bf16 v[224:227], v[88:91], v[36:39], 0
  v_add_f32 v16, v16, v44
  v_add_f32 v16, v16, v45
  v_mfma_f32_16x16x32_bf16 v[228:231], v[92:95], v[36:39], 0
  v_add_f32 v16, v16, v46
  v_add_f32 v16, v16, v47
  v_mfma_f32_16x16x32_bf16 v[232:235], v[64:67], v[36:39], 0
  ds_read_b128 v[64:67], v11 offset:8192
  v_add_f32 v16, v16, v52
  v_mfma_f32_16x16x32_bf16 v[236:239], v[68:71], v[36:39], 0
  ds_read_b128 v[68:71], v11 offset:9216
  v_add_f32 v16, v16, v53
  v_mfma_f32_16x16x32_bf16 v[240:243], v[72:75], v[36:39], 0
  ds_read_b128 v[72:75], v12 offset:8192
  v_add_f32 v16, v16, v54
  v_mfma_f32_16x16x32_bf16 v[244:247], v[76:79], v[36:39], 0
  ds_read_b128 v[76:79], v12 offset:9216
  v_add_f32 v16, v16, v55
  v_mfma_f32_16x16x32_bf16 v[248:251], v[80:83], v[36:39], 0
  ds_read_b128 v[80:83], v13 offset:8192
  v_add_f32 v15, v15, v50
  v_mfma_f32_16x16x32_bf16 v[252:255], v[84:87], v[36:39], 0
  ds_read_b128 v[84:87], v13 offset:9216
  v_add_f32 v15, v15, v51
  s_branch L_Ab_T1
L_Ab_T0:
  s_waitcnt lgkmcnt(6)
  v_mfma_f32_16x16x32_bf16 v[40:43], v[56:59], v[96:99], v[24:27]
  v_mfma_f32_16x16x32_bf16 v[48:51], v[60:63], v[96:99], v[24:27]
  s_waitcnt lgkmcnt(5)
  v_mfma_f32_16x16x32_bf16 v[40:43], v[64:67], v[100:103], v[40:43]
  s_waitcnt lgkmcnt(4)
  v_mfma_f32_16x16x32_bf16 v[48:51], v[68:71], v[100:103], v[48:51]
  s_waitcnt lgkmcnt(3)
  v_mfma_f32_16x16x32_bf16 v[40:43], v[72:75], v[104:107], v[40:43]
  s_waitcnt lgkmcnt(2)
  v_mfma_f32_16x16x32_bf16 v[48:51], v[76:79], v[104:107], v[48:51]
  s_waitcnt lgkmcnt(1)
  v_mfma_f32_16x16x32_bf16 v[40:43], v[80:83], v[108:111], v[40:43]
  s_waitcnt lgkmcnt(0)
  v_mfma_f32_16x16x32_bf16 v[48:51], v[84:87], v[108:111], v[48:51]
  v_mfma_f32_16x16x32_bf16 v[44:47], v[56:59], v[112:115], v[28:31]
  ds_read_b64_tr_b16 v[88:89], v2
  ds_read_b64_tr_b16 v[90:91], v2 offset:1024
  v_mfma_f32_16x16x32_bf16 v[52:55], v[60:63], v[112:115], v[28:31]
  ds_read_b64_tr_b16 v[92:93], v3
  ds_read_b64_tr_b16 v[94:95], v3 offset:1024
  v_mfma_f32_16x16x32_bf16 v[44:47], v[64:67], v[116:119], v[44:47]
  ds_read_b64_tr_b16 v[64:65], v4
  ds_read_b64_tr_b16 v[66:67], v4 offset:1024
  v_max3_f32 v19, v40, v41, v42
  v_max3_f32 v19, v19, v43, v48
  v_max3_f32 v19, v19, v49, v50
  v_max_f32 v19, v19, v51
  v_cmp_lt_f32 vcc, 0x41800000, v19
  v_mfma_f32_16x16x32_bf16 v[52:55], v[68:71], v[116:119], v[52:55]
  ds_read_b64_tr_b16 v[68:69], v5
  ds_read_b64_tr_b16 v[70:71], v5 offset:1024
  s_cbranch_vccnz L_stub_bt0_0
L_ret_bt0_0:
  v_exp_f32 v40, v40
  v_exp_f32 v41, v41
  v_exp_f32 v42, v42
  v_cvt_pk_bf16_f32 v32, v40, v41
  v_exp_f32 v43, v43
  v_exp_f32 v48, v48
  v_cvt_pk_bf16_f32 v33, v42, v43
  v_exp_f32 v49, v49
  v_exp_f32 v50, v50
  v_cvt_pk_bf16_f32 v34, v48, v49
  v_exp_f32 v51, v51
  v_mfma_f32_16x16x32_bf16 v[44:47], v[72:75], v[120:123], v[44:47]
  ds_read_b64_tr_b16 v[72:73], v6
  ds_read_b64_tr_b16 v[74:75], v6 offset:1024
  v_cvt_pk_bf16_f32 v35, v50, v51
  v_mfma_f32_16x16x32_bf16 v[52:55], v[76:79], v[120:123], v[52:55]
  ds_read_b64_tr_b16 v[76:77], v7
  ds_read_b64_tr_b16 v[78:79], v7 offset:1024
  v_mfma_f32_16x16x32_bf16 v[44:47], v[80:83], v[124:127], v[44:47]
  ds_read_b64_tr_b16 v[80:81], v8
  ds_read_b64_tr_b16 v[82:83], v8 offset:1024
  v_mfma_f32_16x16x32_bf16 v[52:55], v[84:87], v[124:127], v[52:55]
  ds_read_b64_tr_b16 v[84:85], v9
  s_waitcnt lgkmcnt(9)
  ds_read_b64_tr_b16 v[86:87], v9 offset:1024
  v_mfma_f32_16x16x32_bf16 v[192:195], v[88:91], v[32:35], v[192:195]
  v_add_f32 v15, v15, v40
  v_add_f32 v15, v15, v41
  v_mfma_f32_16x16x32_bf16 v[196:199], v[92:95], v[32:35], v[196:199]
  v_add_f32 v15, v15, v42
  v_add_f32 v15, v15, v43
  v_mfma_f32_16x16x32_bf16 v[200:203], v[64:67], v[32:35], v[200:203]
  v_max3_f32 v20, v44, v45, v46
  v_max3_f32 v20, v20, v47, v52
  v_max3_f32 v20, v20, v53, v54
  v_max_f32 v20, v20, v55
  v_cmp_lt_f32 vcc, 0x41800000, v20
  s_waitcnt lgkmcnt(8)
  v_mfma_f32_16x16x32_bf16 v[204:207], v[68:71], v[32:35], v[204:207]
  s_cbranch_vccnz L_stub_bt0_1
L_ret_bt0_1:
  v_exp_f32 v44, v44
  v_exp_f32 v45, v45
  v_exp_f32 v46, v46
  s_waitcnt lgkmcnt(5)
  v_mfma_f32_16x16x32_bf16 v[208:211], v[72:75], v[32:35], v[208:211]
  s_waitcnt lgkmcnt(0)
  s_barrier
  v_cvt_pk_bf16_f32 v36, v44, v45
  v_exp_f32 v47, v47
  v_exp_f32 v52, v52
  v_cvt_pk_bf16_f32 v37, v46, v47
  v_mfma_f32_16x16x32_bf16 v[212:215], v[76:79], v[32:35], v[212:215]
  ds_read_b128 v[56:59], v10 offset:8192
  v_exp_f32 v53, v53
  v_exp_f32 v54, v54
  v_cvt_pk_bf16_f32 v38, v52, v53
  v_exp_f32 v55, v55
  v_mfma_f32_16x16x32_bf16 v[216:219], v[80:83], v[32:35], v[216:219]
  ds_read_b128 v[60:63], v10 offset:9216
  v_cvt_pk_bf16_f32 v39, v54, v55
  v_mfma_f32_16x16x32_bf16 v[220:223], v[84:87], v[32:35], v[220:223]
  v_add_f32 v15, v15, v48
  v_add_f32 v15, v15, v49
  v_mfma_f32_16x16x32_bf16 v[224:227], v[88:91], v[36:39], v[224:227]
  v_add_f32 v16, v16, v44
  v_add_f32 v16, v16, v45
  v_mfma_f32_16x16x32_bf16 v[228:231], v[92:95], v[36:39], v[228:231]
  v_add_f32 v16, v16, v46
  v_add_f32 v16, v16, v47
  v_mfma_f32_16x16x32_bf16 v[232:235], v[64:67], v[36:39], v[232:235]
  ds_read_b128 v[64:67], v11 offset:8192
  v_add_f32 v16, v16, v52
  v_mfma_f32_16x16x32_bf16 v[236:239], v[68:71], v[36:39], v[236:239]
  ds_read_b128 v[68:71], v11 offset:9216
  v_add_f32 v16, v16, v53
  v_mfma_f32_16x16x32_bf16 v[240:243], v[72:75], v[36:39], v[240:243]
  ds_read_b128 v[72:75], v12 offset:8192
  v_add_f32 v16, v16, v54
  v_mfma_f32_16x16x32_bf16 v[244:247], v[76:79], v[36:39], v[244:247]
  ds_read_b128 v[76:79], v12 offset:9216
  v_add_f32 v16, v16, v55
  v_mfma_f32_16x16x32_bf16 v[248:251], v[80:83], v[36:39], v[248:251]
  ds_read_b128 v[80:83], v13 offset:8192
  v_add_f32 v15, v15, v50
  v_mfma_f32_16x16x32_bf16 v[252:255], v[84:87], v[36:39], v[252:255]
  ds_read_b128 v[84:87], v13 offset:9216
  v_add_f32 v15, v15, v51
L_Ab_T1:
  s_waitcnt lgkmcnt(6)
  v_mfma_f32_16x16x32_bf16 v[40:43], v[56:59], v[96:99], v[24:27]
  v_mfma_f32_16x16x32_bf16 v[48:51], v[60:63], v[96:99], v[24:27]
  s_waitcnt lgkmcnt(5)
  v_mfma_f32_16x16x32_bf16 v[40:43], v[64:67], v[100:103], v[40:43]
  s_waitcnt lgkmcnt(4)
  v_mfma_f32_16x16x32_bf16 v[48:51], v[68:71], v[100:103], v[48:51]
  s_waitcnt lgkmcnt(3)
  v_mfma_f32_16x16x32_bf16 v[40:43], v[72:75], v[104:107], v[40:43]
  s_waitcnt lgkmcnt(2)
  v_mfma_f32_16x16x32_bf16 v[48:51], v[76:79], v[104:107], v[48:51]
  s_waitcnt lgkmcnt(1)
  v_mfma_f32_16x16x32_bf16 v[40:43], v[80:83], v[108:111], v[40:43]
  s_waitcnt lgkmcnt(0)
  v_mfma_f32_16x16x32_bf16 v[48:51], v[84:87], v[108:111], v[48:51]
  v_mfma_f32_16x16x32_bf16 v[44:47], v[56:59], v[112:115], v[28:31]
  ds_read_b64_tr_b16 v[88:89], v2 offset:8192
  ds_read_b64_tr_b16 v[90:91], v2 offset:9216
  v_mfma_f32_16x16x32_bf16 v[52:55], v[60:63], v[112:115], v[28:31]
  ds_read_b64_tr_b16 v[92:93], v3 offset:8192
  ds_read_b64_tr_b16 v[94:95], v3 offset:9216
  v_mfma_f32_16x16x32_bf16 v[44:47], v[64:67], v[116:119], v[44:47]
  ds_read_b64_tr_b16 v[64:65], v4 offset:8192
  ds_read_b64_tr_b16 v[66:67], v4 offset:9216
  v_max3_f32 v19, v40, v41, v42
  v_max3_f32 v19, v19, v43, v48
  v_max3_f32 v19, v19, v49, v50
  v_max_f32 v19, v19, v51
  v_cmp_lt_f32 vcc, 0x41800000, v19
  v_mfma_f32_16x16x32_bf16 v[52:55], v[68:71], v[116:119], v[52:55]
  ds_read_b64_tr_b16 v[68:69], v5 offset:8192
  ds_read_b64_tr_b16 v[70:71], v5 offset:9216
  s_cbranch_vccnz L_stub_bt1_0
L_ret_bt1_0:
  v_exp_f32 v40, v40
  v_exp_f32 v41, v41
  v_exp_f32 v42, v42
  v_cvt_pk_bf16_f32 v32, v40, v41
  v_exp_f32 v43, v43
  v_exp_f32 v48, v48
  v_cvt_pk_bf16_f32 v33, v42, v43
  v_exp_f32 v49, v49
  v_exp_f32 v50, v50
  v_cvt_pk_bf16_f32 v34, v48, v49
  v_exp_f32 v51, v51
  v_mfma_f32_16x16x32_bf16 v[44:47], v[72:75], v[120:123], v[44:47]
  ds_read_b64_tr_b16 v[72:73], v6 offset:8192
  ds_read_b64_tr_b16 v[74:75], v6 offset:9216
  v_cvt_pk_bf16_f32 v35, v50, v51
  v_mfma_f32_16x16x32_bf16 v[52:55], v[76:79], v[120:123], v[52:55]
  ds_read_b64_tr_b16 v[76:77], v7 offset:8192
  ds_read_b64_tr_b16 v[78:79], v7 offset:9216
  v_mfma_f32_16x16x32_bf16 v[44:47], v[80:83], v[124:127], v[44:47]
  ds_read_b64_tr_b16 v[80:81], v8 offset:8192
  ds_read_b64_tr_b16 v[82:83], v8 offset:9216
  v_mfma_f32_16x16x32_bf16 v[52:55], v[84:87], v[124:127], v[52:55]
  ds_read_b64_tr_b16 v[84:85], v9 offset:8192
  s_waitcnt lgkmcnt(9)
  ds_read_b64_tr_b16 v[86:87], v9 offset:9216
  v_mfma_f32_16x16x32_bf16 v[192:195], v[88:91], v[32:35], v[192:195]
  v_add_f32 v15, v15, v40
  v_add_f32 v15, v15, v41
  v_mfma_f32_16x16x32_bf16 v[196:199], v[92:95], v[32:35], v[196:199]
  v_add_f32 v15, v15, v42
  v_add_f32 v15, v15, v43
  v_mfma_f32_16x16x32_bf16 v[200:203], v[64:67], v[32:35], v[200:203]
  v_max3_f32 v20, v44, v45, v46
  v_max3_f32 v20, v20, v47, v52
  v_max3_f32 v20, v20, v53, v54
  v_max_f32 v20, v20, v55
  v_cmp_lt_f32 vcc, 0x41800000, v20
  s_waitcnt lgkmcnt(8)
  v_mfma_f32_16x16x32_bf16 v[204:207], v[68:71], v[32:35], v[204:207]
  s_cbranch_vccnz L_stub_bt1_1
L_ret_bt1_1:
  v_exp_f32 v44, v44
  v_exp_f32 v45, v45
  v_exp_f32 v46, v46
  s_waitcnt lgkmcnt(5)
  v_mfma_f32_16x16x32_bf16 v[208:211], v[72:75], v[32:35], v[208:211]
  s_waitcnt lgkmcnt(0)
  s_barrier
  v_cvt_pk_bf16_f32 v36, v44, v45
  v_exp_f32 v47, v47
  v_exp_f32 v52, v52
  v_cvt_pk_bf16_f32 v37, v46, v47
  v_mfma_f32_16x16x32_bf16 v[212:215], v[76:79], v[32:35], v[212:215]
  ds_read_b128 v[56:59], v10 offset:16384
  v_exp_f32 v53, v53
  v_exp_f32 v54, v54
  v_cvt_pk_bf16_f32 v38, v52, v53
  v_exp_f32 v55, v55
  v_mfma_f32_16x16x32_bf16 v[216:219], v[80:83], v[32:35], v[216:219]
  ds_read_b128 v[60:63], v10 offset:17408
  v_cvt_pk_bf16_f32 v39, v54, v55
  v_mfma_f32_16x16x32_bf16 v[220:223], v[84:87], v[32:35], v[220:223]
  v_add_f32 v15, v15, v48
  v_add_f32 v15, v15, v49
  v_mfma_f32_16x16x32_bf16 v[224:227], v[88:91], v[36:39], v[224:227]
  v_add_f32 v16, v16, v44
  v_add_f32 v16, v16, v45
  v_mfma_f32_16x16x32_bf16 v[228:231], v[92:95], v[36:39], v[228:231]
  v_add_f32 v16, v16, v46
  v_add_f32 v16, v16, v47
  v_mfma_f32_16x16x32_bf16 v[232:235], v[64:67], v[36:39], v[232:235]
  ds_read_b128 v[64:67], v11 offset:16384
  v_add_f32 v16, v16, v52
  v_mfma_f32_16x16x32_bf16 v[236:239], v[68:71], v[36:39], v[236:239]
  ds_read_b128 v[68:71], v11 offset:17408
  v_add_f32 v16, v16, v53
  v_mfma_f32_16x16x32_bf16 v[240:243], v[72:75], v[36:39], v[240:243]
  ds_read_b128 v[72:75], v12 offset:16384
  v_add_f32 v16, v16, v54
  v_mfma_f32_16x16x32_bf16 v[244:247], v[76:79], v[36:39], v[244:247]
  ds_read_b128 v[76:79], v12 offset:17408
  v_add_f32 v16, v16, v55
  v_mfma_f32_16x16x32_bf16 v[248:251], v[80:83], v[36:39], v[248:251]
  ds_read_b128 v[80:83], v13 offset:16384
  v_add_f32 v15, v15, v50
  v_mfma_f32_16x16x32_bf16 v[252:255], v[84:87], v[36:39], v[252:255]
  ds_read_b128 v[84:87], v13 offset:17408
  v_add_f32 v15, v15, v51
  s_waitcnt lgkmcnt(6)
  v_mfma_f32_16x16x32_bf16 v[40:43], v[56:59], v[96:99], v[24:27]
  v_mfma_f32_16x16x32_bf16 v[48:51], v[60:63], v[96:99], v[24:27]
  s_waitcnt lgkmcnt(5)
  v_mfma_f32_16x16x32_bf16 v[40:43], v[64:67], v[100:103], v[40:43]
  s_waitcnt lgkmcnt(4)
  v_mfma_f32_16x16x32_bf16 v[48:51], v[68:71], v[100:103], v[48:51]
  s_waitcnt lgkmcnt(3)
  v_mfma_f32_16x16x32_bf16 v[40:43], v[72:75], v[104:107], v[40:43]
  s_waitcnt lgkmcnt(2)
  v_mfma_f32_16x16x32_bf16 v[48:51], v[76:79], v[104:107], v[48:51]
  s_waitcnt lgkmcnt(1)
  v_mfma_f32_16x16x32_bf16 v[40:43], v[80:83], v[108:111], v[40:43]
  s_waitcnt lgkmcnt(0)
  v_mfma_f32_16x16x32_bf16 v[48:51], v[84:87], v[108:111], v[48:51]
  v_mfma_f32_16x16x32_bf16 v[44:47], v[56:59], v[112:115], v[28:31]
  ds_read_b64_tr_b16 v[88:89], v2 offset:16384
  ds_read_b64_tr_b16 v[90:91], v2 offset:17408
  v_mfma_f32_16x16x32_bf16 v[52:55], v[60:63], v[112:115], v[28:31]
  ds_read_b64_tr_b16 v[92:93], v3 offset:16384
  ds_read_b64_tr_b16 v[94:95], v3 offset:17408
  v_mfma_f32_16x16x32_bf16 v[44:47], v[64:67], v[116:119], v[44:47]
  ds_read_b64_tr_b16 v[64:65], v4 offset:16384
  ds_read_b64_tr_b16 v[66:67], v4 offset:17408
  v_max3_f32 v19, v40, v41, v42
  v_max3_f32 v19, v19, v43, v48
  v_max3_f32 v19, v19, v49, v50
  v_max_f32 v19, v19, v51
  v_cmp_lt_f32 vcc, 0x41800000, v19
  v_mfma_f32_16x16x32_bf16 v[52:55], v[68:71], v[116:119], v[52:55]
  ds_read_b64_tr_b16 v[68:69], v5 offset:16384
  ds_read_b64_tr_b16 v[70:71], v5 offset:17408
  s_cbranch_vccnz L_stub_bt2_0
L_ret_bt2_0:
  v_exp_f32 v40, v40
  v_exp_f32 v41, v41
  v_exp_f32 v42, v42
  v_cvt_pk_bf16_f32 v32, v40, v41
  v_exp_f32 v43, v43
  v_exp_f32 v48, v48
  v_cvt_pk_bf16_f32 v33, v42, v43
  v_exp_f32 v49, v49
  v_exp_f32 v50, v50
  v_cvt_pk_bf16_f32 v34, v48, v49
  v_exp_f32 v51, v51
  v_mfma_f32_16x16x32_bf16 v[44:47], v[72:75], v[120:123], v[44:47]
  ds_read_b64_tr_b16 v[72:73], v6 offset:16384
  ds_read_b64_tr_b16 v[74:75], v6 offset:17408
  v_cvt_pk_bf16_f32 v35, v50, v51
  v_mfma_f32_16x16x32_bf16 v[52:55], v[76:79], v[120:123], v[52:55]
  ds_read_b64_tr_b16 v[76:77], v7 offset:16384
  ds_read_b64_tr_b16 v[78:79], v7 offset:17408
  v_mfma_f32_16x16x32_bf16 v[44:47], v[80:83], v[124:127], v[44:47]
  ds_read_b64_tr_b16 v[80:81], v8 offset:16384
  ds_read_b64_tr_b16 v[82:83], v8 offset:17408
  v_mfma_f32_16x16x32_bf16 v[52:55], v[84:87], v[124:127], v[52:55]
  ds_read_b64_tr_b16 v[84:85], v9 offset:16384
  s_waitcnt lgkmcnt(9)
  ds_read_b64_tr_b16 v[86:87], v9 offset:17408
  v_mfma_f32_16x16x32_bf16 v[192:195], v[88:91], v[32:35], v[192:195]
  v_add_f32 v15, v15, v40
  v_add_f32 v15, v15, v41
  v_mfma_f32_16x16x32_bf16 v[196:199], v[92:95], v[32:35], v[196:199]
  v_add_f32 v15, v15, v42
  v_add_f32 v15, v15, v43
  v_mfma_f32_16x16x32_bf16 v[200:203], v[64:67], v[32:35], v[200:203]
  v_max3_f32 v20, v44, v45, v46
  v_max3_f32 v20, v20, v47, v52
  v_max3_f32 v20, v20, v53, v54
  v_max_f32 v20, v20, v55
  v_cmp_lt_f32 vcc, 0x41800000, v20
  s_waitcnt lgkmcnt(8)
  v_mfma_f32_16x16x32_bf16 v[204:207], v[68:71], v[32:35], v[204:207]
  s_cbranch_vccnz L_stub_bt2_1
L_ret_bt2_1:
  v_exp_f32 v44, v44
  v_exp_f32 v45, v45
  v_exp_f32 v46, v46
  s_waitcnt lgkmcnt(5)
  v_mfma_f32_16x16x32_bf16 v[208:211], v[72:75], v[32:35], v[208:211]
  s_waitcnt lgkmcnt(0)
  s_barrier
  v_cvt_pk_bf16_f32 v36, v44, v45
  v_exp_f32 v47, v47
  v_exp_f32 v52, v52
  v_cvt_pk_bf16_f32 v37, v46, v47
  v_mfma_f32_16x16x32_bf16 v[212:215], v[76:79], v[32:35], v[212:215]
  ds_read_b128 v[56:59], v10 offset:24576
  v_exp_f32 v53, v53
  v_exp_f32 v54, v54
  v_cvt_pk_bf16_f32 v38, v52, v53
  v_exp_f32 v55, v55
  v_mfma_f32_16x16x32_bf16 v[216:219], v[80:83], v[32:35], v[216:219]
  ds_read_b128 v[60:63], v10 offset:25600
  v_cvt_pk_bf16_f32 v39, v54, v55
  v_mfma_f32_16x16x32_bf16 v[220:223], v[84:87], v[32:35], v[220:223]
  v_add_f32 v15, v15, v48
  v_add_f32 v15, v15, v49
  v_mfma_f32_16x16x32_bf16 v[224:227], v[88:91], v[36:39], v[224:227]
  v_add_f32 v16, v16, v44
  v_add_f32 v16, v16, v45
  v_mfma_f32_16x16x32_bf16 v[228:231], v[92:95], v[36:39], v[228:231]
  v_add_f32 v16, v16, v46
  v_add_f32 v16, v16, v47
  v_mfma_f32_16x16x32_bf16 v[232:235], v[64:67], v[36:39], v[232:235]
  ds_read_b128 v[64:67], v11 offset:24576
  v_add_f32 v16, v16, v52
  v_mfma_f32_16x16x32_bf16 v[236:239], v[68:71], v[36:39], v[236:239]
  ds_read_b128 v[68:71], v11 offset:25600
  v_add_f32 v16, v16, v53
  v_mfma_f32_16x16x32_bf16 v[240:243], v[72:75], v[36:39], v[240:243]
  ds_read_b128 v[72:75], v12 offset:24576
  v_add_f32 v16, v16, v54
  v_mfma_f32_16x16x32_bf16 v[244:247], v[76:79], v[36:39], v[244:247]
  ds_read_b128 v[76:79], v12 offset:25600
  v_add_f32 v16, v16, v55
  v_mfma_f32_16x16x32_bf16 v[248:251], v[80:83], v[36:39], v[248:251]
  ds_read_b128 v[80:83], v13 offset:24576
  v_add_f32 v15, v15, v50
  v_mfma_f32_16x16x32_bf16 v[252:255], v[84:87], v[36:39], v[252:255]
  ds_read_b128 v[84:87], v13 offset:25600
  v_add_f32 v15, v15, v51
  s_sub_u32 s61, s61, 1
  s_cmp_eq_u32 s61, 0
  s_cbranch_scc1 L_Ab_T3L
  s_waitcnt lgkmcnt(6)
  v_mfma_f32_16x16x32_bf16 v[40:43], v[56:59], v[96:99], v[24:27]
  v_mfma_f32_16x16x32_bf16 v[48:51], v[60:63], v[96:99], v[24:27]
  s_waitcnt lgkmcnt(5)
  v_mfma_f32_16x16x32_bf16 v[40:43], v[64:67], v[100:103], v[40:43]
  s_waitcnt lgkmcnt(4)
  v_mfma_f32_16x16x32_bf16 v[48:51], v[68:71], v[100:103], v[48:51]
  s_waitcnt lgkmcnt(3)
  v_mfma_f32_16x16x32_bf16 v[40:43], v[72:75], v[104:107], v[40:43]
  s_waitcnt lgkmcnt(2)
  v_mfma_f32_16x16x32_bf16 v[48:51], v[76:79], v[104:107], v[48:51]
  s_waitcnt lgkmcnt(1)
  v_mfma_f32_16x16x32_bf16 v[40:43], v[80:83], v[108:111], v[40:43]
  s_waitcnt lgkmcnt(0)
  v_mfma_f32_16x16x32_bf16 v[48:51], v[84:87], v[108:111], v[48:51]
  v_mfma_f32_16x16x32_bf16 v[44:47], v[56:59], v[112:115], v[28:31]
  ds_read_b64_tr_b16 v[88:89], v2 offset:24576
  ds_read_b64_tr_b16 v[90:91], v2 offset:25600
  v_mfma_f32_16x16x32_bf16 v[52:55], v[60:63], v[112:115], v[28:31]
  ds_read_b64_tr_b16 v[92:93], v3 offset:24576
  ds_read_b64_tr_b16 v[94:95], v3 offset:25600
  v_mfma_f32_16x16x32_bf16 v[44:47], v[64:67], v[116:119], v[44:47]
  ds_read_b64_tr_b16 v[64:65], v4 offset:24576
  ds_read_b64_tr_b16 v[66:67], v4 offset:25600
  v_max3_f32 v19, v40, v41, v42
  v_max3_f32 v19, v19, v43, v48
  v_max3_f32 v19, v19, v49, v50
  v_max_f32 v19, v19, v51
  v_cmp_lt_f32 vcc, 0x41800000, v19
  v_mfma_f32_16x16x32_bf16 v[52:55], v[68:71], v[116:119], v[52:55]
  ds_read_b64_tr_b16 v[68:69], v5 offset:24576
  ds_read_b64_tr_b16 v[70:71], v5 offset:25600
  s_cbranch_vccnz L_stub_bt3_0
L_ret_bt3_0:
  v_exp_f32 v40, v40
  v_exp_f32 v41, v41
  v_exp_f32 v42, v42
  v_cvt_pk_bf16_f32 v32, v40, v41
  v_exp_f32 v43, v43
  v_exp_f32 v48, v48
  v_cvt_pk_bf16_f32 v33, v42, v43
  v_exp_f32 v49, v49
  v_exp_f32 v50, v50
  v_cvt_pk_bf16_f32 v34, v48, v49
  v_exp_f32 v51, v51
  v_mfma_f32_16x16x32_bf16 v[44:47], v[72:75], v[120:123], v[44:47]
  ds_read_b64_tr_b16 v[72:73], v6 offset:24576
  ds_read_b64_tr_b16 v[74:75], v6 offset:25600
  v_cvt_pk_bf16_f32 v35, v50, v51
  v_mfma_f32_16x16x32_bf16 v[52:55], v[76:79], v[120:123], v[52:55]
  ds_read_b64_tr_b16 v[76:77], v7 offset:24576
  ds_read_b64_tr_b16 v[78:79], v7 offset:25600
  v_mfma_f32_16x16x32_bf16 v[44:47], v[80:83], v[124:127], v[44:47]
  ds_read_b64_tr_b16 v[80:81], v8 offset:24576
  ds_read_b64_tr_b16 v[82:83], v8 offset:25600
  v_mfma_f32_16x16x32_bf16 v[52:55], v[84:87], v[124:127], v[52:55]
  ds_read_b64_tr_b16 v[84:85], v9 offset:24576
  s_waitcnt lgkmcnt(9)
  ds_read_b64_tr_b16 v[86:87], v9 offset:25600
  v_mfma_f32_16x16x32_bf16 v[192:195], v[88:91], v[32:35], v[192:195]
  v_add_f32 v15, v15, v40
  v_add_f32 v15, v15, v41
  v_mfma_f32_16x16x32_bf16 v[196:199], v[92:95], v[32:35], v[196:199]
  v_add_f32 v15, v15, v42
  v_add_f32 v15, v15, v43
  v_mfma_f32_16x16x32_bf16 v[200:203], v[64:67], v[32:35], v[200:203]
  v_max3_f32 v20, v44, v45, v46
  v_max3_f32 v20, v20, v47, v52
  v_max3_f32 v20, v20, v53, v54
  v_max_f32 v20, v20, v55
  v_cmp_lt_f32 vcc, 0x41800000, v20
  s_waitcnt lgkmcnt(8)
  v_mfma_f32_16x16x32_bf16 v[204:207], v[68:71], v[32:35], v[204:207]
  s_cbranch_vccnz L_stub_bt3_1
L_ret_bt3_1:
  v_exp_f32 v44, v44
  v_exp_f32 v45, v45
  v_exp_f32 v46, v46
  s_waitcnt lgkmcnt(5)
  v_mfma_f32_16x16x32_bf16 v[208:211], v[72:75], v[32:35], v[208:211]
  s_waitcnt lgkmcnt(0)
  s_barrier
  v_cvt_pk_bf16_f32 v36, v44, v45
  v_exp_f32 v47, v47
  v_exp_f32 v52, v52
  v_cvt_pk_bf16_f32 v37, v46, v47
  v_mfma_f32_16x16x32_bf16 v[212:215], v[76:79], v[32:35], v[212:215]
  ds_read_b128 v[56:59], v10
  v_exp_f32 v53, v53
  v_exp_f32 v54, v54
  v_cvt_pk_bf16_f32 v38, v52, v53
  v_exp_f32 v55, v55
  v_mfma_f32_16x16x32_bf16 v[216:219], v[80:83], v[32:35], v[216:219]
  ds_read_b128 v[60:63], v10 offset:1024
  v_cvt_pk_bf16_f32 v39, v54, v55
  v_mfma_f32_16x16x32_bf16 v[220:223], v[84:87], v[32:35], v[220:223]
  v_add_f32 v15, v15, v48
  v_add_f32 v15, v15, v49
  v_mfma_f32_16x16x32_bf16 v[224:227], v[88:91], v[36:39], v[224:227]
  v_add_f32 v16, v16, v44
  v_add_f32 v16, v16, v45
  v_mfma_f32_16x16x32_bf16 v[228:231], v[92:95], v[36:39], v[228:231]
  v_add_f32 v16, v16, v46
  v_add_f32 v16, v16, v47
  v_mfma_f32_16x16x32_bf16 v[232:235], v[64:67], v[36:39], v[232:235]
  ds_read_b128 v[64:67], v11
  v_add_f32 v16, v16, v52
  v_mfma_f32_16x16x32_bf16 v[236:239], v[68:71], v[36:39], v[236:239]
  ds_read_b128 v[68:71], v11 offset:1024
  v_add_f32 v16, v16, v53
  v_mfma_f32_16x16x32_bf16 v[240:243], v[72:75], v[36:39], v[240:243]
  ds_read_b128 v[72:75], v12
  v_add_f32 v16, v16, v54
  v_mfma_f32_16x16x32_bf16 v[244:247], v[76:79], v[36:39], v[244:247]
  ds_read_b128 v[76:79], v12 offset:1024
  v_add_f32 v16, v16, v55
  v_mfma_f32_16x16x32_bf16 v[248:251], v[80:83], v[36:39], v[248:251]
  ds_read_b128 v[80:83], v13
  v_add_f32 v15, v15, v50
  v_mfma_f32_16x16x32_bf16 v[252:255], v[84:87], v[36:39], v[252:255]
  ds_read_b128 v[84:87], v13 offset:1024
  v_add_f32 v15, v15, v51
  s_branch L_Ab_T0
L_Ab_T3L:
  s_waitcnt lgkmcnt(6)
  v_mfma_f32_16x16x32_bf16 v[40:43], v[56:59], v[96:99], v[24:27]
  v_mfma_f32_16x16x32_bf16 v[48:51], v[60:63], v[96:99], v[24:27]
  s_waitcnt lgkmcnt(5)
  v_mfma_f32_16x16x32_bf16 v[40:43], v[64:67], v[100:103], v[40:43]
  s_waitcnt lgkmcnt(4)
  v_mfma_f32_16x16x32_bf16 v[48:51], v[68:71], v[100:103], v[48:51]
  s_waitcnt lgkmcnt(3)
  v_mfma_f32_16x16x32_bf16 v[40:43], v[72:75], v[104:107], v[40:43]
  s_waitcnt lgkmcnt(2)
  v_mfma_f32_16x16x32_bf16 v[48:51], v[76:79], v[104:107], v[48:51]
  s_waitcnt lgkmcnt(1)
  v_mfma_f32_16x16x32_bf16 v[40:43], v[80:83], v[108:111], v[40:43]
  s_waitcnt lgkmcnt(0)
  v_mfma_f32_16x16x32_bf16 v[48:51], v[84:87], v[108:111], v[48:51]
  v_mfma_f32_16x16x32_bf16 v[44:47], v[56:59], v[112:115], v[28:31]
  ds_read_b64_tr_b16 v[88:89], v2 offset:24576
  ds_read_b64_tr_b16 v[90:91], v2 offset:25600
  v_mfma_f32_16x16x32_bf16 v[52:55], v[60:63], v[112:115], v[28:31]
  ds_read_b64_tr_b16 v[92:93], v3 offset:24576
  ds_read_b64_tr_b16 v[94:95], v3 offset:25600
  v_mfma_f32_16x16x32_bf16 v[44:47], v[64:67], v[116:119], v[44:47]
  ds_read_b64_tr_b16 v[64:65], v4 offset:24576
  ds_read_b64_tr_b16 v[66:67], v4 offset:25600
  v_max3_f32 v19, v40, v41, v42
  v_max3_f32 v19, v19, v43, v48
  v_max3_f32 v19, v19, v49, v50
  v_max_f32 v19, v19, v51
  v_cmp_lt_f32 vcc, 0x41800000, v19
  v_mfma_f32_16x16x32_bf16 v[52:55], v[68:71], v[116:119], v[52:55]
  ds_read_b64_tr_b16 v[68:69], v5 offset:24576
  ds_read_b64_tr_b16 v[70:71], v5 offset:25600
  s_cbranch_vccnz L_stub_bt3l_0
L_ret_bt3l_0:
  v_exp_f32 v40, v40
  v_exp_f32 v41, v41
  v_exp_f32 v42, v42
  v_cvt_pk_bf16_f32 v32, v40, v41
  v_exp_f32 v43, v43
  v_exp_f32 v48, v48
  v_cvt_pk_bf16_f32 v33, v42, v43
  v_exp_f32 v49, v49
  v_exp_f32 v50, v50
  v_cvt_pk_bf16_f32 v34, v48, v49
  v_exp_f32 v51, v51
  v_mfma_f32_16x16x32_bf16 v[44:47], v[72:75], v[120:123], v[44:47]
  ds_read_b64_tr_b16 v[72:73], v6 offset:24576
  ds_read_b64_tr_b16 v[74:75], v6 offset:25600
  v_cvt_pk_bf16_f32 v35, v50, v51
  v_mfma_f32_16x16x32_bf16 v[52:55], v[76:79], v[120:123], v[52:55]
  ds_read_b64_tr_b16 v[76:77], v7 offset:24576
  ds_read_b64_tr_b16 v[78:79], v7 offset:25600
  v_mfma_f32_16x16x32_bf16 v[44:47], v[80:83], v[124:127], v[44:47]
  ds_read_b64_tr_b16 v[80:81], v8 offset:24576
  ds_read_b64_tr_b16 v[82:83], v8 offset:25600
  v_mfma_f32_16x16x32_bf16 v[52:55], v[84:87], v[124:127], v[52:55]
  ds_read_b64_tr_b16 v[84:85], v9 offset:24576
  s_waitcnt lgkmcnt(9)
  ds_read_b64_tr_b16 v[86:87], v9 offset:25600
  v_mfma_f32_16x16x32_bf16 v[192:195], v[88:91], v[32:35], v[192:195]
  v_add_f32 v15, v15, v40
  v_mfma_f32_16x16x32_bf16 v[196:199], v[92:95], v[32:35], v[196:199]
  v_add_f32 v15, v15, v41
  v_add_f32 v15, v15, v42
  v_mfma_f32_16x16x32_bf16 v[200:203], v[64:67], v[32:35], v[200:203]
  v_max3_f32 v20, v44, v45, v46
  v_max3_f32 v20, v20, v47, v52
  v_max3_f32 v20, v20, v53, v54
  v_max_f32 v20, v20, v55
  v_cmp_lt_f32 vcc, 0x41800000, v20
  s_waitcnt lgkmcnt(8)
  v_mfma_f32_16x16x32_bf16 v[204:207], v[68:71], v[32:35], v[204:207]
  s_cbranch_vccnz L_stub_bt3l_1
L_ret_bt3l_1:
  v_exp_f32 v44, v44
  v_exp_f32 v45, v45
  v_exp_f32 v46, v46
  s_waitcnt lgkmcnt(6)
  v_mfma_f32_16x16x32_bf16 v[208:211], v[72:75], v[32:35], v[208:211]
  v_cvt_pk_bf16_f32 v36, v44, v45
  v_exp_f32 v47, v47
  v_exp_f32 v52, v52
  v_cvt_pk_bf16_f32 v37, v46, v47
  v_exp_f32 v53, v53
  s_waitcnt lgkmcnt(1)
  v_mfma_f32_16x16x32_bf16 v[212:215], v[76:79], v[32:35], v[212:215]
  v_exp_f32 v54, v54
  v_cvt_pk_bf16_f32 v38, v52, v53
  v_exp_f32 v55, v55
  v_mfma_f32_16x16x32_bf16 v[216:219], v[80:83], v[32:35], v[216:219]
  v_cvt_pk_bf16_f32 v39, v54, v55
  s_waitcnt lgkmcnt(0)
  v_mfma_f32_16x16x32_bf16 v[220:223], v[84:87], v[32:35], v[220:223]
  v_add_f32 v15, v15, v43
  v_add_f32 v15, v15, v48
  v_mfma_f32_16x16x32_bf16 v[224:227], v[88:91], v[36:39], v[224:227]
  v_add_f32 v16, v16, v44
  v_add_f32 v15, v15, v49
  v_mfma_f32_16x16x32_bf16 v[228:231], v[92:95], v[36:39], v[228:231]
  v_add_f32 v16, v16, v45
  v_add_f32 v15, v15, v50
  v_mfma_f32_16x16x32_bf16 v[232:235], v[64:67], v[36:39], v[232:235]
  v_add_f32 v16, v16, v46
  v_add_f32 v15, v15, v51
  v_mfma_f32_16x16x32_bf16 v[236:239], v[68:71], v[36:39], v[236:239]
  v_add_f32 v16, v16, v47
  v_mfma_f32_16x16x32_bf16 v[240:243], v[72:75], v[36:39], v[240:243]
  v_add_f32 v16, v16, v52
  v_mfma_f32_16x16x32_bf16 v[244:247], v[76:79], v[36:39], v[244:247]
  v_add_f32 v16, v16, v53
  v_mfma_f32_16x16x32_bf16 v[248:251], v[80:83], v[36:39], v[248:251]
  v_add_f32 v16, v16, v54
  v_mfma_f32_16x16x32_bf16 v[252:255], v[84:87], v[36:39], v[252:255]
  v_add_f32 v16, v16, v55
  v_mov_b32 v22, v15
  s_nop 1
  v_permlane32_swap_b32 v15, v22
  v_add_f32 v15, v15, v22
  v_mov_b32 v22, v15
  s_nop 1
  v_permlane16_swap_b32 v15, v22
  v_add_f32 v15, v15, v22
  v_rcp_f32 v23, v15
  s_nop 0
  v_mul_f32 v192, v192, v23
  v_mul_f32 v193, v193, v23
  v_mul_f32 v194, v194, v23
  v_mul_f32 v195, v195, v23
  v_cvt_pk_bf16_f32 v192, v192, v193
  v_cvt_pk_bf16_f32 v193, v194, v195
  v_mul_f32 v196, v196, v23
  v_mul_f32 v197, v197, v23
  v_mul_f32 v198, v198, v23
  v_mul_f32 v199, v199, v23
  v_cvt_pk_bf16_f32 v194, v196, v197
  v_cvt_pk_bf16_f32 v195, v198, v199
  v_mul_f32 v200, v200, v23
  v_mul_f32 v201, v201, v23
  v_mul_f32 v202, v202, v23
  v_mul_f32 v203, v203, v23
  v_cvt_pk_bf16_f32 v200, v200, v201
  v_cvt_pk_bf16_f32 v201, v202, v203
  v_mul_f32 v204, v204, v23
  v_mul_f32 v205, v205, v23
  v_mul_f32 v206, v206, v23
  v_mul_f32 v207, v207, v23
  v_cvt_pk_bf16_f32 v202, v204, v205
  v_cvt_pk_bf16_f32 v203, v206, v207
  v_mul_f32 v208, v208, v23
  v_mul_f32 v209, v209, v23
  v_mul_f32 v210, v210, v23
  v_mul_f32 v211, v211, v23
  v_cvt_pk_bf16_f32 v208, v208, v209
  v_cvt_pk_bf16_f32 v209, v210, v211
  v_mul_f32 v212, v212, v23
  v_mul_f32 v213, v213, v23
  v_mul_f32 v214, v214, v23
  v_mul_f32 v215, v215, v23
  v_cvt_pk_bf16_f32 v210, v212, v213
  v_cvt_pk_bf16_f32 v211, v214, v215
  v_mul_f32 v216, v216, v23
  v_mul_f32 v217, v217, v23
  v_mul_f32 v218, v218, v23
  v_mul_f32 v219, v219, v23
  v_cvt_pk_bf16_f32 v216, v216, v217
  v_cvt_pk_bf16_f32 v217, v218, v219
  v_mul_f32 v220, v220, v23
  v_mul_f32 v221, v221, v23
  v_mul_f32 v222, v222, v23
  v_mul_f32 v223, v223, v23
  v_cvt_pk_bf16_f32 v218, v220, v221
  v_cvt_pk_bf16_f32 v219, v222, v223
  v_mov_b32 v15, 0
  v_mov_b32 v22, v16
  s_nop 1
  v_permlane32_swap_b32 v16, v22
  v_add_f32 v16, v16, v22
  v_mov_b32 v22, v16
  s_nop 1
  v_permlane16_swap_b32 v16, v22
  v_add_f32 v16, v16, v22
  v_rcp_f32 v23, v16
  s_nop 0
  v_mul_f32 v224, v224, v23
  v_mul_f32 v225, v225, v23
  v_mul_f32 v226, v226, v23
  v_mul_f32 v227, v227, v23
  v_cvt_pk_bf16_f32 v224, v224, v225
  v_cvt_pk_bf16_f32 v225, v226, v227
  v_mul_f32 v228, v228, v23
  v_mul_f32 v229, v229, v23
  v_mul_f32 v230, v230, v23
  v_mul_f32 v231, v231, v23
  v_cvt_pk_bf16_f32 v226, v228, v229
  v_cvt_pk_bf16_f32 v227, v230, v231
  v_mul_f32 v232, v232, v23
  v_mul_f32 v233, v233, v23
  v_mul_f32 v234, v234, v23
  v_mul_f32 v235, v235, v23
  v_cvt_pk_bf16_f32 v232, v232, v233
  v_cvt_pk_bf16_f32 v233, v234, v235
  v_mul_f32 v236, v236, v23
  v_mul_f32 v237, v237, v23
  v_mul_f32 v238, v238, v23
  v_mul_f32 v239, v239, v23
  v_cvt_pk_bf16_f32 v234, v236, v237
  v_cvt_pk_bf16_f32 v235, v238, v239
  v_mul_f32 v240, v240, v23
  v_mul_f32 v241, v241, v23
  v_mul_f32 v242, v242, v23
  v_mul_f32 v243, v243, v23
  v_cvt_pk_bf16_f32 v240, v240, v241
  v_cvt_pk_bf16_f32 v241, v242, v243
  v_mul_f32 v244, v244, v23
  v_mul_f32 v245, v245, v23
  v_mul_f32 v246, v246, v23
  v_mul_f32 v247, v247, v23
  v_cvt_pk_bf16_f32 v242, v244, v245
  v_cvt_pk_bf16_f32 v243, v246, v247
  v_mul_f32 v248, v248, v23
  v_mul_f32 v249, v249, v23
  v_mul_f32 v250, v250, v23
  v_mul_f32 v251, v251, v23
  v_cvt_pk_bf16_f32 v248, v248, v249
  v_cvt_pk_bf16_f32 v249, v250, v251
  v_mul_f32 v252, v252, v23
  v_mul_f32 v253, v253, v23
  v_mul_f32 v254, v254, v23
  v_mul_f32 v255, v255, v23
  v_cvt_pk_bf16_f32 v250, v252, v253
  v_cvt_pk_bf16_f32 v251, v254, v255
  v_mov_b32 v16, 0
  s_add_u32 s36, s36, 1
  s_cmp_gt_u32 s36, 2
  s_cbranch_scc1 L_Ab_pk
  s_cmp_eq_u32 s36, 2
  s_cbranch_scc1 L_Ab_p1
  v_mov_b32 v128, v192
  v_mov_b32 v129, v193
  v_mov_b32 v130, v194
  v_mov_b32 v131, v195
  v_mov_b32 v132, v224
  v_mov_b32 v133, v225
  v_mov_b32 v134, v226
  v_mov_b32 v135, v227
  v_mov_b32 v136, v200
  v_mov_b32 v137, v201
  v_mov_b32 v138, v202
  v_mov_b32 v139, v203
  v_mov_b32 v140, v232
  v_mov_b32 v141, v233
  v_mov_b32 v142, v234
  v_mov_b32 v143, v235
  v_mov_b32 v144, v208
  v_mov_b32 v145, v209
  v_mov_b32 v146, v210
  v_mov_b32 v147, v211
  v_mov_b32 v148, v240
  v_mov_b32 v149, v241
  v_mov_b32 v150, v242
  v_mov_b32 v151, v243
  v_mov_b32 v152, v216
  v_mov_b32 v153, v217
  v_mov_b32 v154, v218
  v_mov_b32 v155, v219
  v_mov_b32 v156, v248
  v_mov_b32 v157, v249
  v_mov_b32 v158, v250
  v_mov_b32 v159, v251
  s_branch L_Ab_pk
L_Ab_p1:
  v_mov_b32 v160, v192
  v_mov_b32 v161, v193
  v_mov_b32 v162, v194
  v_mov_b32 v163, v195
  v_mov_b32 v164, v224
  v_mov_b32 v165, v225
  v_mov_b32 v166, v226
  v_mov_b32 v167, v227
  v_mov_b32 v168, v200
  v_mov_b32 v169, v201
  v_mov_b32 v170, v202
  v_mov_b32 v171, v203
  v_mov_b32 v172, v232
  v_mov_b32 v173, v233
  v_mov_b32 v174, v234
  v_mov_b32 v175, v235
  v_mov_b32 v176, v208
  v_mov_b32 v177, v209
  v_mov_b32 v178, v210
  v_mov_b32 v179, v211
  v_mov_b32 v180, v240
  v_mov_b32 v181, v241
  v_mov_b32 v182, v242
  v_mov_b32 v183, v243
  v_mov_b32 v184, v216
  v_mov_b32 v185, v217
  v_mov_b32 v186, v218
  v_mov_b32 v187, v219
  v_mov_b32 v188, v248
  v_mov_b32 v189, v249
  v_mov_b32 v190, v250
  v_mov_b32 v191, v251
L_Ab_pk:
  s_waitcnt lgkmcnt(0)
  s_barrier
  s_cmp_lt_u32 s36, 3
  s_cbranch_scc1 L_Ab_go
  s_cmp_eq_u32 s36, 4
  s_cbranch_scc1 L_Ab_fin
  s_lshl_b32 s38, s37, 14
  v_add_u32 v19, s38, v14
  ds_write_b128 v19, v[128:131]
  ds_write_b128 v19, v[136:139] offset:1024
  ds_write_b128 v19, v[144:147] offset:2048
  ds_write_b128 v19, v[152:155] offset:3072
  ds_write_b128 v19, v[132:135] offset:4096
  ds_write_b128 v19, v[140:143] offset:5120
  ds_write_b128 v19, v[148:151] offset:6144
  ds_write_b128 v19, v[156:159] offset:7168
  ds_write_b128 v19, v[160:163] offset:8192
  ds_write_b128 v19, v[168:171] offset:9216
  ds_write_b128 v19, v[176:179] offset:10240
  ds_write_b128 v19, v[184:187] offset:11264
  ds_write_b128 v19, v[164:167] offset:12288
  ds_write_b128 v19, v[172:175] offset:13312
  ds_write_b128 v19, v[180:183] offset:14336
  s_waitcnt lgkmcnt(14)
  ds_write_b128 v19, v[188:191] offset:15360
  s_waitcnt lgkmcnt(0)
  s_branch L_Ab_go
L_Ab_fin:
  v_add_u32 v19, 0xffff0000, v18
  ds_write_b128 v19, v[192:195]
  ds_write_b128 v19, v[200:203] offset:1024
  ds_write_b128 v19, v[208:211] offset:2048
  ds_write_b128 v19, v[216:219] offset:3072
  ds_write_b128 v19, v[224:227] offset:4096
  ds_write_b128 v19, v[232:235] offset:5120
  ds_write_b128 v19, v[240:243] offset:6144
  ds_write_b128 v19, v[248:251] offset:7168
  s_barrier
L_Ab_end:
  s_setprio 0
  s_cmp_eq_u32 s32, 0
  s_cbranch_scc1 L_p2_0
  s_cmp_eq_u32 s32, 1
  s_cbranch_scc1 L_p2_1
  s_branch L_p2_2
L_stub_bt0_0:
  s_call_b64 s[58:59], L_rareb_0
  s_branch L_ret_bt0_0
L_stub_bt0_1:
  s_call_b64 s[58:59], L_rareb_1
  s_branch L_ret_bt0_1
L_stub_bt1_0:
  s_call_b64 s[58:59], L_rareb_0
  s_branch L_ret_bt1_0
L_stub_bt1_1:
  s_call_b64 s[58:59], L_rareb_1
  s_branch L_ret_bt1_1
L_stub_bt2_0:
  s_call_b64 s[58:59], L_rareb_0
  s_branch L_ret_bt2_0
L_stub_bt2_1:
  s_call_b64 s[58:59], L_rareb_1
  s_branch L_ret_bt2_1
L_stub_bt3_0:
  s_call_b64 s[58:59], L_rareb_0
  s_branch L_ret_bt3_0
L_stub_bt3_1:
  s_call_b64 s[58:59], L_rareb_1
  s_branch L_ret_bt3_1
L_stub_bt3l_0:
  s_call_b64 s[58:59], L_rareb_0
  s_branch L_ret_bt3l_0
L_stub_bt3l_1:
  s_call_b64 s[58:59], L_rareb_1
  s_branch L_ret_bt3l_1
L_rareb_0:
  s_nop 15
  v_mov_b32 v22, v19
  s_nop 1
  v_permlane32_swap_b32 v19, v22
  v_max_f32 v19, v19, v22
  v_mov_b32 v22, v19
  s_nop 1
  v_permlane16_swap_b32 v19, v22
  v_max_f32 v19, v19, v22
  v_max_f32 v19, 0, v19
  v_sub_f32 v23, 0, v19
  v_exp_f32 v23, v23
  v_sub_f32 v24, v24, v19
  v_sub_f32 v25, v25, v19
  v_sub_f32 v26, v26, v19
  v_sub_f32 v27, v27, v19
  v_sub_f32 v40, v40, v19
  v_sub_f32 v41, v41, v19
  v_sub_f32 v42, v42, v19
  v_sub_f32 v43, v43, v19
  v_sub_f32 v48, v48, v19
  v_sub_f32 v49, v49, v19
  v_sub_f32 v50, v50, v19
  v_sub_f32 v51, v51, v19
  v_mul_f32 v15, v15, v23
  v_mul_f32 v192, v192, v23
  v_mul_f32 v193, v193, v23
  v_mul_f32 v194, v194, v23
  v_mul_f32 v195, v195, v23
  v_mul_f32 v196, v196, v23
  v_mul_f32 v197, v197, v23
  v_mul_f32 v198, v198, v23
  v_mul_f32 v199, v199, v23
  v_mul_f32 v200, v200, v23
  v_mul_f32 v201, v201, v23
  v_mul_f32 v202, v202, v23
  v_mul_f32 v203, v203, v23
  v_mul_f32 v204, v204, v23
  v_mul_f32 v205, v205, v23
  v_mul_f32 v206, v206, v23
  v_mul_f32 v207, v207, v23
  v_mul_f32 v208, v208, v23
  v_mul_f32 v209, v209, v23
  v_mul_f32 v210, v210, v23
  v_mul_f32 v211, v211, v23
  v_mul_f32 v212, v212, v23
  v_mul_f32 v213, v213, v23
  v_mul_f32 v214, v214, v23
  v_mul_f32 v215, v215, v23
  v_mul_f32 v216, v216, v23
  v_mul_f32 v217, v217, v23
  v_mul_f32 v218, v218, v23
  v_mul_f32 v219, v219, v23
  v_mul_f32 v220, v220, v23
  v_mul_f32 v221, v221, v23
  v_mul_f32 v222, v222, v23
  v_mul_f32 v223, v223, v23
  s_nop 3
  s_setpc_b64 s[58:59]
L_rareb_1:
  s_nop 15
  v_mov_b32 v22, v20
  s_nop 1
  v_permlane32_swap_b32 v20, v22
  v_max_f32 v20, v20, v22
  v_mov_b32 v22, v20
  s_nop 1
  v_permlane16_swap_b32 v20, v22
  v_max_f32 v20, v20, v22
  v_max_f32 v20, 0, v20
  v_sub_f32 v23, 0, v20
  v_exp_f32 v23, v23
  v_sub_f32 v28, v28, v20
  v_sub_f32 v29, v29, v20
  v_sub_f32 v30, v30, v20
  v_sub_f32 v31, v31, v20
  v_sub_f32 v44, v44, v20
  v_sub_f32 v45, v45, v20
  v_sub_f32 v46, v46, v20
  v_sub_f32 v47, v47, v20
  v_sub_f32 v52, v52, v20
  v_sub_f32 v53, v53, v20
  v_sub_f32 v54, v54, v20
  v_sub_f32 v55, v55, v20
  v_mul_f32 v16, v16, v23
  v_mul_f32 v224, v224, v23
  v_mul_f32 v225, v225, v23
  v_mul_f32 v226, v226, v23
  v_mul_f32 v227, v227, v23
  v_mul_f32 v228, v228, v23
  v_mul_f32 v229, v229, v23
  v_mul_f32 v230, v230, v23
  v_mul_f32 v231, v231, v23
  v_mul_f32 v232, v232, v23
  v_mul_f32 v233, v233, v23
  v_mul_f32 v234, v234, v23
  v_mul_f32 v235, v235, v23
  v_mul_f32 v236, v236, v23
  v_mul_f32 v237, v237, v23
  v_mul_f32 v238, v238, v23
  v_mul_f32 v239, v239, v23
  v_mul_f32 v240, v240, v23
  v_mul_f32 v241, v241, v23
  v_mul_f32 v242, v242, v23
  v_mul_f32 v243, v243, v23
  v_mul_f32 v244, v244, v23
  v_mul_f32 v245, v245, v23
  v_mul_f32 v246, v246, v23
  v_mul_f32 v247, v247, v23
  v_mul_f32 v248, v248, v23
  v_mul_f32 v249, v249, v23
  v_mul_f32 v250, v250, v23
  v_mul_f32 v251, v251, v23
  v_mul_f32 v252, v252, v23
  v_mul_f32 v253, v253, v23
  v_mul_f32 v254, v254, v23
  v_mul_f32 v255, v255, v23
  s_nop 3
  s_setpc_b64 s[58:59]
L_Ac0:
L_Ac:
  s_mov_b32 s37, s32
  s_mov_b32 s36, 0
  s_mov_b32 s88, 0x3e0293ee
  s_mov_b32 s89, 0x3e0293ee
  v_lshrrev_b32 v19, 4, v0
  v_bfe_u32 v20, v0, 2, 2
  v_lshl_add_u32 v21, v19, 3, v20
  v_lshlrev_b32 v21, 8, v21
  v_and_b32 v19, 1, v19
  v_lshl_add_u32 v20, v19, 2, v20
  v_and_b32 v19, 3, v0
  v_lshl_add_u32 v21, v19, 3, v21
  v_xor_b32 v19, 6, v20
  v_lshl_add_u32 v48, v19, 5, v21
  v_xor_b32 v19, 7, v20
  v_lshl_add_u32 v49, v19, 5, v21
  v_bfe_u32 v19, v0, 1, 3
  v_lshrrev_b32 v20, 4, v0
  v_xor_b32 v19, v19, v20
  v_lshlrev_b32 v19, 4, v19
  v_and_b32 v20, 15, v0
  v_lshl_add_u32 v52, v20, 7, v19
  v_lshlrev_b32 v54, 4, v0
  v_lshrrev_b32 v19, 5, v0
  v_lshl_add_u32 v19, v19, 4, v20
  v_lshlrev_b32 v19, 4, v19
  v_bfe_u32 v20, v0, 4, 1
  v_lshl_add_u32 v19, v20, 3, v19
  v_add_u32 v55, 0x1e800, v19
  v_xor_b32 v53, 64, v52
  v_lshrrev_b32 v19, 4, v0
  v_bfe_u32 v20, v0, 2, 2
  v_lshl_add_u32 v21, v19, 3, v20
  v_lshlrev_b32 v21, 8, v21
  v_and_b32 v19, 1, v19
  v_lshl_add_u32 v20, v19, 2, v20
  v_and_b32 v19, 3, v0
  v_lshl_add_u32 v21, v19, 3, v21
  v_add_u32 v21, 92160, v21
  v_xor_b32 v19, 0, v20
  v_lshl_add_u32 v2, v19, 5, v21
  v_xor_b32 v19, 1, v20
  v_lshl_add_u32 v3, v19, 5, v21
  v_xor_b32 v19, 2, v20
  v_lshl_add_u32 v4, v19, 5, v21
  v_xor_b32 v19, 3, v20
  v_lshl_add_u32 v5, v19, 5, v21
  v_xor_b32 v19, 4, v20
  v_lshl_add_u32 v6, v19, 5, v21
  v_xor_b32 v19, 5, v20
  v_lshl_add_u32 v7, v19, 5, v21
  v_xor_b32 v19, 6, v20
  v_lshl_add_u32 v8, v19, 5, v21
  v_xor_b32 v19, 7, v20
  v_lshl_add_u32 v9, v19, 5, v21
  v_bfe_u32 v19, v0, 2, 2
  v_and_b32 v20, 3, v0
  v_lshl_add_u32 v21, v19, 3, v20
  v_lshlrev_b32 v21, 8, v21
  v_add_u32 v21, 59392, v21
  v_and_b32 v19, 7, v0
  v_lshlrev_b32 v19, 1, v19
  v_lshrrev_b32 v20, 4, v0
  v_xor_b32 v19, v19, v20
  v_xor_b32 v20, 0, v19
  v_lshl_add_u32 v10, v20, 4, v21
  v_xor_b32 v20, 4, v19
  v_lshl_add_u32 v11, v20, 4, v21
  v_xor_b32 v20, 8, v19
  v_lshl_add_u32 v12, v20, 4, v21
  v_xor_b32 v20, 12, v19
  v_lshl_add_u32 v13, v20, 4, v21
  v_lshlrev_b32 v14, 4, v0
  s_lshl_b32 s38, s37, 13
  s_add_u32 s38, s38, 0x1e800
  v_add_u32 v18, s38, v14
  v_mov_b32 v15, 0
  v_mov_b32 v16, 0
  v_mov_b32 v17, 0
  s_getpc_b64 s[42:43]
L_cpf:
  s_sub_u32 s42, s42, L_cpf-concat_heads__mha_block_cached__gqa_block_cached__near_ridge_kernel
  s_subb_u32 s43, s43, 0
  s_lshr_b32 s38, s2, 3
  s_mul_i32 s38, s38, 4096
  s_min_u32 s38, s38, L_end1-concat_heads__mha_block_cached__gqa_block_cached__near_ridge_kernel-4096
  v_lshlrev_b32 v232, 4, v0
  v_add_u32 v232, s38, v232
  global_load_dwordx4 v[234:237], v232, s[42:43] offset:0
  global_load_dwordx4 v[234:237], v232, s[42:43] offset:1024
  global_load_dwordx4 v[234:237], v232, s[42:43] offset:2048
  global_load_dwordx4 v[234:237], v232, s[42:43] offset:3072
  v_add_u32 v232, 4096, v232
  s_lshl_b32 s41, s33, 8
  s_add_u32 s41, s41, s34
  s_add_u32 s41, s41, 0x4000000
  s_lshl_b32 s42, s33, 3
  s_add_u32 s42, s42, s34
  v_mov_b32 v240, s41
  v_mov_b32 v241, 0
  v_mov_b32 v242, s42
  v_mov_b32 v243, 1
  s_mov_b64 exec, 1
  buffer_store_byte v241, v240, s[20:23], 0 offen sc1
  s_mov_b64 exec, -1
  s_waitcnt lgkmcnt(0)
  s_barrier
  v_add_u32 v52, 0xa000, v52
  v_add_u32 v53, 0xa000, v53
  ds_read_b64_tr_b16 v[24:25], v48
  ds_read_b64_tr_b16 v[26:27], v48 offset:1024
  ds_read_b64_tr_b16 v[28:29], v49
  ds_read_b64_tr_b16 v[30:31], v49 offset:1024
  ds_read_b128 v[56:59], v52
  ds_read_b128 v[60:63], v52 offset:2048
  ds_read_b128 v[64:67], v52 offset:4096
  ds_read_b128 v[68:71], v52 offset:6144
  ds_read_b128 v[72:75], v52 offset:8192
  ds_read_b128 v[76:79], v52 offset:10240
  ds_read_b128 v[80:83], v52 offset:12288
  ds_read_b128 v[84:87], v52 offset:14336
  ds_read_b128 v[88:91], v52 offset:16384
  s_waitcnt lgkmcnt(8)
  v_mfma_f32_16x16x32_bf16 v[152:155], v[24:27], v[56:59], 0
  ds_read_b64_tr_b16 v[140:141], v48 offset:8192
  v_mfma_f32_16x16x32_bf16 v[188:191], v[28:31], v[56:59], 0
  ds_read_b64_tr_b16 v[142:143], v48 offset:9216
  s_waitcnt lgkmcnt(9)
  v_mfma_f32_16x16x32_bf16 v[156:159], v[24:27], v[60:63], 0
  ds_read_b64_tr_b16 v[144:145], v49 offset:8192
  v_mfma_f32_16x16x32_bf16 v[192:195], v[28:31], v[60:63], 0
  ds_read_b64_tr_b16 v[146:147], v49 offset:9216
  s_waitcnt lgkmcnt(10)
  v_mfma_f32_16x16x32_bf16 v[160:163], v[24:27], v[64:67], 0
  ds_read_b128 v[104:107], v53
  v_mfma_f32_16x16x32_bf16 v[196:199], v[28:31], v[64:67], 0
  s_waitcnt lgkmcnt(10)
  v_mfma_f32_16x16x32_bf16 v[164:167], v[24:27], v[68:71], 0
  ds_read_b128 v[108:111], v53 offset:2048
  v_mfma_f32_16x16x32_bf16 v[200:203], v[28:31], v[68:71], 0
  ds_read_b128 v[112:115], v53 offset:4096
  s_waitcnt lgkmcnt(11)
  v_mfma_f32_16x16x32_bf16 v[168:171], v[24:27], v[72:75], 0
  ds_read_b128 v[116:119], v53 offset:6144
  v_mfma_f32_16x16x32_bf16 v[204:207], v[28:31], v[72:75], 0
  ds_read_b128 v[120:123], v53 offset:8192
  s_waitcnt lgkmcnt(12)
  v_mfma_f32_16x16x32_bf16 v[172:175], v[24:27], v[76:79], 0
  v_mfma_f32_16x16x32_bf16 v[208:211], v[28:31], v[76:79], 0
  ds_read_b128 v[124:127], v53 offset:10240
  s_waitcnt lgkmcnt(10)
  v_mfma_f32_16x16x32_bf16 v[176:179], v[24:27], v[80:83], 0
  ds_read_b128 v[128:131], v53 offset:12288
  v_mfma_f32_16x16x32_bf16 v[212:215], v[28:31], v[80:83], 0
  ds_read_b128 v[132:135], v53 offset:14336
  v_mfma_f32_16x16x32_bf16 v[180:183], v[24:27], v[84:87], 0
  ds_read_b128 v[136:139], v53 offset:16384
  v_mfma_f32_16x16x32_bf16 v[216:219], v[28:31], v[84:87], 0
  v_mfma_f32_16x16x32_bf16 v[184:187], v[24:27], v[88:91], 0
  v_mfma_f32_16x16x32_bf16 v[220:223], v[28:31], v[88:91], 0
  s_waitcnt lgkmcnt(8)
  v_mfma_f32_16x16x32_bf16 v[152:155], v[140:143], v[104:107], v[152:155]
  v_mfma_f32_16x16x32_bf16 v[188:191], v[144:147], v[104:107], v[188:191]
  s_waitcnt lgkmcnt(7)
  v_mfma_f32_16x16x32_bf16 v[156:159], v[140:143], v[108:111], v[156:159]
  v_mfma_f32_16x16x32_bf16 v[192:195], v[144:147], v[108:111], v[192:195]
  s_waitcnt lgkmcnt(6)
  v_mfma_f32_16x16x32_bf16 v[160:163], v[140:143], v[112:115], v[160:163]
  v_mfma_f32_16x16x32_bf16 v[196:199], v[144:147], v[112:115], v[196:199]
  s_waitcnt lgkmcnt(5)
  v_mfma_f32_16x16x32_bf16 v[164:167], v[140:143], v[116:119], v[164:167]
  v_mfma_f32_16x16x32_bf16 v[200:203], v[144:147], v[116:119], v[200:203]
  s_waitcnt lgkmcnt(4)
  v_mfma_f32_16x16x32_bf16 v[168:171], v[140:143], v[120:123], v[168:171]
  v_mfma_f32_16x16x32_bf16 v[204:207], v[144:147], v[120:123], v[204:207]
  s_waitcnt lgkmcnt(3)
  v_mfma_f32_16x16x32_bf16 v[172:175], v[140:143], v[124:127], v[172:175]
  v_mfma_f32_16x16x32_bf16 v[208:211], v[144:147], v[124:127], v[208:211]
  s_waitcnt lgkmcnt(2)
  v_mfma_f32_16x16x32_bf16 v[176:179], v[140:143], v[128:131], v[176:179]
  v_mfma_f32_16x16x32_bf16 v[212:215], v[144:147], v[128:131], v[212:215]
  s_waitcnt lgkmcnt(1)
  v_mfma_f32_16x16x32_bf16 v[180:183], v[140:143], v[132:135], v[180:183]
  v_mfma_f32_16x16x32_bf16 v[216:219], v[144:147], v[132:135], v[216:219]
  s_waitcnt lgkmcnt(0)
  v_mfma_f32_16x16x32_bf16 v[184:187], v[140:143], v[136:139], v[184:187]
  v_mfma_f32_16x16x32_bf16 v[220:223], v[144:147], v[136:139], v[220:223]
  s_waitcnt lgkmcnt(0)
  s_barrier
  ds_read_b64_tr_b16 v[24:25], v48 offset:16384
  ds_read_b64_tr_b16 v[26:27], v48 offset:17408
  ds_read_b64_tr_b16 v[28:29], v49 offset:16384
  ds_read_b64_tr_b16 v[30:31], v49 offset:17408
  ds_read_b128 v[56:59], v52 offset:26624
  ds_read_b128 v[60:63], v52 offset:28672
  ds_read_b128 v[64:67], v52 offset:30720
  ds_read_b128 v[68:71], v52 offset:32768
  ds_read_b128 v[72:75], v52 offset:34816
  ds_read_b128 v[76:79], v52 offset:36864
  ds_read_b128 v[80:83], v52 offset:38912
  ds_read_b128 v[84:87], v52 offset:40960
  ds_read_b128 v[88:91], v52 offset:43008
  s_waitcnt lgkmcnt(8)
  v_mfma_f32_16x16x32_bf16 v[152:155], v[24:27], v[56:59], v[152:155]
  ds_read_b64_tr_b16 v[140:141], v48 offset:24576
  v_mfma_f32_16x16x32_bf16 v[188:191], v[28:31], v[56:59], v[188:191]
  ds_read_b64_tr_b16 v[142:143], v48 offset:25600
  s_waitcnt lgkmcnt(9)
  v_mfma_f32_16x16x32_bf16 v[156:159], v[24:27], v[60:63], v[156:159]
  ds_read_b64_tr_b16 v[144:145], v49 offset:24576
  v_mfma_f32_16x16x32_bf16 v[192:195], v[28:31], v[60:63], v[192:195]
  ds_read_b64_tr_b16 v[146:147], v49 offset:25600
  s_waitcnt lgkmcnt(10)
  v_mfma_f32_16x16x32_bf16 v[160:163], v[24:27], v[64:67], v[160:163]
  ds_read_b128 v[104:107], v53 offset:26624
  v_mfma_f32_16x16x32_bf16 v[196:199], v[28:31], v[64:67], v[196:199]
  s_waitcnt lgkmcnt(10)
  v_mfma_f32_16x16x32_bf16 v[164:167], v[24:27], v[68:71], v[164:167]
  ds_read_b128 v[108:111], v53 offset:28672
  v_mfma_f32_16x16x32_bf16 v[200:203], v[28:31], v[68:71], v[200:203]
  ds_read_b128 v[112:115], v53 offset:30720
  s_waitcnt lgkmcnt(11)
  v_mfma_f32_16x16x32_bf16 v[168:171], v[24:27], v[72:75], v[168:171]
  ds_read_b128 v[116:119], v53 offset:32768
  v_mfma_f32_16x16x32_bf16 v[204:207], v[28:31], v[72:75], v[204:207]
  ds_read_b128 v[120:123], v53 offset:34816
  s_waitcnt lgkmcnt(12)
  v_mfma_f32_16x16x32_bf16 v[172:175], v[24:27], v[76:79], v[172:175]
  v_mfma_f32_16x16x32_bf16 v[208:211], v[28:31], v[76:79], v[208:211]
  ds_read_b128 v[124:127], v53 offset:36864
  s_waitcnt lgkmcnt(10)
  v_mfma_f32_16x16x32_bf16 v[176:179], v[24:27], v[80:83], v[176:179]
  ds_read_b128 v[128:131], v53 offset:38912
  v_mfma_f32_16x16x32_bf16 v[212:215], v[28:31], v[80:83], v[212:215]
  ds_read_b128 v[132:135], v53 offset:40960
  v_mfma_f32_16x16x32_bf16 v[180:183], v[24:27], v[84:87], v[180:183]
  ds_read_b128 v[136:139], v53 offset:43008
  v_mfma_f32_16x16x32_bf16 v[216:219], v[28:31], v[84:87], v[216:219]
  v_mfma_f32_16x16x32_bf16 v[184:187], v[24:27], v[88:91], v[184:187]
  v_mfma_f32_16x16x32_bf16 v[220:223], v[28:31], v[88:91], v[220:223]
  s_waitcnt lgkmcnt(8)
  v_mfma_f32_16x16x32_bf16 v[152:155], v[140:143], v[104:107], v[152:155]
  v_mfma_f32_16x16x32_bf16 v[188:191], v[144:147], v[104:107], v[188:191]
  s_waitcnt lgkmcnt(7)
  v_mfma_f32_16x16x32_bf16 v[156:159], v[140:143], v[108:111], v[156:159]
  v_mfma_f32_16x16x32_bf16 v[192:195], v[144:147], v[108:111], v[192:195]
  s_waitcnt lgkmcnt(6)
  v_mfma_f32_16x16x32_bf16 v[160:163], v[140:143], v[112:115], v[160:163]
  v_mfma_f32_16x16x32_bf16 v[196:199], v[144:147], v[112:115], v[196:199]
  s_waitcnt lgkmcnt(5)
  v_mfma_f32_16x16x32_bf16 v[164:167], v[140:143], v[116:119], v[164:167]
  v_mfma_f32_16x16x32_bf16 v[200:203], v[144:147], v[116:119], v[200:203]
  s_waitcnt lgkmcnt(4)
  v_mfma_f32_16x16x32_bf16 v[168:171], v[140:143], v[120:123], v[168:171]
  v_mfma_f32_16x16x32_bf16 v[204:207], v[144:147], v[120:123], v[204:207]
  s_waitcnt lgkmcnt(3)
  v_mfma_f32_16x16x32_bf16 v[172:175], v[140:143], v[124:127], v[172:175]
  v_mfma_f32_16x16x32_bf16 v[208:211], v[144:147], v[124:127], v[208:211]
  s_waitcnt lgkmcnt(2)
  v_mfma_f32_16x16x32_bf16 v[176:179], v[140:143], v[128:131], v[176:179]
  v_mfma_f32_16x16x32_bf16 v[212:215], v[144:147], v[128:131], v[212:215]
  s_waitcnt lgkmcnt(1)
  v_mfma_f32_16x16x32_bf16 v[180:183], v[140:143], v[132:135], v[180:183]
  v_mfma_f32_16x16x32_bf16 v[216:219], v[144:147], v[132:135], v[216:219]
  s_waitcnt lgkmcnt(0)
  v_mfma_f32_16x16x32_bf16 v[184:187], v[140:143], v[136:139], v[184:187]
  v_mfma_f32_16x16x32_bf16 v[220:223], v[144:147], v[136:139], v[220:223]
  s_waitcnt lgkmcnt(0)
  s_barrier
  v_add_u32 v48, 0x1e800, v48
  v_add_u32 v49, 0x1e800, v49
  v_add_u32 v52, 0x14800, v52
  v_add_u32 v53, 0x14800, v53
  ds_read_b64_tr_b16 v[24:25], v48
  ds_read_b64_tr_b16 v[26:27], v48 offset:1024
  ds_read_b64_tr_b16 v[28:29], v49
  ds_read_b64_tr_b16 v[30:31], v49 offset:1024
  ds_read_b128 v[56:59], v52 offset:16384
  ds_read_b128 v[60:63], v52 offset:18432
  ds_read_b128 v[64:67], v52 offset:20480
  ds_read_b128 v[68:71], v52 offset:22528
  ds_read_b128 v[72:75], v52 offset:24576
  ds_read_b128 v[76:79], v52 offset:26624
  ds_read_b128 v[80:83], v52 offset:28672
  ds_read_b128 v[84:87], v52 offset:30720
  ds_read_b128 v[88:91], v52 offset:32768
  s_waitcnt lgkmcnt(8)
  v_mfma_f32_16x16x32_bf16 v[152:155], v[24:27], v[56:59], v[152:155]
  ds_read_b64_tr_b16 v[140:141], v48 offset:8192
  v_mfma_f32_16x16x32_bf16 v[188:191], v[28:31], v[56:59], v[188:191]
  ds_read_b64_tr_b16 v[142:143], v48 offset:9216
  s_waitcnt lgkmcnt(9)
  v_mfma_f32_16x16x32_bf16 v[156:159], v[24:27], v[60:63], v[156:159]
  ds_read_b64_tr_b16 v[144:145], v49 offset:8192
  v_mfma_f32_16x16x32_bf16 v[192:195], v[28:31], v[60:63], v[192:195]
  ds_read_b64_tr_b16 v[146:147], v49 offset:9216
  s_waitcnt lgkmcnt(10)
  v_mfma_f32_16x16x32_bf16 v[160:163], v[24:27], v[64:67], v[160:163]
  ds_read_b128 v[104:107], v53 offset:16384
  v_mfma_f32_16x16x32_bf16 v[196:199], v[28:31], v[64:67], v[196:199]
  s_waitcnt lgkmcnt(10)
  v_mfma_f32_16x16x32_bf16 v[164:167], v[24:27], v[68:71], v[164:167]
  ds_read_b128 v[108:111], v53 offset:18432
  v_mfma_f32_16x16x32_bf16 v[200:203], v[28:31], v[68:71], v[200:203]
  ds_read_b128 v[112:115], v53 offset:20480
  s_waitcnt lgkmcnt(11)
  v_mfma_f32_16x16x32_bf16 v[168:171], v[24:27], v[72:75], v[168:171]
  ds_read_b128 v[116:119], v53 offset:22528
  v_mfma_f32_16x16x32_bf16 v[204:207], v[28:31], v[72:75], v[204:207]
  ds_read_b128 v[120:123], v53 offset:24576
  s_waitcnt lgkmcnt(12)
  v_mfma_f32_16x16x32_bf16 v[172:175], v[24:27], v[76:79], v[172:175]
  v_mfma_f32_16x16x32_bf16 v[208:211], v[28:31], v[76:79], v[208:211]
  ds_read_b128 v[124:127], v53 offset:26624
  s_waitcnt lgkmcnt(10)
  v_mfma_f32_16x16x32_bf16 v[176:179], v[24:27], v[80:83], v[176:179]
  ds_read_b128 v[128:131], v53 offset:28672
  v_mfma_f32_16x16x32_bf16 v[212:215], v[28:31], v[80:83], v[212:215]
  ds_read_b128 v[132:135], v53 offset:30720
  v_mfma_f32_16x16x32_bf16 v[180:183], v[24:27], v[84:87], v[180:183]
  ds_read_b128 v[136:139], v53 offset:32768
  v_mfma_f32_16x16x32_bf16 v[216:219], v[28:31], v[84:87], v[216:219]
  v_mfma_f32_16x16x32_bf16 v[184:187], v[24:27], v[88:91], v[184:187]
  v_mfma_f32_16x16x32_bf16 v[220:223], v[28:31], v[88:91], v[220:223]
  s_waitcnt lgkmcnt(8)
  v_mfma_f32_16x16x32_bf16 v[152:155], v[140:143], v[104:107], v[152:155]
  v_mfma_f32_16x16x32_bf16 v[188:191], v[144:147], v[104:107], v[188:191]
  s_waitcnt lgkmcnt(7)
  v_mfma_f32_16x16x32_bf16 v[156:159], v[140:143], v[108:111], v[156:159]
  v_mfma_f32_16x16x32_bf16 v[192:195], v[144:147], v[108:111], v[192:195]
  s_waitcnt lgkmcnt(6)
  v_mfma_f32_16x16x32_bf16 v[160:163], v[140:143], v[112:115], v[160:163]
  v_mfma_f32_16x16x32_bf16 v[196:199], v[144:147], v[112:115], v[196:199]
  s_waitcnt lgkmcnt(5)
  v_mfma_f32_16x16x32_bf16 v[164:167], v[140:143], v[116:119], v[164:167]
  v_mfma_f32_16x16x32_bf16 v[200:203], v[144:147], v[116:119], v[200:203]
  s_waitcnt lgkmcnt(4)
  v_mfma_f32_16x16x32_bf16 v[168:171], v[140:143], v[120:123], v[168:171]
  v_mfma_f32_16x16x32_bf16 v[204:207], v[144:147], v[120:123], v[204:207]
  s_waitcnt lgkmcnt(3)
  v_mfma_f32_16x16x32_bf16 v[172:175], v[140:143], v[124:127], v[172:175]
  v_mfma_f32_16x16x32_bf16 v[208:211], v[144:147], v[124:127], v[208:211]
  s_waitcnt lgkmcnt(2)
  v_mfma_f32_16x16x32_bf16 v[176:179], v[140:143], v[128:131], v[176:179]
  v_mfma_f32_16x16x32_bf16 v[212:215], v[144:147], v[128:131], v[212:215]
  s_waitcnt lgkmcnt(1)
  v_mfma_f32_16x16x32_bf16 v[180:183], v[140:143], v[132:135], v[180:183]
  v_mfma_f32_16x16x32_bf16 v[216:219], v[144:147], v[132:135], v[216:219]
  s_waitcnt lgkmcnt(0)
  v_mfma_f32_16x16x32_bf16 v[184:187], v[140:143], v[136:139], v[184:187]
  v_mfma_f32_16x16x32_bf16 v[220:223], v[144:147], v[136:139], v[220:223]
  s_waitcnt lgkmcnt(0)
  s_barrier
  v_subrev_u32 v48, 0x1e800, v48
  v_subrev_u32 v49, 0x1e800, v49
  v_subrev_u32 v52, 0x14800, v52
  v_subrev_u32 v53, 0x14800, v53
  ds_read_b64_tr_b16 v[24:25], v48
  ds_read_b64_tr_b16 v[26:27], v48 offset:1024
  ds_read_b64_tr_b16 v[28:29], v49
  ds_read_b64_tr_b16 v[30:31], v49 offset:1024
  ds_read_b128 v[56:59], v52
  ds_read_b128 v[60:63], v52 offset:2048
  ds_read_b128 v[64:67], v52 offset:4096
  ds_read_b128 v[68:71], v52 offset:6144
  ds_read_b128 v[72:75], v52 offset:8192
  ds_read_b128 v[76:79], v52 offset:10240
  ds_read_b128 v[80:83], v52 offset:12288
  ds_read_b128 v[84:87], v52 offset:14336
  ds_read_b128 v[88:91], v52 offset:16384
  s_waitcnt lgkmcnt(8)
  v_mfma_f32_16x16x32_bf16 v[152:155], v[24:27], v[56:59], v[152:155]
  ds_read_b64_tr_b16 v[140:141], v48 offset:8192
  v_mfma_f32_16x16x32_bf16 v[188:191], v[28:31], v[56:59], v[188:191]
  ds_read_b64_tr_b16 v[142:143], v48 offset:9216
  s_waitcnt lgkmcnt(9)
  v_mfma_f32_16x16x32_bf16 v[156:159], v[24:27], v[60:63], v[156:159]
  ds_read_b64_tr_b16 v[144:145], v49 offset:8192
  v_mfma_f32_16x16x32_bf16 v[192:195], v[28:31], v[60:63], v[192:195]
  ds_read_b64_tr_b16 v[146:147], v49 offset:9216
  s_waitcnt lgkmcnt(10)
  v_mfma_f32_16x16x32_bf16 v[160:163], v[24:27], v[64:67], v[160:163]
  ds_read_b128 v[104:107], v53
  v_mfma_f32_16x16x32_bf16 v[196:199], v[28:31], v[64:67], v[196:199]
  s_waitcnt lgkmcnt(10)
  v_mfma_f32_16x16x32_bf16 v[164:167], v[24:27], v[68:71], v[164:167]
  ds_read_b128 v[108:111], v53 offset:2048
  v_mfma_f32_16x16x32_bf16 v[200:203], v[28:31], v[68:71], v[200:203]
  ds_read_b128 v[112:115], v53 offset:4096
  s_waitcnt lgkmcnt(11)
  v_mfma_f32_16x16x32_bf16 v[168:171], v[24:27], v[72:75], v[168:171]
  ds_read_b128 v[116:119], v53 offset:6144
  v_mfma_f32_16x16x32_bf16 v[204:207], v[28:31], v[72:75], v[204:207]
  ds_read_b128 v[120:123], v53 offset:8192
  s_waitcnt lgkmcnt(12)
  v_mfma_f32_16x16x32_bf16 v[172:175], v[24:27], v[76:79], v[172:175]
  v_mfma_f32_16x16x32_bf16 v[208:211], v[28:31], v[76:79], v[208:211]
  ds_read_b128 v[124:127], v53 offset:10240
  s_waitcnt lgkmcnt(10)
  v_mfma_f32_16x16x32_bf16 v[176:179], v[24:27], v[80:83], v[176:179]
  ds_read_b128 v[128:131], v53 offset:12288
  v_mfma_f32_16x16x32_bf16 v[212:215], v[28:31], v[80:83], v[212:215]
  ds_read_b128 v[132:135], v53 offset:14336
  v_mfma_f32_16x16x32_bf16 v[180:183], v[24:27], v[84:87], v[180:183]
  ds_read_b128 v[136:139], v53 offset:16384
  v_mfma_f32_16x16x32_bf16 v[216:219], v[28:31], v[84:87], v[216:219]
  v_mfma_f32_16x16x32_bf16 v[184:187], v[24:27], v[88:91], v[184:187]
  v_mfma_f32_16x16x32_bf16 v[220:223], v[28:31], v[88:91], v[220:223]
  s_waitcnt lgkmcnt(8)
  v_mfma_f32_16x16x32_bf16 v[152:155], v[140:143], v[104:107], v[152:155]
  v_mfma_f32_16x16x32_bf16 v[188:191], v[144:147], v[104:107], v[188:191]
  s_waitcnt lgkmcnt(7)
  v_mfma_f32_16x16x32_bf16 v[156:159], v[140:143], v[108:111], v[156:159]
  v_mfma_f32_16x16x32_bf16 v[192:195], v[144:147], v[108:111], v[192:195]
  s_waitcnt lgkmcnt(6)
  v_mfma_f32_16x16x32_bf16 v[160:163], v[140:143], v[112:115], v[160:163]
  v_mfma_f32_16x16x32_bf16 v[196:199], v[144:147], v[112:115], v[196:199]
  s_waitcnt lgkmcnt(5)
  v_mfma_f32_16x16x32_bf16 v[164:167], v[140:143], v[116:119], v[164:167]
  v_mfma_f32_16x16x32_bf16 v[200:203], v[144:147], v[116:119], v[200:203]
  s_waitcnt lgkmcnt(4)
  v_mfma_f32_16x16x32_bf16 v[168:171], v[140:143], v[120:123], v[168:171]
  v_mfma_f32_16x16x32_bf16 v[204:207], v[144:147], v[120:123], v[204:207]
  s_waitcnt lgkmcnt(3)
  v_mfma_f32_16x16x32_bf16 v[172:175], v[140:143], v[124:127], v[172:175]
  v_mfma_f32_16x16x32_bf16 v[208:211], v[144:147], v[124:127], v[208:211]
  s_waitcnt lgkmcnt(2)
  v_mfma_f32_16x16x32_bf16 v[176:179], v[140:143], v[128:131], v[176:179]
  v_mfma_f32_16x16x32_bf16 v[212:215], v[144:147], v[128:131], v[212:215]
  s_waitcnt lgkmcnt(1)
  v_mfma_f32_16x16x32_bf16 v[180:183], v[140:143], v[132:135], v[180:183]
  v_mfma_f32_16x16x32_bf16 v[216:219], v[144:147], v[132:135], v[216:219]
  s_waitcnt lgkmcnt(0)
  v_mfma_f32_16x16x32_bf16 v[184:187], v[140:143], v[136:139], v[184:187]
  v_mfma_f32_16x16x32_bf16 v[220:223], v[144:147], v[136:139], v[220:223]
  s_waitcnt lgkmcnt(0)
  s_barrier
  ds_read_b64_tr_b16 v[24:25], v48 offset:16384
  ds_read_b64_tr_b16 v[26:27], v48 offset:17408
  ds_read_b64_tr_b16 v[28:29], v49 offset:16384
  ds_read_b64_tr_b16 v[30:31], v49 offset:17408
  ds_read_b128 v[56:59], v52 offset:26624
  ds_read_b128 v[60:63], v52 offset:28672
  ds_read_b128 v[64:67], v52 offset:30720
  ds_read_b128 v[68:71], v52 offset:32768
  ds_read_b128 v[72:75], v52 offset:34816
  ds_read_b128 v[76:79], v52 offset:36864
  ds_read_b128 v[80:83], v52 offset:38912
  ds_read_b128 v[84:87], v52 offset:40960
  ds_read_b128 v[88:91], v52 offset:43008
  s_waitcnt lgkmcnt(8)
  v_mfma_f32_16x16x32_bf16 v[152:155], v[24:27], v[56:59], v[152:155]
  ds_read_b64_tr_b16 v[140:141], v48 offset:24576
  v_mfma_f32_16x16x32_bf16 v[188:191], v[28:31], v[56:59], v[188:191]
  ds_read_b64_tr_b16 v[142:143], v48 offset:25600
  s_waitcnt lgkmcnt(9)
  v_mfma_f32_16x16x32_bf16 v[156:159], v[24:27], v[60:63], v[156:159]
  ds_read_b64_tr_b16 v[144:145], v49 offset:24576
  v_mfma_f32_16x16x32_bf16 v[192:195], v[28:31], v[60:63], v[192:195]
  ds_read_b64_tr_b16 v[146:147], v49 offset:25600
  s_waitcnt lgkmcnt(10)
  v_mfma_f32_16x16x32_bf16 v[160:163], v[24:27], v[64:67], v[160:163]
  ds_read_b128 v[104:107], v53 offset:26624
  v_mfma_f32_16x16x32_bf16 v[196:199], v[28:31], v[64:67], v[196:199]
  s_waitcnt lgkmcnt(10)
  v_mfma_f32_16x16x32_bf16 v[164:167], v[24:27], v[68:71], v[164:167]
  ds_read_b128 v[108:111], v53 offset:28672
  v_mfma_f32_16x16x32_bf16 v[200:203], v[28:31], v[68:71], v[200:203]
  ds_read_b128 v[112:115], v53 offset:30720
  s_waitcnt lgkmcnt(11)
  v_mfma_f32_16x16x32_bf16 v[168:171], v[24:27], v[72:75], v[168:171]
  ds_read_b128 v[116:119], v53 offset:32768
  v_mfma_f32_16x16x32_bf16 v[204:207], v[28:31], v[72:75], v[204:207]
  ds_read_b128 v[120:123], v53 offset:34816
  s_waitcnt lgkmcnt(12)
  v_mfma_f32_16x16x32_bf16 v[172:175], v[24:27], v[76:79], v[172:175]
  v_mfma_f32_16x16x32_bf16 v[208:211], v[28:31], v[76:79], v[208:211]
  ds_read_b128 v[124:127], v53 offset:36864
  s_waitcnt lgkmcnt(10)
  v_mfma_f32_16x16x32_bf16 v[176:179], v[24:27], v[80:83], v[176:179]
  ds_read_b128 v[128:131], v53 offset:38912
  v_mfma_f32_16x16x32_bf16 v[212:215], v[28:31], v[80:83], v[212:215]
  ds_read_b128 v[132:135], v53 offset:40960
  v_mfma_f32_16x16x32_bf16 v[180:183], v[24:27], v[84:87], v[180:183]
  ds_read_b128 v[136:139], v53 offset:43008
  v_mfma_f32_16x16x32_bf16 v[216:219], v[28:31], v[84:87], v[216:219]
  v_mfma_f32_16x16x32_bf16 v[184:187], v[24:27], v[88:91], v[184:187]
  v_mfma_f32_16x16x32_bf16 v[220:223], v[28:31], v[88:91], v[220:223]
  s_waitcnt lgkmcnt(8)
  v_mfma_f32_16x16x32_bf16 v[152:155], v[140:143], v[104:107], v[152:155]
  v_mfma_f32_16x16x32_bf16 v[188:191], v[144:147], v[104:107], v[188:191]
  s_waitcnt lgkmcnt(7)
  v_mfma_f32_16x16x32_bf16 v[156:159], v[140:143], v[108:111], v[156:159]
  v_mfma_f32_16x16x32_bf16 v[192:195], v[144:147], v[108:111], v[192:195]
  s_waitcnt lgkmcnt(6)
  v_mfma_f32_16x16x32_bf16 v[160:163], v[140:143], v[112:115], v[160:163]
  v_mfma_f32_16x16x32_bf16 v[196:199], v[144:147], v[112:115], v[196:199]
  s_waitcnt lgkmcnt(5)
  v_mfma_f32_16x16x32_bf16 v[164:167], v[140:143], v[116:119], v[164:167]
  v_mfma_f32_16x16x32_bf16 v[200:203], v[144:147], v[116:119], v[200:203]
  s_waitcnt lgkmcnt(4)
  v_mfma_f32_16x16x32_bf16 v[168:171], v[140:143], v[120:123], v[168:171]
  v_mfma_f32_16x16x32_bf16 v[204:207], v[144:147], v[120:123], v[204:207]
  s_waitcnt lgkmcnt(3)
  v_mfma_f32_16x16x32_bf16 v[172:175], v[140:143], v[124:127], v[172:175]
  v_mfma_f32_16x16x32_bf16 v[208:211], v[144:147], v[124:127], v[208:211]
  s_waitcnt lgkmcnt(2)
  v_mfma_f32_16x16x32_bf16 v[176:179], v[140:143], v[128:131], v[176:179]
  v_mfma_f32_16x16x32_bf16 v[212:215], v[144:147], v[128:131], v[212:215]
  s_waitcnt lgkmcnt(1)
  v_mfma_f32_16x16x32_bf16 v[180:183], v[140:143], v[132:135], v[180:183]
  v_mfma_f32_16x16x32_bf16 v[216:219], v[144:147], v[132:135], v[216:219]
  s_waitcnt lgkmcnt(0)
  v_mfma_f32_16x16x32_bf16 v[184:187], v[140:143], v[136:139], v[184:187]
  v_mfma_f32_16x16x32_bf16 v[220:223], v[144:147], v[136:139], v[220:223]
  s_waitcnt lgkmcnt(0)
  s_barrier
  v_add_u32 v48, 0x1e800, v48
  v_add_u32 v49, 0x1e800, v49
  v_add_u32 v52, 0x14800, v52
  v_add_u32 v53, 0x14800, v53
  ds_read_b64_tr_b16 v[24:25], v48
  ds_read_b64_tr_b16 v[26:27], v48 offset:1024
  ds_read_b64_tr_b16 v[28:29], v49
  ds_read_b64_tr_b16 v[30:31], v49 offset:1024
  ds_read_b128 v[56:59], v52 offset:16384
  ds_read_b128 v[60:63], v52 offset:18432
  ds_read_b128 v[64:67], v52 offset:20480
  ds_read_b128 v[68:71], v52 offset:22528
  ds_read_b128 v[72:75], v52 offset:24576
  ds_read_b128 v[76:79], v52 offset:26624
  ds_read_b128 v[80:83], v52 offset:28672
  ds_read_b128 v[84:87], v52 offset:30720
  ds_read_b128 v[88:91], v52 offset:32768
  s_waitcnt lgkmcnt(8)
  v_mfma_f32_16x16x32_bf16 v[152:155], v[24:27], v[56:59], v[152:155]
  ds_read_b64_tr_b16 v[140:141], v48 offset:8192
  v_mfma_f32_16x16x32_bf16 v[188:191], v[28:31], v[56:59], v[188:191]
  ds_read_b64_tr_b16 v[142:143], v48 offset:9216
  s_waitcnt lgkmcnt(9)
  v_mfma_f32_16x16x32_bf16 v[156:159], v[24:27], v[60:63], v[156:159]
  ds_read_b64_tr_b16 v[144:145], v49 offset:8192
  v_mfma_f32_16x16x32_bf16 v[192:195], v[28:31], v[60:63], v[192:195]
  ds_read_b64_tr_b16 v[146:147], v49 offset:9216
  s_waitcnt lgkmcnt(10)
  v_mfma_f32_16x16x32_bf16 v[160:163], v[24:27], v[64:67], v[160:163]
  ds_read_b128 v[104:107], v53 offset:16384
  v_mfma_f32_16x16x32_bf16 v[196:199], v[28:31], v[64:67], v[196:199]
  s_waitcnt lgkmcnt(10)
  v_mfma_f32_16x16x32_bf16 v[164:167], v[24:27], v[68:71], v[164:167]
  ds_read_b128 v[108:111], v53 offset:18432
  v_mfma_f32_16x16x32_bf16 v[200:203], v[28:31], v[68:71], v[200:203]
  ds_read_b128 v[112:115], v53 offset:20480
  s_waitcnt lgkmcnt(11)
  v_mfma_f32_16x16x32_bf16 v[168:171], v[24:27], v[72:75], v[168:171]
  ds_read_b128 v[116:119], v53 offset:22528
  v_mfma_f32_16x16x32_bf16 v[204:207], v[28:31], v[72:75], v[204:207]
  ds_read_b128 v[120:123], v53 offset:24576
  s_waitcnt lgkmcnt(12)
  v_mfma_f32_16x16x32_bf16 v[172:175], v[24:27], v[76:79], v[172:175]
  v_mfma_f32_16x16x32_bf16 v[208:211], v[28:31], v[76:79], v[208:211]
  ds_read_b128 v[124:127], v53 offset:26624
  s_waitcnt lgkmcnt(10)
  v_mfma_f32_16x16x32_bf16 v[176:179], v[24:27], v[80:83], v[176:179]
  ds_read_b128 v[128:131], v53 offset:28672
  v_mfma_f32_16x16x32_bf16 v[212:215], v[28:31], v[80:83], v[212:215]
  ds_read_b128 v[132:135], v53 offset:30720
  v_mfma_f32_16x16x32_bf16 v[180:183], v[24:27], v[84:87], v[180:183]
  ds_read_b128 v[136:139], v53 offset:32768
  v_mfma_f32_16x16x32_bf16 v[216:219], v[28:31], v[84:87], v[216:219]
  v_mfma_f32_16x16x32_bf16 v[184:187], v[24:27], v[88:91], v[184:187]
  v_mfma_f32_16x16x32_bf16 v[220:223], v[28:31], v[88:91], v[220:223]
  s_waitcnt lgkmcnt(8)
  v_mfma_f32_16x16x32_bf16 v[152:155], v[140:143], v[104:107], v[152:155]
  v_mfma_f32_16x16x32_bf16 v[188:191], v[144:147], v[104:107], v[188:191]
  s_waitcnt lgkmcnt(7)
  v_mfma_f32_16x16x32_bf16 v[156:159], v[140:143], v[108:111], v[156:159]
  v_mfma_f32_16x16x32_bf16 v[192:195], v[144:147], v[108:111], v[192:195]
  s_waitcnt lgkmcnt(6)
  v_mfma_f32_16x16x32_bf16 v[160:163], v[140:143], v[112:115], v[160:163]
  v_mfma_f32_16x16x32_bf16 v[196:199], v[144:147], v[112:115], v[196:199]
  s_waitcnt lgkmcnt(5)
  v_mfma_f32_16x16x32_bf16 v[164:167], v[140:143], v[116:119], v[164:167]
  v_mfma_f32_16x16x32_bf16 v[200:203], v[144:147], v[116:119], v[200:203]
  s_waitcnt lgkmcnt(4)
  v_mfma_f32_16x16x32_bf16 v[168:171], v[140:143], v[120:123], v[168:171]
  v_mfma_f32_16x16x32_bf16 v[204:207], v[144:147], v[120:123], v[204:207]
  s_waitcnt lgkmcnt(3)
  v_mfma_f32_16x16x32_bf16 v[172:175], v[140:143], v[124:127], v[172:175]
  v_mfma_f32_16x16x32_bf16 v[208:211], v[144:147], v[124:127], v[208:211]
  s_waitcnt lgkmcnt(2)
  v_mfma_f32_16x16x32_bf16 v[176:179], v[140:143], v[128:131], v[176:179]
  v_mfma_f32_16x16x32_bf16 v[212:215], v[144:147], v[128:131], v[212:215]
  s_waitcnt lgkmcnt(1)
  v_mfma_f32_16x16x32_bf16 v[180:183], v[140:143], v[132:135], v[180:183]
  v_mfma_f32_16x16x32_bf16 v[216:219], v[144:147], v[132:135], v[216:219]
  s_waitcnt lgkmcnt(0)
  v_mfma_f32_16x16x32_bf16 v[184:187], v[140:143], v[136:139], v[184:187]
  v_mfma_f32_16x16x32_bf16 v[220:223], v[144:147], v[136:139], v[220:223]
  s_waitcnt lgkmcnt(0)
  s_barrier
  v_subrev_u32 v48, 0x1e800, v48
  v_subrev_u32 v49, 0x1e800, v49
  v_subrev_u32 v52, 0x14800, v52
  v_subrev_u32 v53, 0x14800, v53
  ds_read_b64_tr_b16 v[24:25], v48
  ds_read_b64_tr_b16 v[26:27], v48 offset:1024
  ds_read_b64_tr_b16 v[28:29], v49
  ds_read_b64_tr_b16 v[30:31], v49 offset:1024
  ds_read_b128 v[56:59], v52
  ds_read_b128 v[60:63], v52 offset:2048
  ds_read_b128 v[64:67], v52 offset:4096
  ds_read_b128 v[68:71], v52 offset:6144
  ds_read_b128 v[72:75], v52 offset:8192
  ds_read_b128 v[76:79], v52 offset:10240
  ds_read_b128 v[80:83], v52 offset:12288
  ds_read_b128 v[84:87], v52 offset:14336
  ds_read_b128 v[88:91], v52 offset:16384
  s_waitcnt lgkmcnt(8)
  v_mfma_f32_16x16x32_bf16 v[152:155], v[24:27], v[56:59], v[152:155]
  ds_read_b64_tr_b16 v[140:141], v48 offset:8192
  v_mfma_f32_16x16x32_bf16 v[188:191], v[28:31], v[56:59], v[188:191]
  ds_read_b64_tr_b16 v[142:143], v48 offset:9216
  s_waitcnt lgkmcnt(9)
  v_mfma_f32_16x16x32_bf16 v[156:159], v[24:27], v[60:63], v[156:159]
  ds_read_b64_tr_b16 v[144:145], v49 offset:8192
  v_mfma_f32_16x16x32_bf16 v[192:195], v[28:31], v[60:63], v[192:195]
  ds_read_b64_tr_b16 v[146:147], v49 offset:9216
  s_waitcnt lgkmcnt(10)
  v_mfma_f32_16x16x32_bf16 v[160:163], v[24:27], v[64:67], v[160:163]
  ds_read_b128 v[104:107], v53
  v_mfma_f32_16x16x32_bf16 v[196:199], v[28:31], v[64:67], v[196:199]
  s_waitcnt lgkmcnt(10)
  v_mfma_f32_16x16x32_bf16 v[164:167], v[24:27], v[68:71], v[164:167]
  ds_read_b128 v[108:111], v53 offset:2048
  v_mfma_f32_16x16x32_bf16 v[200:203], v[28:31], v[68:71], v[200:203]
  ds_read_b128 v[112:115], v53 offset:4096
  s_waitcnt lgkmcnt(11)
  v_mfma_f32_16x16x32_bf16 v[168:171], v[24:27], v[72:75], v[168:171]
  ds_read_b128 v[116:119], v53 offset:6144
  v_mfma_f32_16x16x32_bf16 v[204:207], v[28:31], v[72:75], v[204:207]
  ds_read_b128 v[120:123], v53 offset:8192
  s_waitcnt lgkmcnt(12)
  v_mfma_f32_16x16x32_bf16 v[172:175], v[24:27], v[76:79], v[172:175]
  v_mfma_f32_16x16x32_bf16 v[208:211], v[28:31], v[76:79], v[208:211]
  ds_read_b128 v[124:127], v53 offset:10240
  s_waitcnt lgkmcnt(10)
  v_mfma_f32_16x16x32_bf16 v[176:179], v[24:27], v[80:83], v[176:179]
  ds_read_b128 v[128:131], v53 offset:12288
  v_mfma_f32_16x16x32_bf16 v[212:215], v[28:31], v[80:83], v[212:215]
  ds_read_b128 v[132:135], v53 offset:14336
  v_mfma_f32_16x16x32_bf16 v[180:183], v[24:27], v[84:87], v[180:183]
  ds_read_b128 v[136:139], v53 offset:16384
  v_mfma_f32_16x16x32_bf16 v[216:219], v[28:31], v[84:87], v[216:219]
  v_mfma_f32_16x16x32_bf16 v[184:187], v[24:27], v[88:91], v[184:187]
  v_mfma_f32_16x16x32_bf16 v[220:223], v[28:31], v[88:91], v[220:223]
  s_waitcnt lgkmcnt(8)
  v_mfma_f32_16x16x32_bf16 v[152:155], v[140:143], v[104:107], v[152:155]
  v_mfma_f32_16x16x32_bf16 v[188:191], v[144:147], v[104:107], v[188:191]
  s_waitcnt lgkmcnt(7)
  v_mfma_f32_16x16x32_bf16 v[156:159], v[140:143], v[108:111], v[156:159]
  v_mfma_f32_16x16x32_bf16 v[192:195], v[144:147], v[108:111], v[192:195]
  s_waitcnt lgkmcnt(6)
  v_mfma_f32_16x16x32_bf16 v[160:163], v[140:143], v[112:115], v[160:163]
  v_mfma_f32_16x16x32_bf16 v[196:199], v[144:147], v[112:115], v[196:199]
  s_waitcnt lgkmcnt(5)
  v_mfma_f32_16x16x32_bf16 v[164:167], v[140:143], v[116:119], v[164:167]
  v_mfma_f32_16x16x32_bf16 v[200:203], v[144:147], v[116:119], v[200:203]
  s_waitcnt lgkmcnt(4)
  v_mfma_f32_16x16x32_bf16 v[168:171], v[140:143], v[120:123], v[168:171]
  v_mfma_f32_16x16x32_bf16 v[204:207], v[144:147], v[120:123], v[204:207]
  s_waitcnt lgkmcnt(3)
  v_mfma_f32_16x16x32_bf16 v[172:175], v[140:143], v[124:127], v[172:175]
  v_mfma_f32_16x16x32_bf16 v[208:211], v[144:147], v[124:127], v[208:211]
  s_waitcnt lgkmcnt(2)
  v_mfma_f32_16x16x32_bf16 v[176:179], v[140:143], v[128:131], v[176:179]
  v_mfma_f32_16x16x32_bf16 v[212:215], v[144:147], v[128:131], v[212:215]
  s_waitcnt lgkmcnt(1)
  v_mfma_f32_16x16x32_bf16 v[180:183], v[140:143], v[132:135], v[180:183]
  v_mfma_f32_16x16x32_bf16 v[216:219], v[144:147], v[132:135], v[216:219]
  s_waitcnt lgkmcnt(0)
  v_mfma_f32_16x16x32_bf16 v[184:187], v[140:143], v[136:139], v[184:187]
  v_mfma_f32_16x16x32_bf16 v[220:223], v[144:147], v[136:139], v[220:223]
  s_waitcnt lgkmcnt(0)
  s_barrier
  ds_read_b64_tr_b16 v[24:25], v48 offset:16384
  ds_read_b64_tr_b16 v[26:27], v48 offset:17408
  ds_read_b64_tr_b16 v[28:29], v49 offset:16384
  ds_read_b64_tr_b16 v[30:31], v49 offset:17408
  ds_read_b128 v[56:59], v52 offset:26624
  ds_read_b128 v[60:63], v52 offset:28672
  ds_read_b128 v[64:67], v52 offset:30720
  ds_read_b128 v[68:71], v52 offset:32768
  ds_read_b128 v[72:75], v52 offset:34816
  ds_read_b128 v[76:79], v52 offset:36864
  ds_read_b128 v[80:83], v52 offset:38912
  ds_read_b128 v[84:87], v52 offset:40960
  ds_read_b128 v[88:91], v52 offset:43008
  s_waitcnt lgkmcnt(8)
  v_mfma_f32_16x16x32_bf16 v[152:155], v[24:27], v[56:59], v[152:155]
  ds_read_b64_tr_b16 v[140:141], v48 offset:24576
  v_mfma_f32_16x16x32_bf16 v[188:191], v[28:31], v[56:59], v[188:191]
  ds_read_b64_tr_b16 v[142:143], v48 offset:25600
  s_waitcnt lgkmcnt(9)
  v_mfma_f32_16x16x32_bf16 v[156:159], v[24:27], v[60:63], v[156:159]
  ds_read_b64_tr_b16 v[144:145], v49 offset:24576
  v_mfma_f32_16x16x32_bf16 v[192:195], v[28:31], v[60:63], v[192:195]
  ds_read_b64_tr_b16 v[146:147], v49 offset:25600
  s_waitcnt lgkmcnt(10)
  v_mfma_f32_16x16x32_bf16 v[160:163], v[24:27], v[64:67], v[160:163]
  ds_read_b128 v[104:107], v53 offset:26624
  v_mfma_f32_16x16x32_bf16 v[196:199], v[28:31], v[64:67], v[196:199]
  s_waitcnt lgkmcnt(10)
  v_mfma_f32_16x16x32_bf16 v[164:167], v[24:27], v[68:71], v[164:167]
  ds_read_b128 v[108:111], v53 offset:28672
  v_mfma_f32_16x16x32_bf16 v[200:203], v[28:31], v[68:71], v[200:203]
  ds_read_b128 v[112:115], v53 offset:30720
  s_waitcnt lgkmcnt(11)
  v_mfma_f32_16x16x32_bf16 v[168:171], v[24:27], v[72:75], v[168:171]
  ds_read_b128 v[116:119], v53 offset:32768
  v_mfma_f32_16x16x32_bf16 v[204:207], v[28:31], v[72:75], v[204:207]
  ds_read_b128 v[120:123], v53 offset:34816
  s_waitcnt lgkmcnt(12)
  v_mfma_f32_16x16x32_bf16 v[172:175], v[24:27], v[76:79], v[172:175]
  v_mfma_f32_16x16x32_bf16 v[208:211], v[28:31], v[76:79], v[208:211]
  ds_read_b128 v[124:127], v53 offset:36864
  s_waitcnt lgkmcnt(10)
  v_mfma_f32_16x16x32_bf16 v[176:179], v[24:27], v[80:83], v[176:179]
  ds_read_b128 v[128:131], v53 offset:38912
  v_mfma_f32_16x16x32_bf16 v[212:215], v[28:31], v[80:83], v[212:215]
  ds_read_b128 v[132:135], v53 offset:40960
  v_mfma_f32_16x16x32_bf16 v[180:183], v[24:27], v[84:87], v[180:183]
  ds_read_b128 v[136:139], v53 offset:43008
  v_mfma_f32_16x16x32_bf16 v[216:219], v[28:31], v[84:87], v[216:219]
  v_mfma_f32_16x16x32_bf16 v[184:187], v[24:27], v[88:91], v[184:187]
  v_mfma_f32_16x16x32_bf16 v[220:223], v[28:31], v[88:91], v[220:223]
  s_waitcnt lgkmcnt(8)
  v_mfma_f32_16x16x32_bf16 v[152:155], v[140:143], v[104:107], v[152:155]
  v_mfma_f32_16x16x32_bf16 v[188:191], v[144:147], v[104:107], v[188:191]
  s_waitcnt lgkmcnt(7)
  v_mfma_f32_16x16x32_bf16 v[156:159], v[140:143], v[108:111], v[156:159]
  v_mfma_f32_16x16x32_bf16 v[192:195], v[144:147], v[108:111], v[192:195]
  s_waitcnt lgkmcnt(6)
  v_mfma_f32_16x16x32_bf16 v[160:163], v[140:143], v[112:115], v[160:163]
  v_mfma_f32_16x16x32_bf16 v[196:199], v[144:147], v[112:115], v[196:199]
  s_waitcnt lgkmcnt(5)
  v_mfma_f32_16x16x32_bf16 v[164:167], v[140:143], v[116:119], v[164:167]
  v_mfma_f32_16x16x32_bf16 v[200:203], v[144:147], v[116:119], v[200:203]
  s_waitcnt lgkmcnt(4)
  v_mfma_f32_16x16x32_bf16 v[168:171], v[140:143], v[120:123], v[168:171]
  v_mfma_f32_16x16x32_bf16 v[204:207], v[144:147], v[120:123], v[204:207]
  s_waitcnt lgkmcnt(3)
  v_mfma_f32_16x16x32_bf16 v[172:175], v[140:143], v[124:127], v[172:175]
  v_mfma_f32_16x16x32_bf16 v[208:211], v[144:147], v[124:127], v[208:211]
  s_waitcnt lgkmcnt(2)
  v_mfma_f32_16x16x32_bf16 v[176:179], v[140:143], v[128:131], v[176:179]
  v_mfma_f32_16x16x32_bf16 v[212:215], v[144:147], v[128:131], v[212:215]
  s_waitcnt lgkmcnt(1)
  v_mfma_f32_16x16x32_bf16 v[180:183], v[140:143], v[132:135], v[180:183]
  v_mfma_f32_16x16x32_bf16 v[216:219], v[144:147], v[132:135], v[216:219]
  s_waitcnt lgkmcnt(0)
  v_mfma_f32_16x16x32_bf16 v[184:187], v[140:143], v[136:139], v[184:187]
  v_mfma_f32_16x16x32_bf16 v[220:223], v[144:147], v[136:139], v[220:223]
  s_waitcnt lgkmcnt(0)
  s_barrier
  v_add_u32 v48, 0x1e800, v48
  v_add_u32 v49, 0x1e800, v49
  v_add_u32 v52, 0x14800, v52
  v_add_u32 v53, 0x14800, v53
  ds_read_b64_tr_b16 v[24:25], v48
  ds_read_b64_tr_b16 v[26:27], v48 offset:1024
  ds_read_b64_tr_b16 v[28:29], v49
  ds_read_b64_tr_b16 v[30:31], v49 offset:1024
  ds_read_b128 v[56:59], v52 offset:16384
  ds_read_b128 v[60:63], v52 offset:18432
  ds_read_b128 v[64:67], v52 offset:20480
  ds_read_b128 v[68:71], v52 offset:22528
  ds_read_b128 v[72:75], v52 offset:24576
  ds_read_b128 v[76:79], v52 offset:26624
  ds_read_b128 v[80:83], v52 offset:28672
  ds_read_b128 v[84:87], v52 offset:30720
  ds_read_b128 v[88:91], v52 offset:32768
  s_waitcnt lgkmcnt(8)
  v_mfma_f32_16x16x32_bf16 v[152:155], v[24:27], v[56:59], v[152:155]
  ds_read_b64_tr_b16 v[140:141], v48 offset:8192
  v_mfma_f32_16x16x32_bf16 v[188:191], v[28:31], v[56:59], v[188:191]
  ds_read_b64_tr_b16 v[142:143], v48 offset:9216
  s_waitcnt lgkmcnt(9)
  v_mfma_f32_16x16x32_bf16 v[156:159], v[24:27], v[60:63], v[156:159]
  ds_read_b64_tr_b16 v[144:145], v49 offset:8192
  v_mfma_f32_16x16x32_bf16 v[192:195], v[28:31], v[60:63], v[192:195]
  ds_read_b64_tr_b16 v[146:147], v49 offset:9216
  s_waitcnt lgkmcnt(10)
  v_mfma_f32_16x16x32_bf16 v[160:163], v[24:27], v[64:67], v[160:163]
  ds_read_b128 v[104:107], v53 offset:16384
  v_mfma_f32_16x16x32_bf16 v[196:199], v[28:31], v[64:67], v[196:199]
  s_waitcnt lgkmcnt(10)
  v_mfma_f32_16x16x32_bf16 v[164:167], v[24:27], v[68:71], v[164:167]
  ds_read_b128 v[108:111], v53 offset:18432
  v_mfma_f32_16x16x32_bf16 v[200:203], v[28:31], v[68:71], v[200:203]
  ds_read_b128 v[112:115], v53 offset:20480
  s_waitcnt lgkmcnt(11)
  v_mfma_f32_16x16x32_bf16 v[168:171], v[24:27], v[72:75], v[168:171]
  ds_read_b128 v[116:119], v53 offset:22528
  v_mfma_f32_16x16x32_bf16 v[204:207], v[28:31], v[72:75], v[204:207]
  ds_read_b128 v[120:123], v53 offset:24576
  s_waitcnt lgkmcnt(12)
  v_mfma_f32_16x16x32_bf16 v[172:175], v[24:27], v[76:79], v[172:175]
  v_mfma_f32_16x16x32_bf16 v[208:211], v[28:31], v[76:79], v[208:211]
  ds_read_b128 v[124:127], v53 offset:26624
  s_waitcnt lgkmcnt(10)
  v_mfma_f32_16x16x32_bf16 v[176:179], v[24:27], v[80:83], v[176:179]
  ds_read_b128 v[128:131], v53 offset:28672
  v_mfma_f32_16x16x32_bf16 v[212:215], v[28:31], v[80:83], v[212:215]
  ds_read_b128 v[132:135], v53 offset:30720
  v_mfma_f32_16x16x32_bf16 v[180:183], v[24:27], v[84:87], v[180:183]
  ds_read_b128 v[136:139], v53 offset:32768
  v_mfma_f32_16x16x32_bf16 v[216:219], v[28:31], v[84:87], v[216:219]
  v_mfma_f32_16x16x32_bf16 v[184:187], v[24:27], v[88:91], v[184:187]
  v_mfma_f32_16x16x32_bf16 v[220:223], v[28:31], v[88:91], v[220:223]
  s_waitcnt lgkmcnt(8)
  v_mfma_f32_16x16x32_bf16 v[152:155], v[140:143], v[104:107], v[152:155]
  v_mfma_f32_16x16x32_bf16 v[188:191], v[144:147], v[104:107], v[188:191]
  s_waitcnt lgkmcnt(7)
  v_mfma_f32_16x16x32_bf16 v[156:159], v[140:143], v[108:111], v[156:159]
  v_mfma_f32_16x16x32_bf16 v[192:195], v[144:147], v[108:111], v[192:195]
  s_waitcnt lgkmcnt(6)
  v_mfma_f32_16x16x32_bf16 v[160:163], v[140:143], v[112:115], v[160:163]
  v_mfma_f32_16x16x32_bf16 v[196:199], v[144:147], v[112:115], v[196:199]
  s_waitcnt lgkmcnt(5)
  v_mfma_f32_16x16x32_bf16 v[164:167], v[140:143], v[116:119], v[164:167]
  v_mfma_f32_16x16x32_bf16 v[200:203], v[144:147], v[116:119], v[200:203]
  s_waitcnt lgkmcnt(4)
  v_mfma_f32_16x16x32_bf16 v[168:171], v[140:143], v[120:123], v[168:171]
  v_mfma_f32_16x16x32_bf16 v[204:207], v[144:147], v[120:123], v[204:207]
  s_waitcnt lgkmcnt(3)
  v_mfma_f32_16x16x32_bf16 v[172:175], v[140:143], v[124:127], v[172:175]
  v_mfma_f32_16x16x32_bf16 v[208:211], v[144:147], v[124:127], v[208:211]
  s_waitcnt lgkmcnt(2)
  v_mfma_f32_16x16x32_bf16 v[176:179], v[140:143], v[128:131], v[176:179]
  v_mfma_f32_16x16x32_bf16 v[212:215], v[144:147], v[128:131], v[212:215]
  s_waitcnt lgkmcnt(1)
  v_mfma_f32_16x16x32_bf16 v[180:183], v[140:143], v[132:135], v[180:183]
  v_mfma_f32_16x16x32_bf16 v[216:219], v[144:147], v[132:135], v[216:219]
  s_waitcnt lgkmcnt(0)
  v_mfma_f32_16x16x32_bf16 v[184:187], v[140:143], v[136:139], v[184:187]
  v_mfma_f32_16x16x32_bf16 v[220:223], v[144:147], v[136:139], v[220:223]
  s_waitcnt lgkmcnt(0)
  s_barrier
  v_subrev_u32 v48, 0x1e800, v48
  v_subrev_u32 v49, 0x1e800, v49
  v_pk_mul_f32 v[152:153], v[152:153], s[88:89]
  v_pk_mul_f32 v[154:155], v[154:155], s[88:89]
  v_cvt_pk_bf16_f32 v248, v152, v153
  v_cvt_pk_bf16_f32 v249, v154, v155
  ds_write_b64 v55, v[248:249] offset:3072
  v_pk_mul_f32 v[188:189], v[188:189], s[88:89]
  v_pk_mul_f32 v[190:191], v[190:191], s[88:89]
  v_cvt_pk_bf16_f32 v250, v188, v189
  v_cvt_pk_bf16_f32 v251, v190, v191
  ds_write_b64 v55, v[250:251] offset:3584
  v_pk_mul_f32 v[156:157], v[156:157], s[88:89]
  v_pk_mul_f32 v[158:159], v[158:159], s[88:89]
  v_cvt_pk_bf16_f32 v252, v156, v157
  v_cvt_pk_bf16_f32 v253, v158, v159
  ds_write_b64 v55, v[252:253] offset:7168
  v_pk_mul_f32 v[192:193], v[192:193], s[88:89]
  v_pk_mul_f32 v[194:195], v[194:195], s[88:89]
  v_cvt_pk_bf16_f32 v254, v192, v193
  v_cvt_pk_bf16_f32 v255, v194, v195
  ds_write_b64 v55, v[254:255] offset:7680
  v_pk_mul_f32 v[160:161], v[160:161], s[88:89]
  v_pk_mul_f32 v[162:163], v[162:163], s[88:89]
  v_cvt_pk_bf16_f32 v248, v160, v161
  v_cvt_pk_bf16_f32 v249, v162, v163
  ds_write_b64 v55, v[248:249] offset:11264
  v_pk_mul_f32 v[196:197], v[196:197], s[88:89]
  v_pk_mul_f32 v[198:199], v[198:199], s[88:89]
  v_cvt_pk_bf16_f32 v250, v196, v197
  v_cvt_pk_bf16_f32 v251, v198, v199
  ds_write_b64 v55, v[250:251] offset:11776
  v_pk_mul_f32 v[164:165], v[164:165], s[88:89]
  v_pk_mul_f32 v[166:167], v[166:167], s[88:89]
  v_cvt_pk_bf16_f32 v252, v164, v165
  v_cvt_pk_bf16_f32 v253, v166, v167
  ds_write_b64 v55, v[252:253] offset:15360
  v_pk_mul_f32 v[200:201], v[200:201], s[88:89]
  v_pk_mul_f32 v[202:203], v[202:203], s[88:89]
  v_cvt_pk_bf16_f32 v254, v200, v201
  v_cvt_pk_bf16_f32 v255, v202, v203
  ds_write_b64 v55, v[254:255] offset:15872
  v_pk_mul_f32 v[168:169], v[168:169], s[88:89]
  v_pk_mul_f32 v[170:171], v[170:171], s[88:89]
  v_cvt_pk_bf16_f32 v248, v168, v169
  v_cvt_pk_bf16_f32 v249, v170, v171
  ds_write_b64 v55, v[248:249] offset:19456
  v_pk_mul_f32 v[204:205], v[204:205], s[88:89]
  v_pk_mul_f32 v[206:207], v[206:207], s[88:89]
  v_cvt_pk_bf16_f32 v250, v204, v205
  v_cvt_pk_bf16_f32 v251, v206, v207
  ds_write_b64 v55, v[250:251] offset:19968
  v_pk_mul_f32 v[172:173], v[172:173], s[88:89]
  v_pk_mul_f32 v[174:175], v[174:175], s[88:89]
  v_cvt_pk_bf16_f32 v252, v172, v173
  v_cvt_pk_bf16_f32 v253, v174, v175
  ds_write_b64 v55, v[252:253] offset:23552
  v_pk_mul_f32 v[208:209], v[208:209], s[88:89]
  v_pk_mul_f32 v[210:211], v[210:211], s[88:89]
  v_cvt_pk_bf16_f32 v254, v208, v209
  v_cvt_pk_bf16_f32 v255, v210, v211
  ds_write_b64 v55, v[254:255] offset:24064
  v_pk_mul_f32 v[176:177], v[176:177], s[88:89]
  v_pk_mul_f32 v[178:179], v[178:179], s[88:89]
  v_cvt_pk_bf16_f32 v248, v176, v177
  v_cvt_pk_bf16_f32 v249, v178, v179
  ds_write_b64 v55, v[248:249] offset:27648
  v_pk_mul_f32 v[212:213], v[212:213], s[88:89]
  v_pk_mul_f32 v[214:215], v[214:215], s[88:89]
  v_cvt_pk_bf16_f32 v250, v212, v213
  v_cvt_pk_bf16_f32 v251, v214, v215
  ds_write_b64 v55, v[250:251] offset:28160
  v_pk_mul_f32 v[180:181], v[180:181], s[88:89]
  v_pk_mul_f32 v[182:183], v[182:183], s[88:89]
  v_cvt_pk_bf16_f32 v252, v180, v181
  v_cvt_pk_bf16_f32 v253, v182, v183
  ds_write_b64 v55, v[252:253] offset:31744
  v_pk_mul_f32 v[216:217], v[216:217], s[88:89]
  v_pk_mul_f32 v[218:219], v[218:219], s[88:89]
  v_cvt_pk_bf16_f32 v254, v216, v217
  v_cvt_pk_bf16_f32 v255, v218, v219
  s_waitcnt lgkmcnt(5)
  ds_write_b64 v55, v[254:255] offset:32256
  v_pk_mul_f32 v[184:185], v[184:185], s[88:89]
  v_pk_mul_f32 v[186:187], v[186:187], s[88:89]
  v_cvt_pk_bf16_f32 v248, v184, v185
  v_cvt_pk_bf16_f32 v249, v186, v187
  ds_write_b64 v55, v[248:249] offset:35840
  v_pk_mul_f32 v[220:221], v[220:221], s[88:89]
  v_pk_mul_f32 v[222:223], v[222:223], s[88:89]
  v_cvt_pk_bf16_f32 v250, v220, v221
  v_cvt_pk_bf16_f32 v251, v222, v223
  ds_write_b64 v55, v[250:251] offset:36352
  s_waitcnt vmcnt(0)
  s_mov_b64 exec, 1
  buffer_store_byte v243, v242, s[64:67], 0 offen sc1
  s_mov_b64 exec, -1
  s_setprio 3
  s_waitcnt lgkmcnt(0)
  s_barrier
L_Ac_go:
  ds_read_b128 v[104:107], v18
  ds_read_b128 v[108:111], v18 offset:1024
  ds_read_b128 v[112:115], v18 offset:2048
  ds_read_b128 v[116:119], v18 offset:3072
  ds_read_b128 v[72:75], v10
  ds_read_b128 v[76:79], v10 offset:1024
  ds_read_b128 v[80:83], v11
  ds_read_b128 v[84:87], v11 offset:1024
  ds_read_b128 v[88:91], v12
  ds_read_b128 v[92:95], v12 offset:1024
  ds_read_b128 v[96:99], v13
  ds_read_b128 v[100:103], v13 offset:1024
  ds_read_b128 v[120:123], v18 offset:4096
  ds_read_b128 v[124:127], v18 offset:5120
  ds_read_b128 v[128:131], v18 offset:6144
  s_waitcnt lgkmcnt(14)
  ds_read_b128 v[132:135], v18 offset:7168
  s_waitcnt lgkmcnt(14)
  ds_read_b128 v[136:139], v18 offset:8192
  s_waitcnt lgkmcnt(14)
  ds_read_b128 v[140:143], v18 offset:9216
  s_waitcnt lgkmcnt(14)
  ds_read_b128 v[144:147], v18 offset:10240
  s_waitcnt lgkmcnt(14)
  ds_read_b128 v[148:151], v18 offset:11264
  s_mov_b32 s61, 4
  v_mfma_f32_16x16x32_bf16 v[48:51], v[72:75], v[104:107], 0
  s_waitcnt lgkmcnt(14)
  v_mfma_f32_16x16x32_bf16 v[60:63], v[76:79], v[104:107], 0
  s_waitcnt lgkmcnt(0)
  ds_write_b128 v18, v[152:155]
  ds_write_b128 v18, v[160:163] offset:1024
  v_mfma_f32_16x16x32_bf16 v[48:51], v[80:83], v[108:111], v[48:51]
  ds_write_b128 v18, v[168:171] offset:2048
  ds_write_b128 v18, v[176:179] offset:3072
  v_mfma_f32_16x16x32_bf16 v[60:63], v[84:87], v[108:111], v[60:63]
  ds_write_b128 v18, v[184:187] offset:4096
  ds_write_b128 v18, v[192:195] offset:5120
  v_mfma_f32_16x16x32_bf16 v[48:51], v[88:91], v[112:115], v[48:51]
  ds_write_b128 v18, v[200:203] offset:6144
  v_mfma_f32_16x16x32_bf16 v[60:63], v[92:95], v[112:115], v[60:63]
  ds_write_b128 v18, v[208:211] offset:7168
  ds_write_b128 v18, v[216:219] offset:8192
  v_mfma_f32_16x16x32_bf16 v[48:51], v[96:99], v[116:119], v[48:51]
  ds_write_b128 v18, v[224:227] offset:9216
  ds_write_b128 v18, v[232:235] offset:10240
  v_mfma_f32_16x16x32_bf16 v[60:63], v[100:103], v[116:119], v[60:63]
  ds_write_b128 v18, v[240:243] offset:11264
  v_mfma_f32_16x16x32_bf16 v[52:55], v[72:75], v[120:123], 0
  ds_read_b64_tr_b16 v[248:249], v2
  ds_read_b64_tr_b16 v[250:251], v2 offset:1024
  v_mfma_f32_16x16x32_bf16 v[64:67], v[76:79], v[120:123], 0
  ds_read_b64_tr_b16 v[252:253], v3
  s_waitcnt lgkmcnt(14)
  ds_read_b64_tr_b16 v[254:255], v3 offset:1024
  v_mfma_f32_16x16x32_bf16 v[52:55], v[80:83], v[124:127], v[52:55]
  s_barrier
  v_max3_f32 v19, v48, v49, v50
  v_max3_f32 v19, v19, v51, v60
  v_max3_f32 v19, v19, v61, v62
  v_max_f32 v19, v19, v63
  v_mfma_f32_16x16x32_bf16 v[64:67], v[84:87], v[124:127], v[64:67]
  v_mov_b32 v22, v19
  s_nop 1
  v_permlane32_swap_b32 v19, v22
  v_max_f32 v19, v19, v22
  v_mov_b32 v22, v19
  s_nop 1
  v_permlane16_swap_b32 v19, v22
  v_mfma_f32_16x16x32_bf16 v[52:55], v[88:91], v[128:131], v[52:55]
  v_max_f32 v19, v19, v22
  v_sub_f32 v48, v48, v19
  v_sub_f32 v49, v49, v19
  v_sub_f32 v50, v50, v19
  v_sub_f32 v51, v51, v19
  v_mfma_f32_16x16x32_bf16 v[64:67], v[92:95], v[128:131], v[64:67]
  v_sub_f32 v60, v60, v19
  v_sub_f32 v61, v61, v19
  v_sub_f32 v62, v62, v19
  v_sub_f32 v63, v63, v19
  v_sub_f32 v24, 0, v19
  v_mfma_f32_16x16x32_bf16 v[52:55], v[96:99], v[132:135], v[52:55]
  v_sub_f32 v25, 0, v19
  v_sub_f32 v26, 0, v19
  v_sub_f32 v27, 0, v19
  v_exp_f32 v48, v48
  v_mfma_f32_16x16x32_bf16 v[64:67], v[100:103], v[132:135], v[64:67]
  v_exp_f32 v49, v49
  v_exp_f32 v50, v50
  v_cvt_pk_bf16_f32 v36, v48, v49
  v_mfma_f32_16x16x32_bf16 v[56:59], v[72:75], v[136:139], 0
  v_exp_f32 v51, v51
  v_exp_f32 v60, v60
  v_cvt_pk_bf16_f32 v37, v50, v51
  v_mfma_f32_16x16x32_bf16 v[68:71], v[76:79], v[136:139], 0
  v_exp_f32 v61, v61
  v_exp_f32 v62, v62
  v_cvt_pk_bf16_f32 v38, v60, v61
  v_mfma_f32_16x16x32_bf16 v[56:59], v[80:83], v[140:143], v[56:59]
  s_waitcnt lgkmcnt(4)
  ds_read_b64_tr_b16 v[80:81], v4
  ds_read_b64_tr_b16 v[82:83], v4 offset:1024
  v_exp_f32 v63, v63
  v_max3_f32 v20, v52, v53, v54
  v_max3_f32 v20, v20, v55, v64
  v_mfma_f32_16x16x32_bf16 v[68:71], v[84:87], v[140:143], v[68:71]
  ds_read_b64_tr_b16 v[84:85], v5
  ds_read_b64_tr_b16 v[86:87], v5 offset:1024
  v_cvt_pk_bf16_f32 v39, v62, v63
  v_max3_f32 v20, v20, v65, v66
  v_max_f32 v20, v20, v67
  v_mov_b32 v22, v20
  v_mfma_f32_16x16x32_bf16 v[56:59], v[88:91], v[144:147], v[56:59]
  ds_read_b64_tr_b16 v[88:89], v6
  ds_read_b64_tr_b16 v[90:91], v6 offset:1024
  v_permlane32_swap_b32 v20, v22
  v_max_f32 v20, v20, v22
  v_mov_b32 v22, v20
  s_nop 1
  v_permlane16_swap_b32 v20, v22
  v_mfma_f32_16x16x32_bf16 v[68:71], v[92:95], v[144:147], v[68:71]
  ds_read_b64_tr_b16 v[92:93], v7
  ds_read_b64_tr_b16 v[94:95], v7 offset:1024
  v_max_f32 v20, v20, v22
  v_sub_f32 v52, v52, v20
  v_sub_f32 v53, v53, v20
  v_sub_f32 v54, v54, v20
  v_mfma_f32_16x16x32_bf16 v[56:59], v[96:99], v[148:151], v[56:59]
  ds_read_b64_tr_b16 v[96:97], v8
  ds_read_b64_tr_b16 v[98:99], v8 offset:1024
  v_sub_f32 v55, v55, v20
  v_sub_f32 v64, v64, v20
  v_sub_f32 v65, v65, v20
  v_sub_f32 v66, v66, v20
  v_mfma_f32_16x16x32_bf16 v[68:71], v[100:103], v[148:151], v[68:71]
  ds_read_b64_tr_b16 v[100:101], v9
  s_waitcnt lgkmcnt(7)
  ds_read_b64_tr_b16 v[102:103], v9 offset:1024
  v_sub_f32 v67, v67, v20
  v_sub_f32 v28, 0, v20
  v_sub_f32 v29, 0, v20
  v_sub_f32 v30, 0, v20
  v_mfma_f32_16x16x32_bf16 v[152:155], v[248:251], v[36:39], 0
  v_sub_f32 v31, 0, v20
  v_exp_f32 v52, v52
  v_exp_f32 v53, v53
  v_mfma_f32_16x16x32_bf16 v[156:159], v[252:255], v[36:39], 0
  v_exp_f32 v54, v54
  v_cvt_pk_bf16_f32 v40, v52, v53
  v_exp_f32 v55, v55
  v_mfma_f32_16x16x32_bf16 v[160:163], v[80:83], v[36:39], 0
  s_waitcnt lgkmcnt(0)
  s_barrier
  v_exp_f32 v64, v64
  v_cvt_pk_bf16_f32 v41, v54, v55
  v_mfma_f32_16x16x32_bf16 v[164:167], v[84:87], v[36:39], 0
  v_exp_f32 v65, v65
  v_exp_f32 v66, v66
  v_cvt_pk_bf16_f32 v42, v64, v65
  v_mfma_f32_16x16x32_bf16 v[168:171], v[88:91], v[36:39], 0
  v_exp_f32 v67, v67
  v_max3_f32 v21, v56, v57, v58
  v_max3_f32 v21, v21, v59, v68
  v_max3_f32 v21, v21, v69, v70
  v_mfma_f32_16x16x32_bf16 v[172:175], v[92:95], v[36:39], 0
  v_cvt_pk_bf16_f32 v43, v66, v67
  v_max_f32 v21, v21, v71
  v_mov_b32 v22, v21
  s_nop 1
  v_permlane32_swap_b32 v21, v22
  v_max_f32 v21, v21, v22
  v_mfma_f32_16x16x32_bf16 v[176:179], v[96:99], v[36:39], 0
  v_mov_b32 v22, v21
  s_nop 1
  v_permlane16_swap_b32 v21, v22
  v_max_f32 v21, v21, v22
  v_sub_f32 v56, v56, v21
  v_mfma_f32_16x16x32_bf16 v[180:183], v[100:103], v[36:39], 0
  v_sub_f32 v57, v57, v21
  v_sub_f32 v58, v58, v21
  v_sub_f32 v59, v59, v21
  v_sub_f32 v68, v68, v21
  v_sub_f32 v69, v69, v21
  v_mfma_f32_16x16x32_bf16 v[184:187], v[248:251], v[40:43], 0
  v_sub_f32 v70, v70, v21
  v_sub_f32 v71, v71, v21
  v_sub_f32 v32, 0, v21
  v_sub_f32 v33, 0, v21
  v_sub_f32 v34, 0, v21
  v_mfma_f32_16x16x32_bf16 v[188:191], v[252:255], v[40:43], 0
  v_sub_f32 v35, 0, v21
  v_exp_f32 v56, v56
  v_exp_f32 v57, v57
  v_mfma_f32_16x16x32_bf16 v[192:195], v[80:83], v[40:43], 0
  v_exp_f32 v58, v58
  v_cvt_pk_bf16_f32 v44, v56, v57
  v_exp_f32 v59, v59
  v_mfma_f32_16x16x32_bf16 v[196:199], v[84:87], v[40:43], 0
  v_exp_f32 v68, v68
  v_cvt_pk_bf16_f32 v45, v58, v59
  v_exp_f32 v69, v69
  v_mfma_f32_16x16x32_bf16 v[200:203], v[88:91], v[40:43], 0
  s_waitcnt lgkmcnt(0)
  s_barrier
  v_exp_f32 v70, v70
  v_cvt_pk_bf16_f32 v46, v68, v69
  v_mfma_f32_16x16x32_bf16 v[204:207], v[92:95], v[40:43], 0
  ds_read_b128 v[72:75], v10 offset:8192
  v_exp_f32 v71, v71
  v_mfma_f32_16x16x32_bf16 v[208:211], v[96:99], v[40:43], 0
  ds_read_b128 v[76:79], v10 offset:9216
  v_cvt_pk_bf16_f32 v47, v70, v71
  v_add_f32 v15, v15, v48
  v_mfma_f32_16x16x32_bf16 v[212:215], v[100:103], v[40:43], 0
  v_add_f32 v16, v16, v52
  v_add_f32 v16, v16, v53
  v_add_f32 v15, v15, v49
  v_mfma_f32_16x16x32_bf16 v[216:219], v[248:251], v[44:47], 0
  v_add_f32 v16, v16, v54
  v_add_f32 v16, v16, v55
  v_mfma_f32_16x16x32_bf16 v[220:223], v[252:255], v[44:47], 0
  v_add_f32 v16, v16, v64
  v_add_f32 v16, v16, v65
  v_mfma_f32_16x16x32_bf16 v[224:227], v[80:83], v[44:47], 0
  ds_read_b128 v[80:83], v11 offset:8192
  v_add_f32 v15, v15, v50
  v_mfma_f32_16x16x32_bf16 v[228:231], v[84:87], v[44:47], 0
  ds_read_b128 v[84:87], v11 offset:9216
  v_add_f32 v15, v15, v51
  v_mfma_f32_16x16x32_bf16 v[232:235], v[88:91], v[44:47], 0
  ds_read_b128 v[88:91], v12 offset:8192
  v_add_f32 v15, v15, v60
  v_mfma_f32_16x16x32_bf16 v[236:239], v[92:95], v[44:47], 0
  ds_read_b128 v[92:95], v12 offset:9216
  v_add_f32 v15, v15, v61
  v_mfma_f32_16x16x32_bf16 v[240:243], v[96:99], v[44:47], 0
  ds_read_b128 v[96:99], v13 offset:8192
  v_add_f32 v15, v15, v62
  v_mfma_f32_16x16x32_bf16 v[244:247], v[100:103], v[44:47], 0
  ds_read_b128 v[100:103], v13 offset:9216
  v_add_f32 v15, v15, v63
  s_branch L_Ac_T1
L_Ac_T0:
  s_waitcnt lgkmcnt(6)
  v_mfma_f32_16x16x32_bf16 v[48:51], v[72:75], v[104:107], v[24:27]
  v_add_f32 v17, v17, v56
  v_mfma_f32_16x16x32_bf16 v[60:63], v[76:79], v[104:107], v[24:27]
  v_add_f32 v16, v16, v66
  v_add_f32 v17, v17, v57
  s_waitcnt lgkmcnt(5)
  v_mfma_f32_16x16x32_bf16 v[48:51], v[80:83], v[108:111], v[48:51]
  v_add_f32 v17, v17, v58
  s_waitcnt lgkmcnt(4)
  v_mfma_f32_16x16x32_bf16 v[60:63], v[84:87], v[108:111], v[60:63]
  v_add_f32 v16, v16, v67
  v_add_f32 v17, v17, v59
  s_waitcnt lgkmcnt(3)
  v_mfma_f32_16x16x32_bf16 v[48:51], v[88:91], v[112:115], v[48:51]
  v_add_f32 v17, v17, v68
  s_waitcnt lgkmcnt(2)
  v_mfma_f32_16x16x32_bf16 v[60:63], v[92:95], v[112:115], v[60:63]
  v_add_f32 v17, v17, v69
  v_add_f32 v17, v17, v70
  s_waitcnt lgkmcnt(1)
  v_mfma_f32_16x16x32_bf16 v[48:51], v[96:99], v[116:119], v[48:51]
  s_waitcnt lgkmcnt(0)
  v_mfma_f32_16x16x32_bf16 v[60:63], v[100:103], v[116:119], v[60:63]
  v_add_f32 v17, v17, v71
  v_mfma_f32_16x16x32_bf16 v[52:55], v[72:75], v[120:123], v[28:31]
  ds_read_b64_tr_b16 v[248:249], v2
  ds_read_b64_tr_b16 v[250:251], v2 offset:1024
  v_mfma_f32_16x16x32_bf16 v[64:67], v[76:79], v[120:123], v[28:31]
  ds_read_b64_tr_b16 v[252:253], v3
  ds_read_b64_tr_b16 v[254:255], v3 offset:1024
  v_mfma_f32_16x16x32_bf16 v[52:55], v[80:83], v[124:127], v[52:55]
  v_max3_f32 v19, v48, v49, v50
  v_max3_f32 v19, v19, v51, v60
  v_max3_f32 v19, v19, v61, v62
  v_mfma_f32_16x16x32_bf16 v[64:67], v[84:87], v[124:127], v[64:67]
  v_max_f32 v19, v19, v63
  v_cmp_lt_f32 vcc, 0x41800000, v19
  v_mfma_f32_16x16x32_bf16 v[52:55], v[88:91], v[128:131], v[52:55]
  s_cbranch_vccnz L_stub_ct0_0
L_ret_ct0_0:
  v_exp_f32 v48, v48
  v_mfma_f32_16x16x32_bf16 v[64:67], v[92:95], v[128:131], v[64:67]
  v_exp_f32 v49, v49
  v_exp_f32 v50, v50
  v_mfma_f32_16x16x32_bf16 v[52:55], v[96:99], v[132:135], v[52:55]
  v_cvt_pk_bf16_f32 v36, v48, v49
  v_exp_f32 v51, v51
  v_mfma_f32_16x16x32_bf16 v[64:67], v[100:103], v[132:135], v[64:67]
  v_exp_f32 v60, v60
  v_cvt_pk_bf16_f32 v37, v50, v51
  v_mfma_f32_16x16x32_bf16 v[56:59], v[72:75], v[136:139], v[32:35]
  v_exp_f32 v61, v61
  v_exp_f32 v62, v62
  v_mfma_f32_16x16x32_bf16 v[68:71], v[76:79], v[136:139], v[32:35]
  v_cvt_pk_bf16_f32 v38, v60, v61
  v_exp_f32 v63, v63
  v_mfma_f32_16x16x32_bf16 v[56:59], v[80:83], v[140:143], v[56:59]
  ds_read_b64_tr_b16 v[80:81], v4
  ds_read_b64_tr_b16 v[82:83], v4 offset:1024
  v_cvt_pk_bf16_f32 v39, v62, v63
  v_max3_f32 v20, v52, v53, v54
  v_mfma_f32_16x16x32_bf16 v[68:71], v[84:87], v[140:143], v[68:71]
  ds_read_b64_tr_b16 v[84:85], v5
  ds_read_b64_tr_b16 v[86:87], v5 offset:1024
  v_max3_f32 v20, v20, v55, v64
  v_max3_f32 v20, v20, v65, v66
  v_mfma_f32_16x16x32_bf16 v[56:59], v[88:91], v[144:147], v[56:59]
  ds_read_b64_tr_b16 v[88:89], v6
  ds_read_b64_tr_b16 v[90:91], v6 offset:1024
  v_max_f32 v20, v20, v67
  v_cmp_lt_f32 vcc, 0x41800000, v20
  v_mfma_f32_16x16x32_bf16 v[68:71], v[92:95], v[144:147], v[68:71]
  ds_read_b64_tr_b16 v[92:93], v7
  ds_read_b64_tr_b16 v[94:95], v7 offset:1024
  s_cbranch_vccnz L_stub_ct0_1
L_ret_ct0_1:
  v_mfma_f32_16x16x32_bf16 v[56:59], v[96:99], v[148:151], v[56:59]
  ds_read_b64_tr_b16 v[96:97], v8
  ds_read_b64_tr_b16 v[98:99], v8 offset:1024
  v_exp_f32 v52, v52
  v_mfma_f32_16x16x32_bf16 v[68:71], v[100:103], v[148:151], v[68:71]
  ds_read_b64_tr_b16 v[100:101], v9
  s_waitcnt lgkmcnt(11)
  ds_read_b64_tr_b16 v[102:103], v9 offset:1024
  v_exp_f32 v53, v53
  v_mfma_f32_16x16x32_bf16 v[152:155], v[248:251], v[36:39], v[152:155]
  v_exp_f32 v54, v54
  v_cvt_pk_bf16_f32 v40, v52, v53
  v_mfma_f32_16x16x32_bf16 v[156:159], v[252:255], v[36:39], v[156:159]
  v_exp_f32 v55, v55
  v_exp_f32 v64, v64
  s_waitcnt lgkmcnt(8)
  v_mfma_f32_16x16x32_bf16 v[160:163], v[80:83], v[36:39], v[160:163]
  v_cvt_pk_bf16_f32 v41, v54, v55
  v_exp_f32 v65, v65
  v_max3_f32 v21, v56, v57, v58
  v_mfma_f32_16x16x32_bf16 v[164:167], v[84:87], v[36:39], v[164:167]
  v_exp_f32 v66, v66
  v_cvt_pk_bf16_f32 v42, v64, v65
  s_waitcnt lgkmcnt(6)
  v_mfma_f32_16x16x32_bf16 v[168:171], v[88:91], v[36:39], v[168:171]
  v_exp_f32 v67, v67
  v_max3_f32 v21, v21, v59, v68
  v_max3_f32 v21, v21, v69, v70
  s_waitcnt lgkmcnt(4)
  v_mfma_f32_16x16x32_bf16 v[172:175], v[92:95], v[36:39], v[172:175]
  v_cvt_pk_bf16_f32 v43, v66, v67
  v_max_f32 v21, v21, v71
  v_cmp_lt_f32 vcc, 0x41800000, v21
  s_waitcnt lgkmcnt(1)
  v_mfma_f32_16x16x32_bf16 v[176:179], v[96:99], v[36:39], v[176:179]
  s_cbranch_vccnz L_stub_ct0_2
L_ret_ct0_2:
  v_exp_f32 v56, v56
  s_waitcnt lgkmcnt(0)
  v_mfma_f32_16x16x32_bf16 v[180:183], v[100:103], v[36:39], v[180:183]
  v_exp_f32 v57, v57
  v_exp_f32 v58, v58
  v_mfma_f32_16x16x32_bf16 v[184:187], v[248:251], v[40:43], v[184:187]
  v_cvt_pk_bf16_f32 v44, v56, v57
  v_exp_f32 v59, v59
  v_mfma_f32_16x16x32_bf16 v[188:191], v[252:255], v[40:43], v[188:191]
  v_exp_f32 v68, v68
  v_cvt_pk_bf16_f32 v45, v58, v59
  v_mfma_f32_16x16x32_bf16 v[192:195], v[80:83], v[40:43], v[192:195]
  v_exp_f32 v69, v69
  v_exp_f32 v70, v70
  v_mfma_f32_16x16x32_bf16 v[196:199], v[84:87], v[40:43], v[196:199]
  v_cvt_pk_bf16_f32 v46, v68, v69
  v_exp_f32 v71, v71
  v_mfma_f32_16x16x32_bf16 v[200:203], v[88:91], v[40:43], v[200:203]
  s_waitcnt lgkmcnt(0)
  s_barrier
  v_cvt_pk_bf16_f32 v47, v70, v71
  v_mfma_f32_16x16x32_bf16 v[204:207], v[92:95], v[40:43], v[204:207]
  ds_read_b128 v[72:75], v10 offset:8192
  v_add_f32 v16, v16, v52
  v_mfma_f32_16x16x32_bf16 v[208:211], v[96:99], v[40:43], v[208:211]
  ds_read_b128 v[76:79], v10 offset:9216
  v_add_f32 v16, v16, v53
  v_mfma_f32_16x16x32_bf16 v[212:215], v[100:103], v[40:43], v[212:215]
  v_add_f32 v16, v16, v54
  v_add_f32 v16, v16, v55
  v_mfma_f32_16x16x32_bf16 v[216:219], v[248:251], v[44:47], v[216:219]
  v_add_f32 v16, v16, v64
  v_add_f32 v15, v15, v48
  v_mfma_f32_16x16x32_bf16 v[220:223], v[252:255], v[44:47], v[220:223]
  v_add_f32 v16, v16, v65
  v_add_f32 v15, v15, v49
  v_mfma_f32_16x16x32_bf16 v[224:227], v[80:83], v[44:47], v[224:227]
  ds_read_b128 v[80:83], v11 offset:8192
  v_add_f32 v15, v15, v50
  v_mfma_f32_16x16x32_bf16 v[228:231], v[84:87], v[44:47], v[228:231]
  ds_read_b128 v[84:87], v11 offset:9216
  v_add_f32 v15, v15, v51
  v_mfma_f32_16x16x32_bf16 v[232:235], v[88:91], v[44:47], v[232:235]
  ds_read_b128 v[88:91], v12 offset:8192
  v_add_f32 v15, v15, v60
  v_mfma_f32_16x16x32_bf16 v[236:239], v[92:95], v[44:47], v[236:239]
  ds_read_b128 v[92:95], v12 offset:9216
  v_add_f32 v15, v15, v61
  v_mfma_f32_16x16x32_bf16 v[240:243], v[96:99], v[44:47], v[240:243]
  ds_read_b128 v[96:99], v13 offset:8192
  v_add_f32 v15, v15, v62
  v_mfma_f32_16x16x32_bf16 v[244:247], v[100:103], v[44:47], v[244:247]
  ds_read_b128 v[100:103], v13 offset:9216
  v_add_f32 v15, v15, v63
L_Ac_T1:
  s_waitcnt lgkmcnt(6)
  v_mfma_f32_16x16x32_bf16 v[48:51], v[72:75], v[104:107], v[24:27]
  v_add_f32 v17, v17, v56
  v_mfma_f32_16x16x32_bf16 v[60:63], v[76:79], v[104:107], v[24:27]
  v_add_f32 v16, v16, v66
  v_add_f32 v17, v17, v57
  s_waitcnt lgkmcnt(5)
  v_mfma_f32_16x16x32_bf16 v[48:51], v[80:83], v[108:111], v[48:51]
  v_add_f32 v17, v17, v58
  s_waitcnt lgkmcnt(4)
  v_mfma_f32_16x16x32_bf16 v[60:63], v[84:87], v[108:111], v[60:63]
  v_add_f32 v16, v16, v67
  v_add_f32 v17, v17, v59
  s_waitcnt lgkmcnt(3)
  v_mfma_f32_16x16x32_bf16 v[48:51], v[88:91], v[112:115], v[48:51]
  v_add_f32 v17, v17, v68
  s_waitcnt lgkmcnt(2)
  v_mfma_f32_16x16x32_bf16 v[60:63], v[92:95], v[112:115], v[60:63]
  v_add_f32 v17, v17, v69
  v_add_f32 v17, v17, v70
  s_waitcnt lgkmcnt(1)
  v_mfma_f32_16x16x32_bf16 v[48:51], v[96:99], v[116:119], v[48:51]
  s_waitcnt lgkmcnt(0)
  v_mfma_f32_16x16x32_bf16 v[60:63], v[100:103], v[116:119], v[60:63]
  v_add_f32 v17, v17, v71
  v_mfma_f32_16x16x32_bf16 v[52:55], v[72:75], v[120:123], v[28:31]
  ds_read_b64_tr_b16 v[248:249], v2 offset:8192
  ds_read_b64_tr_b16 v[250:251], v2 offset:9216
  v_mfma_f32_16x16x32_bf16 v[64:67], v[76:79], v[120:123], v[28:31]
  ds_read_b64_tr_b16 v[252:253], v3 offset:8192
  ds_read_b64_tr_b16 v[254:255], v3 offset:9216
  v_mfma_f32_16x16x32_bf16 v[52:55], v[80:83], v[124:127], v[52:55]
  v_max3_f32 v19, v48, v49, v50
  v_max3_f32 v19, v19, v51, v60
  v_max3_f32 v19, v19, v61, v62
  v_mfma_f32_16x16x32_bf16 v[64:67], v[84:87], v[124:127], v[64:67]
  v_max_f32 v19, v19, v63
  v_cmp_lt_f32 vcc, 0x41800000, v19
  v_mfma_f32_16x16x32_bf16 v[52:55], v[88:91], v[128:131], v[52:55]
  s_cbranch_vccnz L_stub_ct1_0
L_ret_ct1_0:
  v_exp_f32 v48, v48
  v_mfma_f32_16x16x32_bf16 v[64:67], v[92:95], v[128:131], v[64:67]
  v_exp_f32 v49, v49
  v_exp_f32 v50, v50
  v_mfma_f32_16x16x32_bf16 v[52:55], v[96:99], v[132:135], v[52:55]
  v_cvt_pk_bf16_f32 v36, v48, v49
  v_exp_f32 v51, v51
  v_mfma_f32_16x16x32_bf16 v[64:67], v[100:103], v[132:135], v[64:67]
  v_exp_f32 v60, v60
  v_cvt_pk_bf16_f32 v37, v50, v51
  v_mfma_f32_16x16x32_bf16 v[56:59], v[72:75], v[136:139], v[32:35]
  v_exp_f32 v61, v61
  v_exp_f32 v62, v62
  v_mfma_f32_16x16x32_bf16 v[68:71], v[76:79], v[136:139], v[32:35]
  v_cvt_pk_bf16_f32 v38, v60, v61
  v_exp_f32 v63, v63
  v_mfma_f32_16x16x32_bf16 v[56:59], v[80:83], v[140:143], v[56:59]
  ds_read_b64_tr_b16 v[80:81], v4 offset:8192
  ds_read_b64_tr_b16 v[82:83], v4 offset:9216
  v_cvt_pk_bf16_f32 v39, v62, v63
  v_max3_f32 v20, v52, v53, v54
  v_mfma_f32_16x16x32_bf16 v[68:71], v[84:87], v[140:143], v[68:71]
  ds_read_b64_tr_b16 v[84:85], v5 offset:8192
  ds_read_b64_tr_b16 v[86:87], v5 offset:9216
  v_max3_f32 v20, v20, v55, v64
  v_max3_f32 v20, v20, v65, v66
  v_mfma_f32_16x16x32_bf16 v[56:59], v[88:91], v[144:147], v[56:59]
  ds_read_b64_tr_b16 v[88:89], v6 offset:8192
  ds_read_b64_tr_b16 v[90:91], v6 offset:9216
  v_max_f32 v20, v20, v67
  v_cmp_lt_f32 vcc, 0x41800000, v20
  v_mfma_f32_16x16x32_bf16 v[68:71], v[92:95], v[144:147], v[68:71]
  ds_read_b64_tr_b16 v[92:93], v7 offset:8192
  ds_read_b64_tr_b16 v[94:95], v7 offset:9216
  s_cbranch_vccnz L_stub_ct1_1
L_ret_ct1_1:
  v_mfma_f32_16x16x32_bf16 v[56:59], v[96:99], v[148:151], v[56:59]
  ds_read_b64_tr_b16 v[96:97], v8 offset:8192
  ds_read_b64_tr_b16 v[98:99], v8 offset:9216
  v_exp_f32 v52, v52
  v_mfma_f32_16x16x32_bf16 v[68:71], v[100:103], v[148:151], v[68:71]
  ds_read_b64_tr_b16 v[100:101], v9 offset:8192
  s_waitcnt lgkmcnt(11)
  ds_read_b64_tr_b16 v[102:103], v9 offset:9216
  v_exp_f32 v53, v53
  v_mfma_f32_16x16x32_bf16 v[152:155], v[248:251], v[36:39], v[152:155]
  v_exp_f32 v54, v54
  v_cvt_pk_bf16_f32 v40, v52, v53
  v_mfma_f32_16x16x32_bf16 v[156:159], v[252:255], v[36:39], v[156:159]
  v_exp_f32 v55, v55
  v_exp_f32 v64, v64
  s_waitcnt lgkmcnt(8)
  v_mfma_f32_16x16x32_bf16 v[160:163], v[80:83], v[36:39], v[160:163]
  v_cvt_pk_bf16_f32 v41, v54, v55
  v_exp_f32 v65, v65
  v_max3_f32 v21, v56, v57, v58
  v_mfma_f32_16x16x32_bf16 v[164:167], v[84:87], v[36:39], v[164:167]
  v_exp_f32 v66, v66
  v_cvt_pk_bf16_f32 v42, v64, v65
  s_waitcnt lgkmcnt(6)
  v_mfma_f32_16x16x32_bf16 v[168:171], v[88:91], v[36:39], v[168:171]
  v_exp_f32 v67, v67
  v_max3_f32 v21, v21, v59, v68
  v_max3_f32 v21, v21, v69, v70
  s_waitcnt lgkmcnt(4)
  v_mfma_f32_16x16x32_bf16 v[172:175], v[92:95], v[36:39], v[172:175]
  v_cvt_pk_bf16_f32 v43, v66, v67
  v_max_f32 v21, v21, v71
  v_cmp_lt_f32 vcc, 0x41800000, v21
  s_waitcnt lgkmcnt(1)
  v_mfma_f32_16x16x32_bf16 v[176:179], v[96:99], v[36:39], v[176:179]
  s_cbranch_vccnz L_stub_ct1_2
L_ret_ct1_2:
  v_exp_f32 v56, v56
  s_waitcnt lgkmcnt(0)
  v_mfma_f32_16x16x32_bf16 v[180:183], v[100:103], v[36:39], v[180:183]
  v_exp_f32 v57, v57
  v_exp_f32 v58, v58
  v_mfma_f32_16x16x32_bf16 v[184:187], v[248:251], v[40:43], v[184:187]
  v_cvt_pk_bf16_f32 v44, v56, v57
  v_exp_f32 v59, v59
  v_mfma_f32_16x16x32_bf16 v[188:191], v[252:255], v[40:43], v[188:191]
  v_exp_f32 v68, v68
  v_cvt_pk_bf16_f32 v45, v58, v59
  v_mfma_f32_16x16x32_bf16 v[192:195], v[80:83], v[40:43], v[192:195]
  v_exp_f32 v69, v69
  v_exp_f32 v70, v70
  v_mfma_f32_16x16x32_bf16 v[196:199], v[84:87], v[40:43], v[196:199]
  v_cvt_pk_bf16_f32 v46, v68, v69
  v_exp_f32 v71, v71
  v_mfma_f32_16x16x32_bf16 v[200:203], v[88:91], v[40:43], v[200:203]
  s_waitcnt lgkmcnt(0)
  s_barrier
  v_cvt_pk_bf16_f32 v47, v70, v71
  v_mfma_f32_16x16x32_bf16 v[204:207], v[92:95], v[40:43], v[204:207]
  ds_read_b128 v[72:75], v10 offset:16384
  v_add_f32 v16, v16, v52
  v_mfma_f32_16x16x32_bf16 v[208:211], v[96:99], v[40:43], v[208:211]
  ds_read_b128 v[76:79], v10 offset:17408
  v_add_f32 v16, v16, v53
  v_mfma_f32_16x16x32_bf16 v[212:215], v[100:103], v[40:43], v[212:215]
  v_add_f32 v16, v16, v54
  v_add_f32 v16, v16, v55
  v_mfma_f32_16x16x32_bf16 v[216:219], v[248:251], v[44:47], v[216:219]
  v_add_f32 v16, v16, v64
  v_add_f32 v15, v15, v48
  v_mfma_f32_16x16x32_bf16 v[220:223], v[252:255], v[44:47], v[220:223]
  v_add_f32 v16, v16, v65
  v_add_f32 v15, v15, v49
  v_mfma_f32_16x16x32_bf16 v[224:227], v[80:83], v[44:47], v[224:227]
  ds_read_b128 v[80:83], v11 offset:16384
  v_add_f32 v15, v15, v50
  v_mfma_f32_16x16x32_bf16 v[228:231], v[84:87], v[44:47], v[228:231]
  ds_read_b128 v[84:87], v11 offset:17408
  v_add_f32 v15, v15, v51
  v_mfma_f32_16x16x32_bf16 v[232:235], v[88:91], v[44:47], v[232:235]
  ds_read_b128 v[88:91], v12 offset:16384
  v_add_f32 v15, v15, v60
  v_mfma_f32_16x16x32_bf16 v[236:239], v[92:95], v[44:47], v[236:239]
  ds_read_b128 v[92:95], v12 offset:17408
  v_add_f32 v15, v15, v61
  v_mfma_f32_16x16x32_bf16 v[240:243], v[96:99], v[44:47], v[240:243]
  ds_read_b128 v[96:99], v13 offset:16384
  v_add_f32 v15, v15, v62
  v_mfma_f32_16x16x32_bf16 v[244:247], v[100:103], v[44:47], v[244:247]
  ds_read_b128 v[100:103], v13 offset:17408
  v_add_f32 v15, v15, v63
  s_waitcnt lgkmcnt(6)
  v_mfma_f32_16x16x32_bf16 v[48:51], v[72:75], v[104:107], v[24:27]
  v_add_f32 v17, v17, v56
  v_mfma_f32_16x16x32_bf16 v[60:63], v[76:79], v[104:107], v[24:27]
  v_add_f32 v16, v16, v66
  v_add_f32 v17, v17, v57
  s_waitcnt lgkmcnt(5)
  v_mfma_f32_16x16x32_bf16 v[48:51], v[80:83], v[108:111], v[48:51]
  v_add_f32 v17, v17, v58
  s_waitcnt lgkmcnt(4)
  v_mfma_f32_16x16x32_bf16 v[60:63], v[84:87], v[108:111], v[60:63]
  v_add_f32 v16, v16, v67
  v_add_f32 v17, v17, v59
  s_waitcnt lgkmcnt(3)
  v_mfma_f32_16x16x32_bf16 v[48:51], v[88:91], v[112:115], v[48:51]
  v_add_f32 v17, v17, v68
  s_waitcnt lgkmcnt(2)
  v_mfma_f32_16x16x32_bf16 v[60:63], v[92:95], v[112:115], v[60:63]
  v_add_f32 v17, v17, v69
  v_add_f32 v17, v17, v70
  s_waitcnt lgkmcnt(1)
  v_mfma_f32_16x16x32_bf16 v[48:51], v[96:99], v[116:119], v[48:51]
  s_waitcnt lgkmcnt(0)
  v_mfma_f32_16x16x32_bf16 v[60:63], v[100:103], v[116:119], v[60:63]
  v_add_f32 v17, v17, v71
  v_mfma_f32_16x16x32_bf16 v[52:55], v[72:75], v[120:123], v[28:31]
  ds_read_b64_tr_b16 v[248:249], v2 offset:16384
  ds_read_b64_tr_b16 v[250:251], v2 offset:17408
  v_mfma_f32_16x16x32_bf16 v[64:67], v[76:79], v[120:123], v[28:31]
  ds_read_b64_tr_b16 v[252:253], v3 offset:16384
  ds_read_b64_tr_b16 v[254:255], v3 offset:17408
  v_mfma_f32_16x16x32_bf16 v[52:55], v[80:83], v[124:127], v[52:55]
  v_max3_f32 v19, v48, v49, v50
  v_max3_f32 v19, v19, v51, v60
  v_max3_f32 v19, v19, v61, v62
  v_mfma_f32_16x16x32_bf16 v[64:67], v[84:87], v[124:127], v[64:67]
  v_max_f32 v19, v19, v63
  v_cmp_lt_f32 vcc, 0x41800000, v19
  v_mfma_f32_16x16x32_bf16 v[52:55], v[88:91], v[128:131], v[52:55]
  s_cbranch_vccnz L_stub_ct2_0
L_ret_ct2_0:
  v_exp_f32 v48, v48
  v_mfma_f32_16x16x32_bf16 v[64:67], v[92:95], v[128:131], v[64:67]
  v_exp_f32 v49, v49
  v_exp_f32 v50, v50
  v_mfma_f32_16x16x32_bf16 v[52:55], v[96:99], v[132:135], v[52:55]
  v_cvt_pk_bf16_f32 v36, v48, v49
  v_exp_f32 v51, v51
  v_mfma_f32_16x16x32_bf16 v[64:67], v[100:103], v[132:135], v[64:67]
  v_exp_f32 v60, v60
  v_cvt_pk_bf16_f32 v37, v50, v51
  v_mfma_f32_16x16x32_bf16 v[56:59], v[72:75], v[136:139], v[32:35]
  v_exp_f32 v61, v61
  v_exp_f32 v62, v62
  v_mfma_f32_16x16x32_bf16 v[68:71], v[76:79], v[136:139], v[32:35]
  v_cvt_pk_bf16_f32 v38, v60, v61
  v_exp_f32 v63, v63
  v_mfma_f32_16x16x32_bf16 v[56:59], v[80:83], v[140:143], v[56:59]
  ds_read_b64_tr_b16 v[80:81], v4 offset:16384
  ds_read_b64_tr_b16 v[82:83], v4 offset:17408
  v_cvt_pk_bf16_f32 v39, v62, v63
  v_max3_f32 v20, v52, v53, v54
  v_mfma_f32_16x16x32_bf16 v[68:71], v[84:87], v[140:143], v[68:71]
  ds_read_b64_tr_b16 v[84:85], v5 offset:16384
  ds_read_b64_tr_b16 v[86:87], v5 offset:17408
  v_max3_f32 v20, v20, v55, v64
  v_max3_f32 v20, v20, v65, v66
  v_mfma_f32_16x16x32_bf16 v[56:59], v[88:91], v[144:147], v[56:59]
  ds_read_b64_tr_b16 v[88:89], v6 offset:16384
  ds_read_b64_tr_b16 v[90:91], v6 offset:17408
  v_max_f32 v20, v20, v67
  v_cmp_lt_f32 vcc, 0x41800000, v20
  v_mfma_f32_16x16x32_bf16 v[68:71], v[92:95], v[144:147], v[68:71]
  ds_read_b64_tr_b16 v[92:93], v7 offset:16384
  ds_read_b64_tr_b16 v[94:95], v7 offset:17408
  s_cbranch_vccnz L_stub_ct2_1
L_ret_ct2_1:
  v_mfma_f32_16x16x32_bf16 v[56:59], v[96:99], v[148:151], v[56:59]
  ds_read_b64_tr_b16 v[96:97], v8 offset:16384
  ds_read_b64_tr_b16 v[98:99], v8 offset:17408
  v_exp_f32 v52, v52
  v_mfma_f32_16x16x32_bf16 v[68:71], v[100:103], v[148:151], v[68:71]
  ds_read_b64_tr_b16 v[100:101], v9 offset:16384
  s_waitcnt lgkmcnt(11)
  ds_read_b64_tr_b16 v[102:103], v9 offset:17408
  v_exp_f32 v53, v53
  v_mfma_f32_16x16x32_bf16 v[152:155], v[248:251], v[36:39], v[152:155]
  v_exp_f32 v54, v54
  v_cvt_pk_bf16_f32 v40, v52, v53
  v_mfma_f32_16x16x32_bf16 v[156:159], v[252:255], v[36:39], v[156:159]
  v_exp_f32 v55, v55
  v_exp_f32 v64, v64
  s_waitcnt lgkmcnt(8)
  v_mfma_f32_16x16x32_bf16 v[160:163], v[80:83], v[36:39], v[160:163]
  v_cvt_pk_bf16_f32 v41, v54, v55
  v_exp_f32 v65, v65
  v_max3_f32 v21, v56, v57, v58
  v_mfma_f32_16x16x32_bf16 v[164:167], v[84:87], v[36:39], v[164:167]
  v_exp_f32 v66, v66
  v_cvt_pk_bf16_f32 v42, v64, v65
  s_waitcnt lgkmcnt(6)
  v_mfma_f32_16x16x32_bf16 v[168:171], v[88:91], v[36:39], v[168:171]
  v_exp_f32 v67, v67
  v_max3_f32 v21, v21, v59, v68
  v_max3_f32 v21, v21, v69, v70
  s_waitcnt lgkmcnt(4)
  v_mfma_f32_16x16x32_bf16 v[172:175], v[92:95], v[36:39], v[172:175]
  v_cvt_pk_bf16_f32 v43, v66, v67
  v_max_f32 v21, v21, v71
  v_cmp_lt_f32 vcc, 0x41800000, v21
  s_waitcnt lgkmcnt(1)
  v_mfma_f32_16x16x32_bf16 v[176:179], v[96:99], v[36:39], v[176:179]
  s_cbranch_vccnz L_stub_ct2_2
L_ret_ct2_2:
  v_exp_f32 v56, v56
  s_waitcnt lgkmcnt(0)
  v_mfma_f32_16x16x32_bf16 v[180:183], v[100:103], v[36:39], v[180:183]
  v_exp_f32 v57, v57
  v_exp_f32 v58, v58
  v_mfma_f32_16x16x32_bf16 v[184:187], v[248:251], v[40:43], v[184:187]
  v_cvt_pk_bf16_f32 v44, v56, v57
  v_exp_f32 v59, v59
  v_mfma_f32_16x16x32_bf16 v[188:191], v[252:255], v[40:43], v[188:191]
  v_exp_f32 v68, v68
  v_cvt_pk_bf16_f32 v45, v58, v59
  v_mfma_f32_16x16x32_bf16 v[192:195], v[80:83], v[40:43], v[192:195]
  v_exp_f32 v69, v69
  v_exp_f32 v70, v70
  v_mfma_f32_16x16x32_bf16 v[196:199], v[84:87], v[40:43], v[196:199]
  v_cvt_pk_bf16_f32 v46, v68, v69
  v_exp_f32 v71, v71
  v_mfma_f32_16x16x32_bf16 v[200:203], v[88:91], v[40:43], v[200:203]
  s_waitcnt lgkmcnt(0)
  s_barrier
  v_cvt_pk_bf16_f32 v47, v70, v71
  v_mfma_f32_16x16x32_bf16 v[204:207], v[92:95], v[40:43], v[204:207]
  ds_read_b128 v[72:75], v10 offset:24576
  v_add_f32 v16, v16, v52
  v_mfma_f32_16x16x32_bf16 v[208:211], v[96:99], v[40:43], v[208:211]
  ds_read_b128 v[76:79], v10 offset:25600
  v_add_f32 v16, v16, v53
  v_mfma_f32_16x16x32_bf16 v[212:215], v[100:103], v[40:43], v[212:215]
  v_add_f32 v16, v16, v54
  v_add_f32 v16, v16, v55
  v_mfma_f32_16x16x32_bf16 v[216:219], v[248:251], v[44:47], v[216:219]
  v_add_f32 v16, v16, v64
  v_add_f32 v15, v15, v48
  v_mfma_f32_16x16x32_bf16 v[220:223], v[252:255], v[44:47], v[220:223]
  v_add_f32 v16, v16, v65
  v_add_f32 v15, v15, v49
  v_mfma_f32_16x16x32_bf16 v[224:227], v[80:83], v[44:47], v[224:227]
  ds_read_b128 v[80:83], v11 offset:24576
  v_add_f32 v15, v15, v50
  v_mfma_f32_16x16x32_bf16 v[228:231], v[84:87], v[44:47], v[228:231]
  ds_read_b128 v[84:87], v11 offset:25600
  v_add_f32 v15, v15, v51
  v_mfma_f32_16x16x32_bf16 v[232:235], v[88:91], v[44:47], v[232:235]
  ds_read_b128 v[88:91], v12 offset:24576
  v_add_f32 v15, v15, v60
  v_mfma_f32_16x16x32_bf16 v[236:239], v[92:95], v[44:47], v[236:239]
  ds_read_b128 v[92:95], v12 offset:25600
  v_add_f32 v15, v15, v61
  v_mfma_f32_16x16x32_bf16 v[240:243], v[96:99], v[44:47], v[240:243]
  ds_read_b128 v[96:99], v13 offset:24576
  v_add_f32 v15, v15, v62
  v_mfma_f32_16x16x32_bf16 v[244:247], v[100:103], v[44:47], v[244:247]
  ds_read_b128 v[100:103], v13 offset:25600
  v_add_f32 v15, v15, v63
  s_sub_u32 s61, s61, 1
  s_cmp_eq_u32 s61, 0
  s_cbranch_scc1 L_Ac_T3L
  s_waitcnt lgkmcnt(6)
  v_mfma_f32_16x16x32_bf16 v[48:51], v[72:75], v[104:107], v[24:27]
  v_add_f32 v17, v17, v56
  v_mfma_f32_16x16x32_bf16 v[60:63], v[76:79], v[104:107], v[24:27]
  v_add_f32 v16, v16, v66
  v_add_f32 v17, v17, v57
  s_waitcnt lgkmcnt(5)
  v_mfma_f32_16x16x32_bf16 v[48:51], v[80:83], v[108:111], v[48:51]
  v_add_f32 v17, v17, v58
  s_waitcnt lgkmcnt(4)
  v_mfma_f32_16x16x32_bf16 v[60:63], v[84:87], v[108:111], v[60:63]
  v_add_f32 v16, v16, v67
  v_add_f32 v17, v17, v59
  s_waitcnt lgkmcnt(3)
  v_mfma_f32_16x16x32_bf16 v[48:51], v[88:91], v[112:115], v[48:51]
  v_add_f32 v17, v17, v68
  s_waitcnt lgkmcnt(2)
  v_mfma_f32_16x16x32_bf16 v[60:63], v[92:95], v[112:115], v[60:63]
  v_add_f32 v17, v17, v69
  v_add_f32 v17, v17, v70
  s_waitcnt lgkmcnt(1)
  v_mfma_f32_16x16x32_bf16 v[48:51], v[96:99], v[116:119], v[48:51]
  s_waitcnt lgkmcnt(0)
  v_mfma_f32_16x16x32_bf16 v[60:63], v[100:103], v[116:119], v[60:63]
  v_add_f32 v17, v17, v71
  v_mfma_f32_16x16x32_bf16 v[52:55], v[72:75], v[120:123], v[28:31]
  ds_read_b64_tr_b16 v[248:249], v2 offset:24576
  ds_read_b64_tr_b16 v[250:251], v2 offset:25600
  v_mfma_f32_16x16x32_bf16 v[64:67], v[76:79], v[120:123], v[28:31]
  ds_read_b64_tr_b16 v[252:253], v3 offset:24576
  ds_read_b64_tr_b16 v[254:255], v3 offset:25600
  v_mfma_f32_16x16x32_bf16 v[52:55], v[80:83], v[124:127], v[52:55]
  v_max3_f32 v19, v48, v49, v50
  v_max3_f32 v19, v19, v51, v60
  v_max3_f32 v19, v19, v61, v62
  v_mfma_f32_16x16x32_bf16 v[64:67], v[84:87], v[124:127], v[64:67]
  v_max_f32 v19, v19, v63
  v_cmp_lt_f32 vcc, 0x41800000, v19
  v_mfma_f32_16x16x32_bf16 v[52:55], v[88:91], v[128:131], v[52:55]
  s_cbranch_vccnz L_stub_ct3_0
L_ret_ct3_0:
  v_exp_f32 v48, v48
  v_mfma_f32_16x16x32_bf16 v[64:67], v[92:95], v[128:131], v[64:67]
  v_exp_f32 v49, v49
  v_exp_f32 v50, v50
  v_mfma_f32_16x16x32_bf16 v[52:55], v[96:99], v[132:135], v[52:55]
  v_cvt_pk_bf16_f32 v36, v48, v49
  v_exp_f32 v51, v51
  v_mfma_f32_16x16x32_bf16 v[64:67], v[100:103], v[132:135], v[64:67]
  v_exp_f32 v60, v60
  v_cvt_pk_bf16_f32 v37, v50, v51
  v_mfma_f32_16x16x32_bf16 v[56:59], v[72:75], v[136:139], v[32:35]
  v_exp_f32 v61, v61
  v_exp_f32 v62, v62
  v_mfma_f32_16x16x32_bf16 v[68:71], v[76:79], v[136:139], v[32:35]
  v_cvt_pk_bf16_f32 v38, v60, v61
  v_exp_f32 v63, v63
  v_mfma_f32_16x16x32_bf16 v[56:59], v[80:83], v[140:143], v[56:59]
  ds_read_b64_tr_b16 v[80:81], v4 offset:24576
  ds_read_b64_tr_b16 v[82:83], v4 offset:25600
  v_cvt_pk_bf16_f32 v39, v62, v63
  v_max3_f32 v20, v52, v53, v54
  v_mfma_f32_16x16x32_bf16 v[68:71], v[84:87], v[140:143], v[68:71]
  ds_read_b64_tr_b16 v[84:85], v5 offset:24576
  ds_read_b64_tr_b16 v[86:87], v5 offset:25600
  v_max3_f32 v20, v20, v55, v64
  v_max3_f32 v20, v20, v65, v66
  v_mfma_f32_16x16x32_bf16 v[56:59], v[88:91], v[144:147], v[56:59]
  ds_read_b64_tr_b16 v[88:89], v6 offset:24576
  ds_read_b64_tr_b16 v[90:91], v6 offset:25600
  v_max_f32 v20, v20, v67
  v_cmp_lt_f32 vcc, 0x41800000, v20
  v_mfma_f32_16x16x32_bf16 v[68:71], v[92:95], v[144:147], v[68:71]
  ds_read_b64_tr_b16 v[92:93], v7 offset:24576
  ds_read_b64_tr_b16 v[94:95], v7 offset:25600
  s_cbranch_vccnz L_stub_ct3_1
L_ret_ct3_1:
  v_mfma_f32_16x16x32_bf16 v[56:59], v[96:99], v[148:151], v[56:59]
  ds_read_b64_tr_b16 v[96:97], v8 offset:24576
  ds_read_b64_tr_b16 v[98:99], v8 offset:25600
  v_exp_f32 v52, v52
  v_mfma_f32_16x16x32_bf16 v[68:71], v[100:103], v[148:151], v[68:71]
  ds_read_b64_tr_b16 v[100:101], v9 offset:24576
  s_waitcnt lgkmcnt(11)
  ds_read_b64_tr_b16 v[102:103], v9 offset:25600
  v_exp_f32 v53, v53
  v_mfma_f32_16x16x32_bf16 v[152:155], v[248:251], v[36:39], v[152:155]
  v_exp_f32 v54, v54
  v_cvt_pk_bf16_f32 v40, v52, v53
  v_mfma_f32_16x16x32_bf16 v[156:159], v[252:255], v[36:39], v[156:159]
  v_exp_f32 v55, v55
  v_exp_f32 v64, v64
  s_waitcnt lgkmcnt(8)
  v_mfma_f32_16x16x32_bf16 v[160:163], v[80:83], v[36:39], v[160:163]
  v_cvt_pk_bf16_f32 v41, v54, v55
  v_exp_f32 v65, v65
  v_max3_f32 v21, v56, v57, v58
  v_mfma_f32_16x16x32_bf16 v[164:167], v[84:87], v[36:39], v[164:167]
  v_exp_f32 v66, v66
  v_cvt_pk_bf16_f32 v42, v64, v65
  s_waitcnt lgkmcnt(6)
  v_mfma_f32_16x16x32_bf16 v[168:171], v[88:91], v[36:39], v[168:171]
  v_exp_f32 v67, v67
  v_max3_f32 v21, v21, v59, v68
  v_max3_f32 v21, v21, v69, v70
  s_waitcnt lgkmcnt(4)
  v_mfma_f32_16x16x32_bf16 v[172:175], v[92:95], v[36:39], v[172:175]
  v_cvt_pk_bf16_f32 v43, v66, v67
  v_max_f32 v21, v21, v71
  v_cmp_lt_f32 vcc, 0x41800000, v21
  s_waitcnt lgkmcnt(1)
  v_mfma_f32_16x16x32_bf16 v[176:179], v[96:99], v[36:39], v[176:179]
  s_cbranch_vccnz L_stub_ct3_2
L_ret_ct3_2:
  v_exp_f32 v56, v56
  s_waitcnt lgkmcnt(0)
  v_mfma_f32_16x16x32_bf16 v[180:183], v[100:103], v[36:39], v[180:183]
  v_exp_f32 v57, v57
  v_exp_f32 v58, v58
  v_mfma_f32_16x16x32_bf16 v[184:187], v[248:251], v[40:43], v[184:187]
  v_cvt_pk_bf16_f32 v44, v56, v57
  v_exp_f32 v59, v59
  v_mfma_f32_16x16x32_bf16 v[188:191], v[252:255], v[40:43], v[188:191]
  v_exp_f32 v68, v68
  v_cvt_pk_bf16_f32 v45, v58, v59
  v_mfma_f32_16x16x32_bf16 v[192:195], v[80:83], v[40:43], v[192:195]
  v_exp_f32 v69, v69
  v_exp_f32 v70, v70
  v_mfma_f32_16x16x32_bf16 v[196:199], v[84:87], v[40:43], v[196:199]
  v_cvt_pk_bf16_f32 v46, v68, v69
  v_exp_f32 v71, v71
  v_mfma_f32_16x16x32_bf16 v[200:203], v[88:91], v[40:43], v[200:203]
  s_waitcnt lgkmcnt(0)
  s_barrier
  v_cvt_pk_bf16_f32 v47, v70, v71
  v_mfma_f32_16x16x32_bf16 v[204:207], v[92:95], v[40:43], v[204:207]
  ds_read_b128 v[72:75], v10
  v_add_f32 v16, v16, v52
  v_mfma_f32_16x16x32_bf16 v[208:211], v[96:99], v[40:43], v[208:211]
  ds_read_b128 v[76:79], v10 offset:1024
  v_add_f32 v16, v16, v53
  v_mfma_f32_16x16x32_bf16 v[212:215], v[100:103], v[40:43], v[212:215]
  v_add_f32 v16, v16, v54
  v_add_f32 v16, v16, v55
  v_mfma_f32_16x16x32_bf16 v[216:219], v[248:251], v[44:47], v[216:219]
  v_add_f32 v16, v16, v64
  v_add_f32 v15, v15, v48
  v_mfma_f32_16x16x32_bf16 v[220:223], v[252:255], v[44:47], v[220:223]
  v_add_f32 v16, v16, v65
  v_add_f32 v15, v15, v49
  v_mfma_f32_16x16x32_bf16 v[224:227], v[80:83], v[44:47], v[224:227]
  ds_read_b128 v[80:83], v11
  v_add_f32 v15, v15, v50
  v_mfma_f32_16x16x32_bf16 v[228:231], v[84:87], v[44:47], v[228:231]
  ds_read_b128 v[84:87], v11 offset:1024
  v_add_f32 v15, v15, v51
  v_mfma_f32_16x16x32_bf16 v[232:235], v[88:91], v[44:47], v[232:235]
  ds_read_b128 v[88:91], v12
  v_add_f32 v15, v15, v60
  v_mfma_f32_16x16x32_bf16 v[236:239], v[92:95], v[44:47], v[236:239]
  ds_read_b128 v[92:95], v12 offset:1024
  v_add_f32 v15, v15, v61
  v_mfma_f32_16x16x32_bf16 v[240:243], v[96:99], v[44:47], v[240:243]
  ds_read_b128 v[96:99], v13
  v_add_f32 v15, v15, v62
  v_mfma_f32_16x16x32_bf16 v[244:247], v[100:103], v[44:47], v[244:247]
  ds_read_b128 v[100:103], v13 offset:1024
  v_add_f32 v15, v15, v63
  s_branch L_Ac_T0
L_Ac_T3L:
  s_waitcnt lgkmcnt(6)
  v_mfma_f32_16x16x32_bf16 v[48:51], v[72:75], v[104:107], v[24:27]
  v_add_f32 v17, v17, v56
  v_mfma_f32_16x16x32_bf16 v[60:63], v[76:79], v[104:107], v[24:27]
  v_add_f32 v16, v16, v66
  v_add_f32 v17, v17, v57
  s_waitcnt lgkmcnt(5)
  v_mfma_f32_16x16x32_bf16 v[48:51], v[80:83], v[108:111], v[48:51]
  v_add_f32 v17, v17, v58
  s_waitcnt lgkmcnt(4)
  v_mfma_f32_16x16x32_bf16 v[60:63], v[84:87], v[108:111], v[60:63]
  v_add_f32 v16, v16, v67
  v_add_f32 v17, v17, v59
  s_waitcnt lgkmcnt(3)
  v_mfma_f32_16x16x32_bf16 v[48:51], v[88:91], v[112:115], v[48:51]
  v_add_f32 v17, v17, v68
  s_waitcnt lgkmcnt(2)
  v_mfma_f32_16x16x32_bf16 v[60:63], v[92:95], v[112:115], v[60:63]
  v_add_f32 v17, v17, v69
  v_add_f32 v17, v17, v70
  s_waitcnt lgkmcnt(1)
  v_mfma_f32_16x16x32_bf16 v[48:51], v[96:99], v[116:119], v[48:51]
  s_waitcnt lgkmcnt(0)
  v_mfma_f32_16x16x32_bf16 v[60:63], v[100:103], v[116:119], v[60:63]
  v_add_f32 v17, v17, v71
  v_mfma_f32_16x16x32_bf16 v[52:55], v[72:75], v[120:123], v[28:31]
  ds_read_b64_tr_b16 v[248:249], v2 offset:24576
  ds_read_b64_tr_b16 v[250:251], v2 offset:25600
  v_mfma_f32_16x16x32_bf16 v[64:67], v[76:79], v[120:123], v[28:31]
  ds_read_b64_tr_b16 v[252:253], v3 offset:24576
  ds_read_b64_tr_b16 v[254:255], v3 offset:25600
  v_mfma_f32_16x16x32_bf16 v[52:55], v[80:83], v[124:127], v[52:55]
  v_max3_f32 v19, v48, v49, v50
  v_max3_f32 v19, v19, v51, v60
  v_max3_f32 v19, v19, v61, v62
  v_mfma_f32_16x16x32_bf16 v[64:67], v[84:87], v[124:127], v[64:67]
  v_max_f32 v19, v19, v63
  v_cmp_lt_f32 vcc, 0x41800000, v19
  v_mfma_f32_16x16x32_bf16 v[52:55], v[88:91], v[128:131], v[52:55]
  s_cbranch_vccnz L_stub_ct3l_0
L_ret_ct3l_0:
  v_exp_f32 v48, v48
  v_mfma_f32_16x16x32_bf16 v[64:67], v[92:95], v[128:131], v[64:67]
  v_exp_f32 v49, v49
  v_exp_f32 v50, v50
  v_mfma_f32_16x16x32_bf16 v[52:55], v[96:99], v[132:135], v[52:55]
  v_cvt_pk_bf16_f32 v36, v48, v49
  v_exp_f32 v51, v51
  v_mfma_f32_16x16x32_bf16 v[64:67], v[100:103], v[132:135], v[64:67]
  v_exp_f32 v60, v60
  v_cvt_pk_bf16_f32 v37, v50, v51
  v_mfma_f32_16x16x32_bf16 v[56:59], v[72:75], v[136:139], v[32:35]
  v_exp_f32 v61, v61
  v_exp_f32 v62, v62
  v_mfma_f32_16x16x32_bf16 v[68:71], v[76:79], v[136:139], v[32:35]
  v_cvt_pk_bf16_f32 v38, v60, v61
  v_exp_f32 v63, v63
  v_mfma_f32_16x16x32_bf16 v[56:59], v[80:83], v[140:143], v[56:59]
  ds_read_b64_tr_b16 v[80:81], v4 offset:24576
  ds_read_b64_tr_b16 v[82:83], v4 offset:25600
  v_cvt_pk_bf16_f32 v39, v62, v63
  v_max3_f32 v20, v52, v53, v54
  v_mfma_f32_16x16x32_bf16 v[68:71], v[84:87], v[140:143], v[68:71]
  ds_read_b64_tr_b16 v[84:85], v5 offset:24576
  ds_read_b64_tr_b16 v[86:87], v5 offset:25600
  v_max3_f32 v20, v20, v55, v64
  v_max3_f32 v20, v20, v65, v66
  v_mfma_f32_16x16x32_bf16 v[56:59], v[88:91], v[144:147], v[56:59]
  ds_read_b64_tr_b16 v[88:89], v6 offset:24576
  ds_read_b64_tr_b16 v[90:91], v6 offset:25600
  v_max_f32 v20, v20, v67
  v_cmp_lt_f32 vcc, 0x41800000, v20
  v_mfma_f32_16x16x32_bf16 v[68:71], v[92:95], v[144:147], v[68:71]
  ds_read_b64_tr_b16 v[92:93], v7 offset:24576
  ds_read_b64_tr_b16 v[94:95], v7 offset:25600
  s_cbranch_vccnz L_stub_ct3l_1
L_ret_ct3l_1:
  v_mfma_f32_16x16x32_bf16 v[56:59], v[96:99], v[148:151], v[56:59]
  ds_read_b64_tr_b16 v[96:97], v8 offset:24576
  ds_read_b64_tr_b16 v[98:99], v8 offset:25600
  v_exp_f32 v52, v52
  v_mfma_f32_16x16x32_bf16 v[68:71], v[100:103], v[148:151], v[68:71]
  ds_read_b64_tr_b16 v[100:101], v9 offset:24576
  s_waitcnt lgkmcnt(11)
  ds_read_b64_tr_b16 v[102:103], v9 offset:25600
  v_exp_f32 v53, v53
  v_mfma_f32_16x16x32_bf16 v[152:155], v[248:251], v[36:39], v[152:155]
  v_exp_f32 v54, v54
  v_cvt_pk_bf16_f32 v40, v52, v53
  v_mfma_f32_16x16x32_bf16 v[156:159], v[252:255], v[36:39], v[156:159]
  v_exp_f32 v55, v55
  v_exp_f32 v64, v64
  s_waitcnt lgkmcnt(8)
  v_mfma_f32_16x16x32_bf16 v[160:163], v[80:83], v[36:39], v[160:163]
  v_cvt_pk_bf16_f32 v41, v54, v55
  v_exp_f32 v65, v65
  v_max3_f32 v21, v56, v57, v58
  v_mfma_f32_16x16x32_bf16 v[164:167], v[84:87], v[36:39], v[164:167]
  v_exp_f32 v66, v66
  v_cvt_pk_bf16_f32 v42, v64, v65
  s_waitcnt lgkmcnt(6)
  v_mfma_f32_16x16x32_bf16 v[168:171], v[88:91], v[36:39], v[168:171]
  v_exp_f32 v67, v67
  v_max3_f32 v21, v21, v59, v68
  v_max3_f32 v21, v21, v69, v70
  s_waitcnt lgkmcnt(4)
  v_mfma_f32_16x16x32_bf16 v[172:175], v[92:95], v[36:39], v[172:175]
  v_cvt_pk_bf16_f32 v43, v66, v67
  v_max_f32 v21, v21, v71
  v_cmp_lt_f32 vcc, 0x41800000, v21
  s_waitcnt lgkmcnt(1)
  v_mfma_f32_16x16x32_bf16 v[176:179], v[96:99], v[36:39], v[176:179]
  s_cbranch_vccnz L_stub_ct3l_2
L_ret_ct3l_2:
  v_exp_f32 v56, v56
  s_waitcnt lgkmcnt(0)
  v_mfma_f32_16x16x32_bf16 v[180:183], v[100:103], v[36:39], v[180:183]
  v_exp_f32 v57, v57
  v_exp_f32 v58, v58
  v_mfma_f32_16x16x32_bf16 v[184:187], v[248:251], v[40:43], v[184:187]
  v_cvt_pk_bf16_f32 v44, v56, v57
  v_exp_f32 v59, v59
  v_mfma_f32_16x16x32_bf16 v[188:191], v[252:255], v[40:43], v[188:191]
  v_exp_f32 v68, v68
  v_cvt_pk_bf16_f32 v45, v58, v59
  v_mfma_f32_16x16x32_bf16 v[192:195], v[80:83], v[40:43], v[192:195]
  v_exp_f32 v69, v69
  v_exp_f32 v70, v70
  v_mfma_f32_16x16x32_bf16 v[196:199], v[84:87], v[40:43], v[196:199]
  v_cvt_pk_bf16_f32 v46, v68, v69
  v_exp_f32 v71, v71
  v_mfma_f32_16x16x32_bf16 v[200:203], v[88:91], v[40:43], v[200:203]
  v_cvt_pk_bf16_f32 v47, v70, v71
  v_add_f32 v15, v15, v48
  v_mfma_f32_16x16x32_bf16 v[204:207], v[92:95], v[40:43], v[204:207]
  v_add_f32 v16, v16, v52
  v_add_f32 v15, v15, v49
  v_mfma_f32_16x16x32_bf16 v[208:211], v[96:99], v[40:43], v[208:211]
  v_add_f32 v16, v16, v53
  v_add_f32 v15, v15, v50
  v_mfma_f32_16x16x32_bf16 v[212:215], v[100:103], v[40:43], v[212:215]
  v_add_f32 v16, v16, v54
  v_mfma_f32_16x16x32_bf16 v[216:219], v[248:251], v[44:47], v[216:219]
  v_add_f32 v16, v16, v55
  v_add_f32 v16, v16, v66
  v_add_f32 v16, v16, v67
  v_mfma_f32_16x16x32_bf16 v[220:223], v[252:255], v[44:47], v[220:223]
  v_add_f32 v16, v16, v64
  v_add_f32 v17, v17, v56
  v_add_f32 v17, v17, v57
  v_mfma_f32_16x16x32_bf16 v[224:227], v[80:83], v[44:47], v[224:227]
  v_add_f32 v16, v16, v65
  v_add_f32 v17, v17, v58
  v_mfma_f32_16x16x32_bf16 v[228:231], v[84:87], v[44:47], v[228:231]
  v_add_f32 v15, v15, v51
  v_add_f32 v17, v17, v59
  v_mfma_f32_16x16x32_bf16 v[232:235], v[88:91], v[44:47], v[232:235]
  v_add_f32 v15, v15, v60
  v_add_f32 v17, v17, v68
  v_mfma_f32_16x16x32_bf16 v[236:239], v[92:95], v[44:47], v[236:239]
  v_add_f32 v15, v15, v61
  v_add_f32 v17, v17, v69
  v_mfma_f32_16x16x32_bf16 v[240:243], v[96:99], v[44:47], v[240:243]
  v_add_f32 v15, v15, v62
  v_add_f32 v17, v17, v70
  v_mfma_f32_16x16x32_bf16 v[244:247], v[100:103], v[44:47], v[244:247]
  v_add_f32 v15, v15, v63
  v_add_f32 v17, v17, v71
  v_mov_b32 v22, v15
  s_nop 1
  v_permlane32_swap_b32 v15, v22
  v_add_f32 v15, v15, v22
  v_mov_b32 v22, v15
  s_nop 1
  v_permlane16_swap_b32 v15, v22
  v_add_f32 v15, v15, v22
  v_rcp_f32 v23, v15
  s_nop 0
  v_mul_f32 v152, v152, v23
  v_mul_f32 v153, v153, v23
  v_mul_f32 v154, v154, v23
  v_mul_f32 v155, v155, v23
  v_cvt_pk_bf16_f32 v152, v152, v153
  v_cvt_pk_bf16_f32 v153, v154, v155
  v_mul_f32 v156, v156, v23
  v_mul_f32 v157, v157, v23
  v_mul_f32 v158, v158, v23
  v_mul_f32 v159, v159, v23
  v_cvt_pk_bf16_f32 v154, v156, v157
  v_cvt_pk_bf16_f32 v155, v158, v159
  v_mul_f32 v160, v160, v23
  v_mul_f32 v161, v161, v23
  v_mul_f32 v162, v162, v23
  v_mul_f32 v163, v163, v23
  v_cvt_pk_bf16_f32 v160, v160, v161
  v_cvt_pk_bf16_f32 v161, v162, v163
  v_mul_f32 v164, v164, v23
  v_mul_f32 v165, v165, v23
  v_mul_f32 v166, v166, v23
  v_mul_f32 v167, v167, v23
  v_cvt_pk_bf16_f32 v162, v164, v165
  v_cvt_pk_bf16_f32 v163, v166, v167
  v_mul_f32 v168, v168, v23
  v_mul_f32 v169, v169, v23
  v_mul_f32 v170, v170, v23
  v_mul_f32 v171, v171, v23
  v_cvt_pk_bf16_f32 v168, v168, v169
  v_cvt_pk_bf16_f32 v169, v170, v171
  v_mul_f32 v172, v172, v23
  v_mul_f32 v173, v173, v23
  v_mul_f32 v174, v174, v23
  v_mul_f32 v175, v175, v23
  v_cvt_pk_bf16_f32 v170, v172, v173
  v_cvt_pk_bf16_f32 v171, v174, v175
  v_mul_f32 v176, v176, v23
  v_mul_f32 v177, v177, v23
  v_mul_f32 v178, v178, v23
  v_mul_f32 v179, v179, v23
  v_cvt_pk_bf16_f32 v176, v176, v177
  v_cvt_pk_bf16_f32 v177, v178, v179
  v_mul_f32 v180, v180, v23
  v_mul_f32 v181, v181, v23
  v_mul_f32 v182, v182, v23
  v_mul_f32 v183, v183, v23
  v_cvt_pk_bf16_f32 v178, v180, v181
  v_cvt_pk_bf16_f32 v179, v182, v183
  v_mov_b32 v15, 0
  v_mov_b32 v22, v16
  s_nop 1
  v_permlane32_swap_b32 v16, v22
  v_add_f32 v16, v16, v22
  v_mov_b32 v22, v16
  s_nop 1
  v_permlane16_swap_b32 v16, v22
  v_add_f32 v16, v16, v22
  v_rcp_f32 v23, v16
  s_nop 0
  v_mul_f32 v184, v184, v23
  v_mul_f32 v185, v185, v23
  v_mul_f32 v186, v186, v23
  v_mul_f32 v187, v187, v23
  v_cvt_pk_bf16_f32 v184, v184, v185
  v_cvt_pk_bf16_f32 v185, v186, v187
  v_mul_f32 v188, v188, v23
  v_mul_f32 v189, v189, v23
  v_mul_f32 v190, v190, v23
  v_mul_f32 v191, v191, v23
  v_cvt_pk_bf16_f32 v186, v188, v189
  v_cvt_pk_bf16_f32 v187, v190, v191
  v_mul_f32 v192, v192, v23
  v_mul_f32 v193, v193, v23
  v_mul_f32 v194, v194, v23
  v_mul_f32 v195, v195, v23
  v_cvt_pk_bf16_f32 v192, v192, v193
  v_cvt_pk_bf16_f32 v193, v194, v195
  v_mul_f32 v196, v196, v23
  v_mul_f32 v197, v197, v23
  v_mul_f32 v198, v198, v23
  v_mul_f32 v199, v199, v23
  v_cvt_pk_bf16_f32 v194, v196, v197
  v_cvt_pk_bf16_f32 v195, v198, v199
  v_mul_f32 v200, v200, v23
  v_mul_f32 v201, v201, v23
  v_mul_f32 v202, v202, v23
  v_mul_f32 v203, v203, v23
  v_cvt_pk_bf16_f32 v200, v200, v201
  v_cvt_pk_bf16_f32 v201, v202, v203
  v_mul_f32 v204, v204, v23
  v_mul_f32 v205, v205, v23
  v_mul_f32 v206, v206, v23
  v_mul_f32 v207, v207, v23
  v_cvt_pk_bf16_f32 v202, v204, v205
  v_cvt_pk_bf16_f32 v203, v206, v207
  v_mul_f32 v208, v208, v23
  v_mul_f32 v209, v209, v23
  v_mul_f32 v210, v210, v23
  v_mul_f32 v211, v211, v23
  v_cvt_pk_bf16_f32 v208, v208, v209
  v_cvt_pk_bf16_f32 v209, v210, v211
  v_mul_f32 v212, v212, v23
  v_mul_f32 v213, v213, v23
  v_mul_f32 v214, v214, v23
  v_mul_f32 v215, v215, v23
  v_cvt_pk_bf16_f32 v210, v212, v213
  v_cvt_pk_bf16_f32 v211, v214, v215
  v_mov_b32 v16, 0
  v_mov_b32 v22, v17
  s_nop 1
  v_permlane32_swap_b32 v17, v22
  v_add_f32 v17, v17, v22
  v_mov_b32 v22, v17
  s_nop 1
  v_permlane16_swap_b32 v17, v22
  v_add_f32 v17, v17, v22
  v_rcp_f32 v23, v17
  s_nop 0
  v_mul_f32 v216, v216, v23
  v_mul_f32 v217, v217, v23
  v_mul_f32 v218, v218, v23
  v_mul_f32 v219, v219, v23
  v_cvt_pk_bf16_f32 v216, v216, v217
  v_cvt_pk_bf16_f32 v217, v218, v219
  v_mul_f32 v220, v220, v23
  v_mul_f32 v221, v221, v23
  v_mul_f32 v222, v222, v23
  v_mul_f32 v223, v223, v23
  v_cvt_pk_bf16_f32 v218, v220, v221
  v_cvt_pk_bf16_f32 v219, v222, v223
  v_mul_f32 v224, v224, v23
  v_mul_f32 v225, v225, v23
  v_mul_f32 v226, v226, v23
  v_mul_f32 v227, v227, v23
  v_cvt_pk_bf16_f32 v224, v224, v225
  v_cvt_pk_bf16_f32 v225, v226, v227
  v_mul_f32 v228, v228, v23
  v_mul_f32 v229, v229, v23
  v_mul_f32 v230, v230, v23
  v_mul_f32 v231, v231, v23
  v_cvt_pk_bf16_f32 v226, v228, v229
  v_cvt_pk_bf16_f32 v227, v230, v231
  v_mul_f32 v232, v232, v23
  v_mul_f32 v233, v233, v23
  v_mul_f32 v234, v234, v23
  v_mul_f32 v235, v235, v23
  v_cvt_pk_bf16_f32 v232, v232, v233
  v_cvt_pk_bf16_f32 v233, v234, v235
  v_mul_f32 v236, v236, v23
  v_mul_f32 v237, v237, v23
  v_mul_f32 v238, v238, v23
  v_mul_f32 v239, v239, v23
  v_cvt_pk_bf16_f32 v234, v236, v237
  v_cvt_pk_bf16_f32 v235, v238, v239
  v_mul_f32 v240, v240, v23
  v_mul_f32 v241, v241, v23
  v_mul_f32 v242, v242, v23
  v_mul_f32 v243, v243, v23
  v_cvt_pk_bf16_f32 v240, v240, v241
  v_cvt_pk_bf16_f32 v241, v242, v243
  v_mul_f32 v244, v244, v23
  v_mul_f32 v245, v245, v23
  v_mul_f32 v246, v246, v23
  v_mul_f32 v247, v247, v23
  v_cvt_pk_bf16_f32 v242, v244, v245
  v_cvt_pk_bf16_f32 v243, v246, v247
  v_mov_b32 v17, 0
  s_add_u32 s36, s36, 1
  s_waitcnt lgkmcnt(0)
  s_barrier
  s_cmp_lt_u32 s36, 4
  s_cbranch_scc1 L_Ac_go
L_Ac_fin:
  v_add_u32 v19, 0xffff0000, v18
  ds_write_b128 v19, v[152:155]
  ds_write_b128 v19, v[160:163] offset:1024
  ds_write_b128 v19, v[168:171] offset:2048
  ds_write_b128 v19, v[176:179] offset:3072
  ds_write_b128 v19, v[184:187] offset:4096
  ds_write_b128 v19, v[192:195] offset:5120
  ds_write_b128 v19, v[200:203] offset:6144
  ds_write_b128 v19, v[208:211] offset:7168
  ds_write_b128 v19, v[216:219] offset:8192
  ds_write_b128 v19, v[224:227] offset:9216
  ds_write_b128 v19, v[232:235] offset:10240
  ds_write_b128 v19, v[240:243] offset:11264
  s_barrier
L_Ac_end:
  s_setprio 0
  s_branch L_p2_3
L_stub_ct0_0:
  s_call_b64 s[58:59], L_rarec_0
  s_branch L_ret_ct0_0
L_stub_ct0_1:
  s_call_b64 s[58:59], L_rarec_1
  s_branch L_ret_ct0_1
L_stub_ct0_2:
  s_call_b64 s[58:59], L_rarec_2
  s_branch L_ret_ct0_2
L_stub_ct1_0:
  s_call_b64 s[58:59], L_rarec_0
  s_branch L_ret_ct1_0
L_stub_ct1_1:
  s_call_b64 s[58:59], L_rarec_1
  s_branch L_ret_ct1_1
L_stub_ct1_2:
  s_call_b64 s[58:59], L_rarec_2
  s_branch L_ret_ct1_2
L_stub_ct2_0:
  s_call_b64 s[58:59], L_rarec_0
  s_branch L_ret_ct2_0
L_stub_ct2_1:
  s_call_b64 s[58:59], L_rarec_1
  s_branch L_ret_ct2_1
L_stub_ct2_2:
  s_call_b64 s[58:59], L_rarec_2
  s_branch L_ret_ct2_2
L_stub_ct3_0:
  s_call_b64 s[58:59], L_rarec_0
  s_branch L_ret_ct3_0
L_stub_ct3_1:
  s_call_b64 s[58:59], L_rarec_1
  s_branch L_ret_ct3_1
L_stub_ct3_2:
  s_call_b64 s[58:59], L_rarec_2
  s_branch L_ret_ct3_2
L_stub_ct3l_0:
  s_call_b64 s[58:59], L_rarec_0
  s_branch L_ret_ct3l_0
L_stub_ct3l_1:
  s_call_b64 s[58:59], L_rarec_1
  s_branch L_ret_ct3l_1
L_stub_ct3l_2:
  s_call_b64 s[58:59], L_rarec_2
  s_branch L_ret_ct3l_2
L_rarec_0:
  s_nop 15
  v_mov_b32 v22, v19
  s_nop 1
  v_permlane32_swap_b32 v19, v22
  v_max_f32 v19, v19, v22
  v_mov_b32 v22, v19
  s_nop 1
  v_permlane16_swap_b32 v19, v22
  v_max_f32 v19, v19, v22
  v_max_f32 v19, 0, v19
  v_sub_f32 v23, 0, v19
  v_exp_f32 v23, v23
  v_sub_f32 v24, v24, v19
  v_sub_f32 v25, v25, v19
  v_sub_f32 v26, v26, v19
  v_sub_f32 v27, v27, v19
  v_sub_f32 v48, v48, v19
  v_sub_f32 v49, v49, v19
  v_sub_f32 v50, v50, v19
  v_sub_f32 v51, v51, v19
  v_sub_f32 v60, v60, v19
  v_sub_f32 v61, v61, v19
  v_sub_f32 v62, v62, v19
  v_sub_f32 v63, v63, v19
  v_mul_f32 v15, v15, v23
  v_mul_f32 v152, v152, v23
  v_mul_f32 v153, v153, v23
  v_mul_f32 v154, v154, v23
  v_mul_f32 v155, v155, v23
  v_mul_f32 v156, v156, v23
  v_mul_f32 v157, v157, v23
  v_mul_f32 v158, v158, v23
  v_mul_f32 v159, v159, v23
  v_mul_f32 v160, v160, v23
  v_mul_f32 v161, v161, v23
  v_mul_f32 v162, v162, v23
  v_mul_f32 v163, v163, v23
  v_mul_f32 v164, v164, v23
  v_mul_f32 v165, v165, v23
  v_mul_f32 v166, v166, v23
  v_mul_f32 v167, v167, v23
  v_mul_f32 v168, v168, v23
  v_mul_f32 v169, v169, v23
  v_mul_f32 v170, v170, v23
  v_mul_f32 v171, v171, v23
  v_mul_f32 v172, v172, v23
  v_mul_f32 v173, v173, v23
  v_mul_f32 v174, v174, v23
  v_mul_f32 v175, v175, v23
  v_mul_f32 v176, v176, v23
  v_mul_f32 v177, v177, v23
  v_mul_f32 v178, v178, v23
  v_mul_f32 v179, v179, v23
  v_mul_f32 v180, v180, v23
  v_mul_f32 v181, v181, v23
  v_mul_f32 v182, v182, v23
  v_mul_f32 v183, v183, v23
  s_nop 3
  s_setpc_b64 s[58:59]
L_rarec_1:
  s_nop 15
  v_mov_b32 v22, v20
  s_nop 1
  v_permlane32_swap_b32 v20, v22
  v_max_f32 v20, v20, v22
  v_mov_b32 v22, v20
  s_nop 1
  v_permlane16_swap_b32 v20, v22
  v_max_f32 v20, v20, v22
  v_max_f32 v20, 0, v20
  v_sub_f32 v23, 0, v20
  v_exp_f32 v23, v23
  v_sub_f32 v28, v28, v20
  v_sub_f32 v29, v29, v20
  v_sub_f32 v30, v30, v20
  v_sub_f32 v31, v31, v20
  v_sub_f32 v52, v52, v20
  v_sub_f32 v53, v53, v20
  v_sub_f32 v54, v54, v20
  v_sub_f32 v55, v55, v20
  v_sub_f32 v64, v64, v20
  v_sub_f32 v65, v65, v20
  v_sub_f32 v66, v66, v20
  v_sub_f32 v67, v67, v20
  v_mul_f32 v16, v16, v23
  v_mul_f32 v184, v184, v23
  v_mul_f32 v185, v185, v23
  v_mul_f32 v186, v186, v23
  v_mul_f32 v187, v187, v23
  v_mul_f32 v188, v188, v23
  v_mul_f32 v189, v189, v23
  v_mul_f32 v190, v190, v23
  v_mul_f32 v191, v191, v23
  v_mul_f32 v192, v192, v23
  v_mul_f32 v193, v193, v23
  v_mul_f32 v194, v194, v23
  v_mul_f32 v195, v195, v23
  v_mul_f32 v196, v196, v23
  v_mul_f32 v197, v197, v23
  v_mul_f32 v198, v198, v23
  v_mul_f32 v199, v199, v23
  v_mul_f32 v200, v200, v23
  v_mul_f32 v201, v201, v23
  v_mul_f32 v202, v202, v23
  v_mul_f32 v203, v203, v23
  v_mul_f32 v204, v204, v23
  v_mul_f32 v205, v205, v23
  v_mul_f32 v206, v206, v23
  v_mul_f32 v207, v207, v23
  v_mul_f32 v208, v208, v23
  v_mul_f32 v209, v209, v23
  v_mul_f32 v210, v210, v23
  v_mul_f32 v211, v211, v23
  v_mul_f32 v212, v212, v23
  v_mul_f32 v213, v213, v23
  v_mul_f32 v214, v214, v23
  v_mul_f32 v215, v215, v23
  s_nop 3
  s_setpc_b64 s[58:59]
L_rarec_2:
  s_nop 15
  v_mov_b32 v22, v21
  s_nop 1
  v_permlane32_swap_b32 v21, v22
  v_max_f32 v21, v21, v22
  v_mov_b32 v22, v21
  s_nop 1
  v_permlane16_swap_b32 v21, v22
  v_max_f32 v21, v21, v22
  v_max_f32 v21, 0, v21
  v_sub_f32 v23, 0, v21
  v_exp_f32 v23, v23
  v_sub_f32 v32, v32, v21
  v_sub_f32 v33, v33, v21
  v_sub_f32 v34, v34, v21
  v_sub_f32 v35, v35, v21
  v_sub_f32 v56, v56, v21
  v_sub_f32 v57, v57, v21
  v_sub_f32 v58, v58, v21
  v_sub_f32 v59, v59, v21
  v_sub_f32 v68, v68, v21
  v_sub_f32 v69, v69, v21
  v_sub_f32 v70, v70, v21
  v_sub_f32 v71, v71, v21
  v_mul_f32 v17, v17, v23
  v_mul_f32 v216, v216, v23
  v_mul_f32 v217, v217, v23
  v_mul_f32 v218, v218, v23
  v_mul_f32 v219, v219, v23
  v_mul_f32 v220, v220, v23
  v_mul_f32 v221, v221, v23
  v_mul_f32 v222, v222, v23
  v_mul_f32 v223, v223, v23
  v_mul_f32 v224, v224, v23
  v_mul_f32 v225, v225, v23
  v_mul_f32 v226, v226, v23
  v_mul_f32 v227, v227, v23
  v_mul_f32 v228, v228, v23
  v_mul_f32 v229, v229, v23
  v_mul_f32 v230, v230, v23
  v_mul_f32 v231, v231, v23
  v_mul_f32 v232, v232, v23
  v_mul_f32 v233, v233, v23
  v_mul_f32 v234, v234, v23
  v_mul_f32 v235, v235, v23
  v_mul_f32 v236, v236, v23
  v_mul_f32 v237, v237, v23
  v_mul_f32 v238, v238, v23
  v_mul_f32 v239, v239, v23
  v_mul_f32 v240, v240, v23
  v_mul_f32 v241, v241, v23
  v_mul_f32 v242, v242, v23
  v_mul_f32 v243, v243, v23
  v_mul_f32 v244, v244, v23
  v_mul_f32 v245, v245, v23
  v_mul_f32 v246, v246, v23
  v_mul_f32 v247, v247, v23
  s_nop 3
  s_setpc_b64 s[58:59]
L_p2_0:
  v_lshlrev_b32 v2, 4, v0
  v_lshrrev_b32 v14, 2, v0
  v_bfe_u32 v15, v0, 3, 2
  v_lshlrev_b32 v14, 7, v14
  v_and_b32 v9, 3, v0
  v_lshl_add_u32 v14, v9, 3, v14
  v_xor_b32 v9, 0, v15
  v_lshl_add_u32 v3, v9, 5, v14
  v_add_u32 v5, 100352, v3
  v_xor_b32 v9, 1, v15
  v_lshl_add_u32 v4, v9, 5, v14
  v_add_u32 v6, 100352, v4
  v_lshrrev_b32 v14, 4, v0
  v_lshlrev_b32 v14, 1, v14
  v_xor_b32 v14, v14, v0
  v_and_b32 v14, 7, v14
  v_lshlrev_b32 v14, 4, v14
  v_lshrrev_b32 v15, 3, v0
  v_mul_u32_u24 v15, 1152, v15
  v_add_u32 v7, v14, v15
  v_add_u32 v8, 8192, v7
  v_add_u32 v9, 59392, v2
  s_mul_i32 s72, s57, 147456
  s_lshl_b32 s73, s33, 3
  s_add_u32 s73, s73, s34
  s_mul_i32 s73, s73, 165888
  s_add_u32 s73, s73, 0x5000000
  s_lshl_b32 s75, s33, 5
  s_add_u32 s75, s75, s34
  s_mul_i32 s75, s75, 36864
  s_waitcnt lgkmcnt(0)
  v_add_u32 v14, 124928, v2
  ds_read_b128 v[64:67], v14
  ds_read_b128 v[68:71], v14 offset:4096
  ds_read_b128 v[72:75], v14 offset:1024
  ds_read_b128 v[76:79], v14 offset:5120
  ds_read_b128 v[80:83], v14 offset:2048
  ds_read_b128 v[84:87], v14 offset:6144
  ds_read_b128 v[88:91], v14 offset:3072
  ds_read_b128 v[92:95], v14 offset:7168
  s_waitcnt lgkmcnt(0)
  s_barrier
  ds_read_b128 v[96:99], v9
  ds_read_b128 v[100:103], v9 offset:4096
  ds_read_b128 v[104:107], v9 offset:1024
  ds_read_b128 v[108:111], v9 offset:5120
  ds_read_b128 v[112:115], v9 offset:2048
  ds_read_b128 v[116:119], v9 offset:6144
  ds_read_b128 v[120:123], v9 offset:3072
  ds_read_b128 v[124:127], v9 offset:7168
  s_mov_b32 m0, 0x0
  s_add_u32 s39, s72, 0x0
  buffer_load_dwordx4 v7, s[24:27], s39 offen lds
  buffer_load_dwordx4 v8, s[24:27], s39 offen offset:1024 lds
  s_mov_b32 m0, 0x4000
  s_add_u32 s39, s72, 0x24000
  buffer_load_dwordx4 v7, s[24:27], s39 offen lds
  buffer_load_dwordx4 v8, s[24:27], s39 offen offset:1024 lds
  ds_read_b64_tr_b16 v[16:17], v3 offset:40960
  ds_read_b64_tr_b16 v[18:19], v3 offset:43008
  ds_read_b64_tr_b16 v[20:21], v4 offset:40960
  ds_read_b64_tr_b16 v[22:23], v4 offset:43008
  ds_read_b64_tr_b16 v[24:25], v3 offset:45056
  ds_read_b64_tr_b16 v[26:27], v3 offset:47104
  ds_read_b64_tr_b16 v[28:29], v4 offset:45056
  s_waitcnt lgkmcnt(14)
  ds_read_b64_tr_b16 v[30:31], v4 offset:47104
  s_add_u32 s76, s34, 128
  s_mov_b32 s77, 0
  s_mov_b32 s78, 0
  s_mov_b32 s80, 0x7ff00000
  s_waitcnt lgkmcnt(14)
  ds_read_b64_tr_b16 v[48:49], v3 offset:49152
  s_waitcnt lgkmcnt(13)
  ds_read_b64_tr_b16 v[50:51], v3 offset:51200
  s_waitcnt lgkmcnt(8)
  v_mfma_f32_16x16x32_bf16 v[32:35], v[16:19], v[64:67], 0
  v_mfma_f32_16x16x32_bf16 v[40:43], v[16:19], v[68:71], 0
  ds_read_b64_tr_b16 v[52:53], v4 offset:49152
  ds_read_b64_tr_b16 v[54:55], v4 offset:51200
  s_waitcnt lgkmcnt(8)
  v_mfma_f32_16x16x32_bf16 v[36:39], v[20:23], v[64:67], 0
  v_mfma_f32_16x16x32_bf16 v[44:47], v[20:23], v[68:71], 0
  ds_read_b64_tr_b16 v[56:57], v3 offset:53248
  ds_read_b64_tr_b16 v[58:59], v3 offset:55296
  s_waitcnt lgkmcnt(8)
  v_mfma_f32_16x16x32_bf16 v[32:35], v[24:27], v[72:75], v[32:35]
  v_mfma_f32_16x16x32_bf16 v[40:43], v[24:27], v[76:79], v[40:43]
  ds_read_b64_tr_b16 v[60:61], v4 offset:53248
  ds_read_b64_tr_b16 v[62:63], v4 offset:55296
  s_waitcnt lgkmcnt(8)
  v_mfma_f32_16x16x32_bf16 v[36:39], v[28:31], v[72:75], v[36:39]
  v_mfma_f32_16x16x32_bf16 v[44:47], v[28:31], v[76:79], v[44:47]
  s_waitcnt lgkmcnt(0)
  s_barrier
  ds_read_b64_tr_b16 v[16:17], v5
  ds_read_b64_tr_b16 v[18:19], v5 offset:2048
  v_mfma_f32_16x16x32_bf16 v[32:35], v[48:51], v[80:83], v[32:35]
  v_mfma_f32_16x16x32_bf16 v[40:43], v[48:51], v[84:87], v[40:43]
  ds_read_b64_tr_b16 v[20:21], v6
  ds_read_b64_tr_b16 v[22:23], v6 offset:2048
  s_mov_b32 m0, 0xa000
  s_add_u32 s39, s72, 0x48080
  buffer_load_dwordx4 v7, s[24:27], s39 offen lds
  buffer_load_dwordx4 v8, s[24:27], s39 offen offset:1024 lds
  v_mfma_f32_16x16x32_bf16 v[36:39], v[52:55], v[80:83], v[36:39]
  v_mfma_f32_16x16x32_bf16 v[44:47], v[52:55], v[84:87], v[44:47]
  ds_read_b64_tr_b16 v[24:25], v5 offset:4096
  ds_read_b64_tr_b16 v[26:27], v5 offset:6144
  v_mfma_f32_16x16x32_bf16 v[32:35], v[56:59], v[88:91], v[32:35]
  v_mfma_f32_16x16x32_bf16 v[40:43], v[56:59], v[92:95], v[40:43]
  ds_read_b64_tr_b16 v[28:29], v6 offset:4096
  ds_read_b64_tr_b16 v[30:31], v6 offset:6144
  v_mfma_f32_16x16x32_bf16 v[36:39], v[60:63], v[88:91], v[36:39]
  v_mfma_f32_16x16x32_bf16 v[44:47], v[60:63], v[92:95], v[44:47]
  ds_read_b64_tr_b16 v[48:49], v5 offset:8192
  ds_read_b64_tr_b16 v[50:51], v5 offset:10240
  s_waitcnt lgkmcnt(8)
  v_mfma_f32_16x16x32_bf16 v[32:35], v[16:19], v[96:99], v[32:35]
  v_mfma_f32_16x16x32_bf16 v[40:43], v[16:19], v[100:103], v[40:43]
  ds_read_b64_tr_b16 v[52:53], v6 offset:8192
  ds_read_b64_tr_b16 v[54:55], v6 offset:10240
  s_waitcnt lgkmcnt(8)
  v_mfma_f32_16x16x32_bf16 v[36:39], v[20:23], v[96:99], v[36:39]
  v_mfma_f32_16x16x32_bf16 v[44:47], v[20:23], v[100:103], v[44:47]
  ds_read_b64_tr_b16 v[56:57], v5 offset:12288
  ds_read_b64_tr_b16 v[58:59], v5 offset:14336
  s_waitcnt lgkmcnt(8)
  v_mfma_f32_16x16x32_bf16 v[32:35], v[24:27], v[104:107], v[32:35]
  v_mfma_f32_16x16x32_bf16 v[40:43], v[24:27], v[108:111], v[40:43]
  ds_read_b64_tr_b16 v[60:61], v6 offset:12288
  ds_read_b64_tr_b16 v[62:63], v6 offset:14336
  s_waitcnt lgkmcnt(8)
  v_mfma_f32_16x16x32_bf16 v[36:39], v[28:31], v[104:107], v[36:39]
  v_mfma_f32_16x16x32_bf16 v[44:47], v[28:31], v[108:111], v[44:47]
  s_waitcnt vmcnt(4)
  s_waitcnt lgkmcnt(0)
  s_barrier
  ds_read_b64_tr_b16 v[16:17], v3
  ds_read_b64_tr_b16 v[18:19], v3 offset:2048
  v_mfma_f32_16x16x32_bf16 v[32:35], v[48:51], v[112:115], v[32:35]
  v_mfma_f32_16x16x32_bf16 v[40:43], v[48:51], v[116:119], v[40:43]
  ds_read_b64_tr_b16 v[20:21], v4
  ds_read_b64_tr_b16 v[22:23], v4 offset:2048
  s_mov_b32 m0, 0x18800
  s_add_u32 s39, s72, 0x6c080
  buffer_load_dwordx4 v7, s[24:27], s39 offen lds
  buffer_load_dwordx4 v8, s[24:27], s39 offen offset:1024 lds
  v_mfma_f32_16x16x32_bf16 v[36:39], v[52:55], v[112:115], v[36:39]
  v_mfma_f32_16x16x32_bf16 v[44:47], v[52:55], v[116:119], v[44:47]
  ds_read_b64_tr_b16 v[24:25], v3 offset:4096
  ds_read_b64_tr_b16 v[26:27], v3 offset:6144
  v_mfma_f32_16x16x32_bf16 v[32:35], v[56:59], v[120:123], v[32:35]
  v_mfma_f32_16x16x32_bf16 v[40:43], v[56:59], v[124:127], v[40:43]
  ds_read_b64_tr_b16 v[28:29], v4 offset:4096
  ds_read_b64_tr_b16 v[30:31], v4 offset:6144
  v_mfma_f32_16x16x32_bf16 v[36:39], v[60:63], v[120:123], v[36:39]
  v_mfma_f32_16x16x32_bf16 v[44:47], v[60:63], v[124:127], v[44:47]
  ds_read_b64_tr_b16 v[48:49], v3 offset:8192
  ds_read_b64_tr_b16 v[50:51], v3 offset:10240
  s_waitcnt lgkmcnt(8)
  v_mfma_f32_16x16x32_bf16 v[32:35], v[16:19], v[128:131], v[32:35]
  v_mfma_f32_16x16x32_bf16 v[40:43], v[16:19], v[132:135], v[40:43]
  ds_read_b64_tr_b16 v[52:53], v4 offset:8192
  ds_read_b64_tr_b16 v[54:55], v4 offset:10240
  s_waitcnt lgkmcnt(8)
  v_mfma_f32_16x16x32_bf16 v[36:39], v[20:23], v[128:131], v[36:39]
  v_mfma_f32_16x16x32_bf16 v[44:47], v[20:23], v[132:135], v[44:47]
  ds_read_b64_tr_b16 v[56:57], v3 offset:12288
  ds_read_b64_tr_b16 v[58:59], v3 offset:14336
  s_waitcnt lgkmcnt(8)
  v_mfma_f32_16x16x32_bf16 v[32:35], v[24:27], v[136:139], v[32:35]
  v_mfma_f32_16x16x32_bf16 v[40:43], v[24:27], v[140:143], v[40:43]
  ds_read_b64_tr_b16 v[60:61], v4 offset:12288
  ds_read_b64_tr_b16 v[62:63], v4 offset:14336
  s_waitcnt lgkmcnt(8)
  v_mfma_f32_16x16x32_bf16 v[36:39], v[28:31], v[136:139], v[36:39]
  v_mfma_f32_16x16x32_bf16 v[44:47], v[28:31], v[140:143], v[44:47]
  s_waitcnt vmcnt(4)
  s_waitcnt lgkmcnt(0)
  s_barrier
  ds_read_b64_tr_b16 v[16:17], v3 offset:16384
  ds_read_b64_tr_b16 v[18:19], v3 offset:18432
  v_mfma_f32_16x16x32_bf16 v[32:35], v[48:51], v[144:147], v[32:35]
  v_mfma_f32_16x16x32_bf16 v[40:43], v[48:51], v[148:151], v[40:43]
  ds_read_b64_tr_b16 v[20:21], v4 offset:16384
  ds_read_b64_tr_b16 v[22:23], v4 offset:18432
  s_mov_b32 m0, 0x0
  s_add_u32 s39, s72, 0x80
  buffer_load_dwordx4 v7, s[24:27], s39 offen lds
  buffer_load_dwordx4 v8, s[24:27], s39 offen offset:1024 lds
  v_mfma_f32_16x16x32_bf16 v[36:39], v[52:55], v[144:147], v[36:39]
  v_mfma_f32_16x16x32_bf16 v[44:47], v[52:55], v[148:151], v[44:47]
  ds_read_b64_tr_b16 v[24:25], v3 offset:20480
  ds_read_b64_tr_b16 v[26:27], v3 offset:22528
  v_mfma_f32_16x16x32_bf16 v[32:35], v[56:59], v[152:155], v[32:35]
  v_mfma_f32_16x16x32_bf16 v[40:43], v[56:59], v[156:159], v[40:43]
  ds_read_b64_tr_b16 v[28:29], v4 offset:20480
  ds_read_b64_tr_b16 v[30:31], v4 offset:22528
  v_mfma_f32_16x16x32_bf16 v[36:39], v[60:63], v[152:155], v[36:39]
  v_mfma_f32_16x16x32_bf16 v[44:47], v[60:63], v[156:159], v[44:47]
  ds_read_b64_tr_b16 v[48:49], v3 offset:24576
  ds_read_b64_tr_b16 v[50:51], v3 offset:26624
  s_waitcnt lgkmcnt(8)
  v_mfma_f32_16x16x32_bf16 v[32:35], v[16:19], v[160:163], v[32:35]
  v_mfma_f32_16x16x32_bf16 v[40:43], v[16:19], v[164:167], v[40:43]
  ds_read_b64_tr_b16 v[52:53], v4 offset:24576
  ds_read_b64_tr_b16 v[54:55], v4 offset:26624
  s_waitcnt lgkmcnt(8)
  v_mfma_f32_16x16x32_bf16 v[36:39], v[20:23], v[160:163], v[36:39]
  v_mfma_f32_16x16x32_bf16 v[44:47], v[20:23], v[164:167], v[44:47]
  ds_read_b64_tr_b16 v[56:57], v3 offset:28672
  ds_read_b64_tr_b16 v[58:59], v3 offset:30720
  s_waitcnt lgkmcnt(8)
  v_mfma_f32_16x16x32_bf16 v[32:35], v[24:27], v[168:171], v[32:35]
  v_mfma_f32_16x16x32_bf16 v[40:43], v[24:27], v[172:175], v[40:43]
  ds_read_b64_tr_b16 v[60:61], v4 offset:28672
  ds_read_b64_tr_b16 v[62:63], v4 offset:30720
  s_waitcnt lgkmcnt(8)
  v_mfma_f32_16x16x32_bf16 v[36:39], v[28:31], v[168:171], v[36:39]
  v_mfma_f32_16x16x32_bf16 v[44:47], v[28:31], v[172:175], v[44:47]
  s_waitcnt vmcnt(4)
  s_waitcnt lgkmcnt(0)
  s_barrier
  ds_read_b64_tr_b16 v[16:17], v3 offset:40960
  ds_read_b64_tr_b16 v[18:19], v3 offset:43008
  v_mfma_f32_16x16x32_bf16 v[32:35], v[48:51], v[176:179], v[32:35]
  v_mfma_f32_16x16x32_bf16 v[40:43], v[48:51], v[180:183], v[40:43]
  ds_read_b64_tr_b16 v[20:21], v4 offset:40960
  ds_read_b64_tr_b16 v[22:23], v4 offset:43008
  s_mov_b32 m0, 0x4000
  s_add_u32 s39, s72, 0x24080
  buffer_load_dwordx4 v7, s[24:27], s39 offen lds
  buffer_load_dwordx4 v8, s[24:27], s39 offen offset:1024 lds
  v_mfma_f32_16x16x32_bf16 v[36:39], v[52:55], v[176:179], v[36:39]
  v_mfma_f32_16x16x32_bf16 v[44:47], v[52:55], v[180:183], v[44:47]
  ds_read_b64_tr_b16 v[24:25], v3 offset:45056
  ds_read_b64_tr_b16 v[26:27], v3 offset:47104
  v_mfma_f32_16x16x32_bf16 v[32:35], v[56:59], v[184:187], v[32:35]
  v_mfma_f32_16x16x32_bf16 v[40:43], v[56:59], v[188:191], v[40:43]
  ds_read_b64_tr_b16 v[28:29], v4 offset:45056
  ds_read_b64_tr_b16 v[30:31], v4 offset:47104
  v_mfma_f32_16x16x32_bf16 v[36:39], v[60:63], v[184:187], v[36:39]
  v_mfma_f32_16x16x32_bf16 v[44:47], v[60:63], v[188:191], v[44:47]
  s_add_u32 s72, s72, 128
  s_mov_b32 s74, 7
L_op0_loop:
  ds_read_b64_tr_b16 v[48:49], v3 offset:49152
  ds_read_b64_tr_b16 v[50:51], v3 offset:51200
  v_cvt_pk_bf16_f32 v10, v32, v33
  v_cvt_pk_bf16_f32 v11, v34, v35
  s_nop 0
  v_cvt_pk_bf16_f32 v12, v36, v37
  v_cvt_pk_bf16_f32 v13, v38, v39
  s_add_u32 s40, s73, 0x0
  buffer_store_dwordx4 v[10:13], v2, s[20:23], s40 offen sc1
  s_waitcnt lgkmcnt(8)
  v_mfma_f32_16x16x32_bf16 v[32:35], v[16:19], v[64:67], 0
  v_cvt_pk_bf16_f32 v10, v40, v41
  v_cvt_pk_bf16_f32 v11, v42, v43
  v_cvt_pk_bf16_f32 v12, v44, v45
  v_cvt_pk_bf16_f32 v13, v46, v47
  s_add_u32 s40, s73, 0x800
  buffer_store_dwordx4 v[10:13], v2, s[20:23], s40 offen sc1
  v_mfma_f32_16x16x32_bf16 v[40:43], v[16:19], v[68:71], 0
  ds_read_b64_tr_b16 v[52:53], v4 offset:49152
  ds_read_b64_tr_b16 v[54:55], v4 offset:51200
  s_waitcnt lgkmcnt(6)
  v_mfma_f32_16x16x32_bf16 v[36:39], v[20:23], v[64:67], 0
  v_mfma_f32_16x16x32_bf16 v[44:47], v[20:23], v[68:71], 0
  ds_read_b64_tr_b16 v[56:57], v3 offset:53248
  ds_read_b64_tr_b16 v[58:59], v3 offset:55296
  v_mfma_f32_16x16x32_bf16 v[32:35], v[24:27], v[72:75], v[32:35]
  v_mfma_f32_16x16x32_bf16 v[40:43], v[24:27], v[76:79], v[40:43]
  ds_read_b64_tr_b16 v[60:61], v4 offset:53248
  ds_read_b64_tr_b16 v[62:63], v4 offset:55296
  s_waitcnt lgkmcnt(7)
  v_mfma_f32_16x16x32_bf16 v[36:39], v[28:31], v[72:75], v[36:39]
  v_mfma_f32_16x16x32_bf16 v[44:47], v[28:31], v[76:79], v[44:47]
  s_waitcnt vmcnt(6)
  s_waitcnt lgkmcnt(0)
  s_barrier
  ds_read_b64_tr_b16 v[16:17], v5
  ds_read_b64_tr_b16 v[18:19], v5 offset:2048
  v_mfma_f32_16x16x32_bf16 v[32:35], v[48:51], v[80:83], v[32:35]
  v_mfma_f32_16x16x32_bf16 v[40:43], v[48:51], v[84:87], v[40:43]
  ds_read_b64_tr_b16 v[20:21], v6
  ds_read_b64_tr_b16 v[22:23], v6 offset:2048
  s_mov_b32 m0, 0xa000
  s_add_u32 s39, s72, 0x48080
  buffer_load_dwordx4 v7, s[24:27], s39 offen lds
  buffer_load_dwordx4 v8, s[24:27], s39 offen offset:1024 lds
  v_mfma_f32_16x16x32_bf16 v[36:39], v[52:55], v[80:83], v[36:39]
  v_mfma_f32_16x16x32_bf16 v[44:47], v[52:55], v[84:87], v[44:47]
  ds_read_b64_tr_b16 v[24:25], v5 offset:4096
  ds_read_b64_tr_b16 v[26:27], v5 offset:6144
  v_mfma_f32_16x16x32_bf16 v[32:35], v[56:59], v[88:91], v[32:35]
  v_mfma_f32_16x16x32_bf16 v[40:43], v[56:59], v[92:95], v[40:43]
  ds_read_b64_tr_b16 v[28:29], v6 offset:4096
  ds_read_b64_tr_b16 v[30:31], v6 offset:6144
  v_mfma_f32_16x16x32_bf16 v[36:39], v[60:63], v[88:91], v[36:39]
  v_mfma_f32_16x16x32_bf16 v[44:47], v[60:63], v[92:95], v[44:47]
  ds_read_b64_tr_b16 v[48:49], v5 offset:8192
  ds_read_b64_tr_b16 v[50:51], v5 offset:10240
  s_waitcnt lgkmcnt(8)
  v_mfma_f32_16x16x32_bf16 v[32:35], v[16:19], v[96:99], v[32:35]
  v_mfma_f32_16x16x32_bf16 v[40:43], v[16:19], v[100:103], v[40:43]
  ds_read_b64_tr_b16 v[52:53], v6 offset:8192
  ds_read_b64_tr_b16 v[54:55], v6 offset:10240
  s_waitcnt lgkmcnt(8)
  v_mfma_f32_16x16x32_bf16 v[36:39], v[20:23], v[96:99], v[36:39]
  v_mfma_f32_16x16x32_bf16 v[44:47], v[20:23], v[100:103], v[44:47]
  ds_read_b64_tr_b16 v[56:57], v5 offset:12288
  ds_read_b64_tr_b16 v[58:59], v5 offset:14336
  s_waitcnt lgkmcnt(8)
  v_mfma_f32_16x16x32_bf16 v[32:35], v[24:27], v[104:107], v[32:35]
  v_mfma_f32_16x16x32_bf16 v[40:43], v[24:27], v[108:111], v[40:43]
  ds_read_b64_tr_b16 v[60:61], v6 offset:12288
  ds_read_b64_tr_b16 v[62:63], v6 offset:14336
  s_waitcnt lgkmcnt(8)
  v_mfma_f32_16x16x32_bf16 v[36:39], v[28:31], v[104:107], v[36:39]
  v_mfma_f32_16x16x32_bf16 v[44:47], v[28:31], v[108:111], v[44:47]
  s_waitcnt vmcnt(6)
  s_waitcnt lgkmcnt(0)
  s_barrier
  ds_read_b64_tr_b16 v[16:17], v3
  ds_read_b64_tr_b16 v[18:19], v3 offset:2048
  v_mfma_f32_16x16x32_bf16 v[32:35], v[48:51], v[112:115], v[32:35]
  v_mfma_f32_16x16x32_bf16 v[40:43], v[48:51], v[116:119], v[40:43]
  ds_read_b64_tr_b16 v[20:21], v4
  ds_read_b64_tr_b16 v[22:23], v4 offset:2048
  s_mov_b32 m0, 0x18800
  s_add_u32 s39, s72, 0x6c080
  buffer_load_dwordx4 v7, s[24:27], s39 offen lds
  buffer_load_dwordx4 v8, s[24:27], s39 offen offset:1024 lds
  v_mfma_f32_16x16x32_bf16 v[36:39], v[52:55], v[112:115], v[36:39]
  v_mfma_f32_16x16x32_bf16 v[44:47], v[52:55], v[116:119], v[44:47]
  ds_read_b64_tr_b16 v[24:25], v3 offset:4096
  ds_read_b64_tr_b16 v[26:27], v3 offset:6144
  v_mfma_f32_16x16x32_bf16 v[32:35], v[56:59], v[120:123], v[32:35]
  v_mfma_f32_16x16x32_bf16 v[40:43], v[56:59], v[124:127], v[40:43]
  ds_read_b64_tr_b16 v[28:29], v4 offset:4096
  ds_read_b64_tr_b16 v[30:31], v4 offset:6144
  v_mfma_f32_16x16x32_bf16 v[36:39], v[60:63], v[120:123], v[36:39]
  v_mfma_f32_16x16x32_bf16 v[44:47], v[60:63], v[124:127], v[44:47]
  ds_read_b64_tr_b16 v[48:49], v3 offset:8192
  ds_read_b64_tr_b16 v[50:51], v3 offset:10240
  s_waitcnt lgkmcnt(8)
  v_mfma_f32_16x16x32_bf16 v[32:35], v[16:19], v[128:131], v[32:35]
  v_mfma_f32_16x16x32_bf16 v[40:43], v[16:19], v[132:135], v[40:43]
  ds_read_b64_tr_b16 v[52:53], v4 offset:8192
  ds_read_b64_tr_b16 v[54:55], v4 offset:10240
  s_waitcnt lgkmcnt(8)
  v_mfma_f32_16x16x32_bf16 v[36:39], v[20:23], v[128:131], v[36:39]
  v_mfma_f32_16x16x32_bf16 v[44:47], v[20:23], v[132:135], v[44:47]
  ds_read_b64_tr_b16 v[56:57], v3 offset:12288
  ds_read_b64_tr_b16 v[58:59], v3 offset:14336
  s_waitcnt lgkmcnt(8)
  v_mfma_f32_16x16x32_bf16 v[32:35], v[24:27], v[136:139], v[32:35]
  v_mfma_f32_16x16x32_bf16 v[40:43], v[24:27], v[140:143], v[40:43]
  ds_read_b64_tr_b16 v[60:61], v4 offset:12288
  ds_read_b64_tr_b16 v[62:63], v4 offset:14336
  s_waitcnt lgkmcnt(8)
  v_mfma_f32_16x16x32_bf16 v[36:39], v[28:31], v[136:139], v[36:39]
  v_mfma_f32_16x16x32_bf16 v[44:47], v[28:31], v[140:143], v[44:47]
  s_waitcnt vmcnt(6)
  s_waitcnt lgkmcnt(0)
  s_barrier
  ds_read_b64_tr_b16 v[16:17], v3 offset:16384
  ds_read_b64_tr_b16 v[18:19], v3 offset:18432
  v_mfma_f32_16x16x32_bf16 v[32:35], v[48:51], v[144:147], v[32:35]
  v_mfma_f32_16x16x32_bf16 v[40:43], v[48:51], v[148:151], v[40:43]
  ds_read_b64_tr_b16 v[20:21], v4 offset:16384
  ds_read_b64_tr_b16 v[22:23], v4 offset:18432
  s_mov_b32 m0, 0x0
  s_add_u32 s39, s72, 0x80
  buffer_load_dwordx4 v7, s[24:27], s39 offen lds
  buffer_load_dwordx4 v8, s[24:27], s39 offen offset:1024 lds
  v_mfma_f32_16x16x32_bf16 v[36:39], v[52:55], v[144:147], v[36:39]
  v_mfma_f32_16x16x32_bf16 v[44:47], v[52:55], v[148:151], v[44:47]
  ds_read_b64_tr_b16 v[24:25], v3 offset:20480
  ds_read_b64_tr_b16 v[26:27], v3 offset:22528
  v_mfma_f32_16x16x32_bf16 v[32:35], v[56:59], v[152:155], v[32:35]
  v_mfma_f32_16x16x32_bf16 v[40:43], v[56:59], v[156:159], v[40:43]
  ds_read_b64_tr_b16 v[28:29], v4 offset:20480
  ds_read_b64_tr_b16 v[30:31], v4 offset:22528
  v_mfma_f32_16x16x32_bf16 v[36:39], v[60:63], v[152:155], v[36:39]
  v_mfma_f32_16x16x32_bf16 v[44:47], v[60:63], v[156:159], v[44:47]
  ds_read_b64_tr_b16 v[48:49], v3 offset:24576
  ds_read_b64_tr_b16 v[50:51], v3 offset:26624
  s_waitcnt lgkmcnt(8)
  v_mfma_f32_16x16x32_bf16 v[32:35], v[16:19], v[160:163], v[32:35]
  v_mfma_f32_16x16x32_bf16 v[40:43], v[16:19], v[164:167], v[40:43]
  ds_read_b64_tr_b16 v[52:53], v4 offset:24576
  ds_read_b64_tr_b16 v[54:55], v4 offset:26624
  s_waitcnt lgkmcnt(8)
  v_mfma_f32_16x16x32_bf16 v[36:39], v[20:23], v[160:163], v[36:39]
  v_mfma_f32_16x16x32_bf16 v[44:47], v[20:23], v[164:167], v[44:47]
  ds_read_b64_tr_b16 v[56:57], v3 offset:28672
  ds_read_b64_tr_b16 v[58:59], v3 offset:30720
  s_waitcnt lgkmcnt(8)
  v_mfma_f32_16x16x32_bf16 v[32:35], v[24:27], v[168:171], v[32:35]
  v_mfma_f32_16x16x32_bf16 v[40:43], v[24:27], v[172:175], v[40:43]
  ds_read_b64_tr_b16 v[60:61], v4 offset:28672
  ds_read_b64_tr_b16 v[62:63], v4 offset:30720
  s_waitcnt lgkmcnt(8)
  v_mfma_f32_16x16x32_bf16 v[36:39], v[28:31], v[168:171], v[36:39]
  v_mfma_f32_16x16x32_bf16 v[44:47], v[28:31], v[172:175], v[44:47]
  s_waitcnt vmcnt(4)
  s_waitcnt lgkmcnt(0)
  s_barrier
  ds_read_b64_tr_b16 v[16:17], v3 offset:40960
  ds_read_b64_tr_b16 v[18:19], v3 offset:43008
  v_mfma_f32_16x16x32_bf16 v[32:35], v[48:51], v[176:179], v[32:35]
  v_mfma_f32_16x16x32_bf16 v[40:43], v[48:51], v[180:183], v[40:43]
  ds_read_b64_tr_b16 v[20:21], v4 offset:40960
  ds_read_b64_tr_b16 v[22:23], v4 offset:43008
  s_mov_b32 m0, 0x4000
  s_add_u32 s39, s72, 0x24080
  buffer_load_dwordx4 v7, s[24:27], s39 offen lds
  buffer_load_dwordx4 v8, s[24:27], s39 offen offset:1024 lds
  v_mfma_f32_16x16x32_bf16 v[36:39], v[52:55], v[176:179], v[36:39]
  v_mfma_f32_16x16x32_bf16 v[44:47], v[52:55], v[180:183], v[44:47]
  ds_read_b64_tr_b16 v[24:25], v3 offset:45056
  ds_read_b64_tr_b16 v[26:27], v3 offset:47104
  v_mfma_f32_16x16x32_bf16 v[32:35], v[56:59], v[184:187], v[32:35]
  v_mfma_f32_16x16x32_bf16 v[40:43], v[56:59], v[188:191], v[40:43]
  ds_read_b64_tr_b16 v[28:29], v4 offset:45056
  ds_read_b64_tr_b16 v[30:31], v4 offset:47104
  v_mfma_f32_16x16x32_bf16 v[36:39], v[60:63], v[184:187], v[36:39]
  v_mfma_f32_16x16x32_bf16 v[44:47], v[60:63], v[188:191], v[44:47]
  s_add_u32 s72, s72, 128
  s_add_u32 s73, s73, 0x4800
  s_add_u32 s78, s78, 1
  s_sub_u32 s74, s74, 1
  s_cmp_lg_u32 s74, 0
  s_cbranch_scc1 L_op0_loop
  ds_read_b64_tr_b16 v[48:49], v3 offset:49152
  ds_read_b64_tr_b16 v[50:51], v3 offset:51200
  v_cvt_pk_bf16_f32 v10, v32, v33
  v_cvt_pk_bf16_f32 v11, v34, v35
  v_cvt_pk_bf16_f32 v12, v36, v37
  v_cvt_pk_bf16_f32 v13, v38, v39
  s_add_u32 s40, s73, 0x0
  buffer_store_dwordx4 v[10:13], v2, s[20:23], s40 offen sc1
  s_waitcnt lgkmcnt(6)
  v_mfma_f32_16x16x32_bf16 v[32:35], v[16:19], v[64:67], 0
  v_cvt_pk_bf16_f32 v10, v40, v41
  v_cvt_pk_bf16_f32 v11, v42, v43
  v_cvt_pk_bf16_f32 v12, v44, v45
  v_cvt_pk_bf16_f32 v13, v46, v47
  s_add_u32 s40, s73, 0x800
  buffer_store_dwordx4 v[10:13], v2, s[20:23], s40 offen sc1
  v_mfma_f32_16x16x32_bf16 v[40:43], v[16:19], v[68:71], 0
  ds_read_b64_tr_b16 v[52:53], v4 offset:49152
  ds_read_b64_tr_b16 v[54:55], v4 offset:51200
  v_mfma_f32_16x16x32_bf16 v[36:39], v[20:23], v[64:67], 0
  v_mfma_f32_16x16x32_bf16 v[44:47], v[20:23], v[68:71], 0
  ds_read_b64_tr_b16 v[56:57], v3 offset:53248
  ds_read_b64_tr_b16 v[58:59], v3 offset:55296
  s_waitcnt lgkmcnt(6)
  v_mfma_f32_16x16x32_bf16 v[32:35], v[24:27], v[72:75], v[32:35]
  v_mfma_f32_16x16x32_bf16 v[40:43], v[24:27], v[76:79], v[40:43]
  ds_read_b64_tr_b16 v[60:61], v4 offset:53248
  ds_read_b64_tr_b16 v[62:63], v4 offset:55296
  v_mfma_f32_16x16x32_bf16 v[36:39], v[28:31], v[72:75], v[36:39]
  v_mfma_f32_16x16x32_bf16 v[44:47], v[28:31], v[76:79], v[44:47]
  s_waitcnt vmcnt(6)
  s_waitcnt lgkmcnt(0)
  s_barrier
  ds_read_b64_tr_b16 v[16:17], v5
  ds_read_b64_tr_b16 v[18:19], v5 offset:2048
  v_mfma_f32_16x16x32_bf16 v[32:35], v[48:51], v[80:83], v[32:35]
  v_mfma_f32_16x16x32_bf16 v[40:43], v[48:51], v[84:87], v[40:43]
  ds_read_b64_tr_b16 v[20:21], v6
  ds_read_b64_tr_b16 v[22:23], v6 offset:2048
  v_mfma_f32_16x16x32_bf16 v[36:39], v[52:55], v[80:83], v[36:39]
  v_mfma_f32_16x16x32_bf16 v[44:47], v[52:55], v[84:87], v[44:47]
  ds_read_b64_tr_b16 v[24:25], v5 offset:4096
  ds_read_b64_tr_b16 v[26:27], v5 offset:6144
  v_mfma_f32_16x16x32_bf16 v[32:35], v[56:59], v[88:91], v[32:35]
  v_mfma_f32_16x16x32_bf16 v[40:43], v[56:59], v[92:95], v[40:43]
  ds_read_b64_tr_b16 v[28:29], v6 offset:4096
  ds_read_b64_tr_b16 v[30:31], v6 offset:6144
  v_mfma_f32_16x16x32_bf16 v[36:39], v[60:63], v[88:91], v[36:39]
  v_mfma_f32_16x16x32_bf16 v[44:47], v[60:63], v[92:95], v[44:47]
  ds_read_b64_tr_b16 v[48:49], v5 offset:8192
  ds_read_b64_tr_b16 v[50:51], v5 offset:10240
  s_waitcnt lgkmcnt(8)
  v_mfma_f32_16x16x32_bf16 v[32:35], v[16:19], v[96:99], v[32:35]
  v_mfma_f32_16x16x32_bf16 v[40:43], v[16:19], v[100:103], v[40:43]
  ds_read_b64_tr_b16 v[52:53], v6 offset:8192
  ds_read_b64_tr_b16 v[54:55], v6 offset:10240
  s_waitcnt lgkmcnt(8)
  v_mfma_f32_16x16x32_bf16 v[36:39], v[20:23], v[96:99], v[36:39]
  v_mfma_f32_16x16x32_bf16 v[44:47], v[20:23], v[100:103], v[44:47]
  ds_read_b64_tr_b16 v[56:57], v5 offset:12288
  ds_read_b64_tr_b16 v[58:59], v5 offset:14336
  s_waitcnt lgkmcnt(8)
  v_mfma_f32_16x16x32_bf16 v[32:35], v[24:27], v[104:107], v[32:35]
  v_mfma_f32_16x16x32_bf16 v[40:43], v[24:27], v[108:111], v[40:43]
  ds_read_b64_tr_b16 v[60:61], v6 offset:12288
  ds_read_b64_tr_b16 v[62:63], v6 offset:14336
  s_waitcnt lgkmcnt(8)
  v_mfma_f32_16x16x32_bf16 v[36:39], v[28:31], v[104:107], v[36:39]
  v_mfma_f32_16x16x32_bf16 v[44:47], v[28:31], v[108:111], v[44:47]
  s_waitcnt vmcnt(4)
  s_waitcnt lgkmcnt(0)
  s_barrier
  ds_read_b64_tr_b16 v[16:17], v3
  ds_read_b64_tr_b16 v[18:19], v3 offset:2048
  v_mfma_f32_16x16x32_bf16 v[32:35], v[48:51], v[112:115], v[32:35]
  v_mfma_f32_16x16x32_bf16 v[40:43], v[48:51], v[116:119], v[40:43]
  ds_read_b64_tr_b16 v[20:21], v4
  ds_read_b64_tr_b16 v[22:23], v4 offset:2048
  v_mfma_f32_16x16x32_bf16 v[36:39], v[52:55], v[112:115], v[36:39]
  v_mfma_f32_16x16x32_bf16 v[44:47], v[52:55], v[116:119], v[44:47]
  ds_read_b64_tr_b16 v[24:25], v3 offset:4096
  ds_read_b64_tr_b16 v[26:27], v3 offset:6144
  v_mfma_f32_16x16x32_bf16 v[32:35], v[56:59], v[120:123], v[32:35]
  v_mfma_f32_16x16x32_bf16 v[40:43], v[56:59], v[124:127], v[40:43]
  ds_read_b64_tr_b16 v[28:29], v4 offset:4096
  ds_read_b64_tr_b16 v[30:31], v4 offset:6144
  v_mfma_f32_16x16x32_bf16 v[36:39], v[60:63], v[120:123], v[36:39]
  v_mfma_f32_16x16x32_bf16 v[44:47], v[60:63], v[124:127], v[44:47]
  ds_read_b64_tr_b16 v[48:49], v3 offset:8192
  ds_read_b64_tr_b16 v[50:51], v3 offset:10240
  s_waitcnt lgkmcnt(8)
  v_mfma_f32_16x16x32_bf16 v[32:35], v[16:19], v[128:131], v[32:35]
  v_mfma_f32_16x16x32_bf16 v[40:43], v[16:19], v[132:135], v[40:43]
  ds_read_b64_tr_b16 v[52:53], v4 offset:8192
  ds_read_b64_tr_b16 v[54:55], v4 offset:10240
  s_waitcnt lgkmcnt(8)
  v_mfma_f32_16x16x32_bf16 v[36:39], v[20:23], v[128:131], v[36:39]
  v_mfma_f32_16x16x32_bf16 v[44:47], v[20:23], v[132:135], v[44:47]
  ds_read_b64_tr_b16 v[56:57], v3 offset:12288
  ds_read_b64_tr_b16 v[58:59], v3 offset:14336
  s_waitcnt lgkmcnt(8)
  v_mfma_f32_16x16x32_bf16 v[32:35], v[24:27], v[136:139], v[32:35]
  v_mfma_f32_16x16x32_bf16 v[40:43], v[24:27], v[140:143], v[40:43]
  ds_read_b64_tr_b16 v[60:61], v4 offset:12288
  ds_read_b64_tr_b16 v[62:63], v4 offset:14336
  s_waitcnt lgkmcnt(8)
  v_mfma_f32_16x16x32_bf16 v[36:39], v[28:31], v[136:139], v[36:39]
  v_mfma_f32_16x16x32_bf16 v[44:47], v[28:31], v[140:143], v[44:47]
  s_waitcnt vmcnt(0)
  s_waitcnt lgkmcnt(0)
  s_barrier
  ds_read_b64_tr_b16 v[16:17], v3 offset:16384
  ds_read_b64_tr_b16 v[18:19], v3 offset:18432
  v_mfma_f32_16x16x32_bf16 v[32:35], v[48:51], v[144:147], v[32:35]
  v_mfma_f32_16x16x32_bf16 v[40:43], v[48:51], v[148:151], v[40:43]
  ds_read_b64_tr_b16 v[20:21], v4 offset:16384
  ds_read_b64_tr_b16 v[22:23], v4 offset:18432
  v_mfma_f32_16x16x32_bf16 v[36:39], v[52:55], v[144:147], v[36:39]
  v_mfma_f32_16x16x32_bf16 v[44:47], v[52:55], v[148:151], v[44:47]
  ds_read_b64_tr_b16 v[24:25], v3 offset:20480
  ds_read_b64_tr_b16 v[26:27], v3 offset:22528
  v_mfma_f32_16x16x32_bf16 v[32:35], v[56:59], v[152:155], v[32:35]
  v_mfma_f32_16x16x32_bf16 v[40:43], v[56:59], v[156:159], v[40:43]
  ds_read_b64_tr_b16 v[28:29], v4 offset:20480
  ds_read_b64_tr_b16 v[30:31], v4 offset:22528
  v_mfma_f32_16x16x32_bf16 v[36:39], v[60:63], v[152:155], v[36:39]
  v_mfma_f32_16x16x32_bf16 v[44:47], v[60:63], v[156:159], v[44:47]
  ds_read_b64_tr_b16 v[48:49], v3 offset:24576
  ds_read_b64_tr_b16 v[50:51], v3 offset:26624
  s_waitcnt lgkmcnt(8)
  v_mfma_f32_16x16x32_bf16 v[32:35], v[16:19], v[160:163], v[32:35]
  v_mfma_f32_16x16x32_bf16 v[40:43], v[16:19], v[164:167], v[40:43]
  ds_read_b64_tr_b16 v[52:53], v4 offset:24576
  ds_read_b64_tr_b16 v[54:55], v4 offset:26624
  s_waitcnt lgkmcnt(8)
  v_mfma_f32_16x16x32_bf16 v[36:39], v[20:23], v[160:163], v[36:39]
  v_mfma_f32_16x16x32_bf16 v[44:47], v[20:23], v[164:167], v[44:47]
  ds_read_b64_tr_b16 v[56:57], v3 offset:28672
  ds_read_b64_tr_b16 v[58:59], v3 offset:30720
  s_waitcnt lgkmcnt(8)
  v_mfma_f32_16x16x32_bf16 v[32:35], v[24:27], v[168:171], v[32:35]
  v_mfma_f32_16x16x32_bf16 v[40:43], v[24:27], v[172:175], v[40:43]
  ds_read_b64_tr_b16 v[60:61], v4 offset:28672
  ds_read_b64_tr_b16 v[62:63], v4 offset:30720
  s_waitcnt lgkmcnt(8)
  v_mfma_f32_16x16x32_bf16 v[36:39], v[28:31], v[168:171], v[36:39]
  v_mfma_f32_16x16x32_bf16 v[44:47], v[28:31], v[172:175], v[44:47]
  s_waitcnt lgkmcnt(6)
  v_mfma_f32_16x16x32_bf16 v[32:35], v[48:51], v[176:179], v[32:35]
  v_mfma_f32_16x16x32_bf16 v[40:43], v[48:51], v[180:183], v[40:43]
  s_waitcnt lgkmcnt(4)
  v_mfma_f32_16x16x32_bf16 v[36:39], v[52:55], v[176:179], v[36:39]
  v_mfma_f32_16x16x32_bf16 v[44:47], v[52:55], v[180:183], v[44:47]
  s_waitcnt lgkmcnt(2)
  v_mfma_f32_16x16x32_bf16 v[32:35], v[56:59], v[184:187], v[32:35]
  v_mfma_f32_16x16x32_bf16 v[40:43], v[56:59], v[188:191], v[40:43]
  s_waitcnt lgkmcnt(0)
  v_mfma_f32_16x16x32_bf16 v[36:39], v[60:63], v[184:187], v[36:39]
  v_mfma_f32_16x16x32_bf16 v[44:47], v[60:63], v[188:191], v[44:47]
  s_nop 3
  v_cvt_pk_bf16_f32 v10, v32, v33
  v_cvt_pk_bf16_f32 v11, v34, v35
  s_nop 0
  v_cvt_pk_bf16_f32 v12, v36, v37
  v_cvt_pk_bf16_f32 v13, v38, v39
  s_add_u32 s40, s73, 0x4800
  buffer_store_dwordx4 v[10:13], v2, s[20:23], s40 offen sc1
  s_nop 1
  v_cvt_pk_bf16_f32 v10, v40, v41
  v_cvt_pk_bf16_f32 v11, v42, v43
  v_cvt_pk_bf16_f32 v12, v44, v45
  v_cvt_pk_bf16_f32 v13, v46, v47
  s_add_u32 s40, s73, 0x5000
  buffer_store_dwordx4 v[10:13], v2, s[20:23], s40 offen sc1
  s_lshl_b32 s41, s33, 8
  s_add_u32 s41, s41, 0x4000000
  v_mov_b32 v238, s41
  v_and_b32 v239, 15, v0
  v_mul_u32_u24 v239, 2304, v239
  v_lshrrev_b32 v232, 4, v0
  v_lshl_add_u32 v239, v232, 4, v239
  buffer_load_dwordx2 v[236:237], v238, s[20:23], 0 offen sc1
  s_waitcnt vmcnt(0)
  s_barrier
  s_branch L_tail
L_p2_1:
  v_lshlrev_b32 v2, 4, v0
  v_lshrrev_b32 v14, 2, v0
  v_bfe_u32 v15, v0, 3, 2
  v_lshlrev_b32 v14, 7, v14
  v_and_b32 v9, 3, v0
  v_lshl_add_u32 v14, v9, 3, v14
  v_xor_b32 v9, 0, v15
  v_lshl_add_u32 v3, v9, 5, v14
  v_add_u32 v5, 100352, v3
  v_xor_b32 v9, 1, v15
  v_lshl_add_u32 v4, v9, 5, v14
  v_add_u32 v6, 100352, v4
  v_lshrrev_b32 v14, 4, v0
  v_lshlrev_b32 v14, 1, v14
  v_xor_b32 v14, v14, v0
  v_and_b32 v14, 7, v14
  v_lshlrev_b32 v14, 4, v14
  v_lshrrev_b32 v15, 3, v0
  v_mul_u32_u24 v15, 1152, v15
  v_add_u32 v7, v14, v15
  v_add_u32 v8, 8192, v7
  v_add_u32 v9, 59392, v2
  s_mul_i32 s72, s57, 147456
  s_lshl_b32 s73, s33, 3
  s_add_u32 s73, s73, s34
  s_mul_i32 s73, s73, 165888
  s_add_u32 s73, s73, 0x5000000
  s_lshl_b32 s75, s33, 5
  s_add_u32 s75, s75, s34
  s_mul_i32 s75, s75, 36864
  s_waitcnt lgkmcnt(0)
  v_add_u32 v14, 124928, v2
  ds_read_b128 v[64:67], v14 offset:8192
  ds_read_b128 v[68:71], v14 offset:12288
  ds_read_b128 v[72:75], v14 offset:9216
  ds_read_b128 v[76:79], v14 offset:13312
  ds_read_b128 v[80:83], v14 offset:10240
  ds_read_b128 v[84:87], v14 offset:14336
  ds_read_b128 v[88:91], v14 offset:11264
  ds_read_b128 v[92:95], v14 offset:15360
  s_waitcnt lgkmcnt(0)
  s_barrier
  ds_read_b128 v[96:99], v9 offset:8192
  ds_read_b128 v[100:103], v9 offset:12288
  ds_read_b128 v[104:107], v9 offset:9216
  ds_read_b128 v[108:111], v9 offset:13312
  ds_read_b128 v[112:115], v9 offset:10240
  ds_read_b128 v[116:119], v9 offset:14336
  ds_read_b128 v[120:123], v9 offset:11264
  ds_read_b128 v[124:127], v9 offset:15360
  s_mov_b32 m0, 0x800
  s_add_u32 s39, s72, 0x4800
  buffer_load_dwordx4 v7, s[24:27], s39 offen lds
  buffer_load_dwordx4 v8, s[24:27], s39 offen offset:1024 lds
  s_mov_b32 m0, 0x4800
  s_add_u32 s39, s72, 0x28800
  buffer_load_dwordx4 v7, s[24:27], s39 offen lds
  buffer_load_dwordx4 v8, s[24:27], s39 offen offset:1024 lds
  ds_read_b64_tr_b16 v[16:17], v3 offset:40960
  ds_read_b64_tr_b16 v[18:19], v3 offset:43008
  ds_read_b64_tr_b16 v[20:21], v4 offset:40960
  ds_read_b64_tr_b16 v[22:23], v4 offset:43008
  ds_read_b64_tr_b16 v[24:25], v3 offset:45056
  ds_read_b64_tr_b16 v[26:27], v3 offset:47104
  ds_read_b64_tr_b16 v[28:29], v4 offset:45056
  s_waitcnt lgkmcnt(14)
  ds_read_b64_tr_b16 v[30:31], v4 offset:47104
  s_add_u32 s76, s34, 136
  s_mov_b32 s77, 0
  s_mov_b32 s78, 0
  s_mov_b32 s80, 0x7ff00000
  s_waitcnt lgkmcnt(14)
  ds_read_b64_tr_b16 v[48:49], v3 offset:49152
  s_waitcnt lgkmcnt(13)
  ds_read_b64_tr_b16 v[50:51], v3 offset:51200
  s_waitcnt lgkmcnt(8)
  v_mfma_f32_16x16x32_bf16 v[32:35], v[16:19], v[64:67], 0
  v_mfma_f32_16x16x32_bf16 v[40:43], v[16:19], v[68:71], 0
  ds_read_b64_tr_b16 v[52:53], v4 offset:49152
  ds_read_b64_tr_b16 v[54:55], v4 offset:51200
  s_waitcnt lgkmcnt(8)
  v_mfma_f32_16x16x32_bf16 v[36:39], v[20:23], v[64:67], 0
  v_mfma_f32_16x16x32_bf16 v[44:47], v[20:23], v[68:71], 0
  ds_read_b64_tr_b16 v[56:57], v3 offset:53248
  ds_read_b64_tr_b16 v[58:59], v3 offset:55296
  s_waitcnt lgkmcnt(8)
  v_mfma_f32_16x16x32_bf16 v[32:35], v[24:27], v[72:75], v[32:35]
  v_mfma_f32_16x16x32_bf16 v[40:43], v[24:27], v[76:79], v[40:43]
  ds_read_b64_tr_b16 v[60:61], v4 offset:53248
  ds_read_b64_tr_b16 v[62:63], v4 offset:55296
  s_waitcnt lgkmcnt(8)
  v_mfma_f32_16x16x32_bf16 v[36:39], v[28:31], v[72:75], v[36:39]
  v_mfma_f32_16x16x32_bf16 v[44:47], v[28:31], v[76:79], v[44:47]
  s_waitcnt lgkmcnt(0)
  s_barrier
  ds_read_b64_tr_b16 v[16:17], v5
  ds_read_b64_tr_b16 v[18:19], v5 offset:2048
  v_mfma_f32_16x16x32_bf16 v[32:35], v[48:51], v[80:83], v[32:35]
  v_mfma_f32_16x16x32_bf16 v[40:43], v[48:51], v[84:87], v[40:43]
  ds_read_b64_tr_b16 v[20:21], v6
  ds_read_b64_tr_b16 v[22:23], v6 offset:2048
  s_mov_b32 m0, 0xa800
  s_add_u32 s39, s72, 0x4c880
  buffer_load_dwordx4 v7, s[24:27], s39 offen lds
  buffer_load_dwordx4 v8, s[24:27], s39 offen offset:1024 lds
  v_mfma_f32_16x16x32_bf16 v[36:39], v[52:55], v[80:83], v[36:39]
  v_mfma_f32_16x16x32_bf16 v[44:47], v[52:55], v[84:87], v[44:47]
  ds_read_b64_tr_b16 v[24:25], v5 offset:4096
  ds_read_b64_tr_b16 v[26:27], v5 offset:6144
  v_mfma_f32_16x16x32_bf16 v[32:35], v[56:59], v[88:91], v[32:35]
  v_mfma_f32_16x16x32_bf16 v[40:43], v[56:59], v[92:95], v[40:43]
  ds_read_b64_tr_b16 v[28:29], v6 offset:4096
  ds_read_b64_tr_b16 v[30:31], v6 offset:6144
  v_mfma_f32_16x16x32_bf16 v[36:39], v[60:63], v[88:91], v[36:39]
  v_mfma_f32_16x16x32_bf16 v[44:47], v[60:63], v[92:95], v[44:47]
  ds_read_b64_tr_b16 v[48:49], v5 offset:8192
  ds_read_b64_tr_b16 v[50:51], v5 offset:10240
  s_waitcnt lgkmcnt(8)
  v_mfma_f32_16x16x32_bf16 v[32:35], v[16:19], v[96:99], v[32:35]
  v_mfma_f32_16x16x32_bf16 v[40:43], v[16:19], v[100:103], v[40:43]
  ds_read_b64_tr_b16 v[52:53], v6 offset:8192
  ds_read_b64_tr_b16 v[54:55], v6 offset:10240
  s_waitcnt lgkmcnt(8)
  v_mfma_f32_16x16x32_bf16 v[36:39], v[20:23], v[96:99], v[36:39]
  v_mfma_f32_16x16x32_bf16 v[44:47], v[20:23], v[100:103], v[44:47]
  ds_read_b64_tr_b16 v[56:57], v5 offset:12288
  ds_read_b64_tr_b16 v[58:59], v5 offset:14336
  s_waitcnt lgkmcnt(8)
  v_mfma_f32_16x16x32_bf16 v[32:35], v[24:27], v[104:107], v[32:35]
  v_mfma_f32_16x16x32_bf16 v[40:43], v[24:27], v[108:111], v[40:43]
  ds_read_b64_tr_b16 v[60:61], v6 offset:12288
  ds_read_b64_tr_b16 v[62:63], v6 offset:14336
  s_waitcnt lgkmcnt(8)
  v_mfma_f32_16x16x32_bf16 v[36:39], v[28:31], v[104:107], v[36:39]
  v_mfma_f32_16x16x32_bf16 v[44:47], v[28:31], v[108:111], v[44:47]
  s_waitcnt vmcnt(4)
  s_waitcnt lgkmcnt(0)
  s_barrier
  ds_read_b64_tr_b16 v[16:17], v3
  ds_read_b64_tr_b16 v[18:19], v3 offset:2048
  v_mfma_f32_16x16x32_bf16 v[32:35], v[48:51], v[112:115], v[32:35]
  v_mfma_f32_16x16x32_bf16 v[40:43], v[48:51], v[116:119], v[40:43]
  ds_read_b64_tr_b16 v[20:21], v4
  ds_read_b64_tr_b16 v[22:23], v4 offset:2048
  s_mov_b32 m0, 0x19000
  s_add_u32 s39, s72, 0x70880
  buffer_load_dwordx4 v7, s[24:27], s39 offen lds
  buffer_load_dwordx4 v8, s[24:27], s39 offen offset:1024 lds
  v_mfma_f32_16x16x32_bf16 v[36:39], v[52:55], v[112:115], v[36:39]
  v_mfma_f32_16x16x32_bf16 v[44:47], v[52:55], v[116:119], v[44:47]
  ds_read_b64_tr_b16 v[24:25], v3 offset:4096
  ds_read_b64_tr_b16 v[26:27], v3 offset:6144
  v_mfma_f32_16x16x32_bf16 v[32:35], v[56:59], v[120:123], v[32:35]
  v_mfma_f32_16x16x32_bf16 v[40:43], v[56:59], v[124:127], v[40:43]
  ds_read_b64_tr_b16 v[28:29], v4 offset:4096
  ds_read_b64_tr_b16 v[30:31], v4 offset:6144
  v_mfma_f32_16x16x32_bf16 v[36:39], v[60:63], v[120:123], v[36:39]
  v_mfma_f32_16x16x32_bf16 v[44:47], v[60:63], v[124:127], v[44:47]
  ds_read_b64_tr_b16 v[48:49], v3 offset:8192
  ds_read_b64_tr_b16 v[50:51], v3 offset:10240
  s_waitcnt lgkmcnt(8)
  v_mfma_f32_16x16x32_bf16 v[32:35], v[16:19], v[128:131], v[32:35]
  v_mfma_f32_16x16x32_bf16 v[40:43], v[16:19], v[132:135], v[40:43]
  ds_read_b64_tr_b16 v[52:53], v4 offset:8192
  ds_read_b64_tr_b16 v[54:55], v4 offset:10240
  s_waitcnt lgkmcnt(8)
  v_mfma_f32_16x16x32_bf16 v[36:39], v[20:23], v[128:131], v[36:39]
  v_mfma_f32_16x16x32_bf16 v[44:47], v[20:23], v[132:135], v[44:47]
  ds_read_b64_tr_b16 v[56:57], v3 offset:12288
  ds_read_b64_tr_b16 v[58:59], v3 offset:14336
  s_waitcnt lgkmcnt(8)
  v_mfma_f32_16x16x32_bf16 v[32:35], v[24:27], v[136:139], v[32:35]
  v_mfma_f32_16x16x32_bf16 v[40:43], v[24:27], v[140:143], v[40:43]
  ds_read_b64_tr_b16 v[60:61], v4 offset:12288
  ds_read_b64_tr_b16 v[62:63], v4 offset:14336
  s_waitcnt lgkmcnt(8)
  v_mfma_f32_16x16x32_bf16 v[36:39], v[28:31], v[136:139], v[36:39]
  v_mfma_f32_16x16x32_bf16 v[44:47], v[28:31], v[140:143], v[44:47]
  s_waitcnt vmcnt(4)
  s_waitcnt lgkmcnt(0)
  s_barrier
  ds_read_b64_tr_b16 v[16:17], v3 offset:16384
  ds_read_b64_tr_b16 v[18:19], v3 offset:18432
  v_mfma_f32_16x16x32_bf16 v[32:35], v[48:51], v[144:147], v[32:35]
  v_mfma_f32_16x16x32_bf16 v[40:43], v[48:51], v[148:151], v[40:43]
  ds_read_b64_tr_b16 v[20:21], v4 offset:16384
  ds_read_b64_tr_b16 v[22:23], v4 offset:18432
  s_mov_b32 m0, 0x800
  s_add_u32 s39, s72, 0x4880
  buffer_load_dwordx4 v7, s[24:27], s39 offen lds
  buffer_load_dwordx4 v8, s[24:27], s39 offen offset:1024 lds
  v_mfma_f32_16x16x32_bf16 v[36:39], v[52:55], v[144:147], v[36:39]
  v_mfma_f32_16x16x32_bf16 v[44:47], v[52:55], v[148:151], v[44:47]
  ds_read_b64_tr_b16 v[24:25], v3 offset:20480
  ds_read_b64_tr_b16 v[26:27], v3 offset:22528
  v_mfma_f32_16x16x32_bf16 v[32:35], v[56:59], v[152:155], v[32:35]
  v_mfma_f32_16x16x32_bf16 v[40:43], v[56:59], v[156:159], v[40:43]
  ds_read_b64_tr_b16 v[28:29], v4 offset:20480
  ds_read_b64_tr_b16 v[30:31], v4 offset:22528
  v_mfma_f32_16x16x32_bf16 v[36:39], v[60:63], v[152:155], v[36:39]
  v_mfma_f32_16x16x32_bf16 v[44:47], v[60:63], v[156:159], v[44:47]
  ds_read_b64_tr_b16 v[48:49], v3 offset:24576
  ds_read_b64_tr_b16 v[50:51], v3 offset:26624
  s_waitcnt lgkmcnt(8)
  v_mfma_f32_16x16x32_bf16 v[32:35], v[16:19], v[160:163], v[32:35]
  v_mfma_f32_16x16x32_bf16 v[40:43], v[16:19], v[164:167], v[40:43]
  ds_read_b64_tr_b16 v[52:53], v4 offset:24576
  ds_read_b64_tr_b16 v[54:55], v4 offset:26624
  s_waitcnt lgkmcnt(8)
  v_mfma_f32_16x16x32_bf16 v[36:39], v[20:23], v[160:163], v[36:39]
  v_mfma_f32_16x16x32_bf16 v[44:47], v[20:23], v[164:167], v[44:47]
  ds_read_b64_tr_b16 v[56:57], v3 offset:28672
  ds_read_b64_tr_b16 v[58:59], v3 offset:30720
  s_waitcnt lgkmcnt(8)
  v_mfma_f32_16x16x32_bf16 v[32:35], v[24:27], v[168:171], v[32:35]
  v_mfma_f32_16x16x32_bf16 v[40:43], v[24:27], v[172:175], v[40:43]
  ds_read_b64_tr_b16 v[60:61], v4 offset:28672
  ds_read_b64_tr_b16 v[62:63], v4 offset:30720
  s_waitcnt lgkmcnt(8)
  v_mfma_f32_16x16x32_bf16 v[36:39], v[28:31], v[168:171], v[36:39]
  v_mfma_f32_16x16x32_bf16 v[44:47], v[28:31], v[172:175], v[44:47]
  s_waitcnt vmcnt(4)
  s_waitcnt lgkmcnt(0)
  s_barrier
  ds_read_b64_tr_b16 v[16:17], v3 offset:40960
  ds_read_b64_tr_b16 v[18:19], v3 offset:43008
  v_mfma_f32_16x16x32_bf16 v[32:35], v[48:51], v[176:179], v[32:35]
  v_mfma_f32_16x16x32_bf16 v[40:43], v[48:51], v[180:183], v[40:43]
  ds_read_b64_tr_b16 v[20:21], v4 offset:40960
  ds_read_b64_tr_b16 v[22:23], v4 offset:43008
  s_mov_b32 m0, 0x4800
  s_add_u32 s39, s72, 0x28880
  buffer_load_dwordx4 v7, s[24:27], s39 offen lds
  buffer_load_dwordx4 v8, s[24:27], s39 offen offset:1024 lds
  v_mfma_f32_16x16x32_bf16 v[36:39], v[52:55], v[176:179], v[36:39]
  v_mfma_f32_16x16x32_bf16 v[44:47], v[52:55], v[180:183], v[44:47]
  ds_read_b64_tr_b16 v[24:25], v3 offset:45056
  ds_read_b64_tr_b16 v[26:27], v3 offset:47104
  v_mfma_f32_16x16x32_bf16 v[32:35], v[56:59], v[184:187], v[32:35]
  v_mfma_f32_16x16x32_bf16 v[40:43], v[56:59], v[188:191], v[40:43]
  ds_read_b64_tr_b16 v[28:29], v4 offset:45056
  ds_read_b64_tr_b16 v[30:31], v4 offset:47104
  v_mfma_f32_16x16x32_bf16 v[36:39], v[60:63], v[184:187], v[36:39]
  v_mfma_f32_16x16x32_bf16 v[44:47], v[60:63], v[188:191], v[44:47]
  s_add_u32 s72, s72, 128
  s_mov_b32 s74, 7
L_op1_loop:
  ds_read_b64_tr_b16 v[48:49], v3 offset:49152
  ds_read_b64_tr_b16 v[50:51], v3 offset:51200
  v_cvt_pk_bf16_f32 v10, v32, v33
  v_cvt_pk_bf16_f32 v11, v34, v35
  s_nop 0
  v_cvt_pk_bf16_f32 v12, v36, v37
  v_cvt_pk_bf16_f32 v13, v38, v39
  s_add_u32 s40, s73, 0x1000
  buffer_store_dwordx4 v[10:13], v2, s[20:23], s40 offen sc1
  s_waitcnt lgkmcnt(8)
  v_mfma_f32_16x16x32_bf16 v[32:35], v[16:19], v[64:67], 0
  v_cvt_pk_bf16_f32 v10, v40, v41
  v_cvt_pk_bf16_f32 v11, v42, v43
  v_cvt_pk_bf16_f32 v12, v44, v45
  v_cvt_pk_bf16_f32 v13, v46, v47
  s_add_u32 s40, s73, 0x1800
  buffer_store_dwordx4 v[10:13], v2, s[20:23], s40 offen sc1
  v_mfma_f32_16x16x32_bf16 v[40:43], v[16:19], v[68:71], 0
  ds_read_b64_tr_b16 v[52:53], v4 offset:49152
  ds_read_b64_tr_b16 v[54:55], v4 offset:51200
  s_waitcnt lgkmcnt(6)
  v_mfma_f32_16x16x32_bf16 v[36:39], v[20:23], v[64:67], 0
  v_mfma_f32_16x16x32_bf16 v[44:47], v[20:23], v[68:71], 0
  ds_read_b64_tr_b16 v[56:57], v3 offset:53248
  ds_read_b64_tr_b16 v[58:59], v3 offset:55296
  v_mfma_f32_16x16x32_bf16 v[32:35], v[24:27], v[72:75], v[32:35]
  v_mfma_f32_16x16x32_bf16 v[40:43], v[24:27], v[76:79], v[40:43]
  ds_read_b64_tr_b16 v[60:61], v4 offset:53248
  ds_read_b64_tr_b16 v[62:63], v4 offset:55296
  s_waitcnt lgkmcnt(7)
  v_mfma_f32_16x16x32_bf16 v[36:39], v[28:31], v[72:75], v[36:39]
  v_mfma_f32_16x16x32_bf16 v[44:47], v[28:31], v[76:79], v[44:47]
  s_waitcnt vmcnt(6)
  s_waitcnt lgkmcnt(0)
  s_barrier
  ds_read_b64_tr_b16 v[16:17], v5
  ds_read_b64_tr_b16 v[18:19], v5 offset:2048
  v_mfma_f32_16x16x32_bf16 v[32:35], v[48:51], v[80:83], v[32:35]
  v_mfma_f32_16x16x32_bf16 v[40:43], v[48:51], v[84:87], v[40:43]
  ds_read_b64_tr_b16 v[20:21], v6
  ds_read_b64_tr_b16 v[22:23], v6 offset:2048
  s_mov_b32 m0, 0xa800
  s_add_u32 s39, s72, 0x4c880
  buffer_load_dwordx4 v7, s[24:27], s39 offen lds
  buffer_load_dwordx4 v8, s[24:27], s39 offen offset:1024 lds
  v_mfma_f32_16x16x32_bf16 v[36:39], v[52:55], v[80:83], v[36:39]
  v_mfma_f32_16x16x32_bf16 v[44:47], v[52:55], v[84:87], v[44:47]
  ds_read_b64_tr_b16 v[24:25], v5 offset:4096
  ds_read_b64_tr_b16 v[26:27], v5 offset:6144
  v_mfma_f32_16x16x32_bf16 v[32:35], v[56:59], v[88:91], v[32:35]
  v_mfma_f32_16x16x32_bf16 v[40:43], v[56:59], v[92:95], v[40:43]
  ds_read_b64_tr_b16 v[28:29], v6 offset:4096
  ds_read_b64_tr_b16 v[30:31], v6 offset:6144
  v_mfma_f32_16x16x32_bf16 v[36:39], v[60:63], v[88:91], v[36:39]
  v_mfma_f32_16x16x32_bf16 v[44:47], v[60:63], v[92:95], v[44:47]
  ds_read_b64_tr_b16 v[48:49], v5 offset:8192
  ds_read_b64_tr_b16 v[50:51], v5 offset:10240
  s_waitcnt lgkmcnt(8)
  v_mfma_f32_16x16x32_bf16 v[32:35], v[16:19], v[96:99], v[32:35]
  v_mfma_f32_16x16x32_bf16 v[40:43], v[16:19], v[100:103], v[40:43]
  ds_read_b64_tr_b16 v[52:53], v6 offset:8192
  ds_read_b64_tr_b16 v[54:55], v6 offset:10240
  s_waitcnt lgkmcnt(8)
  v_mfma_f32_16x16x32_bf16 v[36:39], v[20:23], v[96:99], v[36:39]
  v_mfma_f32_16x16x32_bf16 v[44:47], v[20:23], v[100:103], v[44:47]
  ds_read_b64_tr_b16 v[56:57], v5 offset:12288
  ds_read_b64_tr_b16 v[58:59], v5 offset:14336
  s_waitcnt lgkmcnt(8)
  v_mfma_f32_16x16x32_bf16 v[32:35], v[24:27], v[104:107], v[32:35]
  v_mfma_f32_16x16x32_bf16 v[40:43], v[24:27], v[108:111], v[40:43]
  ds_read_b64_tr_b16 v[60:61], v6 offset:12288
  ds_read_b64_tr_b16 v[62:63], v6 offset:14336
  s_waitcnt lgkmcnt(8)
  v_mfma_f32_16x16x32_bf16 v[36:39], v[28:31], v[104:107], v[36:39]
  v_mfma_f32_16x16x32_bf16 v[44:47], v[28:31], v[108:111], v[44:47]
  s_waitcnt vmcnt(6)
  s_waitcnt lgkmcnt(0)
  s_barrier
  ds_read_b64_tr_b16 v[16:17], v3
  ds_read_b64_tr_b16 v[18:19], v3 offset:2048
  v_mfma_f32_16x16x32_bf16 v[32:35], v[48:51], v[112:115], v[32:35]
  v_mfma_f32_16x16x32_bf16 v[40:43], v[48:51], v[116:119], v[40:43]
  ds_read_b64_tr_b16 v[20:21], v4
  ds_read_b64_tr_b16 v[22:23], v4 offset:2048
  s_mov_b32 m0, 0x19000
  s_add_u32 s39, s72, 0x70880
  buffer_load_dwordx4 v7, s[24:27], s39 offen lds
  buffer_load_dwordx4 v8, s[24:27], s39 offen offset:1024 lds
  v_mfma_f32_16x16x32_bf16 v[36:39], v[52:55], v[112:115], v[36:39]
  v_mfma_f32_16x16x32_bf16 v[44:47], v[52:55], v[116:119], v[44:47]
  ds_read_b64_tr_b16 v[24:25], v3 offset:4096
  ds_read_b64_tr_b16 v[26:27], v3 offset:6144
  v_mfma_f32_16x16x32_bf16 v[32:35], v[56:59], v[120:123], v[32:35]
  v_mfma_f32_16x16x32_bf16 v[40:43], v[56:59], v[124:127], v[40:43]
  ds_read_b64_tr_b16 v[28:29], v4 offset:4096
  ds_read_b64_tr_b16 v[30:31], v4 offset:6144
  v_mfma_f32_16x16x32_bf16 v[36:39], v[60:63], v[120:123], v[36:39]
  v_mfma_f32_16x16x32_bf16 v[44:47], v[60:63], v[124:127], v[44:47]
  ds_read_b64_tr_b16 v[48:49], v3 offset:8192
  ds_read_b64_tr_b16 v[50:51], v3 offset:10240
  s_waitcnt lgkmcnt(8)
  v_mfma_f32_16x16x32_bf16 v[32:35], v[16:19], v[128:131], v[32:35]
  v_mfma_f32_16x16x32_bf16 v[40:43], v[16:19], v[132:135], v[40:43]
  ds_read_b64_tr_b16 v[52:53], v4 offset:8192
  ds_read_b64_tr_b16 v[54:55], v4 offset:10240
  s_waitcnt lgkmcnt(8)
  v_mfma_f32_16x16x32_bf16 v[36:39], v[20:23], v[128:131], v[36:39]
  v_mfma_f32_16x16x32_bf16 v[44:47], v[20:23], v[132:135], v[44:47]
  ds_read_b64_tr_b16 v[56:57], v3 offset:12288
  ds_read_b64_tr_b16 v[58:59], v3 offset:14336
  s_waitcnt lgkmcnt(8)
  v_mfma_f32_16x16x32_bf16 v[32:35], v[24:27], v[136:139], v[32:35]
  v_mfma_f32_16x16x32_bf16 v[40:43], v[24:27], v[140:143], v[40:43]
  ds_read_b64_tr_b16 v[60:61], v4 offset:12288
  ds_read_b64_tr_b16 v[62:63], v4 offset:14336
  s_waitcnt lgkmcnt(8)
  v_mfma_f32_16x16x32_bf16 v[36:39], v[28:31], v[136:139], v[36:39]
  v_mfma_f32_16x16x32_bf16 v[44:47], v[28:31], v[140:143], v[44:47]
  s_waitcnt vmcnt(6)
  s_waitcnt lgkmcnt(0)
  s_barrier
  ds_read_b64_tr_b16 v[16:17], v3 offset:16384
  ds_read_b64_tr_b16 v[18:19], v3 offset:18432
  v_mfma_f32_16x16x32_bf16 v[32:35], v[48:51], v[144:147], v[32:35]
  v_mfma_f32_16x16x32_bf16 v[40:43], v[48:51], v[148:151], v[40:43]
  ds_read_b64_tr_b16 v[20:21], v4 offset:16384
  ds_read_b64_tr_b16 v[22:23], v4 offset:18432
  s_mov_b32 m0, 0x800
  s_add_u32 s39, s72, 0x4880
  buffer_load_dwordx4 v7, s[24:27], s39 offen lds
  buffer_load_dwordx4 v8, s[24:27], s39 offen offset:1024 lds
  v_mfma_f32_16x16x32_bf16 v[36:39], v[52:55], v[144:147], v[36:39]
  v_mfma_f32_16x16x32_bf16 v[44:47], v[52:55], v[148:151], v[44:47]
  ds_read_b64_tr_b16 v[24:25], v3 offset:20480
  ds_read_b64_tr_b16 v[26:27], v3 offset:22528
  v_mfma_f32_16x16x32_bf16 v[32:35], v[56:59], v[152:155], v[32:35]
  v_mfma_f32_16x16x32_bf16 v[40:43], v[56:59], v[156:159], v[40:43]
  ds_read_b64_tr_b16 v[28:29], v4 offset:20480
  ds_read_b64_tr_b16 v[30:31], v4 offset:22528
  v_mfma_f32_16x16x32_bf16 v[36:39], v[60:63], v[152:155], v[36:39]
  v_mfma_f32_16x16x32_bf16 v[44:47], v[60:63], v[156:159], v[44:47]
  ds_read_b64_tr_b16 v[48:49], v3 offset:24576
  ds_read_b64_tr_b16 v[50:51], v3 offset:26624
  s_waitcnt lgkmcnt(8)
  v_mfma_f32_16x16x32_bf16 v[32:35], v[16:19], v[160:163], v[32:35]
  v_mfma_f32_16x16x32_bf16 v[40:43], v[16:19], v[164:167], v[40:43]
  ds_read_b64_tr_b16 v[52:53], v4 offset:24576
  ds_read_b64_tr_b16 v[54:55], v4 offset:26624
  s_waitcnt lgkmcnt(8)
  v_mfma_f32_16x16x32_bf16 v[36:39], v[20:23], v[160:163], v[36:39]
  v_mfma_f32_16x16x32_bf16 v[44:47], v[20:23], v[164:167], v[44:47]
  ds_read_b64_tr_b16 v[56:57], v3 offset:28672
  ds_read_b64_tr_b16 v[58:59], v3 offset:30720
  s_waitcnt lgkmcnt(8)
  v_mfma_f32_16x16x32_bf16 v[32:35], v[24:27], v[168:171], v[32:35]
  v_mfma_f32_16x16x32_bf16 v[40:43], v[24:27], v[172:175], v[40:43]
  ds_read_b64_tr_b16 v[60:61], v4 offset:28672
  ds_read_b64_tr_b16 v[62:63], v4 offset:30720
  s_waitcnt lgkmcnt(8)
  v_mfma_f32_16x16x32_bf16 v[36:39], v[28:31], v[168:171], v[36:39]
  v_mfma_f32_16x16x32_bf16 v[44:47], v[28:31], v[172:175], v[44:47]
  s_waitcnt vmcnt(4)
  s_waitcnt lgkmcnt(0)
  s_barrier
  ds_read_b64_tr_b16 v[16:17], v3 offset:40960
  ds_read_b64_tr_b16 v[18:19], v3 offset:43008
  v_mfma_f32_16x16x32_bf16 v[32:35], v[48:51], v[176:179], v[32:35]
  v_mfma_f32_16x16x32_bf16 v[40:43], v[48:51], v[180:183], v[40:43]
  ds_read_b64_tr_b16 v[20:21], v4 offset:40960
  ds_read_b64_tr_b16 v[22:23], v4 offset:43008
  s_mov_b32 m0, 0x4800
  s_add_u32 s39, s72, 0x28880
  buffer_load_dwordx4 v7, s[24:27], s39 offen lds
  buffer_load_dwordx4 v8, s[24:27], s39 offen offset:1024 lds
  v_mfma_f32_16x16x32_bf16 v[36:39], v[52:55], v[176:179], v[36:39]
  v_mfma_f32_16x16x32_bf16 v[44:47], v[52:55], v[180:183], v[44:47]
  ds_read_b64_tr_b16 v[24:25], v3 offset:45056
  ds_read_b64_tr_b16 v[26:27], v3 offset:47104
  v_mfma_f32_16x16x32_bf16 v[32:35], v[56:59], v[184:187], v[32:35]
  v_mfma_f32_16x16x32_bf16 v[40:43], v[56:59], v[188:191], v[40:43]
  ds_read_b64_tr_b16 v[28:29], v4 offset:45056
  ds_read_b64_tr_b16 v[30:31], v4 offset:47104
  v_mfma_f32_16x16x32_bf16 v[36:39], v[60:63], v[184:187], v[36:39]
  v_mfma_f32_16x16x32_bf16 v[44:47], v[60:63], v[188:191], v[44:47]
  s_add_u32 s72, s72, 128
  s_add_u32 s73, s73, 0x4800
  s_add_u32 s78, s78, 1
  s_sub_u32 s74, s74, 1
  s_cmp_lg_u32 s74, 0
  s_cbranch_scc1 L_op1_loop
  ds_read_b64_tr_b16 v[48:49], v3 offset:49152
  ds_read_b64_tr_b16 v[50:51], v3 offset:51200
  v_cvt_pk_bf16_f32 v10, v32, v33
  v_cvt_pk_bf16_f32 v11, v34, v35
  v_cvt_pk_bf16_f32 v12, v36, v37
  v_cvt_pk_bf16_f32 v13, v38, v39
  s_add_u32 s40, s73, 0x1000
  buffer_store_dwordx4 v[10:13], v2, s[20:23], s40 offen sc1
  s_waitcnt lgkmcnt(6)
  v_mfma_f32_16x16x32_bf16 v[32:35], v[16:19], v[64:67], 0
  v_cvt_pk_bf16_f32 v10, v40, v41
  v_cvt_pk_bf16_f32 v11, v42, v43
  v_cvt_pk_bf16_f32 v12, v44, v45
  v_cvt_pk_bf16_f32 v13, v46, v47
  s_add_u32 s40, s73, 0x1800
  buffer_store_dwordx4 v[10:13], v2, s[20:23], s40 offen sc1
  v_mfma_f32_16x16x32_bf16 v[40:43], v[16:19], v[68:71], 0
  ds_read_b64_tr_b16 v[52:53], v4 offset:49152
  ds_read_b64_tr_b16 v[54:55], v4 offset:51200
  v_mfma_f32_16x16x32_bf16 v[36:39], v[20:23], v[64:67], 0
  v_mfma_f32_16x16x32_bf16 v[44:47], v[20:23], v[68:71], 0
  ds_read_b64_tr_b16 v[56:57], v3 offset:53248
  ds_read_b64_tr_b16 v[58:59], v3 offset:55296
  s_waitcnt lgkmcnt(6)
  v_mfma_f32_16x16x32_bf16 v[32:35], v[24:27], v[72:75], v[32:35]
  v_mfma_f32_16x16x32_bf16 v[40:43], v[24:27], v[76:79], v[40:43]
  ds_read_b64_tr_b16 v[60:61], v4 offset:53248
  ds_read_b64_tr_b16 v[62:63], v4 offset:55296
  v_mfma_f32_16x16x32_bf16 v[36:39], v[28:31], v[72:75], v[36:39]
  v_mfma_f32_16x16x32_bf16 v[44:47], v[28:31], v[76:79], v[44:47]
  s_waitcnt vmcnt(6)
  s_waitcnt lgkmcnt(0)
  s_barrier
  ds_read_b64_tr_b16 v[16:17], v5
  ds_read_b64_tr_b16 v[18:19], v5 offset:2048
  v_mfma_f32_16x16x32_bf16 v[32:35], v[48:51], v[80:83], v[32:35]
  v_mfma_f32_16x16x32_bf16 v[40:43], v[48:51], v[84:87], v[40:43]
  ds_read_b64_tr_b16 v[20:21], v6
  ds_read_b64_tr_b16 v[22:23], v6 offset:2048
  v_mfma_f32_16x16x32_bf16 v[36:39], v[52:55], v[80:83], v[36:39]
  v_mfma_f32_16x16x32_bf16 v[44:47], v[52:55], v[84:87], v[44:47]
  ds_read_b64_tr_b16 v[24:25], v5 offset:4096
  ds_read_b64_tr_b16 v[26:27], v5 offset:6144
  v_mfma_f32_16x16x32_bf16 v[32:35], v[56:59], v[88:91], v[32:35]
  v_mfma_f32_16x16x32_bf16 v[40:43], v[56:59], v[92:95], v[40:43]
  ds_read_b64_tr_b16 v[28:29], v6 offset:4096
  ds_read_b64_tr_b16 v[30:31], v6 offset:6144
  v_mfma_f32_16x16x32_bf16 v[36:39], v[60:63], v[88:91], v[36:39]
  v_mfma_f32_16x16x32_bf16 v[44:47], v[60:63], v[92:95], v[44:47]
  ds_read_b64_tr_b16 v[48:49], v5 offset:8192
  ds_read_b64_tr_b16 v[50:51], v5 offset:10240
  s_waitcnt lgkmcnt(8)
  v_mfma_f32_16x16x32_bf16 v[32:35], v[16:19], v[96:99], v[32:35]
  v_mfma_f32_16x16x32_bf16 v[40:43], v[16:19], v[100:103], v[40:43]
  ds_read_b64_tr_b16 v[52:53], v6 offset:8192
  ds_read_b64_tr_b16 v[54:55], v6 offset:10240
  s_waitcnt lgkmcnt(8)
  v_mfma_f32_16x16x32_bf16 v[36:39], v[20:23], v[96:99], v[36:39]
  v_mfma_f32_16x16x32_bf16 v[44:47], v[20:23], v[100:103], v[44:47]
  ds_read_b64_tr_b16 v[56:57], v5 offset:12288
  ds_read_b64_tr_b16 v[58:59], v5 offset:14336
  s_waitcnt lgkmcnt(8)
  v_mfma_f32_16x16x32_bf16 v[32:35], v[24:27], v[104:107], v[32:35]
  v_mfma_f32_16x16x32_bf16 v[40:43], v[24:27], v[108:111], v[40:43]
  ds_read_b64_tr_b16 v[60:61], v6 offset:12288
  ds_read_b64_tr_b16 v[62:63], v6 offset:14336
  s_waitcnt lgkmcnt(8)
  v_mfma_f32_16x16x32_bf16 v[36:39], v[28:31], v[104:107], v[36:39]
  v_mfma_f32_16x16x32_bf16 v[44:47], v[28:31], v[108:111], v[44:47]
  s_waitcnt vmcnt(4)
  s_waitcnt lgkmcnt(0)
  s_barrier
  ds_read_b64_tr_b16 v[16:17], v3
  ds_read_b64_tr_b16 v[18:19], v3 offset:2048
  v_mfma_f32_16x16x32_bf16 v[32:35], v[48:51], v[112:115], v[32:35]
  v_mfma_f32_16x16x32_bf16 v[40:43], v[48:51], v[116:119], v[40:43]
  ds_read_b64_tr_b16 v[20:21], v4
  ds_read_b64_tr_b16 v[22:23], v4 offset:2048
  v_mfma_f32_16x16x32_bf16 v[36:39], v[52:55], v[112:115], v[36:39]
  v_mfma_f32_16x16x32_bf16 v[44:47], v[52:55], v[116:119], v[44:47]
  ds_read_b64_tr_b16 v[24:25], v3 offset:4096
  ds_read_b64_tr_b16 v[26:27], v3 offset:6144
  v_mfma_f32_16x16x32_bf16 v[32:35], v[56:59], v[120:123], v[32:35]
  v_mfma_f32_16x16x32_bf16 v[40:43], v[56:59], v[124:127], v[40:43]
  ds_read_b64_tr_b16 v[28:29], v4 offset:4096
  ds_read_b64_tr_b16 v[30:31], v4 offset:6144
  v_mfma_f32_16x16x32_bf16 v[36:39], v[60:63], v[120:123], v[36:39]
  v_mfma_f32_16x16x32_bf16 v[44:47], v[60:63], v[124:127], v[44:47]
  ds_read_b64_tr_b16 v[48:49], v3 offset:8192
  ds_read_b64_tr_b16 v[50:51], v3 offset:10240
  s_waitcnt lgkmcnt(8)
  v_mfma_f32_16x16x32_bf16 v[32:35], v[16:19], v[128:131], v[32:35]
  v_mfma_f32_16x16x32_bf16 v[40:43], v[16:19], v[132:135], v[40:43]
  ds_read_b64_tr_b16 v[52:53], v4 offset:8192
  ds_read_b64_tr_b16 v[54:55], v4 offset:10240
  s_waitcnt lgkmcnt(8)
  v_mfma_f32_16x16x32_bf16 v[36:39], v[20:23], v[128:131], v[36:39]
  v_mfma_f32_16x16x32_bf16 v[44:47], v[20:23], v[132:135], v[44:47]
  ds_read_b64_tr_b16 v[56:57], v3 offset:12288
  ds_read_b64_tr_b16 v[58:59], v3 offset:14336
  s_waitcnt lgkmcnt(8)
  v_mfma_f32_16x16x32_bf16 v[32:35], v[24:27], v[136:139], v[32:35]
  v_mfma_f32_16x16x32_bf16 v[40:43], v[24:27], v[140:143], v[40:43]
  ds_read_b64_tr_b16 v[60:61], v4 offset:12288
  ds_read_b64_tr_b16 v[62:63], v4 offset:14336
  s_waitcnt lgkmcnt(8)
  v_mfma_f32_16x16x32_bf16 v[36:39], v[28:31], v[136:139], v[36:39]
  v_mfma_f32_16x16x32_bf16 v[44:47], v[28:31], v[140:143], v[44:47]
  s_waitcnt vmcnt(0)
  s_waitcnt lgkmcnt(0)
  s_barrier
  ds_read_b64_tr_b16 v[16:17], v3 offset:16384
  ds_read_b64_tr_b16 v[18:19], v3 offset:18432
  v_mfma_f32_16x16x32_bf16 v[32:35], v[48:51], v[144:147], v[32:35]
  v_mfma_f32_16x16x32_bf16 v[40:43], v[48:51], v[148:151], v[40:43]
  ds_read_b64_tr_b16 v[20:21], v4 offset:16384
  ds_read_b64_tr_b16 v[22:23], v4 offset:18432
  v_mfma_f32_16x16x32_bf16 v[36:39], v[52:55], v[144:147], v[36:39]
  v_mfma_f32_16x16x32_bf16 v[44:47], v[52:55], v[148:151], v[44:47]
  ds_read_b64_tr_b16 v[24:25], v3 offset:20480
  ds_read_b64_tr_b16 v[26:27], v3 offset:22528
  v_mfma_f32_16x16x32_bf16 v[32:35], v[56:59], v[152:155], v[32:35]
  v_mfma_f32_16x16x32_bf16 v[40:43], v[56:59], v[156:159], v[40:43]
  ds_read_b64_tr_b16 v[28:29], v4 offset:20480
  ds_read_b64_tr_b16 v[30:31], v4 offset:22528
  v_mfma_f32_16x16x32_bf16 v[36:39], v[60:63], v[152:155], v[36:39]
  v_mfma_f32_16x16x32_bf16 v[44:47], v[60:63], v[156:159], v[44:47]
  ds_read_b64_tr_b16 v[48:49], v3 offset:24576
  ds_read_b64_tr_b16 v[50:51], v3 offset:26624
  s_waitcnt lgkmcnt(8)
  v_mfma_f32_16x16x32_bf16 v[32:35], v[16:19], v[160:163], v[32:35]
  v_mfma_f32_16x16x32_bf16 v[40:43], v[16:19], v[164:167], v[40:43]
  ds_read_b64_tr_b16 v[52:53], v4 offset:24576
  ds_read_b64_tr_b16 v[54:55], v4 offset:26624
  s_waitcnt lgkmcnt(8)
  v_mfma_f32_16x16x32_bf16 v[36:39], v[20:23], v[160:163], v[36:39]
  v_mfma_f32_16x16x32_bf16 v[44:47], v[20:23], v[164:167], v[44:47]
  ds_read_b64_tr_b16 v[56:57], v3 offset:28672
  ds_read_b64_tr_b16 v[58:59], v3 offset:30720
  s_waitcnt lgkmcnt(8)
  v_mfma_f32_16x16x32_bf16 v[32:35], v[24:27], v[168:171], v[32:35]
  v_mfma_f32_16x16x32_bf16 v[40:43], v[24:27], v[172:175], v[40:43]
  ds_read_b64_tr_b16 v[60:61], v4 offset:28672
  ds_read_b64_tr_b16 v[62:63], v4 offset:30720
  s_waitcnt lgkmcnt(8)
  v_mfma_f32_16x16x32_bf16 v[36:39], v[28:31], v[168:171], v[36:39]
  v_mfma_f32_16x16x32_bf16 v[44:47], v[28:31], v[172:175], v[44:47]
  s_waitcnt lgkmcnt(6)
  v_mfma_f32_16x16x32_bf16 v[32:35], v[48:51], v[176:179], v[32:35]
  v_mfma_f32_16x16x32_bf16 v[40:43], v[48:51], v[180:183], v[40:43]
  s_waitcnt lgkmcnt(4)
  v_mfma_f32_16x16x32_bf16 v[36:39], v[52:55], v[176:179], v[36:39]
  v_mfma_f32_16x16x32_bf16 v[44:47], v[52:55], v[180:183], v[44:47]
  s_waitcnt lgkmcnt(2)
  v_mfma_f32_16x16x32_bf16 v[32:35], v[56:59], v[184:187], v[32:35]
  v_mfma_f32_16x16x32_bf16 v[40:43], v[56:59], v[188:191], v[40:43]
  s_waitcnt lgkmcnt(0)
  v_mfma_f32_16x16x32_bf16 v[36:39], v[60:63], v[184:187], v[36:39]
  v_mfma_f32_16x16x32_bf16 v[44:47], v[60:63], v[188:191], v[44:47]
  s_nop 3
  v_cvt_pk_bf16_f32 v10, v32, v33
  v_cvt_pk_bf16_f32 v11, v34, v35
  s_nop 0
  v_cvt_pk_bf16_f32 v12, v36, v37
  v_cvt_pk_bf16_f32 v13, v38, v39
  s_add_u32 s40, s73, 0x5800
  buffer_store_dwordx4 v[10:13], v2, s[20:23], s40 offen sc1
  s_nop 1
  v_cvt_pk_bf16_f32 v10, v40, v41
  v_cvt_pk_bf16_f32 v11, v42, v43
  v_cvt_pk_bf16_f32 v12, v44, v45
  v_cvt_pk_bf16_f32 v13, v46, v47
  s_add_u32 s40, s73, 0x6000
  buffer_store_dwordx4 v[10:13], v2, s[20:23], s40 offen sc1
  s_lshl_b32 s41, s33, 8
  s_add_u32 s41, s41, 0x4000000
  v_mov_b32 v238, s41
  v_and_b32 v239, 15, v0
  v_mul_u32_u24 v239, 2304, v239
  v_lshrrev_b32 v232, 4, v0
  v_lshl_add_u32 v239, v232, 4, v239
  buffer_load_dwordx2 v[236:237], v238, s[20:23], 0 offen sc1
  s_waitcnt vmcnt(0)
  s_barrier
  s_branch L_tail
L_p2_2:
  v_lshlrev_b32 v2, 4, v0
  v_lshrrev_b32 v14, 2, v0
  v_bfe_u32 v15, v0, 3, 2
  v_lshlrev_b32 v14, 7, v14
  v_and_b32 v9, 3, v0
  v_lshl_add_u32 v14, v9, 3, v14
  v_xor_b32 v9, 0, v15
  v_lshl_add_u32 v3, v9, 5, v14
  v_add_u32 v5, 100352, v3
  v_xor_b32 v9, 1, v15
  v_lshl_add_u32 v4, v9, 5, v14
  v_add_u32 v6, 100352, v4
  v_lshrrev_b32 v14, 4, v0
  v_lshlrev_b32 v14, 1, v14
  v_xor_b32 v14, v14, v0
  v_and_b32 v14, 7, v14
  v_lshlrev_b32 v14, 4, v14
  v_lshrrev_b32 v15, 3, v0
  v_mul_u32_u24 v15, 1152, v15
  v_add_u32 v7, v14, v15
  v_add_u32 v8, 8192, v7
  v_add_u32 v9, 59392, v2
  s_mul_i32 s72, s57, 147456
  s_lshl_b32 s73, s33, 3
  s_add_u32 s73, s73, s34
  s_mul_i32 s73, s73, 165888
  s_add_u32 s73, s73, 0x5000000
  s_lshl_b32 s75, s33, 5
  s_add_u32 s75, s75, s34
  s_mul_i32 s75, s75, 36864
  s_waitcnt lgkmcnt(0)
  v_add_u32 v14, 124928, v2
  ds_read_b128 v[64:67], v14 offset:16384
  ds_read_b128 v[68:71], v14 offset:20480
  ds_read_b128 v[72:75], v14 offset:17408
  ds_read_b128 v[76:79], v14 offset:21504
  ds_read_b128 v[80:83], v14 offset:18432
  ds_read_b128 v[84:87], v14 offset:22528
  ds_read_b128 v[88:91], v14 offset:19456
  ds_read_b128 v[92:95], v14 offset:23552
  s_waitcnt lgkmcnt(0)
  s_barrier
  ds_read_b128 v[96:99], v9 offset:16384
  ds_read_b128 v[100:103], v9 offset:20480
  ds_read_b128 v[104:107], v9 offset:17408
  ds_read_b128 v[108:111], v9 offset:21504
  ds_read_b128 v[112:115], v9 offset:18432
  ds_read_b128 v[116:119], v9 offset:22528
  ds_read_b128 v[120:123], v9 offset:19456
  ds_read_b128 v[124:127], v9 offset:23552
  s_mov_b32 m0, 0x1000
  s_add_u32 s39, s72, 0x9000
  buffer_load_dwordx4 v7, s[24:27], s39 offen lds
  buffer_load_dwordx4 v8, s[24:27], s39 offen offset:1024 lds
  s_mov_b32 m0, 0x5000
  s_add_u32 s39, s72, 0x2d000
  buffer_load_dwordx4 v7, s[24:27], s39 offen lds
  buffer_load_dwordx4 v8, s[24:27], s39 offen offset:1024 lds
  ds_read_b64_tr_b16 v[16:17], v3 offset:40960
  ds_read_b64_tr_b16 v[18:19], v3 offset:43008
  ds_read_b64_tr_b16 v[20:21], v4 offset:40960
  ds_read_b64_tr_b16 v[22:23], v4 offset:43008
  ds_read_b64_tr_b16 v[24:25], v3 offset:45056
  ds_read_b64_tr_b16 v[26:27], v3 offset:47104
  ds_read_b64_tr_b16 v[28:29], v4 offset:45056
  s_waitcnt lgkmcnt(14)
  ds_read_b64_tr_b16 v[30:31], v4 offset:47104
  s_add_u32 s76, s34, 0
  s_mov_b32 s77, 0
  s_mov_b32 s78, 0
  s_mov_b32 s80, 0x7ff00000
  s_waitcnt lgkmcnt(14)
  ds_read_b64_tr_b16 v[48:49], v3 offset:49152
  s_waitcnt lgkmcnt(13)
  ds_read_b64_tr_b16 v[50:51], v3 offset:51200
  s_waitcnt lgkmcnt(8)
  v_mfma_f32_16x16x32_bf16 v[32:35], v[16:19], v[64:67], 0
  v_mfma_f32_16x16x32_bf16 v[40:43], v[16:19], v[68:71], 0
  ds_read_b64_tr_b16 v[52:53], v4 offset:49152
  ds_read_b64_tr_b16 v[54:55], v4 offset:51200
  s_waitcnt lgkmcnt(8)
  v_mfma_f32_16x16x32_bf16 v[36:39], v[20:23], v[64:67], 0
  v_mfma_f32_16x16x32_bf16 v[44:47], v[20:23], v[68:71], 0
  ds_read_b64_tr_b16 v[56:57], v3 offset:53248
  ds_read_b64_tr_b16 v[58:59], v3 offset:55296
  s_waitcnt lgkmcnt(8)
  v_mfma_f32_16x16x32_bf16 v[32:35], v[24:27], v[72:75], v[32:35]
  v_mfma_f32_16x16x32_bf16 v[40:43], v[24:27], v[76:79], v[40:43]
  ds_read_b64_tr_b16 v[60:61], v4 offset:53248
  ds_read_b64_tr_b16 v[62:63], v4 offset:55296
  s_waitcnt lgkmcnt(8)
  v_mfma_f32_16x16x32_bf16 v[36:39], v[28:31], v[72:75], v[36:39]
  v_mfma_f32_16x16x32_bf16 v[44:47], v[28:31], v[76:79], v[44:47]
  s_waitcnt lgkmcnt(0)
  s_barrier
  ds_read_b64_tr_b16 v[16:17], v5
  ds_read_b64_tr_b16 v[18:19], v5 offset:2048
  v_mfma_f32_16x16x32_bf16 v[32:35], v[48:51], v[80:83], v[32:35]
  v_mfma_f32_16x16x32_bf16 v[40:43], v[48:51], v[84:87], v[40:43]
  ds_read_b64_tr_b16 v[20:21], v6
  ds_read_b64_tr_b16 v[22:23], v6 offset:2048
  s_mov_b32 m0, 0xb000
  s_add_u32 s39, s72, 0x51080
  buffer_load_dwordx4 v7, s[24:27], s39 offen lds
  buffer_load_dwordx4 v8, s[24:27], s39 offen offset:1024 lds
  v_mfma_f32_16x16x32_bf16 v[36:39], v[52:55], v[80:83], v[36:39]
  v_mfma_f32_16x16x32_bf16 v[44:47], v[52:55], v[84:87], v[44:47]
  ds_read_b64_tr_b16 v[24:25], v5 offset:4096
  ds_read_b64_tr_b16 v[26:27], v5 offset:6144
  v_mfma_f32_16x16x32_bf16 v[32:35], v[56:59], v[88:91], v[32:35]
  v_mfma_f32_16x16x32_bf16 v[40:43], v[56:59], v[92:95], v[40:43]
  ds_read_b64_tr_b16 v[28:29], v6 offset:4096
  ds_read_b64_tr_b16 v[30:31], v6 offset:6144
  v_mfma_f32_16x16x32_bf16 v[36:39], v[60:63], v[88:91], v[36:39]
  v_mfma_f32_16x16x32_bf16 v[44:47], v[60:63], v[92:95], v[44:47]
  ds_read_b64_tr_b16 v[48:49], v5 offset:8192
  ds_read_b64_tr_b16 v[50:51], v5 offset:10240
  s_waitcnt lgkmcnt(8)
  v_mfma_f32_16x16x32_bf16 v[32:35], v[16:19], v[96:99], v[32:35]
  v_mfma_f32_16x16x32_bf16 v[40:43], v[16:19], v[100:103], v[40:43]
  ds_read_b64_tr_b16 v[52:53], v6 offset:8192
  ds_read_b64_tr_b16 v[54:55], v6 offset:10240
  s_waitcnt lgkmcnt(8)
  v_mfma_f32_16x16x32_bf16 v[36:39], v[20:23], v[96:99], v[36:39]
  v_mfma_f32_16x16x32_bf16 v[44:47], v[20:23], v[100:103], v[44:47]
  ds_read_b64_tr_b16 v[56:57], v5 offset:12288
  ds_read_b64_tr_b16 v[58:59], v5 offset:14336
  s_waitcnt lgkmcnt(8)
  v_mfma_f32_16x16x32_bf16 v[32:35], v[24:27], v[104:107], v[32:35]
  v_mfma_f32_16x16x32_bf16 v[40:43], v[24:27], v[108:111], v[40:43]
  ds_read_b64_tr_b16 v[60:61], v6 offset:12288
  ds_read_b64_tr_b16 v[62:63], v6 offset:14336
  s_waitcnt lgkmcnt(8)
  v_mfma_f32_16x16x32_bf16 v[36:39], v[28:31], v[104:107], v[36:39]
  v_mfma_f32_16x16x32_bf16 v[44:47], v[28:31], v[108:111], v[44:47]
  s_waitcnt vmcnt(4)
  s_waitcnt lgkmcnt(0)
  s_barrier
  ds_read_b64_tr_b16 v[16:17], v3
  ds_read_b64_tr_b16 v[18:19], v3 offset:2048
  v_mfma_f32_16x16x32_bf16 v[32:35], v[48:51], v[112:115], v[32:35]
  v_mfma_f32_16x16x32_bf16 v[40:43], v[48:51], v[116:119], v[40:43]
  ds_read_b64_tr_b16 v[20:21], v4
  ds_read_b64_tr_b16 v[22:23], v4 offset:2048
  s_mov_b32 m0, 0x19800
  s_add_u32 s39, s72, 0x75080
  buffer_load_dwordx4 v7, s[24:27], s39 offen lds
  buffer_load_dwordx4 v8, s[24:27], s39 offen offset:1024 lds
  v_mfma_f32_16x16x32_bf16 v[36:39], v[52:55], v[112:115], v[36:39]
  v_mfma_f32_16x16x32_bf16 v[44:47], v[52:55], v[116:119], v[44:47]
  ds_read_b64_tr_b16 v[24:25], v3 offset:4096
  ds_read_b64_tr_b16 v[26:27], v3 offset:6144
  v_mfma_f32_16x16x32_bf16 v[32:35], v[56:59], v[120:123], v[32:35]
  v_mfma_f32_16x16x32_bf16 v[40:43], v[56:59], v[124:127], v[40:43]
  ds_read_b64_tr_b16 v[28:29], v4 offset:4096
  ds_read_b64_tr_b16 v[30:31], v4 offset:6144
  v_mfma_f32_16x16x32_bf16 v[36:39], v[60:63], v[120:123], v[36:39]
  v_mfma_f32_16x16x32_bf16 v[44:47], v[60:63], v[124:127], v[44:47]
  ds_read_b64_tr_b16 v[48:49], v3 offset:8192
  ds_read_b64_tr_b16 v[50:51], v3 offset:10240
  s_waitcnt lgkmcnt(8)
  v_mfma_f32_16x16x32_bf16 v[32:35], v[16:19], v[128:131], v[32:35]
  v_mfma_f32_16x16x32_bf16 v[40:43], v[16:19], v[132:135], v[40:43]
  ds_read_b64_tr_b16 v[52:53], v4 offset:8192
  ds_read_b64_tr_b16 v[54:55], v4 offset:10240
  s_waitcnt lgkmcnt(8)
  v_mfma_f32_16x16x32_bf16 v[36:39], v[20:23], v[128:131], v[36:39]
  v_mfma_f32_16x16x32_bf16 v[44:47], v[20:23], v[132:135], v[44:47]
  ds_read_b64_tr_b16 v[56:57], v3 offset:12288
  ds_read_b64_tr_b16 v[58:59], v3 offset:14336
  s_waitcnt lgkmcnt(8)
  v_mfma_f32_16x16x32_bf16 v[32:35], v[24:27], v[136:139], v[32:35]
  v_mfma_f32_16x16x32_bf16 v[40:43], v[24:27], v[140:143], v[40:43]
  ds_read_b64_tr_b16 v[60:61], v4 offset:12288
  ds_read_b64_tr_b16 v[62:63], v4 offset:14336
  s_waitcnt lgkmcnt(8)
  v_mfma_f32_16x16x32_bf16 v[36:39], v[28:31], v[136:139], v[36:39]
  v_mfma_f32_16x16x32_bf16 v[44:47], v[28:31], v[140:143], v[44:47]
  s_waitcnt vmcnt(4)
  s_waitcnt lgkmcnt(0)
  s_barrier
  ds_read_b64_tr_b16 v[16:17], v3 offset:16384
  ds_read_b64_tr_b16 v[18:19], v3 offset:18432
  v_mfma_f32_16x16x32_bf16 v[32:35], v[48:51], v[144:147], v[32:35]
  v_mfma_f32_16x16x32_bf16 v[40:43], v[48:51], v[148:151], v[40:43]
  ds_read_b64_tr_b16 v[20:21], v4 offset:16384
  ds_read_b64_tr_b16 v[22:23], v4 offset:18432
  s_mov_b32 m0, 0x1000
  s_add_u32 s39, s72, 0x9080
  buffer_load_dwordx4 v7, s[24:27], s39 offen lds
  buffer_load_dwordx4 v8, s[24:27], s39 offen offset:1024 lds
  v_mfma_f32_16x16x32_bf16 v[36:39], v[52:55], v[144:147], v[36:39]
  v_mfma_f32_16x16x32_bf16 v[44:47], v[52:55], v[148:151], v[44:47]
  ds_read_b64_tr_b16 v[24:25], v3 offset:20480
  ds_read_b64_tr_b16 v[26:27], v3 offset:22528
  v_mfma_f32_16x16x32_bf16 v[32:35], v[56:59], v[152:155], v[32:35]
  v_mfma_f32_16x16x32_bf16 v[40:43], v[56:59], v[156:159], v[40:43]
  ds_read_b64_tr_b16 v[28:29], v4 offset:20480
  ds_read_b64_tr_b16 v[30:31], v4 offset:22528
  v_mfma_f32_16x16x32_bf16 v[36:39], v[60:63], v[152:155], v[36:39]
  v_mfma_f32_16x16x32_bf16 v[44:47], v[60:63], v[156:159], v[44:47]
  ds_read_b64_tr_b16 v[48:49], v3 offset:24576
  ds_read_b64_tr_b16 v[50:51], v3 offset:26624
  s_waitcnt lgkmcnt(8)
  v_mfma_f32_16x16x32_bf16 v[32:35], v[16:19], v[160:163], v[32:35]
  v_mfma_f32_16x16x32_bf16 v[40:43], v[16:19], v[164:167], v[40:43]
  ds_read_b64_tr_b16 v[52:53], v4 offset:24576
  ds_read_b64_tr_b16 v[54:55], v4 offset:26624
  s_waitcnt lgkmcnt(8)
  v_mfma_f32_16x16x32_bf16 v[36:39], v[20:23], v[160:163], v[36:39]
  v_mfma_f32_16x16x32_bf16 v[44:47], v[20:23], v[164:167], v[44:47]
  ds_read_b64_tr_b16 v[56:57], v3 offset:28672
  ds_read_b64_tr_b16 v[58:59], v3 offset:30720
  s_waitcnt lgkmcnt(8)
  v_mfma_f32_16x16x32_bf16 v[32:35], v[24:27], v[168:171], v[32:35]
  v_mfma_f32_16x16x32_bf16 v[40:43], v[24:27], v[172:175], v[40:43]
  ds_read_b64_tr_b16 v[60:61], v4 offset:28672
  ds_read_b64_tr_b16 v[62:63], v4 offset:30720
  s_waitcnt lgkmcnt(8)
  v_mfma_f32_16x16x32_bf16 v[36:39], v[28:31], v[168:171], v[36:39]
  v_mfma_f32_16x16x32_bf16 v[44:47], v[28:31], v[172:175], v[44:47]
  s_waitcnt vmcnt(4)
  s_waitcnt lgkmcnt(0)
  s_barrier
  ds_read_b64_tr_b16 v[16:17], v3 offset:40960
  ds_read_b64_tr_b16 v[18:19], v3 offset:43008
  v_mfma_f32_16x16x32_bf16 v[32:35], v[48:51], v[176:179], v[32:35]
  v_mfma_f32_16x16x32_bf16 v[40:43], v[48:51], v[180:183], v[40:43]
  ds_read_b64_tr_b16 v[20:21], v4 offset:40960
  ds_read_b64_tr_b16 v[22:23], v4 offset:43008
  s_mov_b32 m0, 0x5000
  s_add_u32 s39, s72, 0x2d080
  buffer_load_dwordx4 v7, s[24:27], s39 offen lds
  buffer_load_dwordx4 v8, s[24:27], s39 offen offset:1024 lds
  v_mfma_f32_16x16x32_bf16 v[36:39], v[52:55], v[176:179], v[36:39]
  v_mfma_f32_16x16x32_bf16 v[44:47], v[52:55], v[180:183], v[44:47]
  ds_read_b64_tr_b16 v[24:25], v3 offset:45056
  ds_read_b64_tr_b16 v[26:27], v3 offset:47104
  v_mfma_f32_16x16x32_bf16 v[32:35], v[56:59], v[184:187], v[32:35]
  v_mfma_f32_16x16x32_bf16 v[40:43], v[56:59], v[188:191], v[40:43]
  ds_read_b64_tr_b16 v[28:29], v4 offset:45056
  ds_read_b64_tr_b16 v[30:31], v4 offset:47104
  v_mfma_f32_16x16x32_bf16 v[36:39], v[60:63], v[184:187], v[36:39]
  v_mfma_f32_16x16x32_bf16 v[44:47], v[60:63], v[188:191], v[44:47]
  s_add_u32 s72, s72, 128
  s_mov_b32 s74, 7
L_op2_loop:
  ds_read_b64_tr_b16 v[48:49], v3 offset:49152
  ds_read_b64_tr_b16 v[50:51], v3 offset:51200
  v_cvt_pk_bf16_f32 v10, v32, v33
  v_cvt_pk_bf16_f32 v11, v34, v35
  s_nop 0
  v_cvt_pk_bf16_f32 v12, v36, v37
  v_cvt_pk_bf16_f32 v13, v38, v39
  s_add_u32 s40, s73, 0x2000
  buffer_store_dwordx4 v[10:13], v2, s[20:23], s40 offen sc1
  s_waitcnt lgkmcnt(8)
  v_mfma_f32_16x16x32_bf16 v[32:35], v[16:19], v[64:67], 0
  v_cvt_pk_bf16_f32 v10, v40, v41
  v_cvt_pk_bf16_f32 v11, v42, v43
  v_cvt_pk_bf16_f32 v12, v44, v45
  v_cvt_pk_bf16_f32 v13, v46, v47
  s_add_u32 s40, s73, 0x2800
  buffer_store_dwordx4 v[10:13], v2, s[20:23], s40 offen sc1
  v_mfma_f32_16x16x32_bf16 v[40:43], v[16:19], v[68:71], 0
  ds_read_b64_tr_b16 v[52:53], v4 offset:49152
  ds_read_b64_tr_b16 v[54:55], v4 offset:51200
  s_waitcnt lgkmcnt(6)
  v_mfma_f32_16x16x32_bf16 v[36:39], v[20:23], v[64:67], 0
  v_mfma_f32_16x16x32_bf16 v[44:47], v[20:23], v[68:71], 0
  ds_read_b64_tr_b16 v[56:57], v3 offset:53248
  ds_read_b64_tr_b16 v[58:59], v3 offset:55296
  v_mfma_f32_16x16x32_bf16 v[32:35], v[24:27], v[72:75], v[32:35]
  v_mfma_f32_16x16x32_bf16 v[40:43], v[24:27], v[76:79], v[40:43]
  ds_read_b64_tr_b16 v[60:61], v4 offset:53248
  ds_read_b64_tr_b16 v[62:63], v4 offset:55296
  s_waitcnt lgkmcnt(7)
  v_mfma_f32_16x16x32_bf16 v[36:39], v[28:31], v[72:75], v[36:39]
  v_mfma_f32_16x16x32_bf16 v[44:47], v[28:31], v[76:79], v[44:47]
  s_waitcnt vmcnt(6)
  s_waitcnt lgkmcnt(0)
  s_barrier
  ds_read_b64_tr_b16 v[16:17], v5
  ds_read_b64_tr_b16 v[18:19], v5 offset:2048
  v_mfma_f32_16x16x32_bf16 v[32:35], v[48:51], v[80:83], v[32:35]
  v_mfma_f32_16x16x32_bf16 v[40:43], v[48:51], v[84:87], v[40:43]
  ds_read_b64_tr_b16 v[20:21], v6
  ds_read_b64_tr_b16 v[22:23], v6 offset:2048
  s_mov_b32 m0, 0xb000
  s_add_u32 s39, s72, 0x51080
  buffer_load_dwordx4 v7, s[24:27], s39 offen lds
  buffer_load_dwordx4 v8, s[24:27], s39 offen offset:1024 lds
  v_mfma_f32_16x16x32_bf16 v[36:39], v[52:55], v[80:83], v[36:39]
  v_mfma_f32_16x16x32_bf16 v[44:47], v[52:55], v[84:87], v[44:47]
  ds_read_b64_tr_b16 v[24:25], v5 offset:4096
  ds_read_b64_tr_b16 v[26:27], v5 offset:6144
  v_mfma_f32_16x16x32_bf16 v[32:35], v[56:59], v[88:91], v[32:35]
  v_mfma_f32_16x16x32_bf16 v[40:43], v[56:59], v[92:95], v[40:43]
  ds_read_b64_tr_b16 v[28:29], v6 offset:4096
  ds_read_b64_tr_b16 v[30:31], v6 offset:6144
  v_mfma_f32_16x16x32_bf16 v[36:39], v[60:63], v[88:91], v[36:39]
  v_mfma_f32_16x16x32_bf16 v[44:47], v[60:63], v[92:95], v[44:47]
  ds_read_b64_tr_b16 v[48:49], v5 offset:8192
  ds_read_b64_tr_b16 v[50:51], v5 offset:10240
  s_waitcnt lgkmcnt(8)
  v_mfma_f32_16x16x32_bf16 v[32:35], v[16:19], v[96:99], v[32:35]
  v_mfma_f32_16x16x32_bf16 v[40:43], v[16:19], v[100:103], v[40:43]
  ds_read_b64_tr_b16 v[52:53], v6 offset:8192
  ds_read_b64_tr_b16 v[54:55], v6 offset:10240
  s_waitcnt lgkmcnt(8)
  v_mfma_f32_16x16x32_bf16 v[36:39], v[20:23], v[96:99], v[36:39]
  v_mfma_f32_16x16x32_bf16 v[44:47], v[20:23], v[100:103], v[44:47]
  ds_read_b64_tr_b16 v[56:57], v5 offset:12288
  ds_read_b64_tr_b16 v[58:59], v5 offset:14336
  s_waitcnt lgkmcnt(8)
  v_mfma_f32_16x16x32_bf16 v[32:35], v[24:27], v[104:107], v[32:35]
  v_mfma_f32_16x16x32_bf16 v[40:43], v[24:27], v[108:111], v[40:43]
  ds_read_b64_tr_b16 v[60:61], v6 offset:12288
  ds_read_b64_tr_b16 v[62:63], v6 offset:14336
  s_waitcnt lgkmcnt(8)
  v_mfma_f32_16x16x32_bf16 v[36:39], v[28:31], v[104:107], v[36:39]
  v_mfma_f32_16x16x32_bf16 v[44:47], v[28:31], v[108:111], v[44:47]
  s_waitcnt vmcnt(6)
  s_waitcnt lgkmcnt(0)
  s_barrier
  ds_read_b64_tr_b16 v[16:17], v3
  ds_read_b64_tr_b16 v[18:19], v3 offset:2048
  v_mfma_f32_16x16x32_bf16 v[32:35], v[48:51], v[112:115], v[32:35]
  v_mfma_f32_16x16x32_bf16 v[40:43], v[48:51], v[116:119], v[40:43]
  ds_read_b64_tr_b16 v[20:21], v4
  ds_read_b64_tr_b16 v[22:23], v4 offset:2048
  s_mov_b32 m0, 0x19800
  s_add_u32 s39, s72, 0x75080
  buffer_load_dwordx4 v7, s[24:27], s39 offen lds
  buffer_load_dwordx4 v8, s[24:27], s39 offen offset:1024 lds
  v_mfma_f32_16x16x32_bf16 v[36:39], v[52:55], v[112:115], v[36:39]
  v_mfma_f32_16x16x32_bf16 v[44:47], v[52:55], v[116:119], v[44:47]
  ds_read_b64_tr_b16 v[24:25], v3 offset:4096
  ds_read_b64_tr_b16 v[26:27], v3 offset:6144
  v_mfma_f32_16x16x32_bf16 v[32:35], v[56:59], v[120:123], v[32:35]
  v_mfma_f32_16x16x32_bf16 v[40:43], v[56:59], v[124:127], v[40:43]
  ds_read_b64_tr_b16 v[28:29], v4 offset:4096
  ds_read_b64_tr_b16 v[30:31], v4 offset:6144
  v_mfma_f32_16x16x32_bf16 v[36:39], v[60:63], v[120:123], v[36:39]
  v_mfma_f32_16x16x32_bf16 v[44:47], v[60:63], v[124:127], v[44:47]
  ds_read_b64_tr_b16 v[48:49], v3 offset:8192
  ds_read_b64_tr_b16 v[50:51], v3 offset:10240
  s_waitcnt lgkmcnt(8)
  v_mfma_f32_16x16x32_bf16 v[32:35], v[16:19], v[128:131], v[32:35]
  v_mfma_f32_16x16x32_bf16 v[40:43], v[16:19], v[132:135], v[40:43]
  ds_read_b64_tr_b16 v[52:53], v4 offset:8192
  ds_read_b64_tr_b16 v[54:55], v4 offset:10240
  s_waitcnt lgkmcnt(8)
  v_mfma_f32_16x16x32_bf16 v[36:39], v[20:23], v[128:131], v[36:39]
  v_mfma_f32_16x16x32_bf16 v[44:47], v[20:23], v[132:135], v[44:47]
  ds_read_b64_tr_b16 v[56:57], v3 offset:12288
  ds_read_b64_tr_b16 v[58:59], v3 offset:14336
  s_waitcnt lgkmcnt(8)
  v_mfma_f32_16x16x32_bf16 v[32:35], v[24:27], v[136:139], v[32:35]
  v_mfma_f32_16x16x32_bf16 v[40:43], v[24:27], v[140:143], v[40:43]
  ds_read_b64_tr_b16 v[60:61], v4 offset:12288
  ds_read_b64_tr_b16 v[62:63], v4 offset:14336
  s_waitcnt lgkmcnt(8)
  v_mfma_f32_16x16x32_bf16 v[36:39], v[28:31], v[136:139], v[36:39]
  v_mfma_f32_16x16x32_bf16 v[44:47], v[28:31], v[140:143], v[44:47]
  s_waitcnt vmcnt(6)
  s_waitcnt lgkmcnt(0)
  s_barrier
  ds_read_b64_tr_b16 v[16:17], v3 offset:16384
  ds_read_b64_tr_b16 v[18:19], v3 offset:18432
  v_mfma_f32_16x16x32_bf16 v[32:35], v[48:51], v[144:147], v[32:35]
  v_mfma_f32_16x16x32_bf16 v[40:43], v[48:51], v[148:151], v[40:43]
  ds_read_b64_tr_b16 v[20:21], v4 offset:16384
  ds_read_b64_tr_b16 v[22:23], v4 offset:18432
  s_mov_b32 m0, 0x1000
  s_add_u32 s39, s72, 0x9080
  buffer_load_dwordx4 v7, s[24:27], s39 offen lds
  buffer_load_dwordx4 v8, s[24:27], s39 offen offset:1024 lds
  v_mfma_f32_16x16x32_bf16 v[36:39], v[52:55], v[144:147], v[36:39]
  v_mfma_f32_16x16x32_bf16 v[44:47], v[52:55], v[148:151], v[44:47]
  ds_read_b64_tr_b16 v[24:25], v3 offset:20480
  ds_read_b64_tr_b16 v[26:27], v3 offset:22528
  v_mfma_f32_16x16x32_bf16 v[32:35], v[56:59], v[152:155], v[32:35]
  v_mfma_f32_16x16x32_bf16 v[40:43], v[56:59], v[156:159], v[40:43]
  ds_read_b64_tr_b16 v[28:29], v4 offset:20480
  ds_read_b64_tr_b16 v[30:31], v4 offset:22528
  v_mfma_f32_16x16x32_bf16 v[36:39], v[60:63], v[152:155], v[36:39]
  v_mfma_f32_16x16x32_bf16 v[44:47], v[60:63], v[156:159], v[44:47]
  ds_read_b64_tr_b16 v[48:49], v3 offset:24576
  ds_read_b64_tr_b16 v[50:51], v3 offset:26624
  s_waitcnt lgkmcnt(8)
  v_mfma_f32_16x16x32_bf16 v[32:35], v[16:19], v[160:163], v[32:35]
  v_mfma_f32_16x16x32_bf16 v[40:43], v[16:19], v[164:167], v[40:43]
  ds_read_b64_tr_b16 v[52:53], v4 offset:24576
  ds_read_b64_tr_b16 v[54:55], v4 offset:26624
  s_waitcnt lgkmcnt(8)
  v_mfma_f32_16x16x32_bf16 v[36:39], v[20:23], v[160:163], v[36:39]
  v_mfma_f32_16x16x32_bf16 v[44:47], v[20:23], v[164:167], v[44:47]
  ds_read_b64_tr_b16 v[56:57], v3 offset:28672
  ds_read_b64_tr_b16 v[58:59], v3 offset:30720
  s_waitcnt lgkmcnt(8)
  v_mfma_f32_16x16x32_bf16 v[32:35], v[24:27], v[168:171], v[32:35]
  v_mfma_f32_16x16x32_bf16 v[40:43], v[24:27], v[172:175], v[40:43]
  ds_read_b64_tr_b16 v[60:61], v4 offset:28672
  ds_read_b64_tr_b16 v[62:63], v4 offset:30720
  s_waitcnt lgkmcnt(8)
  v_mfma_f32_16x16x32_bf16 v[36:39], v[28:31], v[168:171], v[36:39]
  v_mfma_f32_16x16x32_bf16 v[44:47], v[28:31], v[172:175], v[44:47]
  s_waitcnt vmcnt(4)
  s_waitcnt lgkmcnt(0)
  s_barrier
  ds_read_b64_tr_b16 v[16:17], v3 offset:40960
  ds_read_b64_tr_b16 v[18:19], v3 offset:43008
  v_mfma_f32_16x16x32_bf16 v[32:35], v[48:51], v[176:179], v[32:35]
  v_mfma_f32_16x16x32_bf16 v[40:43], v[48:51], v[180:183], v[40:43]
  ds_read_b64_tr_b16 v[20:21], v4 offset:40960
  ds_read_b64_tr_b16 v[22:23], v4 offset:43008
  s_mov_b32 m0, 0x5000
  s_add_u32 s39, s72, 0x2d080
  buffer_load_dwordx4 v7, s[24:27], s39 offen lds
  buffer_load_dwordx4 v8, s[24:27], s39 offen offset:1024 lds
  v_mfma_f32_16x16x32_bf16 v[36:39], v[52:55], v[176:179], v[36:39]
  v_mfma_f32_16x16x32_bf16 v[44:47], v[52:55], v[180:183], v[44:47]
  ds_read_b64_tr_b16 v[24:25], v3 offset:45056
  ds_read_b64_tr_b16 v[26:27], v3 offset:47104
  v_mfma_f32_16x16x32_bf16 v[32:35], v[56:59], v[184:187], v[32:35]
  v_mfma_f32_16x16x32_bf16 v[40:43], v[56:59], v[188:191], v[40:43]
  ds_read_b64_tr_b16 v[28:29], v4 offset:45056
  ds_read_b64_tr_b16 v[30:31], v4 offset:47104
  v_mfma_f32_16x16x32_bf16 v[36:39], v[60:63], v[184:187], v[36:39]
  v_mfma_f32_16x16x32_bf16 v[44:47], v[60:63], v[188:191], v[44:47]
  s_add_u32 s72, s72, 128
  s_add_u32 s73, s73, 0x4800
  s_add_u32 s78, s78, 1
  s_sub_u32 s74, s74, 1
  s_cmp_lg_u32 s74, 0
  s_cbranch_scc1 L_op2_loop
  ds_read_b64_tr_b16 v[48:49], v3 offset:49152
  ds_read_b64_tr_b16 v[50:51], v3 offset:51200
  v_cvt_pk_bf16_f32 v10, v32, v33
  v_cvt_pk_bf16_f32 v11, v34, v35
  v_cvt_pk_bf16_f32 v12, v36, v37
  v_cvt_pk_bf16_f32 v13, v38, v39
  s_add_u32 s40, s73, 0x2000
  buffer_store_dwordx4 v[10:13], v2, s[20:23], s40 offen sc1
  s_waitcnt lgkmcnt(6)
  v_mfma_f32_16x16x32_bf16 v[32:35], v[16:19], v[64:67], 0
  v_cvt_pk_bf16_f32 v10, v40, v41
  v_cvt_pk_bf16_f32 v11, v42, v43
  v_cvt_pk_bf16_f32 v12, v44, v45
  v_cvt_pk_bf16_f32 v13, v46, v47
  s_add_u32 s40, s73, 0x2800
  buffer_store_dwordx4 v[10:13], v2, s[20:23], s40 offen sc1
  v_mfma_f32_16x16x32_bf16 v[40:43], v[16:19], v[68:71], 0
  ds_read_b64_tr_b16 v[52:53], v4 offset:49152
  ds_read_b64_tr_b16 v[54:55], v4 offset:51200
  v_mfma_f32_16x16x32_bf16 v[36:39], v[20:23], v[64:67], 0
  v_mfma_f32_16x16x32_bf16 v[44:47], v[20:23], v[68:71], 0
  ds_read_b64_tr_b16 v[56:57], v3 offset:53248
  ds_read_b64_tr_b16 v[58:59], v3 offset:55296
  s_waitcnt lgkmcnt(6)
  v_mfma_f32_16x16x32_bf16 v[32:35], v[24:27], v[72:75], v[32:35]
  v_mfma_f32_16x16x32_bf16 v[40:43], v[24:27], v[76:79], v[40:43]
  ds_read_b64_tr_b16 v[60:61], v4 offset:53248
  ds_read_b64_tr_b16 v[62:63], v4 offset:55296
  v_mfma_f32_16x16x32_bf16 v[36:39], v[28:31], v[72:75], v[36:39]
  v_mfma_f32_16x16x32_bf16 v[44:47], v[28:31], v[76:79], v[44:47]
  s_waitcnt vmcnt(6)
  s_waitcnt lgkmcnt(0)
  s_barrier
  ds_read_b64_tr_b16 v[16:17], v5
  ds_read_b64_tr_b16 v[18:19], v5 offset:2048
  v_mfma_f32_16x16x32_bf16 v[32:35], v[48:51], v[80:83], v[32:35]
  v_mfma_f32_16x16x32_bf16 v[40:43], v[48:51], v[84:87], v[40:43]
  ds_read_b64_tr_b16 v[20:21], v6
  ds_read_b64_tr_b16 v[22:23], v6 offset:2048
  v_mfma_f32_16x16x32_bf16 v[36:39], v[52:55], v[80:83], v[36:39]
  v_mfma_f32_16x16x32_bf16 v[44:47], v[52:55], v[84:87], v[44:47]
  ds_read_b64_tr_b16 v[24:25], v5 offset:4096
  ds_read_b64_tr_b16 v[26:27], v5 offset:6144
  v_mfma_f32_16x16x32_bf16 v[32:35], v[56:59], v[88:91], v[32:35]
  v_mfma_f32_16x16x32_bf16 v[40:43], v[56:59], v[92:95], v[40:43]
  ds_read_b64_tr_b16 v[28:29], v6 offset:4096
  ds_read_b64_tr_b16 v[30:31], v6 offset:6144
  v_mfma_f32_16x16x32_bf16 v[36:39], v[60:63], v[88:91], v[36:39]
  v_mfma_f32_16x16x32_bf16 v[44:47], v[60:63], v[92:95], v[44:47]
  ds_read_b64_tr_b16 v[48:49], v5 offset:8192
  ds_read_b64_tr_b16 v[50:51], v5 offset:10240
  s_waitcnt lgkmcnt(8)
  v_mfma_f32_16x16x32_bf16 v[32:35], v[16:19], v[96:99], v[32:35]
  v_mfma_f32_16x16x32_bf16 v[40:43], v[16:19], v[100:103], v[40:43]
  ds_read_b64_tr_b16 v[52:53], v6 offset:8192
  ds_read_b64_tr_b16 v[54:55], v6 offset:10240
  s_waitcnt lgkmcnt(8)
  v_mfma_f32_16x16x32_bf16 v[36:39], v[20:23], v[96:99], v[36:39]
  v_mfma_f32_16x16x32_bf16 v[44:47], v[20:23], v[100:103], v[44:47]
  ds_read_b64_tr_b16 v[56:57], v5 offset:12288
  ds_read_b64_tr_b16 v[58:59], v5 offset:14336
  s_waitcnt lgkmcnt(8)
  v_mfma_f32_16x16x32_bf16 v[32:35], v[24:27], v[104:107], v[32:35]
  v_mfma_f32_16x16x32_bf16 v[40:43], v[24:27], v[108:111], v[40:43]
  ds_read_b64_tr_b16 v[60:61], v6 offset:12288
  ds_read_b64_tr_b16 v[62:63], v6 offset:14336
  s_waitcnt lgkmcnt(8)
  v_mfma_f32_16x16x32_bf16 v[36:39], v[28:31], v[104:107], v[36:39]
  v_mfma_f32_16x16x32_bf16 v[44:47], v[28:31], v[108:111], v[44:47]
  s_waitcnt vmcnt(4)
  s_waitcnt lgkmcnt(0)
  s_barrier
  ds_read_b64_tr_b16 v[16:17], v3
  ds_read_b64_tr_b16 v[18:19], v3 offset:2048
  v_mfma_f32_16x16x32_bf16 v[32:35], v[48:51], v[112:115], v[32:35]
  v_mfma_f32_16x16x32_bf16 v[40:43], v[48:51], v[116:119], v[40:43]
  ds_read_b64_tr_b16 v[20:21], v4
  ds_read_b64_tr_b16 v[22:23], v4 offset:2048
  v_mfma_f32_16x16x32_bf16 v[36:39], v[52:55], v[112:115], v[36:39]
  v_mfma_f32_16x16x32_bf16 v[44:47], v[52:55], v[116:119], v[44:47]
  ds_read_b64_tr_b16 v[24:25], v3 offset:4096
  ds_read_b64_tr_b16 v[26:27], v3 offset:6144
  v_mfma_f32_16x16x32_bf16 v[32:35], v[56:59], v[120:123], v[32:35]
  v_mfma_f32_16x16x32_bf16 v[40:43], v[56:59], v[124:127], v[40:43]
  ds_read_b64_tr_b16 v[28:29], v4 offset:4096
  ds_read_b64_tr_b16 v[30:31], v4 offset:6144
  v_mfma_f32_16x16x32_bf16 v[36:39], v[60:63], v[120:123], v[36:39]
  v_mfma_f32_16x16x32_bf16 v[44:47], v[60:63], v[124:127], v[44:47]
  ds_read_b64_tr_b16 v[48:49], v3 offset:8192
  ds_read_b64_tr_b16 v[50:51], v3 offset:10240
  s_waitcnt lgkmcnt(8)
  v_mfma_f32_16x16x32_bf16 v[32:35], v[16:19], v[128:131], v[32:35]
  v_mfma_f32_16x16x32_bf16 v[40:43], v[16:19], v[132:135], v[40:43]
  ds_read_b64_tr_b16 v[52:53], v4 offset:8192
  ds_read_b64_tr_b16 v[54:55], v4 offset:10240
  s_waitcnt lgkmcnt(8)
  v_mfma_f32_16x16x32_bf16 v[36:39], v[20:23], v[128:131], v[36:39]
  v_mfma_f32_16x16x32_bf16 v[44:47], v[20:23], v[132:135], v[44:47]
  ds_read_b64_tr_b16 v[56:57], v3 offset:12288
  ds_read_b64_tr_b16 v[58:59], v3 offset:14336
  s_waitcnt lgkmcnt(8)
  v_mfma_f32_16x16x32_bf16 v[32:35], v[24:27], v[136:139], v[32:35]
  v_mfma_f32_16x16x32_bf16 v[40:43], v[24:27], v[140:143], v[40:43]
  ds_read_b64_tr_b16 v[60:61], v4 offset:12288
  ds_read_b64_tr_b16 v[62:63], v4 offset:14336
  s_waitcnt lgkmcnt(8)
  v_mfma_f32_16x16x32_bf16 v[36:39], v[28:31], v[136:139], v[36:39]
  v_mfma_f32_16x16x32_bf16 v[44:47], v[28:31], v[140:143], v[44:47]
  s_waitcnt vmcnt(0)
  s_waitcnt lgkmcnt(0)
  s_barrier
  ds_read_b64_tr_b16 v[16:17], v3 offset:16384
  ds_read_b64_tr_b16 v[18:19], v3 offset:18432
  v_mfma_f32_16x16x32_bf16 v[32:35], v[48:51], v[144:147], v[32:35]
  v_mfma_f32_16x16x32_bf16 v[40:43], v[48:51], v[148:151], v[40:43]
  ds_read_b64_tr_b16 v[20:21], v4 offset:16384
  ds_read_b64_tr_b16 v[22:23], v4 offset:18432
  v_mfma_f32_16x16x32_bf16 v[36:39], v[52:55], v[144:147], v[36:39]
  v_mfma_f32_16x16x32_bf16 v[44:47], v[52:55], v[148:151], v[44:47]
  ds_read_b64_tr_b16 v[24:25], v3 offset:20480
  ds_read_b64_tr_b16 v[26:27], v3 offset:22528
  v_mfma_f32_16x16x32_bf16 v[32:35], v[56:59], v[152:155], v[32:35]
  v_mfma_f32_16x16x32_bf16 v[40:43], v[56:59], v[156:159], v[40:43]
  ds_read_b64_tr_b16 v[28:29], v4 offset:20480
  ds_read_b64_tr_b16 v[30:31], v4 offset:22528
  v_mfma_f32_16x16x32_bf16 v[36:39], v[60:63], v[152:155], v[36:39]
  v_mfma_f32_16x16x32_bf16 v[44:47], v[60:63], v[156:159], v[44:47]
  ds_read_b64_tr_b16 v[48:49], v3 offset:24576
  ds_read_b64_tr_b16 v[50:51], v3 offset:26624
  s_waitcnt lgkmcnt(8)
  v_mfma_f32_16x16x32_bf16 v[32:35], v[16:19], v[160:163], v[32:35]
  v_mfma_f32_16x16x32_bf16 v[40:43], v[16:19], v[164:167], v[40:43]
  ds_read_b64_tr_b16 v[52:53], v4 offset:24576
  ds_read_b64_tr_b16 v[54:55], v4 offset:26624
  s_waitcnt lgkmcnt(8)
  v_mfma_f32_16x16x32_bf16 v[36:39], v[20:23], v[160:163], v[36:39]
  v_mfma_f32_16x16x32_bf16 v[44:47], v[20:23], v[164:167], v[44:47]
  ds_read_b64_tr_b16 v[56:57], v3 offset:28672
  ds_read_b64_tr_b16 v[58:59], v3 offset:30720
  s_waitcnt lgkmcnt(8)
  v_mfma_f32_16x16x32_bf16 v[32:35], v[24:27], v[168:171], v[32:35]
  v_mfma_f32_16x16x32_bf16 v[40:43], v[24:27], v[172:175], v[40:43]
  ds_read_b64_tr_b16 v[60:61], v4 offset:28672
  ds_read_b64_tr_b16 v[62:63], v4 offset:30720
  s_waitcnt lgkmcnt(8)
  v_mfma_f32_16x16x32_bf16 v[36:39], v[28:31], v[168:171], v[36:39]
  v_mfma_f32_16x16x32_bf16 v[44:47], v[28:31], v[172:175], v[44:47]
  s_waitcnt lgkmcnt(6)
  v_mfma_f32_16x16x32_bf16 v[32:35], v[48:51], v[176:179], v[32:35]
  v_mfma_f32_16x16x32_bf16 v[40:43], v[48:51], v[180:183], v[40:43]
  s_waitcnt lgkmcnt(4)
  v_mfma_f32_16x16x32_bf16 v[36:39], v[52:55], v[176:179], v[36:39]
  v_mfma_f32_16x16x32_bf16 v[44:47], v[52:55], v[180:183], v[44:47]
  s_waitcnt lgkmcnt(2)
  v_mfma_f32_16x16x32_bf16 v[32:35], v[56:59], v[184:187], v[32:35]
  v_mfma_f32_16x16x32_bf16 v[40:43], v[56:59], v[188:191], v[40:43]
  s_waitcnt lgkmcnt(0)
  v_mfma_f32_16x16x32_bf16 v[36:39], v[60:63], v[184:187], v[36:39]
  v_mfma_f32_16x16x32_bf16 v[44:47], v[60:63], v[188:191], v[44:47]
  s_nop 3
  v_cvt_pk_bf16_f32 v10, v32, v33
  v_cvt_pk_bf16_f32 v11, v34, v35
  s_nop 0
  v_cvt_pk_bf16_f32 v12, v36, v37
  v_cvt_pk_bf16_f32 v13, v38, v39
  s_add_u32 s40, s73, 0x6800
  buffer_store_dwordx4 v[10:13], v2, s[20:23], s40 offen sc1
  s_nop 1
  v_cvt_pk_bf16_f32 v10, v40, v41
  v_cvt_pk_bf16_f32 v11, v42, v43
  v_cvt_pk_bf16_f32 v12, v44, v45
  v_cvt_pk_bf16_f32 v13, v46, v47
  s_add_u32 s40, s73, 0x7000
  buffer_store_dwordx4 v[10:13], v2, s[20:23], s40 offen sc1
  s_lshl_b32 s41, s33, 8
  s_add_u32 s41, s41, 0x4000000
  v_mov_b32 v238, s41
  v_and_b32 v239, 15, v0
  v_mul_u32_u24 v239, 2304, v239
  v_lshrrev_b32 v232, 4, v0
  v_lshl_add_u32 v239, v232, 4, v239
  buffer_load_dwordx2 v[236:237], v238, s[20:23], 0 offen sc1
  s_waitcnt vmcnt(0)
  s_barrier
  s_branch L_tail
L_p2_3:
  v_lshlrev_b32 v2, 4, v0
  v_lshrrev_b32 v14, 2, v0
  v_bfe_u32 v15, v0, 3, 2
  v_lshlrev_b32 v14, 7, v14
  v_and_b32 v9, 3, v0
  v_lshl_add_u32 v14, v9, 3, v14
  v_xor_b32 v9, 0, v15
  v_lshl_add_u32 v3, v9, 5, v14
  v_add_u32 v5, 100352, v3
  v_xor_b32 v9, 1, v15
  v_lshl_add_u32 v4, v9, 5, v14
  v_add_u32 v6, 100352, v4
  v_lshrrev_b32 v14, 4, v0
  v_lshlrev_b32 v14, 1, v14
  v_xor_b32 v14, v14, v0
  v_and_b32 v14, 7, v14
  v_lshlrev_b32 v14, 4, v14
  v_lshrrev_b32 v15, 3, v0
  v_mul_u32_u24 v15, 1152, v15
  v_add_u32 v7, v14, v15
  v_add_u32 v8, 8192, v7
  v_add_u32 v9, 59392, v2
  s_mul_i32 s72, s57, 147456
  s_lshl_b32 s73, s33, 3
  s_add_u32 s73, s73, s34
  s_mul_i32 s73, s73, 165888
  s_add_u32 s73, s73, 0x5000000
  s_lshl_b32 s75, s33, 5
  s_add_u32 s75, s75, s34
  s_mul_i32 s75, s75, 36864
  s_waitcnt lgkmcnt(0)
  ds_read_b128 v[160:163], v2 offset:16384
  ds_read_b128 v[164:167], v2 offset:20480
  ds_read_b128 v[168:171], v2 offset:24576
  ds_read_b128 v[172:175], v2 offset:17408
  ds_read_b128 v[176:179], v2 offset:21504
  ds_read_b128 v[180:183], v2 offset:25600
  ds_read_b128 v[184:187], v2 offset:18432
  ds_read_b128 v[188:191], v2 offset:22528
  ds_read_b128 v[192:195], v2 offset:26624
  ds_read_b128 v[196:199], v2 offset:19456
  ds_read_b128 v[200:203], v2 offset:23552
  ds_read_b128 v[204:207], v2 offset:27648
  ds_read_b128 v[208:211], v2 offset:28672
  ds_read_b128 v[212:215], v2 offset:32768
  ds_read_b128 v[216:219], v2 offset:36864
  s_waitcnt lgkmcnt(14)
  ds_read_b128 v[220:223], v2 offset:29696
  s_waitcnt lgkmcnt(14)
  ds_read_b128 v[224:227], v2 offset:33792
  s_waitcnt lgkmcnt(14)
  ds_read_b128 v[228:231], v2 offset:37888
  s_waitcnt lgkmcnt(14)
  ds_read_b128 v[232:235], v2 offset:30720
  s_waitcnt lgkmcnt(14)
  ds_read_b128 v[236:239], v2 offset:34816
  s_waitcnt lgkmcnt(14)
  ds_read_b128 v[240:243], v2 offset:38912
  s_waitcnt lgkmcnt(14)
  ds_read_b128 v[244:247], v2 offset:31744
  s_waitcnt lgkmcnt(14)
  ds_read_b128 v[248:251], v2 offset:35840
  s_waitcnt lgkmcnt(14)
  ds_read_b128 v[252:255], v2 offset:39936
  v_add_u32 v14, 124928, v2
  s_waitcnt lgkmcnt(14)
  ds_read_b128 v[64:67], v14 offset:24576
  s_waitcnt lgkmcnt(14)
  ds_read_b128 v[68:71], v14 offset:28672
  s_waitcnt lgkmcnt(14)
  ds_read_b128 v[72:75], v14 offset:32768
  s_waitcnt lgkmcnt(14)
  ds_read_b128 v[76:79], v14 offset:25600
  s_waitcnt lgkmcnt(13)
  ds_read_b128 v[80:83], v14 offset:29696
  ds_read_b128 v[84:87], v14 offset:33792
  s_waitcnt lgkmcnt(14)
  ds_read_b128 v[88:91], v14 offset:26624
  s_waitcnt lgkmcnt(14)
  ds_read_b128 v[92:95], v14 offset:30720
  s_waitcnt lgkmcnt(14)
  ds_read_b128 v[96:99], v14 offset:34816
  s_waitcnt lgkmcnt(14)
  ds_read_b128 v[100:103], v14 offset:27648
  s_waitcnt lgkmcnt(14)
  ds_read_b128 v[104:107], v14 offset:31744
  s_waitcnt lgkmcnt(14)
  ds_read_b128 v[108:111], v14 offset:35840
  s_waitcnt lgkmcnt(0)
  s_barrier
  ds_read_b128 v[112:115], v9 offset:24576
  ds_read_b128 v[116:119], v9 offset:28672
  ds_read_b128 v[120:123], v9 offset:32768
  ds_read_b128 v[124:127], v9 offset:25600
  ds_read_b128 v[128:131], v9 offset:29696
  ds_read_b128 v[132:135], v9 offset:33792
  ds_read_b128 v[136:139], v9 offset:26624
  ds_read_b128 v[140:143], v9 offset:30720
  ds_read_b128 v[144:147], v9 offset:34816
  ds_read_b128 v[148:151], v9 offset:27648
  ds_read_b128 v[152:155], v9 offset:31744
  ds_read_b128 v[156:159], v9 offset:35840
  s_mov_b32 m0, 0x1800
  s_add_u32 s39, s72, 0xd800
  buffer_load_dwordx4 v7, s[24:27], s39 offen lds
  buffer_load_dwordx4 v8, s[24:27], s39 offen offset:1024 lds
  s_mov_b32 m0, 0x5800
  s_add_u32 s39, s72, 0x31800
  buffer_load_dwordx4 v7, s[24:27], s39 offen lds
  buffer_load_dwordx4 v8, s[24:27], s39 offen offset:1024 lds
  ds_read_b64_tr_b16 v[16:17], v3 offset:40960
  ds_read_b64_tr_b16 v[18:19], v3 offset:43008
  ds_read_b64_tr_b16 v[20:21], v4 offset:40960
  s_waitcnt lgkmcnt(14)
  ds_read_b64_tr_b16 v[22:23], v4 offset:43008
  s_waitcnt lgkmcnt(14)
  ds_read_b64_tr_b16 v[24:25], v3 offset:45056
  s_waitcnt lgkmcnt(14)
  ds_read_b64_tr_b16 v[26:27], v3 offset:47104
  s_waitcnt lgkmcnt(14)
  ds_read_b64_tr_b16 v[28:29], v4 offset:45056
  s_waitcnt lgkmcnt(14)
  ds_read_b64_tr_b16 v[30:31], v4 offset:47104
  s_setprio 1
  s_add_u32 s76, s34, 16
  s_mov_b32 s77, 0
  s_mov_b32 s78, 0
  s_mov_b32 s80, 0x7ff00000
  s_waitcnt lgkmcnt(9)
  ds_read_b64_tr_b16 v[56:57], v3 offset:49152
  ds_read_b64_tr_b16 v[58:59], v3 offset:51200
  s_waitcnt lgkmcnt(8)
  v_mfma_f32_16x16x32_bf16 v[32:35], v[16:19], v[64:67], 0
  v_mfma_f32_16x16x32_bf16 v[40:43], v[16:19], v[68:71], 0
  v_mfma_f32_16x16x32_bf16 v[48:51], v[16:19], v[72:75], 0
  ds_read_b64_tr_b16 v[16:17], v4 offset:49152
  ds_read_b64_tr_b16 v[18:19], v4 offset:51200
  s_waitcnt lgkmcnt(8)
  v_mfma_f32_16x16x32_bf16 v[36:39], v[20:23], v[64:67], 0
  v_mfma_f32_16x16x32_bf16 v[44:47], v[20:23], v[68:71], 0
  v_mfma_f32_16x16x32_bf16 v[52:55], v[20:23], v[72:75], 0
  ds_read_b64_tr_b16 v[20:21], v3 offset:53248
  ds_read_b64_tr_b16 v[22:23], v3 offset:55296
  s_waitcnt lgkmcnt(8)
  v_mfma_f32_16x16x32_bf16 v[32:35], v[24:27], v[76:79], v[32:35]
  v_mfma_f32_16x16x32_bf16 v[40:43], v[24:27], v[80:83], v[40:43]
  v_mfma_f32_16x16x32_bf16 v[48:51], v[24:27], v[84:87], v[48:51]
  ds_read_b64_tr_b16 v[24:25], v4 offset:53248
  ds_read_b64_tr_b16 v[26:27], v4 offset:55296
  s_waitcnt lgkmcnt(8)
  v_mfma_f32_16x16x32_bf16 v[36:39], v[28:31], v[76:79], v[36:39]
  v_mfma_f32_16x16x32_bf16 v[44:47], v[28:31], v[80:83], v[44:47]
  v_mfma_f32_16x16x32_bf16 v[52:55], v[28:31], v[84:87], v[52:55]
  s_waitcnt lgkmcnt(0)
  s_barrier
  ds_read_b64_tr_b16 v[28:29], v5
  ds_read_b64_tr_b16 v[30:31], v5 offset:2048
  v_mfma_f32_16x16x32_bf16 v[32:35], v[56:59], v[88:91], v[32:35]
  v_mfma_f32_16x16x32_bf16 v[40:43], v[56:59], v[92:95], v[40:43]
  s_mov_b32 m0, 0xb800
  s_add_u32 s39, s72, 0x55880
  buffer_load_dwordx4 v7, s[24:27], s39 offen lds
  buffer_load_dwordx4 v8, s[24:27], s39 offen offset:1024 lds
  v_mfma_f32_16x16x32_bf16 v[48:51], v[56:59], v[96:99], v[48:51]
  ds_read_b64_tr_b16 v[56:57], v6
  ds_read_b64_tr_b16 v[58:59], v6 offset:2048
  v_mfma_f32_16x16x32_bf16 v[36:39], v[16:19], v[88:91], v[36:39]
  v_mfma_f32_16x16x32_bf16 v[44:47], v[16:19], v[92:95], v[44:47]
  v_mfma_f32_16x16x32_bf16 v[52:55], v[16:19], v[96:99], v[52:55]
  ds_read_b64_tr_b16 v[16:17], v5 offset:4096
  ds_read_b64_tr_b16 v[18:19], v5 offset:6144
  v_mfma_f32_16x16x32_bf16 v[32:35], v[20:23], v[100:103], v[32:35]
  v_mfma_f32_16x16x32_bf16 v[40:43], v[20:23], v[104:107], v[40:43]
  v_mfma_f32_16x16x32_bf16 v[48:51], v[20:23], v[108:111], v[48:51]
  ds_read_b64_tr_b16 v[20:21], v6 offset:4096
  ds_read_b64_tr_b16 v[22:23], v6 offset:6144
  v_mfma_f32_16x16x32_bf16 v[36:39], v[24:27], v[100:103], v[36:39]
  v_mfma_f32_16x16x32_bf16 v[44:47], v[24:27], v[104:107], v[44:47]
  v_mfma_f32_16x16x32_bf16 v[52:55], v[24:27], v[108:111], v[52:55]
  ds_read_b64_tr_b16 v[24:25], v5 offset:8192
  ds_read_b64_tr_b16 v[26:27], v5 offset:10240
  s_waitcnt lgkmcnt(8)
  v_mfma_f32_16x16x32_bf16 v[32:35], v[28:31], v[112:115], v[32:35]
  v_mfma_f32_16x16x32_bf16 v[40:43], v[28:31], v[116:119], v[40:43]
  v_mfma_f32_16x16x32_bf16 v[48:51], v[28:31], v[120:123], v[48:51]
  ds_read_b64_tr_b16 v[28:29], v6 offset:8192
  ds_read_b64_tr_b16 v[30:31], v6 offset:10240
  s_waitcnt lgkmcnt(8)
  v_mfma_f32_16x16x32_bf16 v[36:39], v[56:59], v[112:115], v[36:39]
  v_mfma_f32_16x16x32_bf16 v[44:47], v[56:59], v[116:119], v[44:47]
  v_mfma_f32_16x16x32_bf16 v[52:55], v[56:59], v[120:123], v[52:55]
  ds_read_b64_tr_b16 v[56:57], v5 offset:12288
  ds_read_b64_tr_b16 v[58:59], v5 offset:14336
  s_waitcnt lgkmcnt(8)
  v_mfma_f32_16x16x32_bf16 v[32:35], v[16:19], v[124:127], v[32:35]
  v_mfma_f32_16x16x32_bf16 v[40:43], v[16:19], v[128:131], v[40:43]
  v_mfma_f32_16x16x32_bf16 v[48:51], v[16:19], v[132:135], v[48:51]
  ds_read_b64_tr_b16 v[16:17], v6 offset:12288
  ds_read_b64_tr_b16 v[18:19], v6 offset:14336
  s_waitcnt lgkmcnt(8)
  v_mfma_f32_16x16x32_bf16 v[36:39], v[20:23], v[124:127], v[36:39]
  v_mfma_f32_16x16x32_bf16 v[44:47], v[20:23], v[128:131], v[44:47]
  v_mfma_f32_16x16x32_bf16 v[52:55], v[20:23], v[132:135], v[52:55]
  s_waitcnt vmcnt(4)
  s_waitcnt lgkmcnt(0)
  s_barrier
  ds_read_b64_tr_b16 v[20:21], v3
  ds_read_b64_tr_b16 v[22:23], v3 offset:2048
  v_mfma_f32_16x16x32_bf16 v[32:35], v[24:27], v[136:139], v[32:35]
  v_mfma_f32_16x16x32_bf16 v[40:43], v[24:27], v[140:143], v[40:43]
  s_mov_b32 m0, 0x1a000
  s_add_u32 s39, s72, 0x79880
  buffer_load_dwordx4 v7, s[24:27], s39 offen lds
  buffer_load_dwordx4 v8, s[24:27], s39 offen offset:1024 lds
  v_mfma_f32_16x16x32_bf16 v[48:51], v[24:27], v[144:147], v[48:51]
  ds_read_b64_tr_b16 v[24:25], v4
  ds_read_b64_tr_b16 v[26:27], v4 offset:2048
  v_mfma_f32_16x16x32_bf16 v[36:39], v[28:31], v[136:139], v[36:39]
  v_mfma_f32_16x16x32_bf16 v[44:47], v[28:31], v[140:143], v[44:47]
  v_mfma_f32_16x16x32_bf16 v[52:55], v[28:31], v[144:147], v[52:55]
  ds_read_b64_tr_b16 v[28:29], v3 offset:4096
  ds_read_b64_tr_b16 v[30:31], v3 offset:6144
  v_mfma_f32_16x16x32_bf16 v[32:35], v[56:59], v[148:151], v[32:35]
  v_mfma_f32_16x16x32_bf16 v[40:43], v[56:59], v[152:155], v[40:43]
  v_mfma_f32_16x16x32_bf16 v[48:51], v[56:59], v[156:159], v[48:51]
  ds_read_b64_tr_b16 v[56:57], v4 offset:4096
  ds_read_b64_tr_b16 v[58:59], v4 offset:6144
  v_mfma_f32_16x16x32_bf16 v[36:39], v[16:19], v[148:151], v[36:39]
  v_mfma_f32_16x16x32_bf16 v[44:47], v[16:19], v[152:155], v[44:47]
  v_mfma_f32_16x16x32_bf16 v[52:55], v[16:19], v[156:159], v[52:55]
  ds_read_b64_tr_b16 v[16:17], v3 offset:8192
  ds_read_b64_tr_b16 v[18:19], v3 offset:10240
  s_waitcnt lgkmcnt(8)
  v_mfma_f32_16x16x32_bf16 v[32:35], v[20:23], v[160:163], v[32:35]
  v_mfma_f32_16x16x32_bf16 v[40:43], v[20:23], v[164:167], v[40:43]
  v_mfma_f32_16x16x32_bf16 v[48:51], v[20:23], v[168:171], v[48:51]
  ds_read_b64_tr_b16 v[20:21], v4 offset:8192
  ds_read_b64_tr_b16 v[22:23], v4 offset:10240
  s_waitcnt lgkmcnt(8)
  v_mfma_f32_16x16x32_bf16 v[36:39], v[24:27], v[160:163], v[36:39]
  v_mfma_f32_16x16x32_bf16 v[44:47], v[24:27], v[164:167], v[44:47]
  v_mfma_f32_16x16x32_bf16 v[52:55], v[24:27], v[168:171], v[52:55]
  ds_read_b64_tr_b16 v[24:25], v3 offset:12288
  ds_read_b64_tr_b16 v[26:27], v3 offset:14336
  s_waitcnt lgkmcnt(8)
  v_mfma_f32_16x16x32_bf16 v[32:35], v[28:31], v[172:175], v[32:35]
  v_mfma_f32_16x16x32_bf16 v[40:43], v[28:31], v[176:179], v[40:43]
  v_mfma_f32_16x16x32_bf16 v[48:51], v[28:31], v[180:183], v[48:51]
  ds_read_b64_tr_b16 v[28:29], v4 offset:12288
  ds_read_b64_tr_b16 v[30:31], v4 offset:14336
  s_waitcnt lgkmcnt(8)
  v_mfma_f32_16x16x32_bf16 v[36:39], v[56:59], v[172:175], v[36:39]
  v_mfma_f32_16x16x32_bf16 v[44:47], v[56:59], v[176:179], v[44:47]
  v_mfma_f32_16x16x32_bf16 v[52:55], v[56:59], v[180:183], v[52:55]
  s_waitcnt vmcnt(4)
  s_waitcnt lgkmcnt(0)
  s_barrier
  ds_read_b64_tr_b16 v[56:57], v3 offset:16384
  ds_read_b64_tr_b16 v[58:59], v3 offset:18432
  v_mfma_f32_16x16x32_bf16 v[32:35], v[16:19], v[184:187], v[32:35]
  v_mfma_f32_16x16x32_bf16 v[40:43], v[16:19], v[188:191], v[40:43]
  s_mov_b32 m0, 0x1800
  s_add_u32 s39, s72, 0xd880
  buffer_load_dwordx4 v7, s[24:27], s39 offen lds
  buffer_load_dwordx4 v8, s[24:27], s39 offen offset:1024 lds
  v_mfma_f32_16x16x32_bf16 v[48:51], v[16:19], v[192:195], v[48:51]
  ds_read_b64_tr_b16 v[60:61], v4 offset:16384
  ds_read_b64_tr_b16 v[62:63], v4 offset:18432
  v_mfma_f32_16x16x32_bf16 v[36:39], v[20:23], v[184:187], v[36:39]
  v_mfma_f32_16x16x32_bf16 v[44:47], v[20:23], v[188:191], v[44:47]
  v_mfma_f32_16x16x32_bf16 v[52:55], v[20:23], v[192:195], v[52:55]
  ds_read_b64_tr_b16 v[16:17], v3 offset:20480
  ds_read_b64_tr_b16 v[18:19], v3 offset:22528
  v_mfma_f32_16x16x32_bf16 v[32:35], v[24:27], v[196:199], v[32:35]
  v_mfma_f32_16x16x32_bf16 v[40:43], v[24:27], v[200:203], v[40:43]
  v_mfma_f32_16x16x32_bf16 v[48:51], v[24:27], v[204:207], v[48:51]
  ds_read_b64_tr_b16 v[20:21], v4 offset:20480
  ds_read_b64_tr_b16 v[22:23], v4 offset:22528
  v_mfma_f32_16x16x32_bf16 v[36:39], v[28:31], v[196:199], v[36:39]
  v_mfma_f32_16x16x32_bf16 v[44:47], v[28:31], v[200:203], v[44:47]
  v_mfma_f32_16x16x32_bf16 v[52:55], v[28:31], v[204:207], v[52:55]
  ds_read_b64_tr_b16 v[24:25], v3 offset:24576
  ds_read_b64_tr_b16 v[26:27], v3 offset:26624
  s_waitcnt lgkmcnt(8)
  v_mfma_f32_16x16x32_bf16 v[32:35], v[56:59], v[208:211], v[32:35]
  v_mfma_f32_16x16x32_bf16 v[40:43], v[56:59], v[212:215], v[40:43]
  v_mfma_f32_16x16x32_bf16 v[48:51], v[56:59], v[216:219], v[48:51]
  ds_read_b64_tr_b16 v[28:29], v4 offset:24576
  ds_read_b64_tr_b16 v[30:31], v4 offset:26624
  s_waitcnt lgkmcnt(8)
  v_mfma_f32_16x16x32_bf16 v[36:39], v[60:63], v[208:211], v[36:39]
  v_mfma_f32_16x16x32_bf16 v[44:47], v[60:63], v[212:215], v[44:47]
  v_mfma_f32_16x16x32_bf16 v[52:55], v[60:63], v[216:219], v[52:55]
  ds_read_b64_tr_b16 v[56:57], v3 offset:28672
  ds_read_b64_tr_b16 v[58:59], v3 offset:30720
  s_waitcnt lgkmcnt(8)
  v_mfma_f32_16x16x32_bf16 v[32:35], v[16:19], v[220:223], v[32:35]
  v_mfma_f32_16x16x32_bf16 v[40:43], v[16:19], v[224:227], v[40:43]
  v_mfma_f32_16x16x32_bf16 v[48:51], v[16:19], v[228:231], v[48:51]
  ds_read_b64_tr_b16 v[60:61], v4 offset:28672
  ds_read_b64_tr_b16 v[62:63], v4 offset:30720
  s_waitcnt lgkmcnt(8)
  v_mfma_f32_16x16x32_bf16 v[36:39], v[20:23], v[220:223], v[36:39]
  v_mfma_f32_16x16x32_bf16 v[44:47], v[20:23], v[224:227], v[44:47]
  v_mfma_f32_16x16x32_bf16 v[52:55], v[20:23], v[228:231], v[52:55]
  s_waitcnt vmcnt(4)
  s_waitcnt lgkmcnt(0)
  s_barrier
  ds_read_b64_tr_b16 v[16:17], v3 offset:40960
  ds_read_b64_tr_b16 v[18:19], v3 offset:43008
  v_mfma_f32_16x16x32_bf16 v[32:35], v[24:27], v[232:235], v[32:35]
  v_mfma_f32_16x16x32_bf16 v[40:43], v[24:27], v[236:239], v[40:43]
  s_mov_b32 m0, 0x5800
  s_add_u32 s39, s72, 0x31880
  buffer_load_dwordx4 v7, s[24:27], s39 offen lds
  buffer_load_dwordx4 v8, s[24:27], s39 offen offset:1024 lds
  v_mfma_f32_16x16x32_bf16 v[48:51], v[24:27], v[240:243], v[48:51]
  ds_read_b64_tr_b16 v[20:21], v4 offset:40960
  ds_read_b64_tr_b16 v[22:23], v4 offset:43008
  v_mfma_f32_16x16x32_bf16 v[36:39], v[28:31], v[232:235], v[36:39]
  v_mfma_f32_16x16x32_bf16 v[44:47], v[28:31], v[236:239], v[44:47]
  v_mfma_f32_16x16x32_bf16 v[52:55], v[28:31], v[240:243], v[52:55]
  ds_read_b64_tr_b16 v[24:25], v3 offset:45056
  ds_read_b64_tr_b16 v[26:27], v3 offset:47104
  v_mfma_f32_16x16x32_bf16 v[32:35], v[56:59], v[244:247], v[32:35]
  v_mfma_f32_16x16x32_bf16 v[40:43], v[56:59], v[248:251], v[40:43]
  v_mfma_f32_16x16x32_bf16 v[48:51], v[56:59], v[252:255], v[48:51]
  ds_read_b64_tr_b16 v[28:29], v4 offset:45056
  ds_read_b64_tr_b16 v[30:31], v4 offset:47104
  v_mfma_f32_16x16x32_bf16 v[36:39], v[60:63], v[244:247], v[36:39]
  v_mfma_f32_16x16x32_bf16 v[44:47], v[60:63], v[248:251], v[44:47]
  v_mfma_f32_16x16x32_bf16 v[52:55], v[60:63], v[252:255], v[52:55]
  s_add_u32 s72, s72, 128
  s_mov_b32 s74, 7
L_op3_loop:
  ds_read_b64_tr_b16 v[56:57], v3 offset:49152
  ds_read_b64_tr_b16 v[58:59], v3 offset:51200
  v_cvt_pk_bf16_f32 v10, v32, v33
  v_cvt_pk_bf16_f32 v11, v34, v35
  v_cvt_pk_bf16_f32 v12, v36, v37
  v_cvt_pk_bf16_f32 v13, v38, v39
  s_add_u32 s40, s73, 0x3000
  buffer_store_dwordx4 v[10:13], v2, s[20:23], s40 offen sc1
  s_waitcnt lgkmcnt(8)
  v_mfma_f32_16x16x32_bf16 v[32:35], v[16:19], v[64:67], 0
  v_cvt_pk_bf16_f32 v10, v40, v41
  v_cvt_pk_bf16_f32 v11, v42, v43
  v_cvt_pk_bf16_f32 v12, v44, v45
  v_cvt_pk_bf16_f32 v13, v46, v47
  s_add_u32 s40, s73, 0x3800
  buffer_store_dwordx4 v[10:13], v2, s[20:23], s40 offen sc1
  v_mfma_f32_16x16x32_bf16 v[40:43], v[16:19], v[68:71], 0
  s_nop 0
  v_cvt_pk_bf16_f32 v10, v48, v49
  v_cvt_pk_bf16_f32 v11, v50, v51
  v_cvt_pk_bf16_f32 v12, v52, v53
  v_cvt_pk_bf16_f32 v13, v54, v55
  s_add_u32 s40, s73, 0x4000
  buffer_store_dwordx4 v[10:13], v2, s[20:23], s40 offen sc1
  v_mfma_f32_16x16x32_bf16 v[48:51], v[16:19], v[72:75], 0
  ds_read_b64_tr_b16 v[16:17], v4 offset:49152
  ds_read_b64_tr_b16 v[18:19], v4 offset:51200
  s_waitcnt lgkmcnt(4)
  v_mfma_f32_16x16x32_bf16 v[36:39], v[20:23], v[64:67], 0
  v_mfma_f32_16x16x32_bf16 v[44:47], v[20:23], v[68:71], 0
  v_mfma_f32_16x16x32_bf16 v[52:55], v[20:23], v[72:75], 0
  ds_read_b64_tr_b16 v[20:21], v3 offset:53248
  ds_read_b64_tr_b16 v[22:23], v3 offset:55296
  v_mfma_f32_16x16x32_bf16 v[32:35], v[24:27], v[76:79], v[32:35]
  v_mfma_f32_16x16x32_bf16 v[40:43], v[24:27], v[80:83], v[40:43]
  v_mfma_f32_16x16x32_bf16 v[48:51], v[24:27], v[84:87], v[48:51]
  ds_read_b64_tr_b16 v[24:25], v4 offset:53248
  ds_read_b64_tr_b16 v[26:27], v4 offset:55296
  v_mfma_f32_16x16x32_bf16 v[36:39], v[28:31], v[76:79], v[36:39]
  v_mfma_f32_16x16x32_bf16 v[44:47], v[28:31], v[80:83], v[44:47]
  v_mfma_f32_16x16x32_bf16 v[52:55], v[28:31], v[84:87], v[52:55]
  s_waitcnt vmcnt(7)
  s_waitcnt lgkmcnt(0)
  s_barrier
  ds_read_b64_tr_b16 v[28:29], v5
  ds_read_b64_tr_b16 v[30:31], v5 offset:2048
  v_mfma_f32_16x16x32_bf16 v[32:35], v[56:59], v[88:91], v[32:35]
  v_mfma_f32_16x16x32_bf16 v[40:43], v[56:59], v[92:95], v[40:43]
  s_mov_b32 m0, 0xb800
  s_add_u32 s39, s72, 0x55880
  buffer_load_dwordx4 v7, s[24:27], s39 offen lds
  buffer_load_dwordx4 v8, s[24:27], s39 offen offset:1024 lds
  v_mfma_f32_16x16x32_bf16 v[48:51], v[56:59], v[96:99], v[48:51]
  ds_read_b64_tr_b16 v[56:57], v6
  ds_read_b64_tr_b16 v[58:59], v6 offset:2048
  v_mfma_f32_16x16x32_bf16 v[36:39], v[16:19], v[88:91], v[36:39]
  v_mfma_f32_16x16x32_bf16 v[44:47], v[16:19], v[92:95], v[44:47]
  v_mfma_f32_16x16x32_bf16 v[52:55], v[16:19], v[96:99], v[52:55]
  ds_read_b64_tr_b16 v[16:17], v5 offset:4096
  ds_read_b64_tr_b16 v[18:19], v5 offset:6144
  v_mfma_f32_16x16x32_bf16 v[32:35], v[20:23], v[100:103], v[32:35]
  v_mfma_f32_16x16x32_bf16 v[40:43], v[20:23], v[104:107], v[40:43]
  v_mfma_f32_16x16x32_bf16 v[48:51], v[20:23], v[108:111], v[48:51]
  ds_read_b64_tr_b16 v[20:21], v6 offset:4096
  ds_read_b64_tr_b16 v[22:23], v6 offset:6144
  v_mfma_f32_16x16x32_bf16 v[36:39], v[24:27], v[100:103], v[36:39]
  v_mfma_f32_16x16x32_bf16 v[44:47], v[24:27], v[104:107], v[44:47]
  v_mfma_f32_16x16x32_bf16 v[52:55], v[24:27], v[108:111], v[52:55]
  ds_read_b64_tr_b16 v[24:25], v5 offset:8192
  ds_read_b64_tr_b16 v[26:27], v5 offset:10240
  s_waitcnt lgkmcnt(8)
  v_mfma_f32_16x16x32_bf16 v[32:35], v[28:31], v[112:115], v[32:35]
  v_mfma_f32_16x16x32_bf16 v[40:43], v[28:31], v[116:119], v[40:43]
  v_mfma_f32_16x16x32_bf16 v[48:51], v[28:31], v[120:123], v[48:51]
  ds_read_b64_tr_b16 v[28:29], v6 offset:8192
  ds_read_b64_tr_b16 v[30:31], v6 offset:10240
  s_waitcnt lgkmcnt(8)
  v_mfma_f32_16x16x32_bf16 v[36:39], v[56:59], v[112:115], v[36:39]
  v_mfma_f32_16x16x32_bf16 v[44:47], v[56:59], v[116:119], v[44:47]
  v_mfma_f32_16x16x32_bf16 v[52:55], v[56:59], v[120:123], v[52:55]
  ds_read_b64_tr_b16 v[56:57], v5 offset:12288
  ds_read_b64_tr_b16 v[58:59], v5 offset:14336
  s_waitcnt lgkmcnt(8)
  v_mfma_f32_16x16x32_bf16 v[32:35], v[16:19], v[124:127], v[32:35]
  v_mfma_f32_16x16x32_bf16 v[40:43], v[16:19], v[128:131], v[40:43]
  v_mfma_f32_16x16x32_bf16 v[48:51], v[16:19], v[132:135], v[48:51]
  ds_read_b64_tr_b16 v[16:17], v6 offset:12288
  ds_read_b64_tr_b16 v[18:19], v6 offset:14336
  s_waitcnt lgkmcnt(8)
  v_mfma_f32_16x16x32_bf16 v[36:39], v[20:23], v[124:127], v[36:39]
  v_mfma_f32_16x16x32_bf16 v[44:47], v[20:23], v[128:131], v[44:47]
  v_mfma_f32_16x16x32_bf16 v[52:55], v[20:23], v[132:135], v[52:55]
  s_waitcnt vmcnt(7)
  s_waitcnt lgkmcnt(0)
  s_barrier
  ds_read_b64_tr_b16 v[20:21], v3
  ds_read_b64_tr_b16 v[22:23], v3 offset:2048
  v_mfma_f32_16x16x32_bf16 v[32:35], v[24:27], v[136:139], v[32:35]
  v_mfma_f32_16x16x32_bf16 v[40:43], v[24:27], v[140:143], v[40:43]
  s_mov_b32 m0, 0x1a000
  s_add_u32 s39, s72, 0x79880
  buffer_load_dwordx4 v7, s[24:27], s39 offen lds
  buffer_load_dwordx4 v8, s[24:27], s39 offen offset:1024 lds
  v_mfma_f32_16x16x32_bf16 v[48:51], v[24:27], v[144:147], v[48:51]
  ds_read_b64_tr_b16 v[24:25], v4
  ds_read_b64_tr_b16 v[26:27], v4 offset:2048
  v_mfma_f32_16x16x32_bf16 v[36:39], v[28:31], v[136:139], v[36:39]
  v_mfma_f32_16x16x32_bf16 v[44:47], v[28:31], v[140:143], v[44:47]
  v_mfma_f32_16x16x32_bf16 v[52:55], v[28:31], v[144:147], v[52:55]
  ds_read_b64_tr_b16 v[28:29], v3 offset:4096
  ds_read_b64_tr_b16 v[30:31], v3 offset:6144
  v_mfma_f32_16x16x32_bf16 v[32:35], v[56:59], v[148:151], v[32:35]
  v_mfma_f32_16x16x32_bf16 v[40:43], v[56:59], v[152:155], v[40:43]
  v_mfma_f32_16x16x32_bf16 v[48:51], v[56:59], v[156:159], v[48:51]
  ds_read_b64_tr_b16 v[56:57], v4 offset:4096
  ds_read_b64_tr_b16 v[58:59], v4 offset:6144
  v_mfma_f32_16x16x32_bf16 v[36:39], v[16:19], v[148:151], v[36:39]
  v_mfma_f32_16x16x32_bf16 v[44:47], v[16:19], v[152:155], v[44:47]
  v_mfma_f32_16x16x32_bf16 v[52:55], v[16:19], v[156:159], v[52:55]
  ds_read_b64_tr_b16 v[16:17], v3 offset:8192
  ds_read_b64_tr_b16 v[18:19], v3 offset:10240
  s_waitcnt lgkmcnt(8)
  v_mfma_f32_16x16x32_bf16 v[32:35], v[20:23], v[160:163], v[32:35]
  v_mfma_f32_16x16x32_bf16 v[40:43], v[20:23], v[164:167], v[40:43]
  v_mfma_f32_16x16x32_bf16 v[48:51], v[20:23], v[168:171], v[48:51]
  ds_read_b64_tr_b16 v[20:21], v4 offset:8192
  ds_read_b64_tr_b16 v[22:23], v4 offset:10240
  s_waitcnt lgkmcnt(8)
  v_mfma_f32_16x16x32_bf16 v[36:39], v[24:27], v[160:163], v[36:39]
  v_mfma_f32_16x16x32_bf16 v[44:47], v[24:27], v[164:167], v[44:47]
  v_mfma_f32_16x16x32_bf16 v[52:55], v[24:27], v[168:171], v[52:55]
  ds_read_b64_tr_b16 v[24:25], v3 offset:12288
  ds_read_b64_tr_b16 v[26:27], v3 offset:14336
  s_waitcnt lgkmcnt(8)
  v_mfma_f32_16x16x32_bf16 v[32:35], v[28:31], v[172:175], v[32:35]
  v_mfma_f32_16x16x32_bf16 v[40:43], v[28:31], v[176:179], v[40:43]
  v_mfma_f32_16x16x32_bf16 v[48:51], v[28:31], v[180:183], v[48:51]
  ds_read_b64_tr_b16 v[28:29], v4 offset:12288
  ds_read_b64_tr_b16 v[30:31], v4 offset:14336
  s_waitcnt lgkmcnt(8)
  v_mfma_f32_16x16x32_bf16 v[36:39], v[56:59], v[172:175], v[36:39]
  v_mfma_f32_16x16x32_bf16 v[44:47], v[56:59], v[176:179], v[44:47]
  v_mfma_f32_16x16x32_bf16 v[52:55], v[56:59], v[180:183], v[52:55]
  s_waitcnt vmcnt(7)
  s_waitcnt lgkmcnt(0)
  s_barrier
  ds_read_b64_tr_b16 v[56:57], v3 offset:16384
  ds_read_b64_tr_b16 v[58:59], v3 offset:18432
  v_mfma_f32_16x16x32_bf16 v[32:35], v[16:19], v[184:187], v[32:35]
  v_mfma_f32_16x16x32_bf16 v[40:43], v[16:19], v[188:191], v[40:43]
  s_mov_b32 m0, 0x1800
  s_add_u32 s39, s72, 0xd880
  buffer_load_dwordx4 v7, s[24:27], s39 offen lds
  buffer_load_dwordx4 v8, s[24:27], s39 offen offset:1024 lds
  v_mfma_f32_16x16x32_bf16 v[48:51], v[16:19], v[192:195], v[48:51]
  ds_read_b64_tr_b16 v[60:61], v4 offset:16384
  ds_read_b64_tr_b16 v[62:63], v4 offset:18432
  v_mfma_f32_16x16x32_bf16 v[36:39], v[20:23], v[184:187], v[36:39]
  v_mfma_f32_16x16x32_bf16 v[44:47], v[20:23], v[188:191], v[44:47]
  v_mfma_f32_16x16x32_bf16 v[52:55], v[20:23], v[192:195], v[52:55]
  ds_read_b64_tr_b16 v[16:17], v3 offset:20480
  ds_read_b64_tr_b16 v[18:19], v3 offset:22528
  v_mfma_f32_16x16x32_bf16 v[32:35], v[24:27], v[196:199], v[32:35]
  v_mfma_f32_16x16x32_bf16 v[40:43], v[24:27], v[200:203], v[40:43]
  v_mfma_f32_16x16x32_bf16 v[48:51], v[24:27], v[204:207], v[48:51]
  ds_read_b64_tr_b16 v[20:21], v4 offset:20480
  ds_read_b64_tr_b16 v[22:23], v4 offset:22528
  v_mfma_f32_16x16x32_bf16 v[36:39], v[28:31], v[196:199], v[36:39]
  v_mfma_f32_16x16x32_bf16 v[44:47], v[28:31], v[200:203], v[44:47]
  v_mfma_f32_16x16x32_bf16 v[52:55], v[28:31], v[204:207], v[52:55]
  ds_read_b64_tr_b16 v[24:25], v3 offset:24576
  ds_read_b64_tr_b16 v[26:27], v3 offset:26624
  s_waitcnt lgkmcnt(8)
  v_mfma_f32_16x16x32_bf16 v[32:35], v[56:59], v[208:211], v[32:35]
  v_mfma_f32_16x16x32_bf16 v[40:43], v[56:59], v[212:215], v[40:43]
  v_mfma_f32_16x16x32_bf16 v[48:51], v[56:59], v[216:219], v[48:51]
  ds_read_b64_tr_b16 v[28:29], v4 offset:24576
  ds_read_b64_tr_b16 v[30:31], v4 offset:26624
  s_waitcnt lgkmcnt(8)
  v_mfma_f32_16x16x32_bf16 v[36:39], v[60:63], v[208:211], v[36:39]
  v_mfma_f32_16x16x32_bf16 v[44:47], v[60:63], v[212:215], v[44:47]
  v_mfma_f32_16x16x32_bf16 v[52:55], v[60:63], v[216:219], v[52:55]
  ds_read_b64_tr_b16 v[56:57], v3 offset:28672
  ds_read_b64_tr_b16 v[58:59], v3 offset:30720
  s_waitcnt lgkmcnt(8)
  v_mfma_f32_16x16x32_bf16 v[32:35], v[16:19], v[220:223], v[32:35]
  v_mfma_f32_16x16x32_bf16 v[40:43], v[16:19], v[224:227], v[40:43]
  v_mfma_f32_16x16x32_bf16 v[48:51], v[16:19], v[228:231], v[48:51]
  ds_read_b64_tr_b16 v[60:61], v4 offset:28672
  ds_read_b64_tr_b16 v[62:63], v4 offset:30720
  s_waitcnt lgkmcnt(8)
  v_mfma_f32_16x16x32_bf16 v[36:39], v[20:23], v[220:223], v[36:39]
  v_mfma_f32_16x16x32_bf16 v[44:47], v[20:23], v[224:227], v[44:47]
  v_mfma_f32_16x16x32_bf16 v[52:55], v[20:23], v[228:231], v[52:55]
  s_waitcnt vmcnt(4)
  s_waitcnt lgkmcnt(0)
  s_barrier
  ds_read_b64_tr_b16 v[16:17], v3 offset:40960
  ds_read_b64_tr_b16 v[18:19], v3 offset:43008
  v_mfma_f32_16x16x32_bf16 v[32:35], v[24:27], v[232:235], v[32:35]
  v_mfma_f32_16x16x32_bf16 v[40:43], v[24:27], v[236:239], v[40:43]
  s_mov_b32 m0, 0x5800
  s_add_u32 s39, s72, 0x31880
  buffer_load_dwordx4 v7, s[24:27], s39 offen lds
  buffer_load_dwordx4 v8, s[24:27], s39 offen offset:1024 lds
  v_mfma_f32_16x16x32_bf16 v[48:51], v[24:27], v[240:243], v[48:51]
  ds_read_b64_tr_b16 v[20:21], v4 offset:40960
  ds_read_b64_tr_b16 v[22:23], v4 offset:43008
  v_mfma_f32_16x16x32_bf16 v[36:39], v[28:31], v[232:235], v[36:39]
  v_mfma_f32_16x16x32_bf16 v[44:47], v[28:31], v[236:239], v[44:47]
  v_mfma_f32_16x16x32_bf16 v[52:55], v[28:31], v[240:243], v[52:55]
  ds_read_b64_tr_b16 v[24:25], v3 offset:45056
  ds_read_b64_tr_b16 v[26:27], v3 offset:47104
  v_mfma_f32_16x16x32_bf16 v[32:35], v[56:59], v[244:247], v[32:35]
  v_mfma_f32_16x16x32_bf16 v[40:43], v[56:59], v[248:251], v[40:43]
  v_mfma_f32_16x16x32_bf16 v[48:51], v[56:59], v[252:255], v[48:51]
  ds_read_b64_tr_b16 v[28:29], v4 offset:45056
  ds_read_b64_tr_b16 v[30:31], v4 offset:47104
  v_mfma_f32_16x16x32_bf16 v[36:39], v[60:63], v[244:247], v[36:39]
  v_mfma_f32_16x16x32_bf16 v[44:47], v[60:63], v[248:251], v[44:47]
  v_mfma_f32_16x16x32_bf16 v[52:55], v[60:63], v[252:255], v[52:55]
  s_add_u32 s72, s72, 128
  s_add_u32 s73, s73, 0x4800
  s_add_u32 s78, s78, 1
  s_sub_u32 s74, s74, 1
  s_cmp_lg_u32 s74, 0
  s_cbranch_scc1 L_op3_loop
  ds_read_b64_tr_b16 v[56:57], v3 offset:49152
  ds_read_b64_tr_b16 v[58:59], v3 offset:51200
  v_cvt_pk_bf16_f32 v10, v32, v33
  v_cvt_pk_bf16_f32 v11, v34, v35
  v_cvt_pk_bf16_f32 v12, v36, v37
  v_cvt_pk_bf16_f32 v13, v38, v39
  s_add_u32 s40, s73, 0x3000
  buffer_store_dwordx4 v[10:13], v2, s[20:23], s40 offen sc1
  s_waitcnt lgkmcnt(6)
  v_mfma_f32_16x16x32_bf16 v[32:35], v[16:19], v[64:67], 0
  v_cvt_pk_bf16_f32 v10, v40, v41
  v_cvt_pk_bf16_f32 v11, v42, v43
  v_cvt_pk_bf16_f32 v12, v44, v45
  v_cvt_pk_bf16_f32 v13, v46, v47
  s_add_u32 s40, s73, 0x3800
  buffer_store_dwordx4 v[10:13], v2, s[20:23], s40 offen sc1
  v_mfma_f32_16x16x32_bf16 v[40:43], v[16:19], v[68:71], 0
  s_nop 0
  v_cvt_pk_bf16_f32 v10, v48, v49
  v_cvt_pk_bf16_f32 v11, v50, v51
  v_cvt_pk_bf16_f32 v12, v52, v53
  v_cvt_pk_bf16_f32 v13, v54, v55
  s_add_u32 s40, s73, 0x4000
  buffer_store_dwordx4 v[10:13], v2, s[20:23], s40 offen sc1
  v_mfma_f32_16x16x32_bf16 v[48:51], v[16:19], v[72:75], 0
  ds_read_b64_tr_b16 v[16:17], v4 offset:49152
  ds_read_b64_tr_b16 v[18:19], v4 offset:51200
  v_mfma_f32_16x16x32_bf16 v[36:39], v[20:23], v[64:67], 0
  v_mfma_f32_16x16x32_bf16 v[44:47], v[20:23], v[68:71], 0
  v_mfma_f32_16x16x32_bf16 v[52:55], v[20:23], v[72:75], 0
  ds_read_b64_tr_b16 v[20:21], v3 offset:53248
  ds_read_b64_tr_b16 v[22:23], v3 offset:55296
  s_waitcnt lgkmcnt(4)
  v_mfma_f32_16x16x32_bf16 v[32:35], v[24:27], v[76:79], v[32:35]
  v_mfma_f32_16x16x32_bf16 v[40:43], v[24:27], v[80:83], v[40:43]
  v_mfma_f32_16x16x32_bf16 v[48:51], v[24:27], v[84:87], v[48:51]
  ds_read_b64_tr_b16 v[24:25], v4 offset:53248
  ds_read_b64_tr_b16 v[26:27], v4 offset:55296
  v_mfma_f32_16x16x32_bf16 v[36:39], v[28:31], v[76:79], v[36:39]
  v_mfma_f32_16x16x32_bf16 v[44:47], v[28:31], v[80:83], v[44:47]
  v_mfma_f32_16x16x32_bf16 v[52:55], v[28:31], v[84:87], v[52:55]
  s_waitcnt vmcnt(7)
  s_waitcnt lgkmcnt(0)
  s_barrier
  ds_read_b64_tr_b16 v[28:29], v5
  ds_read_b64_tr_b16 v[30:31], v5 offset:2048
  v_mfma_f32_16x16x32_bf16 v[32:35], v[56:59], v[88:91], v[32:35]
  v_mfma_f32_16x16x32_bf16 v[40:43], v[56:59], v[92:95], v[40:43]
  v_mfma_f32_16x16x32_bf16 v[48:51], v[56:59], v[96:99], v[48:51]
  ds_read_b64_tr_b16 v[56:57], v6
  ds_read_b64_tr_b16 v[58:59], v6 offset:2048
  v_mfma_f32_16x16x32_bf16 v[36:39], v[16:19], v[88:91], v[36:39]
  v_mfma_f32_16x16x32_bf16 v[44:47], v[16:19], v[92:95], v[44:47]
  v_mfma_f32_16x16x32_bf16 v[52:55], v[16:19], v[96:99], v[52:55]
  ds_read_b64_tr_b16 v[16:17], v5 offset:4096
  ds_read_b64_tr_b16 v[18:19], v5 offset:6144
  v_mfma_f32_16x16x32_bf16 v[32:35], v[20:23], v[100:103], v[32:35]
  v_mfma_f32_16x16x32_bf16 v[40:43], v[20:23], v[104:107], v[40:43]
  v_mfma_f32_16x16x32_bf16 v[48:51], v[20:23], v[108:111], v[48:51]
  ds_read_b64_tr_b16 v[20:21], v6 offset:4096
  ds_read_b64_tr_b16 v[22:23], v6 offset:6144
  v_mfma_f32_16x16x32_bf16 v[36:39], v[24:27], v[100:103], v[36:39]
  v_mfma_f32_16x16x32_bf16 v[44:47], v[24:27], v[104:107], v[44:47]
  v_mfma_f32_16x16x32_bf16 v[52:55], v[24:27], v[108:111], v[52:55]
  ds_read_b64_tr_b16 v[24:25], v5 offset:8192
  ds_read_b64_tr_b16 v[26:27], v5 offset:10240
  s_waitcnt lgkmcnt(8)
  v_mfma_f32_16x16x32_bf16 v[32:35], v[28:31], v[112:115], v[32:35]
  v_mfma_f32_16x16x32_bf16 v[40:43], v[28:31], v[116:119], v[40:43]
  v_mfma_f32_16x16x32_bf16 v[48:51], v[28:31], v[120:123], v[48:51]
  ds_read_b64_tr_b16 v[28:29], v6 offset:8192
  ds_read_b64_tr_b16 v[30:31], v6 offset:10240
  s_waitcnt lgkmcnt(8)
  v_mfma_f32_16x16x32_bf16 v[36:39], v[56:59], v[112:115], v[36:39]
  v_mfma_f32_16x16x32_bf16 v[44:47], v[56:59], v[116:119], v[44:47]
  v_mfma_f32_16x16x32_bf16 v[52:55], v[56:59], v[120:123], v[52:55]
  ds_read_b64_tr_b16 v[56:57], v5 offset:12288
  ds_read_b64_tr_b16 v[58:59], v5 offset:14336
  s_waitcnt lgkmcnt(8)
  v_mfma_f32_16x16x32_bf16 v[32:35], v[16:19], v[124:127], v[32:35]
  v_mfma_f32_16x16x32_bf16 v[40:43], v[16:19], v[128:131], v[40:43]
  v_mfma_f32_16x16x32_bf16 v[48:51], v[16:19], v[132:135], v[48:51]
  ds_read_b64_tr_b16 v[16:17], v6 offset:12288
  ds_read_b64_tr_b16 v[18:19], v6 offset:14336
  s_waitcnt lgkmcnt(8)
  v_mfma_f32_16x16x32_bf16 v[36:39], v[20:23], v[124:127], v[36:39]
  v_mfma_f32_16x16x32_bf16 v[44:47], v[20:23], v[128:131], v[44:47]
  v_mfma_f32_16x16x32_bf16 v[52:55], v[20:23], v[132:135], v[52:55]
  s_waitcnt vmcnt(5)
  s_waitcnt lgkmcnt(0)
  s_barrier
  ds_read_b64_tr_b16 v[20:21], v3
  ds_read_b64_tr_b16 v[22:23], v3 offset:2048
  v_mfma_f32_16x16x32_bf16 v[32:35], v[24:27], v[136:139], v[32:35]
  v_mfma_f32_16x16x32_bf16 v[40:43], v[24:27], v[140:143], v[40:43]
  v_mfma_f32_16x16x32_bf16 v[48:51], v[24:27], v[144:147], v[48:51]
  ds_read_b64_tr_b16 v[24:25], v4
  ds_read_b64_tr_b16 v[26:27], v4 offset:2048
  v_mfma_f32_16x16x32_bf16 v[36:39], v[28:31], v[136:139], v[36:39]
  v_mfma_f32_16x16x32_bf16 v[44:47], v[28:31], v[140:143], v[44:47]
  v_mfma_f32_16x16x32_bf16 v[52:55], v[28:31], v[144:147], v[52:55]
  ds_read_b64_tr_b16 v[28:29], v3 offset:4096
  ds_read_b64_tr_b16 v[30:31], v3 offset:6144
  v_mfma_f32_16x16x32_bf16 v[32:35], v[56:59], v[148:151], v[32:35]
  v_mfma_f32_16x16x32_bf16 v[40:43], v[56:59], v[152:155], v[40:43]
  v_mfma_f32_16x16x32_bf16 v[48:51], v[56:59], v[156:159], v[48:51]
  ds_read_b64_tr_b16 v[56:57], v4 offset:4096
  ds_read_b64_tr_b16 v[58:59], v4 offset:6144
  v_mfma_f32_16x16x32_bf16 v[36:39], v[16:19], v[148:151], v[36:39]
  v_mfma_f32_16x16x32_bf16 v[44:47], v[16:19], v[152:155], v[44:47]
  v_mfma_f32_16x16x32_bf16 v[52:55], v[16:19], v[156:159], v[52:55]
  ds_read_b64_tr_b16 v[16:17], v3 offset:8192
  ds_read_b64_tr_b16 v[18:19], v3 offset:10240
  s_waitcnt lgkmcnt(8)
  v_mfma_f32_16x16x32_bf16 v[32:35], v[20:23], v[160:163], v[32:35]
  v_mfma_f32_16x16x32_bf16 v[40:43], v[20:23], v[164:167], v[40:43]
  v_mfma_f32_16x16x32_bf16 v[48:51], v[20:23], v[168:171], v[48:51]
  ds_read_b64_tr_b16 v[20:21], v4 offset:8192
  ds_read_b64_tr_b16 v[22:23], v4 offset:10240
  s_waitcnt lgkmcnt(8)
  v_mfma_f32_16x16x32_bf16 v[36:39], v[24:27], v[160:163], v[36:39]
  v_mfma_f32_16x16x32_bf16 v[44:47], v[24:27], v[164:167], v[44:47]
  v_mfma_f32_16x16x32_bf16 v[52:55], v[24:27], v[168:171], v[52:55]
  ds_read_b64_tr_b16 v[24:25], v3 offset:12288
  ds_read_b64_tr_b16 v[26:27], v3 offset:14336
  s_waitcnt lgkmcnt(8)
  v_mfma_f32_16x16x32_bf16 v[32:35], v[28:31], v[172:175], v[32:35]
  v_mfma_f32_16x16x32_bf16 v[40:43], v[28:31], v[176:179], v[40:43]
  v_mfma_f32_16x16x32_bf16 v[48:51], v[28:31], v[180:183], v[48:51]
  ds_read_b64_tr_b16 v[28:29], v4 offset:12288
  ds_read_b64_tr_b16 v[30:31], v4 offset:14336
  s_waitcnt lgkmcnt(8)
  v_mfma_f32_16x16x32_bf16 v[36:39], v[56:59], v[172:175], v[36:39]
  v_mfma_f32_16x16x32_bf16 v[44:47], v[56:59], v[176:179], v[44:47]
  v_mfma_f32_16x16x32_bf16 v[52:55], v[56:59], v[180:183], v[52:55]
  s_waitcnt vmcnt(0)
  s_waitcnt lgkmcnt(0)
  s_barrier
  ds_read_b64_tr_b16 v[56:57], v3 offset:16384
  ds_read_b64_tr_b16 v[58:59], v3 offset:18432
  v_mfma_f32_16x16x32_bf16 v[32:35], v[16:19], v[184:187], v[32:35]
  v_mfma_f32_16x16x32_bf16 v[40:43], v[16:19], v[188:191], v[40:43]
  v_mfma_f32_16x16x32_bf16 v[48:51], v[16:19], v[192:195], v[48:51]
  ds_read_b64_tr_b16 v[60:61], v4 offset:16384
  ds_read_b64_tr_b16 v[62:63], v4 offset:18432
  v_mfma_f32_16x16x32_bf16 v[36:39], v[20:23], v[184:187], v[36:39]
  v_mfma_f32_16x16x32_bf16 v[44:47], v[20:23], v[188:191], v[44:47]
  v_mfma_f32_16x16x32_bf16 v[52:55], v[20:23], v[192:195], v[52:55]
  ds_read_b64_tr_b16 v[16:17], v3 offset:20480
  ds_read_b64_tr_b16 v[18:19], v3 offset:22528
  v_mfma_f32_16x16x32_bf16 v[32:35], v[24:27], v[196:199], v[32:35]
  v_mfma_f32_16x16x32_bf16 v[40:43], v[24:27], v[200:203], v[40:43]
  v_mfma_f32_16x16x32_bf16 v[48:51], v[24:27], v[204:207], v[48:51]
  ds_read_b64_tr_b16 v[20:21], v4 offset:20480
  ds_read_b64_tr_b16 v[22:23], v4 offset:22528
  v_mfma_f32_16x16x32_bf16 v[36:39], v[28:31], v[196:199], v[36:39]
  v_mfma_f32_16x16x32_bf16 v[44:47], v[28:31], v[200:203], v[44:47]
  v_mfma_f32_16x16x32_bf16 v[52:55], v[28:31], v[204:207], v[52:55]
  ds_read_b64_tr_b16 v[24:25], v3 offset:24576
  ds_read_b64_tr_b16 v[26:27], v3 offset:26624
  s_waitcnt lgkmcnt(8)
  v_mfma_f32_16x16x32_bf16 v[32:35], v[56:59], v[208:211], v[32:35]
  v_mfma_f32_16x16x32_bf16 v[40:43], v[56:59], v[212:215], v[40:43]
  v_mfma_f32_16x16x32_bf16 v[48:51], v[56:59], v[216:219], v[48:51]
  ds_read_b64_tr_b16 v[28:29], v4 offset:24576
  ds_read_b64_tr_b16 v[30:31], v4 offset:26624
  s_waitcnt lgkmcnt(8)
  v_mfma_f32_16x16x32_bf16 v[36:39], v[60:63], v[208:211], v[36:39]
  v_mfma_f32_16x16x32_bf16 v[44:47], v[60:63], v[212:215], v[44:47]
  v_mfma_f32_16x16x32_bf16 v[52:55], v[60:63], v[216:219], v[52:55]
  ds_read_b64_tr_b16 v[56:57], v3 offset:28672
  ds_read_b64_tr_b16 v[58:59], v3 offset:30720
  s_waitcnt lgkmcnt(8)
  v_mfma_f32_16x16x32_bf16 v[32:35], v[16:19], v[220:223], v[32:35]
  v_mfma_f32_16x16x32_bf16 v[40:43], v[16:19], v[224:227], v[40:43]
  v_mfma_f32_16x16x32_bf16 v[48:51], v[16:19], v[228:231], v[48:51]
  ds_read_b64_tr_b16 v[60:61], v4 offset:28672
  ds_read_b64_tr_b16 v[62:63], v4 offset:30720
  s_waitcnt lgkmcnt(8)
  v_mfma_f32_16x16x32_bf16 v[36:39], v[20:23], v[220:223], v[36:39]
  v_mfma_f32_16x16x32_bf16 v[44:47], v[20:23], v[224:227], v[44:47]
  v_mfma_f32_16x16x32_bf16 v[52:55], v[20:23], v[228:231], v[52:55]
  s_waitcnt lgkmcnt(6)
  v_mfma_f32_16x16x32_bf16 v[32:35], v[24:27], v[232:235], v[32:35]
  v_mfma_f32_16x16x32_bf16 v[40:43], v[24:27], v[236:239], v[40:43]
  v_mfma_f32_16x16x32_bf16 v[48:51], v[24:27], v[240:243], v[48:51]
  s_waitcnt lgkmcnt(4)
  v_mfma_f32_16x16x32_bf16 v[36:39], v[28:31], v[232:235], v[36:39]
  v_mfma_f32_16x16x32_bf16 v[44:47], v[28:31], v[236:239], v[44:47]
  v_mfma_f32_16x16x32_bf16 v[52:55], v[28:31], v[240:243], v[52:55]
  s_waitcnt lgkmcnt(2)
  v_mfma_f32_16x16x32_bf16 v[32:35], v[56:59], v[244:247], v[32:35]
  v_mfma_f32_16x16x32_bf16 v[40:43], v[56:59], v[248:251], v[40:43]
  v_mfma_f32_16x16x32_bf16 v[48:51], v[56:59], v[252:255], v[48:51]
  s_waitcnt lgkmcnt(0)
  v_mfma_f32_16x16x32_bf16 v[36:39], v[60:63], v[244:247], v[36:39]
  v_mfma_f32_16x16x32_bf16 v[44:47], v[60:63], v[248:251], v[44:47]
  v_mfma_f32_16x16x32_bf16 v[52:55], v[60:63], v[252:255], v[52:55]
  s_nop 1
  v_cvt_pk_bf16_f32 v10, v32, v33
  v_cvt_pk_bf16_f32 v11, v34, v35
  s_nop 1
  v_cvt_pk_bf16_f32 v12, v36, v37
  v_cvt_pk_bf16_f32 v13, v38, v39
  s_add_u32 s40, s73, 0x7800
  buffer_store_dwordx4 v[10:13], v2, s[20:23], s40 offen sc1
  s_nop 1
  v_cvt_pk_bf16_f32 v10, v40, v41
  v_cvt_pk_bf16_f32 v11, v42, v43
  v_cvt_pk_bf16_f32 v12, v44, v45
  v_cvt_pk_bf16_f32 v13, v46, v47
  s_add_u32 s40, s73, 0x8000
  buffer_store_dwordx4 v[10:13], v2, s[20:23], s40 offen sc1
  s_nop 1
  v_cvt_pk_bf16_f32 v10, v48, v49
  v_cvt_pk_bf16_f32 v11, v50, v51
  v_cvt_pk_bf16_f32 v12, v52, v53
  v_cvt_pk_bf16_f32 v13, v54, v55
  s_add_u32 s40, s73, 0x8800
  buffer_store_dwordx4 v[10:13], v2, s[20:23], s40 offen sc1
  s_lshl_b32 s41, s33, 8
  s_add_u32 s41, s41, 0x4000000
  v_mov_b32 v238, s41
  v_and_b32 v239, 15, v0
  v_mul_u32_u24 v239, 2304, v239
  v_lshrrev_b32 v232, 4, v0
  v_lshl_add_u32 v239, v232, 4, v239
  buffer_load_dwordx2 v[236:237], v238, s[20:23], 0 offen sc1
  s_waitcnt vmcnt(0)
  s_barrier
  s_branch L_tail
L_tail:
  s_lshl_b32 s76, s32, 3
  s_add_u32 s76, s76, s34
  s_add_u32 s76, s76, 64
  s_mov_b32 s83, 0x100000
  v_readfirstlane_b32 s81, v236
  v_readfirstlane_b32 s82, v237
  s_mul_i32 s41, s76, 3641
  s_lshr_b32 s41, s41, 16
  s_add_u32 s42, s41, 1
  s_mul_i32 s42, s42, 0x01010101
  s_or_b32 s81, s81, 0x80808080
  s_or_b32 s82, s82, 0x80808080
  s_sub_u32 s81, s81, s42
  s_sub_u32 s82, s82, s42
  s_and_b32 s81, s81, s82
  s_and_b32 s81, s81, 0x80808080
  s_cmp_eq_u32 s81, 0x80808080
  s_cbranch_scc1 L_spxa_go
L_spxa:
  buffer_load_dwordx2 v[236:237], v238, s[20:23], 0 offen sc1
  s_waitcnt vmcnt(0)
  v_readfirstlane_b32 s81, v236
  v_readfirstlane_b32 s82, v237
  s_mul_i32 s41, s76, 3641
  s_lshr_b32 s41, s41, 16
  s_add_u32 s42, s41, 1
  s_mul_i32 s42, s42, 0x01010101
  s_or_b32 s81, s81, 0x80808080
  s_or_b32 s82, s82, 0x80808080
  s_sub_u32 s81, s81, s42
  s_sub_u32 s82, s82, s42
  s_and_b32 s81, s81, s82
  s_and_b32 s81, s81, 0x80808080
  s_cmp_eq_u32 s81, 0x80808080
  s_cbranch_scc1 L_spxa_go
  s_sleep 1
  s_sub_u32 s83, s83, 1
  s_cmp_lg_u32 s83, 0
  s_cbranch_scc1 L_spxa
L_spxa_go:
  s_mul_i32 s41, s76, 3641
  s_lshr_b32 s41, s41, 16
  s_lshl_b32 s42, s33, 3
  s_mul_i32 s79, s42, 165888
  s_lshl_b32 s42, s76, 10
  s_add_u32 s79, s79, s42
  s_add_u32 s79, s79, 0x5000000
  buffer_load_dwordx4 v[64:67], v2, s[20:23], s79 offen sc1
  s_add_u32 s79, s79, 0x28800
  buffer_load_dwordx4 v[68:71], v2, s[20:23], s79 offen sc1
  s_add_u32 s79, s79, 0x28800
  buffer_load_dwordx4 v[72:75], v2, s[20:23], s79 offen sc1
  s_add_u32 s79, s79, 0x28800
  buffer_load_dwordx4 v[76:79], v2, s[20:23], s79 offen sc1
  s_add_u32 s79, s79, 0x28800
  buffer_load_dwordx4 v[80:83], v2, s[20:23], s79 offen sc1
  s_add_u32 s79, s79, 0x28800
  buffer_load_dwordx4 v[84:87], v2, s[20:23], s79 offen sc1
  s_add_u32 s79, s79, 0x28800
  buffer_load_dwordx4 v[88:91], v2, s[20:23], s79 offen sc1
  s_add_u32 s79, s79, 0x28800
  buffer_load_dwordx4 v[92:95], v2, s[20:23], s79 offen sc1
  s_mul_i32 s42, s41, 18
  s_sub_u32 s42, s76, s42
  s_lshl_b32 s77, s41, 7
  s_and_b32 s41, s42, 1
  s_lshl_b32 s41, s41, 6
  s_add_u32 s77, s77, s41
  s_lshr_b32 s42, s42, 1
  s_mul_i32 s41, s35, 9
  s_add_u32 s41, s41, s42
  s_mul_i32 s41, s41, 36864
  s_add_u32 s77, s77, s41
  s_lshr_b32 s41, s33, 4
  s_mul_i32 s41, s41, 1152
  s_add_u32 s77, s77, s41
  s_sub_u32 s76, s76, 64
  s_mul_i32 s41, s76, 3641
  s_lshr_b32 s41, s41, 16
  s_lshl_b32 s42, s33, 3
  s_mul_i32 s79, s42, 165888
  s_lshl_b32 s42, s76, 10
  s_add_u32 s79, s79, s42
  s_add_u32 s79, s79, 0x5000000
  buffer_load_dwordx4 v[96:99], v2, s[20:23], s79 offen sc1
  s_add_u32 s79, s79, 0x28800
  buffer_load_dwordx4 v[100:103], v2, s[20:23], s79 offen sc1
  s_add_u32 s79, s79, 0x28800
  buffer_load_dwordx4 v[104:107], v2, s[20:23], s79 offen sc1
  s_add_u32 s79, s79, 0x28800
  buffer_load_dwordx4 v[108:111], v2, s[20:23], s79 offen sc1
  s_add_u32 s79, s79, 0x28800
  buffer_load_dwordx4 v[112:115], v2, s[20:23], s79 offen sc1
  s_add_u32 s79, s79, 0x28800
  buffer_load_dwordx4 v[116:119], v2, s[20:23], s79 offen sc1
  s_add_u32 s79, s79, 0x28800
  buffer_load_dwordx4 v[120:123], v2, s[20:23], s79 offen sc1
  s_add_u32 s79, s79, 0x28800
  buffer_load_dwordx4 v[124:127], v2, s[20:23], s79 offen sc1
  s_mul_i32 s42, s41, 18
  s_sub_u32 s42, s76, s42
  s_lshl_b32 s80, s41, 7
  s_and_b32 s41, s42, 1
  s_lshl_b32 s41, s41, 6
  s_add_u32 s80, s80, s41
  s_lshr_b32 s42, s42, 1
  s_mul_i32 s41, s35, 9
  s_add_u32 s41, s41, s42
  s_mul_i32 s41, s41, 36864
  s_add_u32 s80, s80, s41
  s_lshr_b32 s41, s33, 4
  s_mul_i32 s41, s41, 1152
  s_add_u32 s80, s80, s41
  s_waitcnt vmcnt(14)
  v_lshlrev_b32 v224, 16, v64
  v_and_b32 v225, 0xffff0000, v64
  v_lshlrev_b32 v226, 16, v65
  v_and_b32 v227, 0xffff0000, v65
  v_lshlrev_b32 v228, 16, v66
  v_and_b32 v229, 0xffff0000, v66
  v_lshlrev_b32 v230, 16, v67
  v_and_b32 v231, 0xffff0000, v67
  v_lshlrev_b32 v232, 16, v68
  v_and_b32 v233, 0xffff0000, v68
  v_add_f32 v224, v224, v232
  v_add_f32 v225, v225, v233
  v_lshlrev_b32 v234, 16, v69
  v_and_b32 v235, 0xffff0000, v69
  v_add_f32 v226, v226, v234
  v_add_f32 v227, v227, v235
  v_lshlrev_b32 v232, 16, v70
  v_and_b32 v233, 0xffff0000, v70
  v_add_f32 v228, v228, v232
  v_add_f32 v229, v229, v233
  v_lshlrev_b32 v234, 16, v71
  v_and_b32 v235, 0xffff0000, v71
  v_add_f32 v230, v230, v234
  v_add_f32 v231, v231, v235
  s_waitcnt vmcnt(12)
  v_lshlrev_b32 v232, 16, v72
  v_and_b32 v233, 0xffff0000, v72
  v_add_f32 v224, v224, v232
  v_add_f32 v225, v225, v233
  v_lshlrev_b32 v234, 16, v73
  v_and_b32 v235, 0xffff0000, v73
  v_add_f32 v226, v226, v234
  v_add_f32 v227, v227, v235
  v_lshlrev_b32 v232, 16, v74
  v_and_b32 v233, 0xffff0000, v74
  v_add_f32 v228, v228, v232
  v_add_f32 v229, v229, v233
  v_lshlrev_b32 v234, 16, v75
  v_and_b32 v235, 0xffff0000, v75
  v_add_f32 v230, v230, v234
  v_add_f32 v231, v231, v235
  v_lshlrev_b32 v232, 16, v76
  v_and_b32 v233, 0xffff0000, v76
  v_add_f32 v224, v224, v232
  v_add_f32 v225, v225, v233
  v_lshlrev_b32 v234, 16, v77
  v_and_b32 v235, 0xffff0000, v77
  v_add_f32 v226, v226, v234
  v_add_f32 v227, v227, v235
  v_lshlrev_b32 v232, 16, v78
  v_and_b32 v233, 0xffff0000, v78
  v_add_f32 v228, v228, v232
  v_add_f32 v229, v229, v233
  v_lshlrev_b32 v234, 16, v79
  v_and_b32 v235, 0xffff0000, v79
  v_add_f32 v230, v230, v234
  v_add_f32 v231, v231, v235
  s_waitcnt vmcnt(10)
  v_lshlrev_b32 v232, 16, v80
  v_and_b32 v233, 0xffff0000, v80
  v_add_f32 v224, v224, v232
  v_add_f32 v225, v225, v233
  v_lshlrev_b32 v234, 16, v81
  v_and_b32 v235, 0xffff0000, v81
  v_add_f32 v226, v226, v234
  v_add_f32 v227, v227, v235
  v_lshlrev_b32 v232, 16, v82
  v_and_b32 v233, 0xffff0000, v82
  v_add_f32 v228, v228, v232
  v_add_f32 v229, v229, v233
  v_lshlrev_b32 v234, 16, v83
  v_and_b32 v235, 0xffff0000, v83
  v_add_f32 v230, v230, v234
  v_add_f32 v231, v231, v235
  v_lshlrev_b32 v232, 16, v84
  v_and_b32 v233, 0xffff0000, v84
  v_add_f32 v224, v224, v232
  v_add_f32 v225, v225, v233
  v_lshlrev_b32 v234, 16, v85
  v_and_b32 v235, 0xffff0000, v85
  v_add_f32 v226, v226, v234
  v_add_f32 v227, v227, v235
  v_lshlrev_b32 v232, 16, v86
  v_and_b32 v233, 0xffff0000, v86
  v_add_f32 v228, v228, v232
  v_add_f32 v229, v229, v233
  v_lshlrev_b32 v234, 16, v87
  v_and_b32 v235, 0xffff0000, v87
  v_add_f32 v230, v230, v234
  v_add_f32 v231, v231, v235
  s_waitcnt vmcnt(8)
  v_lshlrev_b32 v232, 16, v88
  v_and_b32 v233, 0xffff0000, v88
  v_add_f32 v224, v224, v232
  v_add_f32 v225, v225, v233
  v_lshlrev_b32 v234, 16, v89
  v_and_b32 v235, 0xffff0000, v89
  v_add_f32 v226, v226, v234
  v_add_f32 v227, v227, v235
  v_lshlrev_b32 v232, 16, v90
  v_and_b32 v233, 0xffff0000, v90
  v_add_f32 v228, v228, v232
  v_add_f32 v229, v229, v233
  v_lshlrev_b32 v234, 16, v91
  v_and_b32 v235, 0xffff0000, v91
  v_add_f32 v230, v230, v234
  v_add_f32 v231, v231, v235
  v_lshlrev_b32 v232, 16, v92
  v_and_b32 v233, 0xffff0000, v92
  v_add_f32 v224, v224, v232
  v_add_f32 v225, v225, v233
  v_lshlrev_b32 v234, 16, v93
  v_and_b32 v235, 0xffff0000, v93
  v_add_f32 v226, v226, v234
  v_add_f32 v227, v227, v235
  v_lshlrev_b32 v232, 16, v94
  v_and_b32 v233, 0xffff0000, v94
  v_add_f32 v228, v228, v232
  v_add_f32 v229, v229, v233
  v_lshlrev_b32 v234, 16, v95
  v_and_b32 v235, 0xffff0000, v95
  v_add_f32 v230, v230, v234
  v_add_f32 v231, v231, v235
  v_cvt_pk_bf16_f32 v232, v224, v225
  v_cvt_pk_bf16_f32 v233, v226, v227
  v_cvt_pk_bf16_f32 v234, v228, v229
  v_cvt_pk_bf16_f32 v235, v230, v231
  s_nop 0
  v_permlane32_swap_b32 v232, v234
  v_permlane32_swap_b32 v233, v235
  s_nop 0
  v_permlane16_swap_b32 v232, v234
  v_permlane16_swap_b32 v233, v235
  buffer_store_dwordx4 v[232:235], v239, s[28:31], s77 offen
  s_nop 1
  buffer_load_dwordx2 v[236:237], v238, s[20:23], 0 offen sc1
  s_waitcnt vmcnt(8)
  v_lshlrev_b32 v224, 16, v96
  v_and_b32 v225, 0xffff0000, v96
  v_lshlrev_b32 v226, 16, v97
  v_and_b32 v227, 0xffff0000, v97
  v_lshlrev_b32 v228, 16, v98
  v_and_b32 v229, 0xffff0000, v98
  v_lshlrev_b32 v230, 16, v99
  v_and_b32 v231, 0xffff0000, v99
  v_lshlrev_b32 v232, 16, v100
  v_and_b32 v233, 0xffff0000, v100
  v_add_f32 v224, v224, v232
  v_add_f32 v225, v225, v233
  v_lshlrev_b32 v234, 16, v101
  v_and_b32 v235, 0xffff0000, v101
  v_add_f32 v226, v226, v234
  v_add_f32 v227, v227, v235
  v_lshlrev_b32 v232, 16, v102
  v_and_b32 v233, 0xffff0000, v102
  v_add_f32 v228, v228, v232
  v_add_f32 v229, v229, v233
  v_lshlrev_b32 v234, 16, v103
  v_and_b32 v235, 0xffff0000, v103
  v_add_f32 v230, v230, v234
  v_add_f32 v231, v231, v235
  s_waitcnt vmcnt(6)
  v_lshlrev_b32 v232, 16, v104
  v_and_b32 v233, 0xffff0000, v104
  v_add_f32 v224, v224, v232
  v_add_f32 v225, v225, v233
  v_lshlrev_b32 v234, 16, v105
  v_and_b32 v235, 0xffff0000, v105
  v_add_f32 v226, v226, v234
  v_add_f32 v227, v227, v235
  v_lshlrev_b32 v232, 16, v106
  v_and_b32 v233, 0xffff0000, v106
  v_add_f32 v228, v228, v232
  v_add_f32 v229, v229, v233
  v_lshlrev_b32 v234, 16, v107
  v_and_b32 v235, 0xffff0000, v107
  v_add_f32 v230, v230, v234
  v_add_f32 v231, v231, v235
  v_lshlrev_b32 v232, 16, v108
  v_and_b32 v233, 0xffff0000, v108
  v_add_f32 v224, v224, v232
  v_add_f32 v225, v225, v233
  v_lshlrev_b32 v234, 16, v109
  v_and_b32 v235, 0xffff0000, v109
  v_add_f32 v226, v226, v234
  v_add_f32 v227, v227, v235
  v_lshlrev_b32 v232, 16, v110
  v_and_b32 v233, 0xffff0000, v110
  v_add_f32 v228, v228, v232
  v_add_f32 v229, v229, v233
  v_lshlrev_b32 v234, 16, v111
  v_and_b32 v235, 0xffff0000, v111
  v_add_f32 v230, v230, v234
  v_add_f32 v231, v231, v235
  s_waitcnt vmcnt(4)
  v_lshlrev_b32 v232, 16, v112
  v_and_b32 v233, 0xffff0000, v112
  v_add_f32 v224, v224, v232
  v_add_f32 v225, v225, v233
  v_lshlrev_b32 v234, 16, v113
  v_and_b32 v235, 0xffff0000, v113
  v_add_f32 v226, v226, v234
  v_add_f32 v227, v227, v235
  v_lshlrev_b32 v232, 16, v114
  v_and_b32 v233, 0xffff0000, v114
  v_add_f32 v228, v228, v232
  v_add_f32 v229, v229, v233
  v_lshlrev_b32 v234, 16, v115
  v_and_b32 v235, 0xffff0000, v115
  v_add_f32 v230, v230, v234
  v_add_f32 v231, v231, v235
  v_lshlrev_b32 v232, 16, v116
  v_and_b32 v233, 0xffff0000, v116
  v_add_f32 v224, v224, v232
  v_add_f32 v225, v225, v233
  v_lshlrev_b32 v234, 16, v117
  v_and_b32 v235, 0xffff0000, v117
  v_add_f32 v226, v226, v234
  v_add_f32 v227, v227, v235
  v_lshlrev_b32 v232, 16, v118
  v_and_b32 v233, 0xffff0000, v118
  v_add_f32 v228, v228, v232
  v_add_f32 v229, v229, v233
  v_lshlrev_b32 v234, 16, v119
  v_and_b32 v235, 0xffff0000, v119
  v_add_f32 v230, v230, v234
  v_add_f32 v231, v231, v235
  s_waitcnt vmcnt(2)
  v_lshlrev_b32 v232, 16, v120
  v_and_b32 v233, 0xffff0000, v120
  v_add_f32 v224, v224, v232
  v_add_f32 v225, v225, v233
  v_lshlrev_b32 v234, 16, v121
  v_and_b32 v235, 0xffff0000, v121
  v_add_f32 v226, v226, v234
  v_add_f32 v227, v227, v235
  v_lshlrev_b32 v232, 16, v122
  v_and_b32 v233, 0xffff0000, v122
  v_add_f32 v228, v228, v232
  v_add_f32 v229, v229, v233
  v_lshlrev_b32 v234, 16, v123
  v_and_b32 v235, 0xffff0000, v123
  v_add_f32 v230, v230, v234
  v_add_f32 v231, v231, v235
  v_lshlrev_b32 v232, 16, v124
  v_and_b32 v233, 0xffff0000, v124
  v_add_f32 v224, v224, v232
  v_add_f32 v225, v225, v233
  v_lshlrev_b32 v234, 16, v125
  v_and_b32 v235, 0xffff0000, v125
  v_add_f32 v226, v226, v234
  v_add_f32 v227, v227, v235
  v_lshlrev_b32 v232, 16, v126
  v_and_b32 v233, 0xffff0000, v126
  v_add_f32 v228, v228, v232
  v_add_f32 v229, v229, v233
  v_lshlrev_b32 v234, 16, v127
  v_and_b32 v235, 0xffff0000, v127
  v_add_f32 v230, v230, v234
  v_add_f32 v231, v231, v235
  v_cvt_pk_bf16_f32 v232, v224, v225
  v_cvt_pk_bf16_f32 v233, v226, v227
  v_cvt_pk_bf16_f32 v234, v228, v229
  v_cvt_pk_bf16_f32 v235, v230, v231
  s_nop 0
  v_permlane32_swap_b32 v232, v234
  v_permlane32_swap_b32 v233, v235
  s_nop 0
  v_permlane16_swap_b32 v232, v234
  v_permlane16_swap_b32 v233, v235
  buffer_store_dwordx4 v[232:235], v239, s[28:31], s80 offen
  s_nop 1
  s_add_u32 s76, s76, 128
  s_cmp_ge_u32 s76, 162
  s_cbranch_scc1 L_t2e
  s_waitcnt vmcnt(1)
  s_mov_b32 s83, 0x100000
  v_readfirstlane_b32 s81, v236
  v_readfirstlane_b32 s82, v237
  s_mul_i32 s41, s76, 3641
  s_lshr_b32 s41, s41, 16
  s_add_u32 s42, s41, 1
  s_mul_i32 s42, s42, 0x01010101
  s_or_b32 s81, s81, 0x80808080
  s_or_b32 s82, s82, 0x80808080
  s_sub_u32 s81, s81, s42
  s_sub_u32 s82, s82, s42
  s_and_b32 s81, s81, s82
  s_and_b32 s81, s81, 0x80808080
  s_cmp_eq_u32 s81, 0x80808080
  s_cbranch_scc1 L_spxb_go
L_spxb:
  buffer_load_dwordx2 v[236:237], v238, s[20:23], 0 offen sc1
  s_waitcnt vmcnt(0)
  v_readfirstlane_b32 s81, v236
  v_readfirstlane_b32 s82, v237
  s_mul_i32 s41, s76, 3641
  s_lshr_b32 s41, s41, 16
  s_add_u32 s42, s41, 1
  s_mul_i32 s42, s42, 0x01010101
  s_or_b32 s81, s81, 0x80808080
  s_or_b32 s82, s82, 0x80808080
  s_sub_u32 s81, s81, s42
  s_sub_u32 s82, s82, s42
  s_and_b32 s81, s81, s82
  s_and_b32 s81, s81, 0x80808080
  s_cmp_eq_u32 s81, 0x80808080
  s_cbranch_scc1 L_spxb_go
  s_sleep 1
  s_sub_u32 s83, s83, 1
  s_cmp_lg_u32 s83, 0
  s_cbranch_scc1 L_spxb
L_spxb_go:
  s_mul_i32 s41, s76, 3641
  s_lshr_b32 s41, s41, 16
  s_lshl_b32 s42, s33, 3
  s_mul_i32 s79, s42, 165888
  s_lshl_b32 s42, s76, 10
  s_add_u32 s79, s79, s42
  s_add_u32 s79, s79, 0x5000000
  buffer_load_dwordx4 v[128:131], v2, s[20:23], s79 offen sc1
  s_add_u32 s79, s79, 0x28800
  buffer_load_dwordx4 v[132:135], v2, s[20:23], s79 offen sc1
  s_add_u32 s79, s79, 0x28800
  buffer_load_dwordx4 v[136:139], v2, s[20:23], s79 offen sc1
  s_add_u32 s79, s79, 0x28800
  buffer_load_dwordx4 v[140:143], v2, s[20:23], s79 offen sc1
  s_add_u32 s79, s79, 0x28800
  buffer_load_dwordx4 v[144:147], v2, s[20:23], s79 offen sc1
  s_add_u32 s79, s79, 0x28800
  buffer_load_dwordx4 v[148:151], v2, s[20:23], s79 offen sc1
  s_add_u32 s79, s79, 0x28800
  buffer_load_dwordx4 v[152:155], v2, s[20:23], s79 offen sc1
  s_add_u32 s79, s79, 0x28800
  buffer_load_dwordx4 v[156:159], v2, s[20:23], s79 offen sc1
  s_mul_i32 s42, s41, 18
  s_sub_u32 s42, s76, s42
  s_lshl_b32 s78, s41, 7
  s_and_b32 s41, s42, 1
  s_lshl_b32 s41, s41, 6
  s_add_u32 s78, s78, s41
  s_lshr_b32 s42, s42, 1
  s_mul_i32 s41, s35, 9
  s_add_u32 s41, s41, s42
  s_mul_i32 s41, s41, 36864
  s_add_u32 s78, s78, s41
  s_lshr_b32 s41, s33, 4
  s_mul_i32 s41, s41, 1152
  s_add_u32 s78, s78, s41
  s_waitcnt vmcnt(6)
  v_lshlrev_b32 v224, 16, v128
  v_and_b32 v225, 0xffff0000, v128
  v_lshlrev_b32 v226, 16, v129
  v_and_b32 v227, 0xffff0000, v129
  v_lshlrev_b32 v228, 16, v130
  v_and_b32 v229, 0xffff0000, v130
  v_lshlrev_b32 v230, 16, v131
  v_and_b32 v231, 0xffff0000, v131
  v_lshlrev_b32 v232, 16, v132
  v_and_b32 v233, 0xffff0000, v132
  v_add_f32 v224, v224, v232
  v_add_f32 v225, v225, v233
  v_lshlrev_b32 v234, 16, v133
  v_and_b32 v235, 0xffff0000, v133
  v_add_f32 v226, v226, v234
  v_add_f32 v227, v227, v235
  v_lshlrev_b32 v232, 16, v134
  v_and_b32 v233, 0xffff0000, v134
  v_add_f32 v228, v228, v232
  v_add_f32 v229, v229, v233
  v_lshlrev_b32 v234, 16, v135
  v_and_b32 v235, 0xffff0000, v135
  v_add_f32 v230, v230, v234
  v_add_f32 v231, v231, v235
  s_waitcnt vmcnt(4)
  v_lshlrev_b32 v232, 16, v136
  v_and_b32 v233, 0xffff0000, v136
  v_add_f32 v224, v224, v232
  v_add_f32 v225, v225, v233
  v_lshlrev_b32 v234, 16, v137
  v_and_b32 v235, 0xffff0000, v137
  v_add_f32 v226, v226, v234
  v_add_f32 v227, v227, v235
  v_lshlrev_b32 v232, 16, v138
  v_and_b32 v233, 0xffff0000, v138
  v_add_f32 v228, v228, v232
  v_add_f32 v229, v229, v233
  v_lshlrev_b32 v234, 16, v139
  v_and_b32 v235, 0xffff0000, v139
  v_add_f32 v230, v230, v234
  v_add_f32 v231, v231, v235
  v_lshlrev_b32 v232, 16, v140
  v_and_b32 v233, 0xffff0000, v140
  v_add_f32 v224, v224, v232
  v_add_f32 v225, v225, v233
  v_lshlrev_b32 v234, 16, v141
  v_and_b32 v235, 0xffff0000, v141
  v_add_f32 v226, v226, v234
  v_add_f32 v227, v227, v235
  v_lshlrev_b32 v232, 16, v142
  v_and_b32 v233, 0xffff0000, v142
  v_add_f32 v228, v228, v232
  v_add_f32 v229, v229, v233
  v_lshlrev_b32 v234, 16, v143
  v_and_b32 v235, 0xffff0000, v143
  v_add_f32 v230, v230, v234
  v_add_f32 v231, v231, v235
  s_waitcnt vmcnt(2)
  v_lshlrev_b32 v232, 16, v144
  v_and_b32 v233, 0xffff0000, v144
  v_add_f32 v224, v224, v232
  v_add_f32 v225, v225, v233
  v_lshlrev_b32 v234, 16, v145
  v_and_b32 v235, 0xffff0000, v145
  v_add_f32 v226, v226, v234
  v_add_f32 v227, v227, v235
  v_lshlrev_b32 v232, 16, v146
  v_and_b32 v233, 0xffff0000, v146
  v_add_f32 v228, v228, v232
  v_add_f32 v229, v229, v233
  v_lshlrev_b32 v234, 16, v147
  v_and_b32 v235, 0xffff0000, v147
  v_add_f32 v230, v230, v234
  v_add_f32 v231, v231, v235
  v_lshlrev_b32 v232, 16, v148
  v_and_b32 v233, 0xffff0000, v148
  v_add_f32 v224, v224, v232
  v_add_f32 v225, v225, v233
  v_lshlrev_b32 v234, 16, v149
  v_and_b32 v235, 0xffff0000, v149
  v_add_f32 v226, v226, v234
  v_add_f32 v227, v227, v235
  v_lshlrev_b32 v232, 16, v150
  v_and_b32 v233, 0xffff0000, v150
  v_add_f32 v228, v228, v232
  v_add_f32 v229, v229, v233
  v_lshlrev_b32 v234, 16, v151
  v_and_b32 v235, 0xffff0000, v151
  v_add_f32 v230, v230, v234
  v_add_f32 v231, v231, v235
  s_waitcnt vmcnt(0)
  v_lshlrev_b32 v232, 16, v152
  v_and_b32 v233, 0xffff0000, v152
  v_add_f32 v224, v224, v232
  v_add_f32 v225, v225, v233
  v_lshlrev_b32 v234, 16, v153
  v_and_b32 v235, 0xffff0000, v153
  v_add_f32 v226, v226, v234
  v_add_f32 v227, v227, v235
  v_lshlrev_b32 v232, 16, v154
  v_and_b32 v233, 0xffff0000, v154
  v_add_f32 v228, v228, v232
  v_add_f32 v229, v229, v233
  v_lshlrev_b32 v234, 16, v155
  v_and_b32 v235, 0xffff0000, v155
  v_add_f32 v230, v230, v234
  v_add_f32 v231, v231, v235
  v_lshlrev_b32 v232, 16, v156
  v_and_b32 v233, 0xffff0000, v156
  v_add_f32 v224, v224, v232
  v_add_f32 v225, v225, v233
  v_lshlrev_b32 v234, 16, v157
  v_and_b32 v235, 0xffff0000, v157
  v_add_f32 v226, v226, v234
  v_add_f32 v227, v227, v235
  v_lshlrev_b32 v232, 16, v158
  v_and_b32 v233, 0xffff0000, v158
  v_add_f32 v228, v228, v232
  v_add_f32 v229, v229, v233
  v_lshlrev_b32 v234, 16, v159
  v_and_b32 v235, 0xffff0000, v159
  v_add_f32 v230, v230, v234
  v_add_f32 v231, v231, v235
  v_cvt_pk_bf16_f32 v232, v224, v225
  v_cvt_pk_bf16_f32 v233, v226, v227
  v_cvt_pk_bf16_f32 v234, v228, v229
  v_cvt_pk_bf16_f32 v235, v230, v231
  s_nop 0
  v_permlane32_swap_b32 v232, v234
  v_permlane32_swap_b32 v233, v235
  s_nop 0
  v_permlane16_swap_b32 v232, v234
  v_permlane16_swap_b32 v233, v235
  buffer_store_dwordx4 v[232:235], v239, s[28:31], s78 offen
  s_nop 1
L_t2e:
  s_endpgm
L_Bx:
  s_sub_u32 s37, s32, 4
  s_mov_b32 s36, 0
  s_mov_b32 s88, 0x3e0293ee
  s_mov_b32 s89, 0x3e0293ee
  v_lshrrev_b32 v18, 4, v0
  v_bfe_u32 v19, v0, 2, 2
  v_lshl_add_u32 v28, v18, 3, v19
  v_lshlrev_b32 v28, 8, v28
  v_and_b32 v18, 1, v18
  v_lshl_add_u32 v19, v18, 2, v19
  v_and_b32 v18, 3, v0
  v_lshl_add_u32 v28, v18, 3, v28
  v_xor_b32 v18, 0, v19
  v_lshl_add_u32 v2, v18, 5, v28
  v_xor_b32 v18, 1, v19
  v_lshl_add_u32 v3, v18, 5, v28
  v_xor_b32 v18, 2, v19
  v_lshl_add_u32 v4, v18, 5, v28
  v_xor_b32 v18, 3, v19
  v_lshl_add_u32 v5, v18, 5, v28
  v_xor_b32 v18, 4, v19
  v_lshl_add_u32 v6, v18, 5, v28
  v_xor_b32 v18, 5, v19
  v_lshl_add_u32 v7, v18, 5, v28
  v_xor_b32 v18, 6, v19
  v_lshl_add_u32 v8, v18, 5, v28
  v_xor_b32 v18, 7, v19
  v_lshl_add_u32 v9, v18, 5, v28
  v_bfe_u32 v18, v0, 1, 3
  v_lshrrev_b32 v19, 4, v0
  v_xor_b32 v18, v18, v19
  v_lshlrev_b32 v18, 4, v18
  v_and_b32 v19, 15, v0
  v_lshl_add_u32 v10, v19, 7, v18
  v_lshlrev_b32 v12, 4, v0
  v_lshrrev_b32 v18, 5, v0
  v_lshl_add_u32 v18, v18, 4, v19
  v_lshlrev_b32 v18, 4, v18
  v_bfe_u32 v19, v0, 4, 1
  v_lshl_add_u32 v18, v19, 3, v18
  v_add_u32 v13, 0x1e800, v18
  s_mul_i32 s38, s37, 3072
  s_mul_i32 s39, s37, 12288
  s_mul_i32 s40, s37, 6144
  v_add_u32 v10, s40, v10
  v_add_u32 v12, s38, v12
  v_add_u32 v13, s39, v13
  v_xor_b32 v11, 64, v10
  s_setprio 0
  s_mul_i32 s38, s35, 2
  s_mul_i32 s39, s34, 1
  s_add_u32 s38, s38, s39
  s_mul_i32 s39, s38, 57
  s_lshr_b32 s39, s39, 9
  s_mul_i32 s39, s39, 9
  s_sub_u32 s91, s38, s39
  s_lshl_b32 s90, s91, 1
  s_mul_i32 s50, s35, 165888
  s_mul_i32 s38, s37, 82944
  s_add_u32 s50, s50, s38
  s_mul_i32 s62, s37, 9216
  s_lshl_b32 s40, s37, 2
  s_lshl_b32 s38, s91, 1
  s_add_u32 s38, s38, 8
  s_sub_u32 s39, s38, 18
  s_cmp_ge_u32 s38, 18
  s_cselect_b32 s38, s39, s38
  s_lshl_b32 s38, s38, 6
  s_add_u32 s84, s38, s50
  s_lshl_b32 s38, s91, 1
  s_add_u32 s38, s38, 10
  s_sub_u32 s39, s38, 18
  s_cmp_ge_u32 s38, 18
  s_cselect_b32 s38, s39, s38
  s_lshl_b32 s38, s38, 6
  s_add_u32 s85, s38, s50
  s_lshl_b32 s38, s91, 1
  s_add_u32 s38, s38, 12
  s_sub_u32 s39, s38, 18
  s_cmp_ge_u32 s38, 18
  s_cselect_b32 s38, s39, s38
  s_lshl_b32 s38, s38, 6
  s_add_u32 s86, s38, s50
  s_lshl_b32 s38, s91, 1
  s_add_u32 s38, s38, 14
  s_sub_u32 s39, s38, 18
  s_cmp_ge_u32 s38, 18
  s_cselect_b32 s38, s39, s38
  s_lshl_b32 s38, s38, 6
  s_add_u32 s87, s38, s50
  s_lshl_b32 s38, s91, 1
  s_add_u32 s38, s38, 6
  s_sub_u32 s39, s38, 18
  s_cmp_ge_u32 s38, 18
  s_cselect_b32 s38, s39, s38
  s_lshl_b32 s38, s38, 6
  s_add_u32 s82, s38, s50
  s_lshl_b32 s38, s91, 1
  s_add_u32 s38, s38, 16
  s_sub_u32 s39, s38, 18
  s_cmp_ge_u32 s38, 18
  s_cselect_b32 s38, s39, s38
  s_lshl_b32 s38, s38, 6
  s_add_u32 s83, s38, s50
  v_lshrrev_b32 v18, 4, v0
  v_or_b32 v18, 0, v18
  v_xor_b32 v18, s40, v18
  v_xor_b32 v18, v18, v0
  v_and_b32 v18, 7, v18
  v_lshlrev_b32 v18, 4, v18
  v_lshrrev_b32 v19, 3, v0
  v_mul_u32_u24 v19, 1152, v19
  v_add_u32 v18, v18, v19
  v_add_u32 v14, 0, v18
  v_lshrrev_b32 v18, 4, v0
  v_or_b32 v18, 4, v18
  v_xor_b32 v18, s40, v18
  v_xor_b32 v18, v18, v0
  v_and_b32 v18, 7, v18
  v_lshlrev_b32 v18, 4, v18
  v_lshrrev_b32 v19, 3, v0
  v_mul_u32_u24 v19, 1152, v19
  v_add_u32 v18, v18, v19
  v_add_u32 v15, 8192, v18
  v_lshrrev_b32 v18, 4, v0
  v_or_b32 v18, 0, v18
  v_xor_b32 v18, s40, v18
  v_xor_b32 v18, v18, v0
  v_and_b32 v18, 7, v18
  v_lshlrev_b32 v18, 4, v18
  v_lshrrev_b32 v19, 3, v0
  v_mul_u32_u24 v19, 1152, v19
  v_add_u32 v18, v18, v19
  v_add_u32 v16, 16384, v18
  v_lshrrev_b32 v18, 4, v0
  v_or_b32 v18, 4, v18
  v_xor_b32 v18, s40, v18
  v_xor_b32 v18, v18, v0
  v_and_b32 v18, 7, v18
  v_lshlrev_b32 v18, 4, v18
  v_lshrrev_b32 v19, 3, v0
  v_mul_u32_u24 v19, 1152, v19
  v_add_u32 v18, v18, v19
  v_add_u32 v17, 24576, v18
  s_waitcnt lgkmcnt(0)
  s_barrier
  v_add_u32 v10, 0xa000, v10
  v_add_u32 v11, 0xa000, v11
  ds_read_b64_tr_b16 v[124:125], v2
  ds_read_b64_tr_b16 v[126:127], v2 offset:1024
  ds_read_b64_tr_b16 v[128:129], v3
  ds_read_b64_tr_b16 v[130:131], v3 offset:1024
  ds_read_b64_tr_b16 v[132:133], v4
  ds_read_b64_tr_b16 v[134:135], v4 offset:1024
  ds_read_b64_tr_b16 v[136:137], v5
  ds_read_b64_tr_b16 v[138:139], v5 offset:1024
  ds_read_b128 v[168:171], v10
  ds_read_b128 v[172:175], v10 offset:2048
  ds_read_b128 v[176:179], v10 offset:4096
  s_waitcnt lgkmcnt(2)
  v_mfma_f32_16x16x32_bf16 v[28:31], v[124:127], v[168:171], 0
  ds_read_b64_tr_b16 v[140:141], v2 offset:8192
  ds_read_b64_tr_b16 v[142:143], v2 offset:9216
  v_mfma_f32_16x16x32_bf16 v[40:43], v[128:131], v[168:171], 0
  ds_read_b64_tr_b16 v[144:145], v3 offset:8192
  v_mfma_f32_16x16x32_bf16 v[52:55], v[132:135], v[168:171], 0
  ds_read_b64_tr_b16 v[146:147], v3 offset:9216
  v_mfma_f32_16x16x32_bf16 v[64:67], v[136:139], v[168:171], 0
  ds_read_b64_tr_b16 v[148:149], v4 offset:8192
  s_waitcnt lgkmcnt(6)
  v_mfma_f32_16x16x32_bf16 v[32:35], v[124:127], v[172:175], 0
  ds_read_b64_tr_b16 v[150:151], v4 offset:9216
  v_mfma_f32_16x16x32_bf16 v[44:47], v[128:131], v[172:175], 0
  ds_read_b64_tr_b16 v[152:153], v5 offset:8192
  v_mfma_f32_16x16x32_bf16 v[56:59], v[132:135], v[172:175], 0
  ds_read_b64_tr_b16 v[154:155], v5 offset:9216
  v_mfma_f32_16x16x32_bf16 v[68:71], v[136:139], v[172:175], 0
  ds_read_b128 v[180:183], v11
  s_waitcnt lgkmcnt(9)
  v_mfma_f32_16x16x32_bf16 v[36:39], v[124:127], v[176:179], 0
  ds_read_b128 v[184:187], v11 offset:2048
  v_mfma_f32_16x16x32_bf16 v[48:51], v[128:131], v[176:179], 0
  ds_read_b128 v[188:191], v11 offset:4096
  v_mfma_f32_16x16x32_bf16 v[60:63], v[132:135], v[176:179], 0
  v_mfma_f32_16x16x32_bf16 v[72:75], v[136:139], v[176:179], 0
  s_waitcnt lgkmcnt(2)
  v_mfma_f32_16x16x32_bf16 v[28:31], v[140:143], v[180:183], v[28:31]
  v_mfma_f32_16x16x32_bf16 v[40:43], v[144:147], v[180:183], v[40:43]
  v_mfma_f32_16x16x32_bf16 v[52:55], v[148:151], v[180:183], v[52:55]
  v_mfma_f32_16x16x32_bf16 v[64:67], v[152:155], v[180:183], v[64:67]
  s_waitcnt lgkmcnt(1)
  v_mfma_f32_16x16x32_bf16 v[32:35], v[140:143], v[184:187], v[32:35]
  v_mfma_f32_16x16x32_bf16 v[44:47], v[144:147], v[184:187], v[44:47]
  v_mfma_f32_16x16x32_bf16 v[56:59], v[148:151], v[184:187], v[56:59]
  v_mfma_f32_16x16x32_bf16 v[68:71], v[152:155], v[184:187], v[68:71]
  s_waitcnt lgkmcnt(0)
  v_mfma_f32_16x16x32_bf16 v[36:39], v[140:143], v[188:191], v[36:39]
  v_mfma_f32_16x16x32_bf16 v[48:51], v[144:147], v[188:191], v[48:51]
  v_mfma_f32_16x16x32_bf16 v[60:63], v[148:151], v[188:191], v[60:63]
  v_mfma_f32_16x16x32_bf16 v[72:75], v[152:155], v[188:191], v[72:75]
  s_waitcnt lgkmcnt(0)
  s_barrier
  ds_read_b64_tr_b16 v[124:125], v2 offset:16384
  ds_read_b64_tr_b16 v[126:127], v2 offset:17408
  ds_read_b64_tr_b16 v[128:129], v3 offset:16384
  ds_read_b64_tr_b16 v[130:131], v3 offset:17408
  ds_read_b64_tr_b16 v[132:133], v4 offset:16384
  ds_read_b64_tr_b16 v[134:135], v4 offset:17408
  ds_read_b64_tr_b16 v[136:137], v5 offset:16384
  ds_read_b64_tr_b16 v[138:139], v5 offset:17408
  ds_read_b128 v[192:195], v10 offset:26624
  ds_read_b128 v[196:199], v10 offset:28672
  ds_read_b128 v[200:203], v10 offset:30720
  s_waitcnt lgkmcnt(2)
  v_mfma_f32_16x16x32_bf16 v[28:31], v[124:127], v[192:195], v[28:31]
  ds_read_b64_tr_b16 v[140:141], v2 offset:24576
  ds_read_b64_tr_b16 v[142:143], v2 offset:25600
  v_mfma_f32_16x16x32_bf16 v[40:43], v[128:131], v[192:195], v[40:43]
  ds_read_b64_tr_b16 v[144:145], v3 offset:24576
  v_mfma_f32_16x16x32_bf16 v[52:55], v[132:135], v[192:195], v[52:55]
  ds_read_b64_tr_b16 v[146:147], v3 offset:25600
  v_mfma_f32_16x16x32_bf16 v[64:67], v[136:139], v[192:195], v[64:67]
  ds_read_b64_tr_b16 v[148:149], v4 offset:24576
  s_waitcnt lgkmcnt(6)
  v_mfma_f32_16x16x32_bf16 v[32:35], v[124:127], v[196:199], v[32:35]
  ds_read_b64_tr_b16 v[150:151], v4 offset:25600
  v_mfma_f32_16x16x32_bf16 v[44:47], v[128:131], v[196:199], v[44:47]
  ds_read_b64_tr_b16 v[152:153], v5 offset:24576
  v_mfma_f32_16x16x32_bf16 v[56:59], v[132:135], v[196:199], v[56:59]
  ds_read_b64_tr_b16 v[154:155], v5 offset:25600
  v_mfma_f32_16x16x32_bf16 v[68:71], v[136:139], v[196:199], v[68:71]
  ds_read_b128 v[204:207], v11 offset:26624
  s_waitcnt lgkmcnt(9)
  v_mfma_f32_16x16x32_bf16 v[36:39], v[124:127], v[200:203], v[36:39]
  ds_read_b128 v[208:211], v11 offset:28672
  v_mfma_f32_16x16x32_bf16 v[48:51], v[128:131], v[200:203], v[48:51]
  ds_read_b128 v[212:215], v11 offset:30720
  v_mfma_f32_16x16x32_bf16 v[60:63], v[132:135], v[200:203], v[60:63]
  v_mfma_f32_16x16x32_bf16 v[72:75], v[136:139], v[200:203], v[72:75]
  s_waitcnt lgkmcnt(2)
  v_mfma_f32_16x16x32_bf16 v[28:31], v[140:143], v[204:207], v[28:31]
  v_mfma_f32_16x16x32_bf16 v[40:43], v[144:147], v[204:207], v[40:43]
  v_mfma_f32_16x16x32_bf16 v[52:55], v[148:151], v[204:207], v[52:55]
  v_mfma_f32_16x16x32_bf16 v[64:67], v[152:155], v[204:207], v[64:67]
  s_waitcnt lgkmcnt(1)
  v_mfma_f32_16x16x32_bf16 v[32:35], v[140:143], v[208:211], v[32:35]
  v_mfma_f32_16x16x32_bf16 v[44:47], v[144:147], v[208:211], v[44:47]
  v_mfma_f32_16x16x32_bf16 v[56:59], v[148:151], v[208:211], v[56:59]
  v_mfma_f32_16x16x32_bf16 v[68:71], v[152:155], v[208:211], v[68:71]
  s_waitcnt lgkmcnt(0)
  v_mfma_f32_16x16x32_bf16 v[36:39], v[140:143], v[212:215], v[36:39]
  v_mfma_f32_16x16x32_bf16 v[48:51], v[144:147], v[212:215], v[48:51]
  v_mfma_f32_16x16x32_bf16 v[60:63], v[148:151], v[212:215], v[60:63]
  v_mfma_f32_16x16x32_bf16 v[72:75], v[152:155], v[212:215], v[72:75]
  s_waitcnt lgkmcnt(0)
  s_barrier
  v_add_u32 v2, 0x1e800, v2
  v_add_u32 v3, 0x1e800, v3
  v_add_u32 v4, 0x1e800, v4
  v_add_u32 v5, 0x1e800, v5
  v_add_u32 v10, 0x14800, v10
  v_add_u32 v11, 0x14800, v11
  ds_read_b64_tr_b16 v[124:125], v2
  ds_read_b64_tr_b16 v[126:127], v2 offset:1024
  ds_read_b64_tr_b16 v[128:129], v3
  ds_read_b64_tr_b16 v[130:131], v3 offset:1024
  ds_read_b64_tr_b16 v[132:133], v4
  ds_read_b64_tr_b16 v[134:135], v4 offset:1024
  ds_read_b64_tr_b16 v[136:137], v5
  ds_read_b64_tr_b16 v[138:139], v5 offset:1024
  ds_read_b128 v[216:219], v10 offset:16384
  ds_read_b128 v[220:223], v10 offset:18432
  ds_read_b128 v[224:227], v10 offset:20480
  s_waitcnt lgkmcnt(2)
  v_mfma_f32_16x16x32_bf16 v[28:31], v[124:127], v[216:219], v[28:31]
  ds_read_b64_tr_b16 v[140:141], v2 offset:8192
  ds_read_b64_tr_b16 v[142:143], v2 offset:9216
  v_mfma_f32_16x16x32_bf16 v[40:43], v[128:131], v[216:219], v[40:43]
  ds_read_b64_tr_b16 v[144:145], v3 offset:8192
  v_mfma_f32_16x16x32_bf16 v[52:55], v[132:135], v[216:219], v[52:55]
  ds_read_b64_tr_b16 v[146:147], v3 offset:9216
  v_mfma_f32_16x16x32_bf16 v[64:67], v[136:139], v[216:219], v[64:67]
  ds_read_b64_tr_b16 v[148:149], v4 offset:8192
  s_waitcnt lgkmcnt(6)
  v_mfma_f32_16x16x32_bf16 v[32:35], v[124:127], v[220:223], v[32:35]
  ds_read_b64_tr_b16 v[150:151], v4 offset:9216
  v_mfma_f32_16x16x32_bf16 v[44:47], v[128:131], v[220:223], v[44:47]
  ds_read_b64_tr_b16 v[152:153], v5 offset:8192
  v_mfma_f32_16x16x32_bf16 v[56:59], v[132:135], v[220:223], v[56:59]
  ds_read_b64_tr_b16 v[154:155], v5 offset:9216
  v_mfma_f32_16x16x32_bf16 v[68:71], v[136:139], v[220:223], v[68:71]
  ds_read_b128 v[228:231], v11 offset:16384
  s_waitcnt lgkmcnt(9)
  v_mfma_f32_16x16x32_bf16 v[36:39], v[124:127], v[224:227], v[36:39]
  ds_read_b128 v[232:235], v11 offset:18432
  v_mfma_f32_16x16x32_bf16 v[48:51], v[128:131], v[224:227], v[48:51]
  ds_read_b128 v[236:239], v11 offset:20480
  v_mfma_f32_16x16x32_bf16 v[60:63], v[132:135], v[224:227], v[60:63]
  v_mfma_f32_16x16x32_bf16 v[72:75], v[136:139], v[224:227], v[72:75]
  s_waitcnt lgkmcnt(2)
  v_mfma_f32_16x16x32_bf16 v[28:31], v[140:143], v[228:231], v[28:31]
  v_mfma_f32_16x16x32_bf16 v[40:43], v[144:147], v[228:231], v[40:43]
  v_mfma_f32_16x16x32_bf16 v[52:55], v[148:151], v[228:231], v[52:55]
  v_mfma_f32_16x16x32_bf16 v[64:67], v[152:155], v[228:231], v[64:67]
  s_waitcnt lgkmcnt(1)
  v_mfma_f32_16x16x32_bf16 v[32:35], v[140:143], v[232:235], v[32:35]
  v_mfma_f32_16x16x32_bf16 v[44:47], v[144:147], v[232:235], v[44:47]
  v_mfma_f32_16x16x32_bf16 v[56:59], v[148:151], v[232:235], v[56:59]
  v_mfma_f32_16x16x32_bf16 v[68:71], v[152:155], v[232:235], v[68:71]
  s_waitcnt lgkmcnt(0)
  v_mfma_f32_16x16x32_bf16 v[36:39], v[140:143], v[236:239], v[36:39]
  v_mfma_f32_16x16x32_bf16 v[48:51], v[144:147], v[236:239], v[48:51]
  v_mfma_f32_16x16x32_bf16 v[60:63], v[148:151], v[236:239], v[60:63]
  v_mfma_f32_16x16x32_bf16 v[72:75], v[152:155], v[236:239], v[72:75]
  s_waitcnt lgkmcnt(0)
  s_barrier
  v_subrev_u32 v2, 0x1e800, v2
  v_subrev_u32 v3, 0x1e800, v3
  v_subrev_u32 v4, 0x1e800, v4
  v_subrev_u32 v5, 0x1e800, v5
  v_subrev_u32 v10, 0x14800, v10
  v_subrev_u32 v11, 0x14800, v11
  ds_read_b64_tr_b16 v[124:125], v2
  ds_read_b64_tr_b16 v[126:127], v2 offset:1024
  ds_read_b64_tr_b16 v[128:129], v3
  ds_read_b64_tr_b16 v[130:131], v3 offset:1024
  ds_read_b64_tr_b16 v[132:133], v4
  ds_read_b64_tr_b16 v[134:135], v4 offset:1024
  ds_read_b64_tr_b16 v[136:137], v5
  ds_read_b64_tr_b16 v[138:139], v5 offset:1024
  ds_read_b128 v[156:159], v10
  ds_read_b128 v[160:163], v10 offset:2048
  ds_read_b128 v[164:167], v10 offset:4096
  s_waitcnt lgkmcnt(2)
  v_mfma_f32_16x16x32_bf16 v[28:31], v[124:127], v[156:159], v[28:31]
  ds_read_b64_tr_b16 v[140:141], v2 offset:8192
  ds_read_b64_tr_b16 v[142:143], v2 offset:9216
  v_mfma_f32_16x16x32_bf16 v[40:43], v[128:131], v[156:159], v[40:43]
  ds_read_b64_tr_b16 v[144:145], v3 offset:8192
  v_mfma_f32_16x16x32_bf16 v[52:55], v[132:135], v[156:159], v[52:55]
  ds_read_b64_tr_b16 v[146:147], v3 offset:9216
  v_mfma_f32_16x16x32_bf16 v[64:67], v[136:139], v[156:159], v[64:67]
  ds_read_b64_tr_b16 v[148:149], v4 offset:8192
  s_waitcnt lgkmcnt(6)
  v_mfma_f32_16x16x32_bf16 v[32:35], v[124:127], v[160:163], v[32:35]
  ds_read_b64_tr_b16 v[150:151], v4 offset:9216
  v_mfma_f32_16x16x32_bf16 v[44:47], v[128:131], v[160:163], v[44:47]
  ds_read_b64_tr_b16 v[152:153], v5 offset:8192
  v_mfma_f32_16x16x32_bf16 v[56:59], v[132:135], v[160:163], v[56:59]
  ds_read_b64_tr_b16 v[154:155], v5 offset:9216
  v_mfma_f32_16x16x32_bf16 v[68:71], v[136:139], v[160:163], v[68:71]
  ds_read_b128 v[76:79], v11
  s_waitcnt lgkmcnt(9)
  v_mfma_f32_16x16x32_bf16 v[36:39], v[124:127], v[164:167], v[36:39]
  ds_read_b128 v[80:83], v11 offset:2048
  v_mfma_f32_16x16x32_bf16 v[48:51], v[128:131], v[164:167], v[48:51]
  ds_read_b128 v[84:87], v11 offset:4096
  v_mfma_f32_16x16x32_bf16 v[60:63], v[132:135], v[164:167], v[60:63]
  v_mfma_f32_16x16x32_bf16 v[72:75], v[136:139], v[164:167], v[72:75]
  s_waitcnt lgkmcnt(2)
  v_mfma_f32_16x16x32_bf16 v[28:31], v[140:143], v[76:79], v[28:31]
  v_mfma_f32_16x16x32_bf16 v[40:43], v[144:147], v[76:79], v[40:43]
  v_mfma_f32_16x16x32_bf16 v[52:55], v[148:151], v[76:79], v[52:55]
  v_mfma_f32_16x16x32_bf16 v[64:67], v[152:155], v[76:79], v[64:67]
  s_waitcnt lgkmcnt(1)
  v_mfma_f32_16x16x32_bf16 v[32:35], v[140:143], v[80:83], v[32:35]
  v_mfma_f32_16x16x32_bf16 v[44:47], v[144:147], v[80:83], v[44:47]
  v_mfma_f32_16x16x32_bf16 v[56:59], v[148:151], v[80:83], v[56:59]
  v_mfma_f32_16x16x32_bf16 v[68:71], v[152:155], v[80:83], v[68:71]
  s_waitcnt lgkmcnt(0)
  v_mfma_f32_16x16x32_bf16 v[36:39], v[140:143], v[84:87], v[36:39]
  v_mfma_f32_16x16x32_bf16 v[48:51], v[144:147], v[84:87], v[48:51]
  v_mfma_f32_16x16x32_bf16 v[60:63], v[148:151], v[84:87], v[60:63]
  v_mfma_f32_16x16x32_bf16 v[72:75], v[152:155], v[84:87], v[72:75]
  s_waitcnt lgkmcnt(0)
  s_barrier
  ds_read_b64_tr_b16 v[124:125], v2 offset:16384
  ds_read_b64_tr_b16 v[126:127], v2 offset:17408
  ds_read_b64_tr_b16 v[128:129], v3 offset:16384
  ds_read_b64_tr_b16 v[130:131], v3 offset:17408
  ds_read_b64_tr_b16 v[132:133], v4 offset:16384
  ds_read_b64_tr_b16 v[134:135], v4 offset:17408
  ds_read_b64_tr_b16 v[136:137], v5 offset:16384
  ds_read_b64_tr_b16 v[138:139], v5 offset:17408
  ds_read_b128 v[156:159], v10 offset:26624
  ds_read_b128 v[160:163], v10 offset:28672
  ds_read_b128 v[164:167], v10 offset:30720
  s_waitcnt lgkmcnt(2)
  v_mfma_f32_16x16x32_bf16 v[28:31], v[124:127], v[156:159], v[28:31]
  ds_read_b64_tr_b16 v[140:141], v2 offset:24576
  ds_read_b64_tr_b16 v[142:143], v2 offset:25600
  v_mfma_f32_16x16x32_bf16 v[40:43], v[128:131], v[156:159], v[40:43]
  ds_read_b64_tr_b16 v[144:145], v3 offset:24576
  v_mfma_f32_16x16x32_bf16 v[52:55], v[132:135], v[156:159], v[52:55]
  ds_read_b64_tr_b16 v[146:147], v3 offset:25600
  v_mfma_f32_16x16x32_bf16 v[64:67], v[136:139], v[156:159], v[64:67]
  ds_read_b64_tr_b16 v[148:149], v4 offset:24576
  s_waitcnt lgkmcnt(6)
  v_mfma_f32_16x16x32_bf16 v[32:35], v[124:127], v[160:163], v[32:35]
  ds_read_b64_tr_b16 v[150:151], v4 offset:25600
  v_mfma_f32_16x16x32_bf16 v[44:47], v[128:131], v[160:163], v[44:47]
  ds_read_b64_tr_b16 v[152:153], v5 offset:24576
  v_mfma_f32_16x16x32_bf16 v[56:59], v[132:135], v[160:163], v[56:59]
  ds_read_b64_tr_b16 v[154:155], v5 offset:25600
  v_mfma_f32_16x16x32_bf16 v[68:71], v[136:139], v[160:163], v[68:71]
  ds_read_b128 v[76:79], v11 offset:26624
  s_waitcnt lgkmcnt(9)
  v_mfma_f32_16x16x32_bf16 v[36:39], v[124:127], v[164:167], v[36:39]
  ds_read_b128 v[80:83], v11 offset:28672
  v_mfma_f32_16x16x32_bf16 v[48:51], v[128:131], v[164:167], v[48:51]
  ds_read_b128 v[84:87], v11 offset:30720
  v_mfma_f32_16x16x32_bf16 v[60:63], v[132:135], v[164:167], v[60:63]
  v_mfma_f32_16x16x32_bf16 v[72:75], v[136:139], v[164:167], v[72:75]
  s_waitcnt lgkmcnt(2)
  v_mfma_f32_16x16x32_bf16 v[28:31], v[140:143], v[76:79], v[28:31]
  v_mfma_f32_16x16x32_bf16 v[40:43], v[144:147], v[76:79], v[40:43]
  v_mfma_f32_16x16x32_bf16 v[52:55], v[148:151], v[76:79], v[52:55]
  v_mfma_f32_16x16x32_bf16 v[64:67], v[152:155], v[76:79], v[64:67]
  s_waitcnt lgkmcnt(1)
  v_mfma_f32_16x16x32_bf16 v[32:35], v[140:143], v[80:83], v[32:35]
  v_mfma_f32_16x16x32_bf16 v[44:47], v[144:147], v[80:83], v[44:47]
  v_mfma_f32_16x16x32_bf16 v[56:59], v[148:151], v[80:83], v[56:59]
  v_mfma_f32_16x16x32_bf16 v[68:71], v[152:155], v[80:83], v[68:71]
  s_waitcnt lgkmcnt(0)
  v_mfma_f32_16x16x32_bf16 v[36:39], v[140:143], v[84:87], v[36:39]
  v_mfma_f32_16x16x32_bf16 v[48:51], v[144:147], v[84:87], v[48:51]
  v_mfma_f32_16x16x32_bf16 v[60:63], v[148:151], v[84:87], v[60:63]
  v_mfma_f32_16x16x32_bf16 v[72:75], v[152:155], v[84:87], v[72:75]
  s_waitcnt lgkmcnt(0)
  s_barrier
  v_add_u32 v2, 0x1e800, v2
  v_add_u32 v3, 0x1e800, v3
  v_add_u32 v4, 0x1e800, v4
  v_add_u32 v5, 0x1e800, v5
  v_add_u32 v10, 0x14800, v10
  v_add_u32 v11, 0x14800, v11
  ds_read_b64_tr_b16 v[124:125], v2
  ds_read_b64_tr_b16 v[126:127], v2 offset:1024
  ds_read_b64_tr_b16 v[128:129], v3
  ds_read_b64_tr_b16 v[130:131], v3 offset:1024
  ds_read_b64_tr_b16 v[132:133], v4
  ds_read_b64_tr_b16 v[134:135], v4 offset:1024
  ds_read_b64_tr_b16 v[136:137], v5
  ds_read_b64_tr_b16 v[138:139], v5 offset:1024
  ds_read_b128 v[156:159], v10 offset:16384
  ds_read_b128 v[160:163], v10 offset:18432
  ds_read_b128 v[164:167], v10 offset:20480
  s_waitcnt lgkmcnt(2)
  v_mfma_f32_16x16x32_bf16 v[28:31], v[124:127], v[156:159], v[28:31]
  ds_read_b64_tr_b16 v[140:141], v2 offset:8192
  ds_read_b64_tr_b16 v[142:143], v2 offset:9216
  v_mfma_f32_16x16x32_bf16 v[40:43], v[128:131], v[156:159], v[40:43]
  ds_read_b64_tr_b16 v[144:145], v3 offset:8192
  v_mfma_f32_16x16x32_bf16 v[52:55], v[132:135], v[156:159], v[52:55]
  ds_read_b64_tr_b16 v[146:147], v3 offset:9216
  v_mfma_f32_16x16x32_bf16 v[64:67], v[136:139], v[156:159], v[64:67]
  ds_read_b64_tr_b16 v[148:149], v4 offset:8192
  s_waitcnt lgkmcnt(6)
  v_mfma_f32_16x16x32_bf16 v[32:35], v[124:127], v[160:163], v[32:35]
  ds_read_b64_tr_b16 v[150:151], v4 offset:9216
  v_mfma_f32_16x16x32_bf16 v[44:47], v[128:131], v[160:163], v[44:47]
  ds_read_b64_tr_b16 v[152:153], v5 offset:8192
  v_mfma_f32_16x16x32_bf16 v[56:59], v[132:135], v[160:163], v[56:59]
  ds_read_b64_tr_b16 v[154:155], v5 offset:9216
  v_mfma_f32_16x16x32_bf16 v[68:71], v[136:139], v[160:163], v[68:71]
  ds_read_b128 v[76:79], v11 offset:16384
  s_waitcnt lgkmcnt(9)
  v_mfma_f32_16x16x32_bf16 v[36:39], v[124:127], v[164:167], v[36:39]
  ds_read_b128 v[80:83], v11 offset:18432
  v_mfma_f32_16x16x32_bf16 v[48:51], v[128:131], v[164:167], v[48:51]
  ds_read_b128 v[84:87], v11 offset:20480
  v_mfma_f32_16x16x32_bf16 v[60:63], v[132:135], v[164:167], v[60:63]
  v_mfma_f32_16x16x32_bf16 v[72:75], v[136:139], v[164:167], v[72:75]
  s_waitcnt lgkmcnt(2)
  v_mfma_f32_16x16x32_bf16 v[28:31], v[140:143], v[76:79], v[28:31]
  v_mfma_f32_16x16x32_bf16 v[40:43], v[144:147], v[76:79], v[40:43]
  v_mfma_f32_16x16x32_bf16 v[52:55], v[148:151], v[76:79], v[52:55]
  v_mfma_f32_16x16x32_bf16 v[64:67], v[152:155], v[76:79], v[64:67]
  s_waitcnt lgkmcnt(1)
  v_mfma_f32_16x16x32_bf16 v[32:35], v[140:143], v[80:83], v[32:35]
  v_mfma_f32_16x16x32_bf16 v[44:47], v[144:147], v[80:83], v[44:47]
  v_mfma_f32_16x16x32_bf16 v[56:59], v[148:151], v[80:83], v[56:59]
  v_mfma_f32_16x16x32_bf16 v[68:71], v[152:155], v[80:83], v[68:71]
  s_waitcnt lgkmcnt(0)
  v_mfma_f32_16x16x32_bf16 v[36:39], v[140:143], v[84:87], v[36:39]
  v_mfma_f32_16x16x32_bf16 v[48:51], v[144:147], v[84:87], v[48:51]
  v_mfma_f32_16x16x32_bf16 v[60:63], v[148:151], v[84:87], v[60:63]
  v_mfma_f32_16x16x32_bf16 v[72:75], v[152:155], v[84:87], v[72:75]
  s_waitcnt lgkmcnt(0)
  s_barrier
  v_subrev_u32 v2, 0x1e800, v2
  v_subrev_u32 v3, 0x1e800, v3
  v_subrev_u32 v4, 0x1e800, v4
  v_subrev_u32 v5, 0x1e800, v5
  v_subrev_u32 v10, 0x14800, v10
  v_subrev_u32 v11, 0x14800, v11
  ds_read_b64_tr_b16 v[124:125], v2
  ds_read_b64_tr_b16 v[126:127], v2 offset:1024
  ds_read_b64_tr_b16 v[128:129], v3
  ds_read_b64_tr_b16 v[130:131], v3 offset:1024
  ds_read_b64_tr_b16 v[132:133], v4
  ds_read_b64_tr_b16 v[134:135], v4 offset:1024
  ds_read_b64_tr_b16 v[136:137], v5
  ds_read_b64_tr_b16 v[138:139], v5 offset:1024
  ds_read_b128 v[156:159], v10
  ds_read_b128 v[160:163], v10 offset:2048
  ds_read_b128 v[164:167], v10 offset:4096
  s_waitcnt lgkmcnt(2)
  v_mfma_f32_16x16x32_bf16 v[28:31], v[124:127], v[156:159], v[28:31]
  ds_read_b64_tr_b16 v[140:141], v2 offset:8192
  ds_read_b64_tr_b16 v[142:143], v2 offset:9216
  v_mfma_f32_16x16x32_bf16 v[40:43], v[128:131], v[156:159], v[40:43]
  ds_read_b64_tr_b16 v[144:145], v3 offset:8192
  v_mfma_f32_16x16x32_bf16 v[52:55], v[132:135], v[156:159], v[52:55]
  ds_read_b64_tr_b16 v[146:147], v3 offset:9216
  v_mfma_f32_16x16x32_bf16 v[64:67], v[136:139], v[156:159], v[64:67]
  ds_read_b64_tr_b16 v[148:149], v4 offset:8192
  s_waitcnt lgkmcnt(6)
  v_mfma_f32_16x16x32_bf16 v[32:35], v[124:127], v[160:163], v[32:35]
  ds_read_b64_tr_b16 v[150:151], v4 offset:9216
  v_mfma_f32_16x16x32_bf16 v[44:47], v[128:131], v[160:163], v[44:47]
  ds_read_b64_tr_b16 v[152:153], v5 offset:8192
  v_mfma_f32_16x16x32_bf16 v[56:59], v[132:135], v[160:163], v[56:59]
  ds_read_b64_tr_b16 v[154:155], v5 offset:9216
  v_mfma_f32_16x16x32_bf16 v[68:71], v[136:139], v[160:163], v[68:71]
  ds_read_b128 v[76:79], v11
  s_waitcnt lgkmcnt(9)
  v_mfma_f32_16x16x32_bf16 v[36:39], v[124:127], v[164:167], v[36:39]
  ds_read_b128 v[80:83], v11 offset:2048
  v_mfma_f32_16x16x32_bf16 v[48:51], v[128:131], v[164:167], v[48:51]
  ds_read_b128 v[84:87], v11 offset:4096
  v_mfma_f32_16x16x32_bf16 v[60:63], v[132:135], v[164:167], v[60:63]
  v_mfma_f32_16x16x32_bf16 v[72:75], v[136:139], v[164:167], v[72:75]
  s_waitcnt lgkmcnt(2)
  v_mfma_f32_16x16x32_bf16 v[28:31], v[140:143], v[76:79], v[28:31]
  v_mfma_f32_16x16x32_bf16 v[40:43], v[144:147], v[76:79], v[40:43]
  v_mfma_f32_16x16x32_bf16 v[52:55], v[148:151], v[76:79], v[52:55]
  v_mfma_f32_16x16x32_bf16 v[64:67], v[152:155], v[76:79], v[64:67]
  s_waitcnt lgkmcnt(1)
  v_mfma_f32_16x16x32_bf16 v[32:35], v[140:143], v[80:83], v[32:35]
  v_mfma_f32_16x16x32_bf16 v[44:47], v[144:147], v[80:83], v[44:47]
  v_mfma_f32_16x16x32_bf16 v[56:59], v[148:151], v[80:83], v[56:59]
  v_mfma_f32_16x16x32_bf16 v[68:71], v[152:155], v[80:83], v[68:71]
  s_waitcnt lgkmcnt(0)
  v_mfma_f32_16x16x32_bf16 v[36:39], v[140:143], v[84:87], v[36:39]
  v_mfma_f32_16x16x32_bf16 v[48:51], v[144:147], v[84:87], v[48:51]
  v_mfma_f32_16x16x32_bf16 v[60:63], v[148:151], v[84:87], v[60:63]
  v_mfma_f32_16x16x32_bf16 v[72:75], v[152:155], v[84:87], v[72:75]
  s_waitcnt lgkmcnt(0)
  s_barrier
  ds_read_b64_tr_b16 v[124:125], v2 offset:16384
  ds_read_b64_tr_b16 v[126:127], v2 offset:17408
  ds_read_b64_tr_b16 v[128:129], v3 offset:16384
  ds_read_b64_tr_b16 v[130:131], v3 offset:17408
  ds_read_b64_tr_b16 v[132:133], v4 offset:16384
  ds_read_b64_tr_b16 v[134:135], v4 offset:17408
  ds_read_b64_tr_b16 v[136:137], v5 offset:16384
  ds_read_b64_tr_b16 v[138:139], v5 offset:17408
  ds_read_b128 v[156:159], v10 offset:26624
  ds_read_b128 v[160:163], v10 offset:28672
  ds_read_b128 v[164:167], v10 offset:30720
  s_waitcnt lgkmcnt(2)
  v_mfma_f32_16x16x32_bf16 v[28:31], v[124:127], v[156:159], v[28:31]
  ds_read_b64_tr_b16 v[140:141], v2 offset:24576
  ds_read_b64_tr_b16 v[142:143], v2 offset:25600
  v_mfma_f32_16x16x32_bf16 v[40:43], v[128:131], v[156:159], v[40:43]
  ds_read_b64_tr_b16 v[144:145], v3 offset:24576
  v_mfma_f32_16x16x32_bf16 v[52:55], v[132:135], v[156:159], v[52:55]
  ds_read_b64_tr_b16 v[146:147], v3 offset:25600
  v_mfma_f32_16x16x32_bf16 v[64:67], v[136:139], v[156:159], v[64:67]
  ds_read_b64_tr_b16 v[148:149], v4 offset:24576
  s_waitcnt lgkmcnt(6)
  v_mfma_f32_16x16x32_bf16 v[32:35], v[124:127], v[160:163], v[32:35]
  ds_read_b64_tr_b16 v[150:151], v4 offset:25600
  v_mfma_f32_16x16x32_bf16 v[44:47], v[128:131], v[160:163], v[44:47]
  ds_read_b64_tr_b16 v[152:153], v5 offset:24576
  v_mfma_f32_16x16x32_bf16 v[56:59], v[132:135], v[160:163], v[56:59]
  ds_read_b64_tr_b16 v[154:155], v5 offset:25600
  v_mfma_f32_16x16x32_bf16 v[68:71], v[136:139], v[160:163], v[68:71]
  ds_read_b128 v[76:79], v11 offset:26624
  s_waitcnt lgkmcnt(9)
  v_mfma_f32_16x16x32_bf16 v[36:39], v[124:127], v[164:167], v[36:39]
  ds_read_b128 v[80:83], v11 offset:28672
  v_mfma_f32_16x16x32_bf16 v[48:51], v[128:131], v[164:167], v[48:51]
  ds_read_b128 v[84:87], v11 offset:30720
  v_mfma_f32_16x16x32_bf16 v[60:63], v[132:135], v[164:167], v[60:63]
  v_mfma_f32_16x16x32_bf16 v[72:75], v[136:139], v[164:167], v[72:75]
  s_waitcnt lgkmcnt(2)
  v_mfma_f32_16x16x32_bf16 v[28:31], v[140:143], v[76:79], v[28:31]
  v_mfma_f32_16x16x32_bf16 v[40:43], v[144:147], v[76:79], v[40:43]
  v_mfma_f32_16x16x32_bf16 v[52:55], v[148:151], v[76:79], v[52:55]
  v_mfma_f32_16x16x32_bf16 v[64:67], v[152:155], v[76:79], v[64:67]
  s_waitcnt lgkmcnt(1)
  v_mfma_f32_16x16x32_bf16 v[32:35], v[140:143], v[80:83], v[32:35]
  v_mfma_f32_16x16x32_bf16 v[44:47], v[144:147], v[80:83], v[44:47]
  v_mfma_f32_16x16x32_bf16 v[56:59], v[148:151], v[80:83], v[56:59]
  v_mfma_f32_16x16x32_bf16 v[68:71], v[152:155], v[80:83], v[68:71]
  s_waitcnt lgkmcnt(0)
  v_mfma_f32_16x16x32_bf16 v[36:39], v[140:143], v[84:87], v[36:39]
  v_mfma_f32_16x16x32_bf16 v[48:51], v[144:147], v[84:87], v[48:51]
  v_mfma_f32_16x16x32_bf16 v[60:63], v[148:151], v[84:87], v[60:63]
  v_mfma_f32_16x16x32_bf16 v[72:75], v[152:155], v[84:87], v[72:75]
  s_waitcnt lgkmcnt(0)
  s_barrier
  v_add_u32 v2, 0x1e800, v2
  v_add_u32 v3, 0x1e800, v3
  v_add_u32 v4, 0x1e800, v4
  v_add_u32 v5, 0x1e800, v5
  v_add_u32 v10, 0x14800, v10
  v_add_u32 v11, 0x14800, v11
  ds_read_b64_tr_b16 v[124:125], v2
  ds_read_b64_tr_b16 v[126:127], v2 offset:1024
  ds_read_b64_tr_b16 v[128:129], v3
  ds_read_b64_tr_b16 v[130:131], v3 offset:1024
  ds_read_b64_tr_b16 v[132:133], v4
  ds_read_b64_tr_b16 v[134:135], v4 offset:1024
  ds_read_b64_tr_b16 v[136:137], v5
  ds_read_b64_tr_b16 v[138:139], v5 offset:1024
  ds_read_b128 v[156:159], v10 offset:16384
  ds_read_b128 v[160:163], v10 offset:18432
  ds_read_b128 v[164:167], v10 offset:20480
  s_waitcnt lgkmcnt(2)
  v_mfma_f32_16x16x32_bf16 v[28:31], v[124:127], v[156:159], v[28:31]
  ds_read_b64_tr_b16 v[140:141], v2 offset:8192
  ds_read_b64_tr_b16 v[142:143], v2 offset:9216
  v_mfma_f32_16x16x32_bf16 v[40:43], v[128:131], v[156:159], v[40:43]
  ds_read_b64_tr_b16 v[144:145], v3 offset:8192
  v_mfma_f32_16x16x32_bf16 v[52:55], v[132:135], v[156:159], v[52:55]
  ds_read_b64_tr_b16 v[146:147], v3 offset:9216
  v_mfma_f32_16x16x32_bf16 v[64:67], v[136:139], v[156:159], v[64:67]
  ds_read_b64_tr_b16 v[148:149], v4 offset:8192
  s_waitcnt lgkmcnt(6)
  v_mfma_f32_16x16x32_bf16 v[32:35], v[124:127], v[160:163], v[32:35]
  ds_read_b64_tr_b16 v[150:151], v4 offset:9216
  v_mfma_f32_16x16x32_bf16 v[44:47], v[128:131], v[160:163], v[44:47]
  ds_read_b64_tr_b16 v[152:153], v5 offset:8192
  v_mfma_f32_16x16x32_bf16 v[56:59], v[132:135], v[160:163], v[56:59]
  ds_read_b64_tr_b16 v[154:155], v5 offset:9216
  v_mfma_f32_16x16x32_bf16 v[68:71], v[136:139], v[160:163], v[68:71]
  ds_read_b128 v[76:79], v11 offset:16384
  s_waitcnt lgkmcnt(9)
  v_mfma_f32_16x16x32_bf16 v[36:39], v[124:127], v[164:167], v[36:39]
  ds_read_b128 v[80:83], v11 offset:18432
  v_mfma_f32_16x16x32_bf16 v[48:51], v[128:131], v[164:167], v[48:51]
  ds_read_b128 v[84:87], v11 offset:20480
  v_mfma_f32_16x16x32_bf16 v[60:63], v[132:135], v[164:167], v[60:63]
  v_mfma_f32_16x16x32_bf16 v[72:75], v[136:139], v[164:167], v[72:75]
  s_waitcnt lgkmcnt(2)
  v_mfma_f32_16x16x32_bf16 v[28:31], v[140:143], v[76:79], v[28:31]
  v_mfma_f32_16x16x32_bf16 v[40:43], v[144:147], v[76:79], v[40:43]
  v_mfma_f32_16x16x32_bf16 v[52:55], v[148:151], v[76:79], v[52:55]
  v_mfma_f32_16x16x32_bf16 v[64:67], v[152:155], v[76:79], v[64:67]
  s_waitcnt lgkmcnt(1)
  v_mfma_f32_16x16x32_bf16 v[32:35], v[140:143], v[80:83], v[32:35]
  v_mfma_f32_16x16x32_bf16 v[44:47], v[144:147], v[80:83], v[44:47]
  v_mfma_f32_16x16x32_bf16 v[56:59], v[148:151], v[80:83], v[56:59]
  v_mfma_f32_16x16x32_bf16 v[68:71], v[152:155], v[80:83], v[68:71]
  s_waitcnt lgkmcnt(0)
  v_mfma_f32_16x16x32_bf16 v[36:39], v[140:143], v[84:87], v[36:39]
  v_mfma_f32_16x16x32_bf16 v[48:51], v[144:147], v[84:87], v[48:51]
  v_mfma_f32_16x16x32_bf16 v[60:63], v[148:151], v[84:87], v[60:63]
  v_mfma_f32_16x16x32_bf16 v[72:75], v[152:155], v[84:87], v[72:75]
  v_subrev_u32 v2, 0x1e800, v2
  v_subrev_u32 v3, 0x1e800, v3
  v_subrev_u32 v4, 0x1e800, v4
  v_subrev_u32 v5, 0x1e800, v5
  v_subrev_u32 v252, 0x14800, v10
  v_subrev_u32 v253, 0x14800, v11
  s_waitcnt lgkmcnt(0)
  s_barrier
  ds_read_b64_tr_b16 v[124:125], v2
  ds_read_b64_tr_b16 v[126:127], v2 offset:1024
  ds_read_b64_tr_b16 v[128:129], v3
  ds_read_b64_tr_b16 v[130:131], v3 offset:1024
  ds_read_b64_tr_b16 v[132:133], v4
  ds_read_b64_tr_b16 v[134:135], v4 offset:1024
  ds_read_b64_tr_b16 v[136:137], v5
  ds_read_b64_tr_b16 v[138:139], v5 offset:1024
  ds_read_b64_tr_b16 v[140:141], v6
  ds_read_b64_tr_b16 v[142:143], v6 offset:1024
  ds_read_b64_tr_b16 v[144:145], v7
  ds_read_b64_tr_b16 v[146:147], v7 offset:1024
  ds_read_b64_tr_b16 v[148:149], v8
  ds_read_b64_tr_b16 v[150:151], v8 offset:1024
  ds_read_b64_tr_b16 v[152:153], v9
  s_waitcnt lgkmcnt(14)
  ds_read_b64_tr_b16 v[154:155], v9 offset:1024
  v_pk_mul_f32 v[28:29], v[28:29], s[88:89]
  v_pk_mul_f32 v[30:31], v[30:31], s[88:89]
  v_cvt_pk_bf16_f32 v20, v28, v29
  v_cvt_pk_bf16_f32 v21, v30, v31
  s_waitcnt lgkmcnt(14)
  ds_write_b64 v13, v[20:21]
  v_pk_mul_f32 v[40:41], v[40:41], s[88:89]
  v_pk_mul_f32 v[42:43], v[42:43], s[88:89]
  v_cvt_pk_bf16_f32 v22, v40, v41
  v_cvt_pk_bf16_f32 v23, v42, v43
  s_waitcnt lgkmcnt(14)
  ds_write_b64 v13, v[22:23] offset:512
  v_pk_mul_f32 v[32:33], v[32:33], s[88:89]
  v_pk_mul_f32 v[34:35], v[34:35], s[88:89]
  v_mfma_f32_16x16x32_bf16 v[28:31], v[124:127], v[168:171], 0
  v_cvt_pk_bf16_f32 v24, v32, v33
  v_cvt_pk_bf16_f32 v25, v34, v35
  s_waitcnt lgkmcnt(11)
  ds_write_b64 v13, v[24:25] offset:4096
  v_pk_mul_f32 v[44:45], v[44:45], s[88:89]
  v_pk_mul_f32 v[46:47], v[46:47], s[88:89]
  v_mfma_f32_16x16x32_bf16 v[40:43], v[128:131], v[168:171], 0
  v_cvt_pk_bf16_f32 v26, v44, v45
  v_cvt_pk_bf16_f32 v27, v46, v47
  ds_write_b64 v13, v[26:27] offset:4608
  v_pk_mul_f32 v[36:37], v[36:37], s[88:89]
  v_pk_mul_f32 v[38:39], v[38:39], s[88:89]
  v_mfma_f32_16x16x32_bf16 v[32:35], v[124:127], v[172:175], 0
  v_cvt_pk_bf16_f32 v20, v36, v37
  v_cvt_pk_bf16_f32 v21, v38, v39
  ds_write_b64 v13, v[20:21] offset:8192
  v_pk_mul_f32 v[48:49], v[48:49], s[88:89]
  v_pk_mul_f32 v[50:51], v[50:51], s[88:89]
  v_mfma_f32_16x16x32_bf16 v[44:47], v[128:131], v[172:175], 0
  v_cvt_pk_bf16_f32 v22, v48, v49
  v_cvt_pk_bf16_f32 v23, v50, v51
  ds_write_b64 v13, v[22:23] offset:8704
  v_pk_mul_f32 v[52:53], v[52:53], s[88:89]
  v_pk_mul_f32 v[54:55], v[54:55], s[88:89]
  v_mfma_f32_16x16x32_bf16 v[36:39], v[124:127], v[176:179], 0
  v_cvt_pk_bf16_f32 v24, v52, v53
  v_cvt_pk_bf16_f32 v25, v54, v55
  s_waitcnt lgkmcnt(4)
  ds_write_b64 v13, v[24:25] offset:1024
  v_pk_mul_f32 v[64:65], v[64:65], s[88:89]
  v_pk_mul_f32 v[66:67], v[66:67], s[88:89]
  v_mfma_f32_16x16x32_bf16 v[48:51], v[128:131], v[176:179], 0
  v_cvt_pk_bf16_f32 v26, v64, v65
  v_cvt_pk_bf16_f32 v27, v66, v67
  ds_write_b64 v13, v[26:27] offset:1536
  v_pk_mul_f32 v[56:57], v[56:57], s[88:89]
  v_pk_mul_f32 v[58:59], v[58:59], s[88:89]
  v_mfma_f32_16x16x32_bf16 v[52:55], v[132:135], v[168:171], 0
  v_cvt_pk_bf16_f32 v20, v56, v57
  v_cvt_pk_bf16_f32 v21, v58, v59
  ds_write_b64 v13, v[20:21] offset:5120
  v_pk_mul_f32 v[68:69], v[68:69], s[88:89]
  v_pk_mul_f32 v[70:71], v[70:71], s[88:89]
  v_mfma_f32_16x16x32_bf16 v[64:67], v[136:139], v[168:171], 0
  v_cvt_pk_bf16_f32 v22, v68, v69
  v_cvt_pk_bf16_f32 v23, v70, v71
  ds_write_b64 v13, v[22:23] offset:5632
  v_pk_mul_f32 v[60:61], v[60:61], s[88:89]
  v_pk_mul_f32 v[62:63], v[62:63], s[88:89]
  v_mfma_f32_16x16x32_bf16 v[56:59], v[132:135], v[172:175], 0
  v_cvt_pk_bf16_f32 v24, v60, v61
  v_cvt_pk_bf16_f32 v25, v62, v63
  ds_write_b64 v13, v[24:25] offset:9216
  v_pk_mul_f32 v[72:73], v[72:73], s[88:89]
  v_pk_mul_f32 v[74:75], v[74:75], s[88:89]
  v_mfma_f32_16x16x32_bf16 v[68:71], v[136:139], v[172:175], 0
  v_cvt_pk_bf16_f32 v26, v72, v73
  v_cvt_pk_bf16_f32 v27, v74, v75
  ds_write_b64 v13, v[26:27] offset:9728
  v_mfma_f32_16x16x32_bf16 v[60:63], v[132:135], v[176:179], 0
  v_mfma_f32_16x16x32_bf16 v[72:75], v[136:139], v[176:179], 0
  v_mfma_f32_16x16x32_bf16 v[76:79], v[140:143], v[168:171], 0
  v_mfma_f32_16x16x32_bf16 v[88:91], v[144:147], v[168:171], 0
  v_mfma_f32_16x16x32_bf16 v[80:83], v[140:143], v[172:175], 0
  v_mfma_f32_16x16x32_bf16 v[92:95], v[144:147], v[172:175], 0
  v_mfma_f32_16x16x32_bf16 v[84:87], v[140:143], v[176:179], 0
  v_mfma_f32_16x16x32_bf16 v[96:99], v[144:147], v[176:179], 0
  v_mfma_f32_16x16x32_bf16 v[100:103], v[148:151], v[168:171], 0
  v_mfma_f32_16x16x32_bf16 v[112:115], v[152:155], v[168:171], 0
  v_mfma_f32_16x16x32_bf16 v[104:107], v[148:151], v[172:175], 0
  v_mfma_f32_16x16x32_bf16 v[116:119], v[152:155], v[172:175], 0
  v_mfma_f32_16x16x32_bf16 v[108:111], v[148:151], v[176:179], 0
  v_mfma_f32_16x16x32_bf16 v[120:123], v[152:155], v[176:179], 0
L_Bx_loop:
  s_waitcnt lgkmcnt(0)
  s_barrier
  s_setprio 3
  ds_read_b64_tr_b16 v[124:125], v2 offset:8192
  ds_read_b64_tr_b16 v[126:127], v2 offset:9216
  ds_read_b64_tr_b16 v[128:129], v3 offset:8192
  ds_read_b64_tr_b16 v[130:131], v3 offset:9216
  ds_read_b64_tr_b16 v[132:133], v4 offset:8192
  ds_read_b64_tr_b16 v[134:135], v4 offset:9216
  ds_read_b64_tr_b16 v[136:137], v5 offset:8192
  ds_read_b64_tr_b16 v[138:139], v5 offset:9216
  ds_read_b64_tr_b16 v[140:141], v6 offset:8192
  ds_read_b64_tr_b16 v[142:143], v6 offset:9216
  ds_read_b64_tr_b16 v[144:145], v7 offset:8192
  ds_read_b64_tr_b16 v[146:147], v7 offset:9216
  ds_read_b64_tr_b16 v[148:149], v8 offset:8192
  ds_read_b64_tr_b16 v[150:151], v8 offset:9216
  ds_read_b64_tr_b16 v[152:153], v9 offset:8192
  s_waitcnt lgkmcnt(14)
  ds_read_b64_tr_b16 v[154:155], v9 offset:9216
  s_waitcnt lgkmcnt(14)
  v_mfma_f32_16x16x32_bf16 v[28:31], v[124:127], v[180:183], v[28:31]
  v_mfma_f32_16x16x32_bf16 v[32:35], v[124:127], v[184:187], v[32:35]
  v_mfma_f32_16x16x32_bf16 v[36:39], v[124:127], v[188:191], v[36:39]
  s_waitcnt lgkmcnt(12)
  v_mfma_f32_16x16x32_bf16 v[40:43], v[128:131], v[180:183], v[40:43]
  v_mfma_f32_16x16x32_bf16 v[44:47], v[128:131], v[184:187], v[44:47]
  v_mfma_f32_16x16x32_bf16 v[48:51], v[128:131], v[188:191], v[48:51]
  s_waitcnt lgkmcnt(10)
  v_mfma_f32_16x16x32_bf16 v[52:55], v[132:135], v[180:183], v[52:55]
  v_mfma_f32_16x16x32_bf16 v[56:59], v[132:135], v[184:187], v[56:59]
  v_mfma_f32_16x16x32_bf16 v[60:63], v[132:135], v[188:191], v[60:63]
  s_waitcnt lgkmcnt(8)
  v_mfma_f32_16x16x32_bf16 v[64:67], v[136:139], v[180:183], v[64:67]
  v_mfma_f32_16x16x32_bf16 v[68:71], v[136:139], v[184:187], v[68:71]
  v_mfma_f32_16x16x32_bf16 v[72:75], v[136:139], v[188:191], v[72:75]
  s_waitcnt lgkmcnt(6)
  v_mfma_f32_16x16x32_bf16 v[76:79], v[140:143], v[180:183], v[76:79]
  v_mfma_f32_16x16x32_bf16 v[80:83], v[140:143], v[184:187], v[80:83]
  v_mfma_f32_16x16x32_bf16 v[84:87], v[140:143], v[188:191], v[84:87]
  s_waitcnt lgkmcnt(4)
  v_mfma_f32_16x16x32_bf16 v[88:91], v[144:147], v[180:183], v[88:91]
  v_mfma_f32_16x16x32_bf16 v[92:95], v[144:147], v[184:187], v[92:95]
  v_mfma_f32_16x16x32_bf16 v[96:99], v[144:147], v[188:191], v[96:99]
  s_waitcnt lgkmcnt(2)
  v_mfma_f32_16x16x32_bf16 v[100:103], v[148:151], v[180:183], v[100:103]
  v_mfma_f32_16x16x32_bf16 v[104:107], v[148:151], v[184:187], v[104:107]
  v_mfma_f32_16x16x32_bf16 v[108:111], v[148:151], v[188:191], v[108:111]
  s_waitcnt lgkmcnt(0)
  v_mfma_f32_16x16x32_bf16 v[112:115], v[152:155], v[180:183], v[112:115]
  v_mfma_f32_16x16x32_bf16 v[116:119], v[152:155], v[184:187], v[116:119]
  v_mfma_f32_16x16x32_bf16 v[120:123], v[152:155], v[188:191], v[120:123]
  s_setprio 0
  s_waitcnt lgkmcnt(0)
  s_barrier
  s_setprio 3
  ds_read_b64_tr_b16 v[124:125], v2 offset:16384
  ds_read_b64_tr_b16 v[126:127], v2 offset:17408
  ds_read_b64_tr_b16 v[128:129], v3 offset:16384
  ds_read_b64_tr_b16 v[130:131], v3 offset:17408
  ds_read_b64_tr_b16 v[132:133], v4 offset:16384
  ds_read_b64_tr_b16 v[134:135], v4 offset:17408
  ds_read_b64_tr_b16 v[136:137], v5 offset:16384
  ds_read_b64_tr_b16 v[138:139], v5 offset:17408
  ds_read_b64_tr_b16 v[140:141], v6 offset:16384
  ds_read_b64_tr_b16 v[142:143], v6 offset:17408
  ds_read_b64_tr_b16 v[144:145], v7 offset:16384
  ds_read_b64_tr_b16 v[146:147], v7 offset:17408
  ds_read_b64_tr_b16 v[148:149], v8 offset:16384
  ds_read_b64_tr_b16 v[150:151], v8 offset:17408
  ds_read_b64_tr_b16 v[152:153], v9 offset:16384
  s_waitcnt lgkmcnt(14)
  ds_read_b64_tr_b16 v[154:155], v9 offset:17408
  s_add_u32 s40, s82, 0x0
  s_add_u32 m0, s62, 0xa000
  s_nop 0
  buffer_load_dwordx4 v14, s[16:19], s40 offen lds
  buffer_load_dwordx4 v15, s[16:19], s40 offen offset:1024 lds
  buffer_load_dwordx4 v16, s[16:19], s40 offen offset:2048 lds
  buffer_load_dwordx4 v17, s[16:19], s40 offen offset:3072 lds
  s_waitcnt lgkmcnt(14)
  v_mfma_f32_16x16x32_bf16 v[28:31], v[124:127], v[192:195], v[28:31]
  v_mfma_f32_16x16x32_bf16 v[32:35], v[124:127], v[196:199], v[32:35]
  v_mfma_f32_16x16x32_bf16 v[36:39], v[124:127], v[200:203], v[36:39]
  s_waitcnt lgkmcnt(12)
  v_mfma_f32_16x16x32_bf16 v[40:43], v[128:131], v[192:195], v[40:43]
  v_mfma_f32_16x16x32_bf16 v[44:47], v[128:131], v[196:199], v[44:47]
  v_mfma_f32_16x16x32_bf16 v[48:51], v[128:131], v[200:203], v[48:51]
  s_add_u32 s40, s82, 0x9000
  s_add_u32 m0, s62, 0xb000
  s_nop 0
  buffer_load_dwordx4 v14, s[16:19], s40 offen lds
  buffer_load_dwordx4 v15, s[16:19], s40 offen offset:1024 lds
  buffer_load_dwordx4 v16, s[16:19], s40 offen offset:2048 lds
  buffer_load_dwordx4 v17, s[16:19], s40 offen offset:3072 lds
  s_waitcnt lgkmcnt(6)
  v_mfma_f32_16x16x32_bf16 v[52:55], v[132:135], v[192:195], v[52:55]
  v_mfma_f32_16x16x32_bf16 v[56:59], v[132:135], v[196:199], v[56:59]
  v_mfma_f32_16x16x32_bf16 v[60:63], v[132:135], v[200:203], v[60:63]
  v_mfma_f32_16x16x32_bf16 v[64:67], v[136:139], v[192:195], v[64:67]
  v_mfma_f32_16x16x32_bf16 v[68:71], v[136:139], v[196:199], v[68:71]
  v_mfma_f32_16x16x32_bf16 v[72:75], v[136:139], v[200:203], v[72:75]
  s_add_u32 s40, s82, 0x12000
  s_add_u32 m0, s62, 0xc000
  s_nop 0
  buffer_load_dwordx4 v14, s[16:19], s40 offen lds
  v_mfma_f32_16x16x32_bf16 v[76:79], v[140:143], v[192:195], v[76:79]
  v_mfma_f32_16x16x32_bf16 v[80:83], v[140:143], v[196:199], v[80:83]
  v_mfma_f32_16x16x32_bf16 v[84:87], v[140:143], v[200:203], v[84:87]
  s_waitcnt lgkmcnt(0)
  v_mfma_f32_16x16x32_bf16 v[88:91], v[144:147], v[192:195], v[88:91]
  v_mfma_f32_16x16x32_bf16 v[92:95], v[144:147], v[196:199], v[92:95]
  v_mfma_f32_16x16x32_bf16 v[96:99], v[144:147], v[200:203], v[96:99]
  v_mfma_f32_16x16x32_bf16 v[100:103], v[148:151], v[192:195], v[100:103]
  v_mfma_f32_16x16x32_bf16 v[104:107], v[148:151], v[196:199], v[104:107]
  v_mfma_f32_16x16x32_bf16 v[108:111], v[148:151], v[200:203], v[108:111]
  v_mfma_f32_16x16x32_bf16 v[112:115], v[152:155], v[192:195], v[112:115]
  v_mfma_f32_16x16x32_bf16 v[116:119], v[152:155], v[196:199], v[116:119]
  v_mfma_f32_16x16x32_bf16 v[120:123], v[152:155], v[200:203], v[120:123]
  s_setprio 0
  s_waitcnt lgkmcnt(0)
  s_barrier
  s_setprio 3
  ds_read_b64_tr_b16 v[124:125], v2 offset:24576
  ds_read_b64_tr_b16 v[126:127], v2 offset:25600
  ds_read_b64_tr_b16 v[128:129], v3 offset:24576
  ds_read_b64_tr_b16 v[130:131], v3 offset:25600
  ds_read_b64_tr_b16 v[132:133], v4 offset:24576
  ds_read_b64_tr_b16 v[134:135], v4 offset:25600
  ds_read_b64_tr_b16 v[136:137], v5 offset:24576
  ds_read_b64_tr_b16 v[138:139], v5 offset:25600
  ds_read_b64_tr_b16 v[140:141], v6 offset:24576
  ds_read_b64_tr_b16 v[142:143], v6 offset:25600
  ds_read_b64_tr_b16 v[144:145], v7 offset:24576
  ds_read_b64_tr_b16 v[146:147], v7 offset:25600
  ds_read_b64_tr_b16 v[148:149], v8 offset:24576
  ds_read_b64_tr_b16 v[150:151], v8 offset:25600
  ds_read_b64_tr_b16 v[152:153], v9 offset:24576
  s_waitcnt lgkmcnt(14)
  ds_read_b64_tr_b16 v[154:155], v9 offset:25600
  s_waitcnt lgkmcnt(14)
  v_mfma_f32_16x16x32_bf16 v[28:31], v[124:127], v[204:207], v[28:31]
  v_mfma_f32_16x16x32_bf16 v[32:35], v[124:127], v[208:211], v[32:35]
  v_mfma_f32_16x16x32_bf16 v[36:39], v[124:127], v[212:215], v[36:39]
  s_waitcnt lgkmcnt(12)
  v_mfma_f32_16x16x32_bf16 v[40:43], v[128:131], v[204:207], v[40:43]
  v_mfma_f32_16x16x32_bf16 v[44:47], v[128:131], v[208:211], v[44:47]
  v_mfma_f32_16x16x32_bf16 v[48:51], v[128:131], v[212:215], v[48:51]
  s_waitcnt lgkmcnt(10)
  v_mfma_f32_16x16x32_bf16 v[52:55], v[132:135], v[204:207], v[52:55]
  v_mfma_f32_16x16x32_bf16 v[56:59], v[132:135], v[208:211], v[56:59]
  v_mfma_f32_16x16x32_bf16 v[60:63], v[132:135], v[212:215], v[60:63]
  s_waitcnt lgkmcnt(8)
  v_mfma_f32_16x16x32_bf16 v[64:67], v[136:139], v[204:207], v[64:67]
  v_mfma_f32_16x16x32_bf16 v[68:71], v[136:139], v[208:211], v[68:71]
  v_mfma_f32_16x16x32_bf16 v[72:75], v[136:139], v[212:215], v[72:75]
  s_waitcnt lgkmcnt(6)
  v_mfma_f32_16x16x32_bf16 v[76:79], v[140:143], v[204:207], v[76:79]
  v_mfma_f32_16x16x32_bf16 v[80:83], v[140:143], v[208:211], v[80:83]
  v_mfma_f32_16x16x32_bf16 v[84:87], v[140:143], v[212:215], v[84:87]
  s_waitcnt lgkmcnt(4)
  v_mfma_f32_16x16x32_bf16 v[88:91], v[144:147], v[204:207], v[88:91]
  v_mfma_f32_16x16x32_bf16 v[92:95], v[144:147], v[208:211], v[92:95]
  v_mfma_f32_16x16x32_bf16 v[96:99], v[144:147], v[212:215], v[96:99]
  s_waitcnt lgkmcnt(2)
  v_mfma_f32_16x16x32_bf16 v[100:103], v[148:151], v[204:207], v[100:103]
  v_mfma_f32_16x16x32_bf16 v[104:107], v[148:151], v[208:211], v[104:107]
  v_mfma_f32_16x16x32_bf16 v[108:111], v[148:151], v[212:215], v[108:111]
  s_waitcnt lgkmcnt(0)
  v_mfma_f32_16x16x32_bf16 v[112:115], v[152:155], v[204:207], v[112:115]
  v_mfma_f32_16x16x32_bf16 v[116:119], v[152:155], v[208:211], v[116:119]
  v_mfma_f32_16x16x32_bf16 v[120:123], v[152:155], v[212:215], v[120:123]
  s_setprio 0
  s_waitcnt lgkmcnt(0)
  s_barrier
  ds_read_b64_tr_b16 v[124:125], v2
  ds_read_b64_tr_b16 v[126:127], v2 offset:1024
  ds_read_b64_tr_b16 v[128:129], v3
  ds_read_b64_tr_b16 v[130:131], v3 offset:1024
  ds_read_b64_tr_b16 v[132:133], v4
  ds_read_b64_tr_b16 v[134:135], v4 offset:1024
  ds_read_b64_tr_b16 v[136:137], v5
  ds_read_b64_tr_b16 v[138:139], v5 offset:1024
  ds_read_b64_tr_b16 v[140:141], v6
  ds_read_b64_tr_b16 v[142:143], v6 offset:1024
  ds_read_b64_tr_b16 v[144:145], v7
  ds_read_b64_tr_b16 v[146:147], v7 offset:1024
  ds_read_b64_tr_b16 v[148:149], v8
  ds_read_b64_tr_b16 v[150:151], v8 offset:1024
  ds_read_b64_tr_b16 v[152:153], v9
  s_waitcnt lgkmcnt(14)
  ds_read_b64_tr_b16 v[154:155], v9 offset:1024
  s_add_u32 s40, s84, 0x0
  s_add_u32 m0, s62, 0x1e800
  s_nop 0
  buffer_load_dwordx4 v14, s[16:19], s40 offen lds
  buffer_load_dwordx4 v15, s[16:19], s40 offen offset:1024 lds
  buffer_load_dwordx4 v16, s[16:19], s40 offen offset:2048 lds
  buffer_load_dwordx4 v17, s[16:19], s40 offen offset:3072 lds
  s_waitcnt lgkmcnt(14)
  v_mfma_f32_16x16x32_bf16 v[28:31], v[124:127], v[216:219], v[28:31]
  v_mfma_f32_16x16x32_bf16 v[32:35], v[124:127], v[220:223], v[32:35]
  v_mfma_f32_16x16x32_bf16 v[36:39], v[124:127], v[224:227], v[36:39]
  s_waitcnt lgkmcnt(12)
  v_mfma_f32_16x16x32_bf16 v[40:43], v[128:131], v[216:219], v[40:43]
  v_mfma_f32_16x16x32_bf16 v[44:47], v[128:131], v[220:223], v[44:47]
  v_mfma_f32_16x16x32_bf16 v[48:51], v[128:131], v[224:227], v[48:51]
  s_add_u32 s40, s84, 0x9000
  s_add_u32 m0, s62, 0x1f800
  s_nop 0
  buffer_load_dwordx4 v14, s[16:19], s40 offen lds
  buffer_load_dwordx4 v15, s[16:19], s40 offen offset:1024 lds
  buffer_load_dwordx4 v16, s[16:19], s40 offen offset:2048 lds
  buffer_load_dwordx4 v17, s[16:19], s40 offen offset:3072 lds
  s_waitcnt lgkmcnt(6)
  v_mfma_f32_16x16x32_bf16 v[52:55], v[132:135], v[216:219], v[52:55]
  v_mfma_f32_16x16x32_bf16 v[56:59], v[132:135], v[220:223], v[56:59]
  v_mfma_f32_16x16x32_bf16 v[60:63], v[132:135], v[224:227], v[60:63]
  v_mfma_f32_16x16x32_bf16 v[64:67], v[136:139], v[216:219], v[64:67]
  v_mfma_f32_16x16x32_bf16 v[68:71], v[136:139], v[220:223], v[68:71]
  v_mfma_f32_16x16x32_bf16 v[72:75], v[136:139], v[224:227], v[72:75]
  s_add_u32 s40, s84, 0x12000
  s_add_u32 m0, s62, 0x20800
  s_nop 0
  buffer_load_dwordx4 v14, s[16:19], s40 offen lds
  v_mfma_f32_16x16x32_bf16 v[76:79], v[140:143], v[216:219], v[76:79]
  v_mfma_f32_16x16x32_bf16 v[80:83], v[140:143], v[220:223], v[80:83]
  v_mfma_f32_16x16x32_bf16 v[84:87], v[140:143], v[224:227], v[84:87]
  s_waitcnt lgkmcnt(0)
  v_mfma_f32_16x16x32_bf16 v[88:91], v[144:147], v[216:219], v[88:91]
  v_mfma_f32_16x16x32_bf16 v[92:95], v[144:147], v[220:223], v[92:95]
  v_mfma_f32_16x16x32_bf16 v[96:99], v[144:147], v[224:227], v[96:99]
  v_mfma_f32_16x16x32_bf16 v[100:103], v[148:151], v[216:219], v[100:103]
  v_mfma_f32_16x16x32_bf16 v[104:107], v[148:151], v[220:223], v[104:107]
  v_mfma_f32_16x16x32_bf16 v[108:111], v[148:151], v[224:227], v[108:111]
  v_mfma_f32_16x16x32_bf16 v[112:115], v[152:155], v[216:219], v[112:115]
  v_mfma_f32_16x16x32_bf16 v[116:119], v[152:155], v[220:223], v[116:119]
  v_mfma_f32_16x16x32_bf16 v[120:123], v[152:155], v[224:227], v[120:123]
  s_waitcnt lgkmcnt(0)
  s_barrier
  ds_read_b64_tr_b16 v[124:125], v2 offset:8192
  ds_read_b64_tr_b16 v[126:127], v2 offset:9216
  ds_read_b64_tr_b16 v[128:129], v3 offset:8192
  ds_read_b64_tr_b16 v[130:131], v3 offset:9216
  ds_read_b64_tr_b16 v[132:133], v4 offset:8192
  ds_read_b64_tr_b16 v[134:135], v4 offset:9216
  ds_read_b64_tr_b16 v[136:137], v5 offset:8192
  ds_read_b64_tr_b16 v[138:139], v5 offset:9216
  ds_read_b64_tr_b16 v[140:141], v6 offset:8192
  ds_read_b64_tr_b16 v[142:143], v6 offset:9216
  ds_read_b64_tr_b16 v[144:145], v7 offset:8192
  ds_read_b64_tr_b16 v[146:147], v7 offset:9216
  ds_read_b64_tr_b16 v[148:149], v8 offset:8192
  ds_read_b64_tr_b16 v[150:151], v8 offset:9216
  ds_read_b64_tr_b16 v[152:153], v9 offset:8192
  s_waitcnt lgkmcnt(14)
  ds_read_b64_tr_b16 v[154:155], v9 offset:9216
  s_waitcnt lgkmcnt(14)
  v_mfma_f32_16x16x32_bf16 v[28:31], v[124:127], v[228:231], v[28:31]
  v_mfma_f32_16x16x32_bf16 v[32:35], v[124:127], v[232:235], v[32:35]
  v_mfma_f32_16x16x32_bf16 v[36:39], v[124:127], v[236:239], v[36:39]
  s_waitcnt lgkmcnt(12)
  v_mfma_f32_16x16x32_bf16 v[40:43], v[128:131], v[228:231], v[40:43]
  v_mfma_f32_16x16x32_bf16 v[44:47], v[128:131], v[232:235], v[44:47]
  v_mfma_f32_16x16x32_bf16 v[48:51], v[128:131], v[236:239], v[48:51]
  s_waitcnt lgkmcnt(10)
  v_mfma_f32_16x16x32_bf16 v[52:55], v[132:135], v[228:231], v[52:55]
  v_mfma_f32_16x16x32_bf16 v[56:59], v[132:135], v[232:235], v[56:59]
  v_mfma_f32_16x16x32_bf16 v[60:63], v[132:135], v[236:239], v[60:63]
  s_waitcnt lgkmcnt(8)
  v_mfma_f32_16x16x32_bf16 v[64:67], v[136:139], v[228:231], v[64:67]
  v_mfma_f32_16x16x32_bf16 v[68:71], v[136:139], v[232:235], v[68:71]
  v_mfma_f32_16x16x32_bf16 v[72:75], v[136:139], v[236:239], v[72:75]
  s_waitcnt lgkmcnt(6)
  v_mfma_f32_16x16x32_bf16 v[76:79], v[140:143], v[228:231], v[76:79]
  v_mfma_f32_16x16x32_bf16 v[80:83], v[140:143], v[232:235], v[80:83]
  v_mfma_f32_16x16x32_bf16 v[84:87], v[140:143], v[236:239], v[84:87]
  s_waitcnt lgkmcnt(4)
  v_mfma_f32_16x16x32_bf16 v[88:91], v[144:147], v[228:231], v[88:91]
  v_mfma_f32_16x16x32_bf16 v[92:95], v[144:147], v[232:235], v[92:95]
  v_mfma_f32_16x16x32_bf16 v[96:99], v[144:147], v[236:239], v[96:99]
  s_waitcnt lgkmcnt(2)
  v_mfma_f32_16x16x32_bf16 v[100:103], v[148:151], v[228:231], v[100:103]
  v_mfma_f32_16x16x32_bf16 v[104:107], v[148:151], v[232:235], v[104:107]
  v_mfma_f32_16x16x32_bf16 v[108:111], v[148:151], v[236:239], v[108:111]
  s_waitcnt lgkmcnt(0)
  v_mfma_f32_16x16x32_bf16 v[112:115], v[152:155], v[228:231], v[112:115]
  v_mfma_f32_16x16x32_bf16 v[116:119], v[152:155], v[232:235], v[116:119]
  v_mfma_f32_16x16x32_bf16 v[120:123], v[152:155], v[236:239], v[120:123]
  s_waitcnt vmcnt(9)
  s_waitcnt lgkmcnt(0)
  s_barrier
  ds_read_b128 v[156:159], v252
  ds_read_b128 v[160:163], v252 offset:2048
  ds_read_b128 v[164:167], v252 offset:4096
  ds_read_b64_tr_b16 v[124:125], v2 offset:16384
  ds_read_b64_tr_b16 v[126:127], v2 offset:17408
  ds_read_b64_tr_b16 v[128:129], v3 offset:16384
  ds_read_b64_tr_b16 v[130:131], v3 offset:17408
  ds_read_b64_tr_b16 v[132:133], v4 offset:16384
  ds_read_b64_tr_b16 v[134:135], v4 offset:17408
  ds_read_b64_tr_b16 v[136:137], v5 offset:16384
  ds_read_b64_tr_b16 v[138:139], v5 offset:17408
  ds_read_b64_tr_b16 v[140:141], v6 offset:16384
  ds_read_b64_tr_b16 v[142:143], v6 offset:17408
  ds_read_b64_tr_b16 v[144:145], v7 offset:16384
  ds_read_b64_tr_b16 v[146:147], v7 offset:17408
  s_waitcnt lgkmcnt(14)
  ds_read_b64_tr_b16 v[148:149], v8 offset:16384
  s_waitcnt lgkmcnt(14)
  ds_read_b64_tr_b16 v[150:151], v8 offset:17408
  s_waitcnt lgkmcnt(14)
  ds_read_b64_tr_b16 v[152:153], v9 offset:16384
  s_waitcnt lgkmcnt(14)
  ds_read_b64_tr_b16 v[154:155], v9 offset:17408
  s_add_u32 s40, s85, 0x0
  s_add_u32 m0, s62, 0x23000
  s_nop 0
  buffer_load_dwordx4 v14, s[16:19], s40 offen lds
  buffer_load_dwordx4 v15, s[16:19], s40 offen offset:1024 lds
  buffer_load_dwordx4 v16, s[16:19], s40 offen offset:2048 lds
  buffer_load_dwordx4 v17, s[16:19], s40 offen offset:3072 lds
  s_waitcnt lgkmcnt(14)
  v_mfma_f32_16x16x32_bf16 v[28:31], v[124:127], v[156:159], v[28:31]
  v_mfma_f32_16x16x32_bf16 v[32:35], v[124:127], v[160:163], v[32:35]
  v_mfma_f32_16x16x32_bf16 v[36:39], v[124:127], v[164:167], v[36:39]
  s_waitcnt lgkmcnt(12)
  v_mfma_f32_16x16x32_bf16 v[40:43], v[128:131], v[156:159], v[40:43]
  v_mfma_f32_16x16x32_bf16 v[44:47], v[128:131], v[160:163], v[44:47]
  v_mfma_f32_16x16x32_bf16 v[48:51], v[128:131], v[164:167], v[48:51]
  s_add_u32 s40, s85, 0x9000
  s_add_u32 m0, s62, 0x24000
  s_nop 0
  buffer_load_dwordx4 v14, s[16:19], s40 offen lds
  buffer_load_dwordx4 v15, s[16:19], s40 offen offset:1024 lds
  buffer_load_dwordx4 v16, s[16:19], s40 offen offset:2048 lds
  buffer_load_dwordx4 v17, s[16:19], s40 offen offset:3072 lds
  s_waitcnt lgkmcnt(4)
  v_mfma_f32_16x16x32_bf16 v[52:55], v[132:135], v[156:159], v[52:55]
  v_mfma_f32_16x16x32_bf16 v[56:59], v[132:135], v[160:163], v[56:59]
  v_mfma_f32_16x16x32_bf16 v[60:63], v[132:135], v[164:167], v[60:63]
  v_mfma_f32_16x16x32_bf16 v[64:67], v[136:139], v[156:159], v[64:67]
  v_mfma_f32_16x16x32_bf16 v[68:71], v[136:139], v[160:163], v[68:71]
  v_mfma_f32_16x16x32_bf16 v[72:75], v[136:139], v[164:167], v[72:75]
  s_add_u32 s40, s85, 0x12000
  s_add_u32 m0, s62, 0x25000
  s_nop 0
  buffer_load_dwordx4 v14, s[16:19], s40 offen lds
  v_mfma_f32_16x16x32_bf16 v[76:79], v[140:143], v[156:159], v[76:79]
  v_mfma_f32_16x16x32_bf16 v[80:83], v[140:143], v[160:163], v[80:83]
  v_mfma_f32_16x16x32_bf16 v[84:87], v[140:143], v[164:167], v[84:87]
  v_mfma_f32_16x16x32_bf16 v[88:91], v[144:147], v[156:159], v[88:91]
  v_mfma_f32_16x16x32_bf16 v[92:95], v[144:147], v[160:163], v[92:95]
  v_mfma_f32_16x16x32_bf16 v[96:99], v[144:147], v[164:167], v[96:99]
  s_waitcnt lgkmcnt(0)
  v_mfma_f32_16x16x32_bf16 v[100:103], v[148:151], v[156:159], v[100:103]
  v_mfma_f32_16x16x32_bf16 v[104:107], v[148:151], v[160:163], v[104:107]
  v_mfma_f32_16x16x32_bf16 v[108:111], v[148:151], v[164:167], v[108:111]
  v_mfma_f32_16x16x32_bf16 v[112:115], v[152:155], v[156:159], v[112:115]
  v_mfma_f32_16x16x32_bf16 v[116:119], v[152:155], v[160:163], v[116:119]
  v_mfma_f32_16x16x32_bf16 v[120:123], v[152:155], v[164:167], v[120:123]
  s_waitcnt lgkmcnt(0)
  s_barrier
  ds_read_b128 v[156:159], v253
  ds_read_b128 v[160:163], v253 offset:2048
  ds_read_b128 v[164:167], v253 offset:4096
  ds_read_b64_tr_b16 v[124:125], v2 offset:24576
  ds_read_b64_tr_b16 v[126:127], v2 offset:25600
  ds_read_b64_tr_b16 v[128:129], v3 offset:24576
  ds_read_b64_tr_b16 v[130:131], v3 offset:25600
  ds_read_b64_tr_b16 v[132:133], v4 offset:24576
  ds_read_b64_tr_b16 v[134:135], v4 offset:25600
  ds_read_b64_tr_b16 v[136:137], v5 offset:24576
  ds_read_b64_tr_b16 v[138:139], v5 offset:25600
  ds_read_b64_tr_b16 v[140:141], v6 offset:24576
  ds_read_b64_tr_b16 v[142:143], v6 offset:25600
  ds_read_b64_tr_b16 v[144:145], v7 offset:24576
  ds_read_b64_tr_b16 v[146:147], v7 offset:25600
  s_waitcnt lgkmcnt(14)
  ds_read_b64_tr_b16 v[148:149], v8 offset:24576
  s_waitcnt lgkmcnt(14)
  ds_read_b64_tr_b16 v[150:151], v8 offset:25600
  s_waitcnt lgkmcnt(14)
  ds_read_b64_tr_b16 v[152:153], v9 offset:24576
  s_waitcnt lgkmcnt(14)
  ds_read_b64_tr_b16 v[154:155], v9 offset:25600
  s_waitcnt lgkmcnt(14)
  v_mfma_f32_16x16x32_bf16 v[28:31], v[124:127], v[156:159], v[28:31]
  v_mfma_f32_16x16x32_bf16 v[32:35], v[124:127], v[160:163], v[32:35]
  v_mfma_f32_16x16x32_bf16 v[36:39], v[124:127], v[164:167], v[36:39]
  s_waitcnt lgkmcnt(12)
  v_mfma_f32_16x16x32_bf16 v[40:43], v[128:131], v[156:159], v[40:43]
  v_mfma_f32_16x16x32_bf16 v[44:47], v[128:131], v[160:163], v[44:47]
  v_mfma_f32_16x16x32_bf16 v[48:51], v[128:131], v[164:167], v[48:51]
  s_waitcnt lgkmcnt(10)
  v_mfma_f32_16x16x32_bf16 v[52:55], v[132:135], v[156:159], v[52:55]
  v_mfma_f32_16x16x32_bf16 v[56:59], v[132:135], v[160:163], v[56:59]
  v_mfma_f32_16x16x32_bf16 v[60:63], v[132:135], v[164:167], v[60:63]
  s_waitcnt lgkmcnt(8)
  v_mfma_f32_16x16x32_bf16 v[64:67], v[136:139], v[156:159], v[64:67]
  v_mfma_f32_16x16x32_bf16 v[68:71], v[136:139], v[160:163], v[68:71]
  v_mfma_f32_16x16x32_bf16 v[72:75], v[136:139], v[164:167], v[72:75]
  s_waitcnt lgkmcnt(6)
  v_mfma_f32_16x16x32_bf16 v[76:79], v[140:143], v[156:159], v[76:79]
  v_mfma_f32_16x16x32_bf16 v[80:83], v[140:143], v[160:163], v[80:83]
  v_mfma_f32_16x16x32_bf16 v[84:87], v[140:143], v[164:167], v[84:87]
  s_waitcnt lgkmcnt(4)
  v_mfma_f32_16x16x32_bf16 v[88:91], v[144:147], v[156:159], v[88:91]
  v_mfma_f32_16x16x32_bf16 v[92:95], v[144:147], v[160:163], v[92:95]
  v_mfma_f32_16x16x32_bf16 v[96:99], v[144:147], v[164:167], v[96:99]
  s_waitcnt lgkmcnt(2)
  v_mfma_f32_16x16x32_bf16 v[100:103], v[148:151], v[156:159], v[100:103]
  v_mfma_f32_16x16x32_bf16 v[104:107], v[148:151], v[160:163], v[104:107]
  v_mfma_f32_16x16x32_bf16 v[108:111], v[148:151], v[164:167], v[108:111]
  s_waitcnt lgkmcnt(0)
  v_mfma_f32_16x16x32_bf16 v[112:115], v[152:155], v[156:159], v[112:115]
  v_mfma_f32_16x16x32_bf16 v[116:119], v[152:155], v[160:163], v[116:119]
  v_mfma_f32_16x16x32_bf16 v[120:123], v[152:155], v[164:167], v[120:123]
  s_waitcnt vmcnt(9)
  s_waitcnt lgkmcnt(0)
  s_barrier
  ds_read_b128 v[156:159], v10
  ds_read_b128 v[160:163], v10 offset:2048
  ds_read_b128 v[164:167], v10 offset:4096
  ds_read_b64_tr_b16 v[124:125], v2
  ds_read_b64_tr_b16 v[126:127], v2 offset:1024
  ds_read_b64_tr_b16 v[128:129], v3
  ds_read_b64_tr_b16 v[130:131], v3 offset:1024
  ds_read_b64_tr_b16 v[132:133], v4
  ds_read_b64_tr_b16 v[134:135], v4 offset:1024
  ds_read_b64_tr_b16 v[136:137], v5
  ds_read_b64_tr_b16 v[138:139], v5 offset:1024
  ds_read_b64_tr_b16 v[140:141], v6
  ds_read_b64_tr_b16 v[142:143], v6 offset:1024
  ds_read_b64_tr_b16 v[144:145], v7
  ds_read_b64_tr_b16 v[146:147], v7 offset:1024
  s_waitcnt lgkmcnt(14)
  ds_read_b64_tr_b16 v[148:149], v8
  s_waitcnt lgkmcnt(14)
  ds_read_b64_tr_b16 v[150:151], v8 offset:1024
  s_waitcnt lgkmcnt(14)
  ds_read_b64_tr_b16 v[152:153], v9
  s_waitcnt lgkmcnt(14)
  ds_read_b64_tr_b16 v[154:155], v9 offset:1024
  s_waitcnt lgkmcnt(14)
  v_mfma_f32_16x16x32_bf16 v[28:31], v[124:127], v[156:159], v[28:31]
  v_mfma_f32_16x16x32_bf16 v[32:35], v[124:127], v[160:163], v[32:35]
  v_mfma_f32_16x16x32_bf16 v[36:39], v[124:127], v[164:167], v[36:39]
  s_waitcnt lgkmcnt(12)
  v_mfma_f32_16x16x32_bf16 v[40:43], v[128:131], v[156:159], v[40:43]
  v_mfma_f32_16x16x32_bf16 v[44:47], v[128:131], v[160:163], v[44:47]
  v_mfma_f32_16x16x32_bf16 v[48:51], v[128:131], v[164:167], v[48:51]
  s_waitcnt lgkmcnt(10)
  v_mfma_f32_16x16x32_bf16 v[52:55], v[132:135], v[156:159], v[52:55]
  v_mfma_f32_16x16x32_bf16 v[56:59], v[132:135], v[160:163], v[56:59]
  v_mfma_f32_16x16x32_bf16 v[60:63], v[132:135], v[164:167], v[60:63]
  s_waitcnt lgkmcnt(8)
  v_mfma_f32_16x16x32_bf16 v[64:67], v[136:139], v[156:159], v[64:67]
  v_mfma_f32_16x16x32_bf16 v[68:71], v[136:139], v[160:163], v[68:71]
  v_mfma_f32_16x16x32_bf16 v[72:75], v[136:139], v[164:167], v[72:75]
  s_waitcnt lgkmcnt(6)
  v_mfma_f32_16x16x32_bf16 v[76:79], v[140:143], v[156:159], v[76:79]
  v_mfma_f32_16x16x32_bf16 v[80:83], v[140:143], v[160:163], v[80:83]
  v_mfma_f32_16x16x32_bf16 v[84:87], v[140:143], v[164:167], v[84:87]
  s_waitcnt lgkmcnt(4)
  v_mfma_f32_16x16x32_bf16 v[88:91], v[144:147], v[156:159], v[88:91]
  v_mfma_f32_16x16x32_bf16 v[92:95], v[144:147], v[160:163], v[92:95]
  v_mfma_f32_16x16x32_bf16 v[96:99], v[144:147], v[164:167], v[96:99]
  s_waitcnt lgkmcnt(2)
  v_mfma_f32_16x16x32_bf16 v[100:103], v[148:151], v[156:159], v[100:103]
  v_mfma_f32_16x16x32_bf16 v[104:107], v[148:151], v[160:163], v[104:107]
  v_mfma_f32_16x16x32_bf16 v[108:111], v[148:151], v[164:167], v[108:111]
  s_waitcnt lgkmcnt(0)
  v_mfma_f32_16x16x32_bf16 v[112:115], v[152:155], v[156:159], v[112:115]
  v_mfma_f32_16x16x32_bf16 v[116:119], v[152:155], v[160:163], v[116:119]
  v_mfma_f32_16x16x32_bf16 v[120:123], v[152:155], v[164:167], v[120:123]
  s_waitcnt lgkmcnt(0)
  s_barrier
  ds_read_b128 v[156:159], v11
  ds_read_b128 v[160:163], v11 offset:2048
  ds_read_b128 v[164:167], v11 offset:4096
  ds_read_b64_tr_b16 v[124:125], v2 offset:8192
  ds_read_b64_tr_b16 v[126:127], v2 offset:9216
  ds_read_b64_tr_b16 v[128:129], v3 offset:8192
  ds_read_b64_tr_b16 v[130:131], v3 offset:9216
  ds_read_b64_tr_b16 v[132:133], v4 offset:8192
  ds_read_b64_tr_b16 v[134:135], v4 offset:9216
  ds_read_b64_tr_b16 v[136:137], v5 offset:8192
  ds_read_b64_tr_b16 v[138:139], v5 offset:9216
  ds_read_b64_tr_b16 v[140:141], v6 offset:8192
  ds_read_b64_tr_b16 v[142:143], v6 offset:9216
  ds_read_b64_tr_b16 v[144:145], v7 offset:8192
  ds_read_b64_tr_b16 v[146:147], v7 offset:9216
  s_waitcnt lgkmcnt(14)
  ds_read_b64_tr_b16 v[148:149], v8 offset:8192
  s_waitcnt lgkmcnt(14)
  ds_read_b64_tr_b16 v[150:151], v8 offset:9216
  s_waitcnt lgkmcnt(14)
  ds_read_b64_tr_b16 v[152:153], v9 offset:8192
  s_waitcnt lgkmcnt(14)
  ds_read_b64_tr_b16 v[154:155], v9 offset:9216
  s_add_u32 s40, s83, 0x0
  s_add_u32 m0, s62, 0xa000
  s_nop 0
  buffer_load_dwordx4 v14, s[16:19], s40 offen lds
  buffer_load_dwordx4 v15, s[16:19], s40 offen offset:1024 lds
  buffer_load_dwordx4 v16, s[16:19], s40 offen offset:2048 lds
  buffer_load_dwordx4 v17, s[16:19], s40 offen offset:3072 lds
  s_waitcnt lgkmcnt(14)
  v_mfma_f32_16x16x32_bf16 v[28:31], v[124:127], v[156:159], v[28:31]
  v_mfma_f32_16x16x32_bf16 v[32:35], v[124:127], v[160:163], v[32:35]
  v_mfma_f32_16x16x32_bf16 v[36:39], v[124:127], v[164:167], v[36:39]
  s_waitcnt lgkmcnt(12)
  v_mfma_f32_16x16x32_bf16 v[40:43], v[128:131], v[156:159], v[40:43]
  v_mfma_f32_16x16x32_bf16 v[44:47], v[128:131], v[160:163], v[44:47]
  v_mfma_f32_16x16x32_bf16 v[48:51], v[128:131], v[164:167], v[48:51]
  s_add_u32 s40, s83, 0x9000
  s_add_u32 m0, s62, 0xb000
  s_nop 0
  buffer_load_dwordx4 v14, s[16:19], s40 offen lds
  buffer_load_dwordx4 v15, s[16:19], s40 offen offset:1024 lds
  buffer_load_dwordx4 v16, s[16:19], s40 offen offset:2048 lds
  buffer_load_dwordx4 v17, s[16:19], s40 offen offset:3072 lds
  s_waitcnt lgkmcnt(4)
  v_mfma_f32_16x16x32_bf16 v[52:55], v[132:135], v[156:159], v[52:55]
  v_mfma_f32_16x16x32_bf16 v[56:59], v[132:135], v[160:163], v[56:59]
  v_mfma_f32_16x16x32_bf16 v[60:63], v[132:135], v[164:167], v[60:63]
  v_mfma_f32_16x16x32_bf16 v[64:67], v[136:139], v[156:159], v[64:67]
  v_mfma_f32_16x16x32_bf16 v[68:71], v[136:139], v[160:163], v[68:71]
  v_mfma_f32_16x16x32_bf16 v[72:75], v[136:139], v[164:167], v[72:75]
  s_add_u32 s40, s83, 0x12000
  s_add_u32 m0, s62, 0xc000
  s_nop 0
  buffer_load_dwordx4 v14, s[16:19], s40 offen lds
  v_mfma_f32_16x16x32_bf16 v[76:79], v[140:143], v[156:159], v[76:79]
  v_mfma_f32_16x16x32_bf16 v[80:83], v[140:143], v[160:163], v[80:83]
  v_mfma_f32_16x16x32_bf16 v[84:87], v[140:143], v[164:167], v[84:87]
  v_mfma_f32_16x16x32_bf16 v[88:91], v[144:147], v[156:159], v[88:91]
  v_mfma_f32_16x16x32_bf16 v[92:95], v[144:147], v[160:163], v[92:95]
  v_mfma_f32_16x16x32_bf16 v[96:99], v[144:147], v[164:167], v[96:99]
  s_waitcnt lgkmcnt(0)
  v_mfma_f32_16x16x32_bf16 v[100:103], v[148:151], v[156:159], v[100:103]
  v_mfma_f32_16x16x32_bf16 v[104:107], v[148:151], v[160:163], v[104:107]
  v_mfma_f32_16x16x32_bf16 v[108:111], v[148:151], v[164:167], v[108:111]
  v_mfma_f32_16x16x32_bf16 v[112:115], v[152:155], v[156:159], v[112:115]
  v_mfma_f32_16x16x32_bf16 v[116:119], v[152:155], v[160:163], v[116:119]
  v_mfma_f32_16x16x32_bf16 v[120:123], v[152:155], v[164:167], v[120:123]
  s_waitcnt vmcnt(9)
  s_waitcnt lgkmcnt(0)
  s_barrier
  ds_read_b128 v[156:159], v10 offset:18432
  ds_read_b128 v[160:163], v10 offset:20480
  ds_read_b128 v[164:167], v10 offset:22528
  ds_read_b64_tr_b16 v[124:125], v2 offset:16384
  ds_read_b64_tr_b16 v[126:127], v2 offset:17408
  ds_read_b64_tr_b16 v[128:129], v3 offset:16384
  ds_read_b64_tr_b16 v[130:131], v3 offset:17408
  ds_read_b64_tr_b16 v[132:133], v4 offset:16384
  ds_read_b64_tr_b16 v[134:135], v4 offset:17408
  ds_read_b64_tr_b16 v[136:137], v5 offset:16384
  ds_read_b64_tr_b16 v[138:139], v5 offset:17408
  ds_read_b64_tr_b16 v[140:141], v6 offset:16384
  ds_read_b64_tr_b16 v[142:143], v6 offset:17408
  ds_read_b64_tr_b16 v[144:145], v7 offset:16384
  ds_read_b64_tr_b16 v[146:147], v7 offset:17408
  s_waitcnt lgkmcnt(14)
  ds_read_b64_tr_b16 v[148:149], v8 offset:16384
  s_waitcnt lgkmcnt(14)
  ds_read_b64_tr_b16 v[150:151], v8 offset:17408
  s_waitcnt lgkmcnt(14)
  ds_read_b64_tr_b16 v[152:153], v9 offset:16384
  s_waitcnt lgkmcnt(14)
  ds_read_b64_tr_b16 v[154:155], v9 offset:17408
  s_add_u32 s40, s86, 0x0
  s_add_u32 m0, s62, 0x1e800
  s_nop 0
  buffer_load_dwordx4 v14, s[16:19], s40 offen lds
  buffer_load_dwordx4 v15, s[16:19], s40 offen offset:1024 lds
  buffer_load_dwordx4 v16, s[16:19], s40 offen offset:2048 lds
  buffer_load_dwordx4 v17, s[16:19], s40 offen offset:3072 lds
  s_waitcnt lgkmcnt(14)
  v_mfma_f32_16x16x32_bf16 v[28:31], v[124:127], v[156:159], v[28:31]
  v_mfma_f32_16x16x32_bf16 v[32:35], v[124:127], v[160:163], v[32:35]
  v_mfma_f32_16x16x32_bf16 v[36:39], v[124:127], v[164:167], v[36:39]
  s_waitcnt lgkmcnt(12)
  v_mfma_f32_16x16x32_bf16 v[40:43], v[128:131], v[156:159], v[40:43]
  v_mfma_f32_16x16x32_bf16 v[44:47], v[128:131], v[160:163], v[44:47]
  v_mfma_f32_16x16x32_bf16 v[48:51], v[128:131], v[164:167], v[48:51]
  s_add_u32 s40, s86, 0x9000
  s_add_u32 m0, s62, 0x1f800
  s_nop 0
  buffer_load_dwordx4 v14, s[16:19], s40 offen lds
  buffer_load_dwordx4 v15, s[16:19], s40 offen offset:1024 lds
  buffer_load_dwordx4 v16, s[16:19], s40 offen offset:2048 lds
  buffer_load_dwordx4 v17, s[16:19], s40 offen offset:3072 lds
  s_waitcnt lgkmcnt(4)
  v_mfma_f32_16x16x32_bf16 v[52:55], v[132:135], v[156:159], v[52:55]
  v_mfma_f32_16x16x32_bf16 v[56:59], v[132:135], v[160:163], v[56:59]
  v_mfma_f32_16x16x32_bf16 v[60:63], v[132:135], v[164:167], v[60:63]
  v_mfma_f32_16x16x32_bf16 v[64:67], v[136:139], v[156:159], v[64:67]
  v_mfma_f32_16x16x32_bf16 v[68:71], v[136:139], v[160:163], v[68:71]
  v_mfma_f32_16x16x32_bf16 v[72:75], v[136:139], v[164:167], v[72:75]
  s_add_u32 s40, s86, 0x12000
  s_add_u32 m0, s62, 0x20800
  s_nop 0
  buffer_load_dwordx4 v14, s[16:19], s40 offen lds
  v_mfma_f32_16x16x32_bf16 v[76:79], v[140:143], v[156:159], v[76:79]
  v_mfma_f32_16x16x32_bf16 v[80:83], v[140:143], v[160:163], v[80:83]
  v_mfma_f32_16x16x32_bf16 v[84:87], v[140:143], v[164:167], v[84:87]
  v_mfma_f32_16x16x32_bf16 v[88:91], v[144:147], v[156:159], v[88:91]
  v_mfma_f32_16x16x32_bf16 v[92:95], v[144:147], v[160:163], v[92:95]
  v_mfma_f32_16x16x32_bf16 v[96:99], v[144:147], v[164:167], v[96:99]
  s_waitcnt lgkmcnt(0)
  v_mfma_f32_16x16x32_bf16 v[100:103], v[148:151], v[156:159], v[100:103]
  v_mfma_f32_16x16x32_bf16 v[104:107], v[148:151], v[160:163], v[104:107]
  v_mfma_f32_16x16x32_bf16 v[108:111], v[148:151], v[164:167], v[108:111]
  v_mfma_f32_16x16x32_bf16 v[112:115], v[152:155], v[156:159], v[112:115]
  v_mfma_f32_16x16x32_bf16 v[116:119], v[152:155], v[160:163], v[116:119]
  v_mfma_f32_16x16x32_bf16 v[120:123], v[152:155], v[164:167], v[120:123]
  s_waitcnt lgkmcnt(0)
  s_barrier
  ds_read_b128 v[156:159], v11 offset:18432
  ds_read_b128 v[160:163], v11 offset:20480
  ds_read_b128 v[164:167], v11 offset:22528
  ds_read_b64_tr_b16 v[124:125], v2 offset:24576
  ds_read_b64_tr_b16 v[126:127], v2 offset:25600
  ds_read_b64_tr_b16 v[128:129], v3 offset:24576
  ds_read_b64_tr_b16 v[130:131], v3 offset:25600
  ds_read_b64_tr_b16 v[132:133], v4 offset:24576
  ds_read_b64_tr_b16 v[134:135], v4 offset:25600
  ds_read_b64_tr_b16 v[136:137], v5 offset:24576
  ds_read_b64_tr_b16 v[138:139], v5 offset:25600
  ds_read_b64_tr_b16 v[140:141], v6 offset:24576
  ds_read_b64_tr_b16 v[142:143], v6 offset:25600
  ds_read_b64_tr_b16 v[144:145], v7 offset:24576
  ds_read_b64_tr_b16 v[146:147], v7 offset:25600
  s_waitcnt lgkmcnt(14)
  ds_read_b64_tr_b16 v[148:149], v8 offset:24576
  s_waitcnt lgkmcnt(14)
  ds_read_b64_tr_b16 v[150:151], v8 offset:25600
  s_waitcnt lgkmcnt(14)
  ds_read_b64_tr_b16 v[152:153], v9 offset:24576
  s_waitcnt lgkmcnt(14)
  ds_read_b64_tr_b16 v[154:155], v9 offset:25600
  s_waitcnt lgkmcnt(14)
  v_mfma_f32_16x16x32_bf16 v[28:31], v[124:127], v[156:159], v[28:31]
  v_mfma_f32_16x16x32_bf16 v[32:35], v[124:127], v[160:163], v[32:35]
  v_mfma_f32_16x16x32_bf16 v[36:39], v[124:127], v[164:167], v[36:39]
  s_waitcnt lgkmcnt(12)
  v_mfma_f32_16x16x32_bf16 v[40:43], v[128:131], v[156:159], v[40:43]
  v_mfma_f32_16x16x32_bf16 v[44:47], v[128:131], v[160:163], v[44:47]
  v_mfma_f32_16x16x32_bf16 v[48:51], v[128:131], v[164:167], v[48:51]
  s_waitcnt lgkmcnt(10)
  v_mfma_f32_16x16x32_bf16 v[52:55], v[132:135], v[156:159], v[52:55]
  v_mfma_f32_16x16x32_bf16 v[56:59], v[132:135], v[160:163], v[56:59]
  v_mfma_f32_16x16x32_bf16 v[60:63], v[132:135], v[164:167], v[60:63]
  s_waitcnt lgkmcnt(8)
  v_mfma_f32_16x16x32_bf16 v[64:67], v[136:139], v[156:159], v[64:67]
  v_mfma_f32_16x16x32_bf16 v[68:71], v[136:139], v[160:163], v[68:71]
  v_mfma_f32_16x16x32_bf16 v[72:75], v[136:139], v[164:167], v[72:75]
  s_waitcnt lgkmcnt(6)
  v_mfma_f32_16x16x32_bf16 v[76:79], v[140:143], v[156:159], v[76:79]
  v_mfma_f32_16x16x32_bf16 v[80:83], v[140:143], v[160:163], v[80:83]
  v_mfma_f32_16x16x32_bf16 v[84:87], v[140:143], v[164:167], v[84:87]
  s_waitcnt lgkmcnt(4)
  v_mfma_f32_16x16x32_bf16 v[88:91], v[144:147], v[156:159], v[88:91]
  v_mfma_f32_16x16x32_bf16 v[92:95], v[144:147], v[160:163], v[92:95]
  v_mfma_f32_16x16x32_bf16 v[96:99], v[144:147], v[164:167], v[96:99]
  s_waitcnt lgkmcnt(2)
  v_mfma_f32_16x16x32_bf16 v[100:103], v[148:151], v[156:159], v[100:103]
  v_mfma_f32_16x16x32_bf16 v[104:107], v[148:151], v[160:163], v[104:107]
  v_mfma_f32_16x16x32_bf16 v[108:111], v[148:151], v[164:167], v[108:111]
  s_waitcnt lgkmcnt(0)
  v_mfma_f32_16x16x32_bf16 v[112:115], v[152:155], v[156:159], v[112:115]
  v_mfma_f32_16x16x32_bf16 v[116:119], v[152:155], v[160:163], v[116:119]
  v_mfma_f32_16x16x32_bf16 v[120:123], v[152:155], v[164:167], v[120:123]
  s_waitcnt vmcnt(0)
  s_waitcnt lgkmcnt(0)
  s_barrier
  ds_read_b128 v[156:159], v10
  ds_read_b128 v[160:163], v10 offset:2048
  ds_read_b128 v[164:167], v10 offset:4096
  ds_read_b64_tr_b16 v[124:125], v2 offset:32768
  ds_read_b64_tr_b16 v[126:127], v2 offset:33792
  ds_read_b64_tr_b16 v[128:129], v3 offset:32768
  ds_read_b64_tr_b16 v[130:131], v3 offset:33792
  ds_read_b64_tr_b16 v[132:133], v4 offset:32768
  ds_read_b64_tr_b16 v[134:135], v4 offset:33792
  ds_read_b64_tr_b16 v[136:137], v5 offset:32768
  ds_read_b64_tr_b16 v[138:139], v5 offset:33792
  ds_read_b64_tr_b16 v[140:141], v6 offset:32768
  ds_read_b64_tr_b16 v[142:143], v6 offset:33792
  ds_read_b64_tr_b16 v[144:145], v7 offset:32768
  ds_read_b64_tr_b16 v[146:147], v7 offset:33792
  s_waitcnt lgkmcnt(14)
  ds_read_b64_tr_b16 v[148:149], v8 offset:32768
  s_waitcnt lgkmcnt(14)
  ds_read_b64_tr_b16 v[150:151], v8 offset:33792
  s_waitcnt lgkmcnt(14)
  ds_read_b64_tr_b16 v[152:153], v9 offset:32768
  s_waitcnt lgkmcnt(14)
  ds_read_b64_tr_b16 v[154:155], v9 offset:33792
  s_add_u32 s40, s87, 0x0
  s_add_u32 m0, s62, 0x23000
  s_nop 0
  buffer_load_dwordx4 v14, s[16:19], s40 offen lds
  buffer_load_dwordx4 v15, s[16:19], s40 offen offset:1024 lds
  buffer_load_dwordx4 v16, s[16:19], s40 offen offset:2048 lds
  buffer_load_dwordx4 v17, s[16:19], s40 offen offset:3072 lds
  s_waitcnt lgkmcnt(14)
  v_mfma_f32_16x16x32_bf16 v[28:31], v[124:127], v[156:159], v[28:31]
  v_mfma_f32_16x16x32_bf16 v[32:35], v[124:127], v[160:163], v[32:35]
  v_mfma_f32_16x16x32_bf16 v[36:39], v[124:127], v[164:167], v[36:39]
  s_waitcnt lgkmcnt(12)
  v_mfma_f32_16x16x32_bf16 v[40:43], v[128:131], v[156:159], v[40:43]
  v_mfma_f32_16x16x32_bf16 v[44:47], v[128:131], v[160:163], v[44:47]
  v_mfma_f32_16x16x32_bf16 v[48:51], v[128:131], v[164:167], v[48:51]
  s_add_u32 s40, s87, 0x9000
  s_add_u32 m0, s62, 0x24000
  s_nop 0
  buffer_load_dwordx4 v14, s[16:19], s40 offen lds
  buffer_load_dwordx4 v15, s[16:19], s40 offen offset:1024 lds
  buffer_load_dwordx4 v16, s[16:19], s40 offen offset:2048 lds
  buffer_load_dwordx4 v17, s[16:19], s40 offen offset:3072 lds
  s_waitcnt lgkmcnt(4)
  v_mfma_f32_16x16x32_bf16 v[52:55], v[132:135], v[156:159], v[52:55]
  v_mfma_f32_16x16x32_bf16 v[56:59], v[132:135], v[160:163], v[56:59]
  v_mfma_f32_16x16x32_bf16 v[60:63], v[132:135], v[164:167], v[60:63]
  v_mfma_f32_16x16x32_bf16 v[64:67], v[136:139], v[156:159], v[64:67]
  v_mfma_f32_16x16x32_bf16 v[68:71], v[136:139], v[160:163], v[68:71]
  v_mfma_f32_16x16x32_bf16 v[72:75], v[136:139], v[164:167], v[72:75]
  s_add_u32 s40, s87, 0x12000
  s_add_u32 m0, s62, 0x25000
  s_nop 0
  buffer_load_dwordx4 v14, s[16:19], s40 offen lds
  v_mfma_f32_16x16x32_bf16 v[76:79], v[140:143], v[156:159], v[76:79]
  v_mfma_f32_16x16x32_bf16 v[80:83], v[140:143], v[160:163], v[80:83]
  v_mfma_f32_16x16x32_bf16 v[84:87], v[140:143], v[164:167], v[84:87]
  v_mfma_f32_16x16x32_bf16 v[88:91], v[144:147], v[156:159], v[88:91]
  v_mfma_f32_16x16x32_bf16 v[92:95], v[144:147], v[160:163], v[92:95]
  v_mfma_f32_16x16x32_bf16 v[96:99], v[144:147], v[164:167], v[96:99]
  s_waitcnt lgkmcnt(0)
  v_mfma_f32_16x16x32_bf16 v[100:103], v[148:151], v[156:159], v[100:103]
  v_mfma_f32_16x16x32_bf16 v[104:107], v[148:151], v[160:163], v[104:107]
  v_mfma_f32_16x16x32_bf16 v[108:111], v[148:151], v[164:167], v[108:111]
  v_mfma_f32_16x16x32_bf16 v[112:115], v[152:155], v[156:159], v[112:115]
  v_mfma_f32_16x16x32_bf16 v[116:119], v[152:155], v[160:163], v[116:119]
  v_mfma_f32_16x16x32_bf16 v[120:123], v[152:155], v[164:167], v[120:123]
  s_waitcnt lgkmcnt(0)
  s_barrier
  ds_read_b128 v[156:159], v11
  ds_read_b128 v[160:163], v11 offset:2048
  ds_read_b128 v[164:167], v11 offset:4096
  ds_read_b64_tr_b16 v[124:125], v2
  ds_read_b64_tr_b16 v[126:127], v2 offset:1024
  ds_read_b64_tr_b16 v[128:129], v3
  ds_read_b64_tr_b16 v[130:131], v3 offset:1024
  ds_read_b64_tr_b16 v[132:133], v4
  ds_read_b64_tr_b16 v[134:135], v4 offset:1024
  ds_read_b64_tr_b16 v[136:137], v5
  ds_read_b64_tr_b16 v[138:139], v5 offset:1024
  ds_read_b64_tr_b16 v[140:141], v6
  ds_read_b64_tr_b16 v[142:143], v6 offset:1024
  ds_read_b64_tr_b16 v[144:145], v7
  ds_read_b64_tr_b16 v[146:147], v7 offset:1024
  s_waitcnt lgkmcnt(14)
  ds_read_b64_tr_b16 v[148:149], v8
  s_waitcnt lgkmcnt(14)
  ds_read_b64_tr_b16 v[150:151], v8 offset:1024
  s_waitcnt lgkmcnt(14)
  ds_read_b64_tr_b16 v[152:153], v9
  s_waitcnt lgkmcnt(14)
  ds_read_b64_tr_b16 v[154:155], v9 offset:1024
  s_waitcnt lgkmcnt(14)
  v_mfma_f32_16x16x32_bf16 v[28:31], v[124:127], v[156:159], v[28:31]
  v_mfma_f32_16x16x32_bf16 v[32:35], v[124:127], v[160:163], v[32:35]
  v_mfma_f32_16x16x32_bf16 v[36:39], v[124:127], v[164:167], v[36:39]
  s_waitcnt lgkmcnt(12)
  v_mfma_f32_16x16x32_bf16 v[40:43], v[128:131], v[156:159], v[40:43]
  v_mfma_f32_16x16x32_bf16 v[44:47], v[128:131], v[160:163], v[44:47]
  v_mfma_f32_16x16x32_bf16 v[48:51], v[128:131], v[164:167], v[48:51]
  s_waitcnt lgkmcnt(10)
  v_mfma_f32_16x16x32_bf16 v[52:55], v[132:135], v[156:159], v[52:55]
  v_mfma_f32_16x16x32_bf16 v[56:59], v[132:135], v[160:163], v[56:59]
  v_mfma_f32_16x16x32_bf16 v[60:63], v[132:135], v[164:167], v[60:63]
  s_waitcnt lgkmcnt(8)
  v_mfma_f32_16x16x32_bf16 v[64:67], v[136:139], v[156:159], v[64:67]
  v_mfma_f32_16x16x32_bf16 v[68:71], v[136:139], v[160:163], v[68:71]
  v_mfma_f32_16x16x32_bf16 v[72:75], v[136:139], v[164:167], v[72:75]
  s_waitcnt lgkmcnt(6)
  v_mfma_f32_16x16x32_bf16 v[76:79], v[140:143], v[156:159], v[76:79]
  v_mfma_f32_16x16x32_bf16 v[80:83], v[140:143], v[160:163], v[80:83]
  v_mfma_f32_16x16x32_bf16 v[84:87], v[140:143], v[164:167], v[84:87]
  s_waitcnt lgkmcnt(4)
  v_mfma_f32_16x16x32_bf16 v[88:91], v[144:147], v[156:159], v[88:91]
  v_mfma_f32_16x16x32_bf16 v[92:95], v[144:147], v[160:163], v[92:95]
  v_mfma_f32_16x16x32_bf16 v[96:99], v[144:147], v[164:167], v[96:99]
  s_waitcnt lgkmcnt(2)
  v_mfma_f32_16x16x32_bf16 v[100:103], v[148:151], v[156:159], v[100:103]
  v_mfma_f32_16x16x32_bf16 v[104:107], v[148:151], v[160:163], v[104:107]
  v_mfma_f32_16x16x32_bf16 v[108:111], v[148:151], v[164:167], v[108:111]
  s_waitcnt lgkmcnt(0)
  v_mfma_f32_16x16x32_bf16 v[112:115], v[152:155], v[156:159], v[112:115]
  v_mfma_f32_16x16x32_bf16 v[116:119], v[152:155], v[160:163], v[116:119]
  v_mfma_f32_16x16x32_bf16 v[120:123], v[152:155], v[164:167], v[120:123]
  s_waitcnt vmcnt(0)
  s_waitcnt lgkmcnt(0)
  s_barrier
  ds_read_b128 v[156:159], v10 offset:18432
  ds_read_b128 v[160:163], v10 offset:20480
  ds_read_b128 v[164:167], v10 offset:22528
  ds_read_b64_tr_b16 v[124:125], v2 offset:8192
  ds_read_b64_tr_b16 v[126:127], v2 offset:9216
  ds_read_b64_tr_b16 v[128:129], v3 offset:8192
  ds_read_b64_tr_b16 v[130:131], v3 offset:9216
  ds_read_b64_tr_b16 v[132:133], v4 offset:8192
  ds_read_b64_tr_b16 v[134:135], v4 offset:9216
  ds_read_b64_tr_b16 v[136:137], v5 offset:8192
  ds_read_b64_tr_b16 v[138:139], v5 offset:9216
  ds_read_b64_tr_b16 v[140:141], v6 offset:8192
  ds_read_b64_tr_b16 v[142:143], v6 offset:9216
  ds_read_b64_tr_b16 v[144:145], v7 offset:8192
  ds_read_b64_tr_b16 v[146:147], v7 offset:9216
  s_waitcnt lgkmcnt(14)
  ds_read_b64_tr_b16 v[148:149], v8 offset:8192
  s_waitcnt lgkmcnt(14)
  ds_read_b64_tr_b16 v[150:151], v8 offset:9216
  s_waitcnt lgkmcnt(14)
  ds_read_b64_tr_b16 v[152:153], v9 offset:8192
  s_waitcnt lgkmcnt(14)
  ds_read_b64_tr_b16 v[154:155], v9 offset:9216
  s_waitcnt lgkmcnt(14)
  v_mfma_f32_16x16x32_bf16 v[28:31], v[124:127], v[156:159], v[28:31]
  v_mfma_f32_16x16x32_bf16 v[32:35], v[124:127], v[160:163], v[32:35]
  v_mfma_f32_16x16x32_bf16 v[36:39], v[124:127], v[164:167], v[36:39]
  s_waitcnt lgkmcnt(12)
  v_mfma_f32_16x16x32_bf16 v[40:43], v[128:131], v[156:159], v[40:43]
  v_mfma_f32_16x16x32_bf16 v[44:47], v[128:131], v[160:163], v[44:47]
  v_mfma_f32_16x16x32_bf16 v[48:51], v[128:131], v[164:167], v[48:51]
  s_waitcnt lgkmcnt(10)
  v_mfma_f32_16x16x32_bf16 v[52:55], v[132:135], v[156:159], v[52:55]
  v_mfma_f32_16x16x32_bf16 v[56:59], v[132:135], v[160:163], v[56:59]
  v_mfma_f32_16x16x32_bf16 v[60:63], v[132:135], v[164:167], v[60:63]
  s_waitcnt lgkmcnt(8)
  v_mfma_f32_16x16x32_bf16 v[64:67], v[136:139], v[156:159], v[64:67]
  v_mfma_f32_16x16x32_bf16 v[68:71], v[136:139], v[160:163], v[68:71]
  v_mfma_f32_16x16x32_bf16 v[72:75], v[136:139], v[164:167], v[72:75]
  s_waitcnt lgkmcnt(6)
  v_mfma_f32_16x16x32_bf16 v[76:79], v[140:143], v[156:159], v[76:79]
  v_mfma_f32_16x16x32_bf16 v[80:83], v[140:143], v[160:163], v[80:83]
  v_mfma_f32_16x16x32_bf16 v[84:87], v[140:143], v[164:167], v[84:87]
  s_waitcnt lgkmcnt(4)
  v_mfma_f32_16x16x32_bf16 v[88:91], v[144:147], v[156:159], v[88:91]
  v_mfma_f32_16x16x32_bf16 v[92:95], v[144:147], v[160:163], v[92:95]
  v_mfma_f32_16x16x32_bf16 v[96:99], v[144:147], v[164:167], v[96:99]
  s_waitcnt lgkmcnt(2)
  v_mfma_f32_16x16x32_bf16 v[100:103], v[148:151], v[156:159], v[100:103]
  v_mfma_f32_16x16x32_bf16 v[104:107], v[148:151], v[160:163], v[104:107]
  v_mfma_f32_16x16x32_bf16 v[108:111], v[148:151], v[164:167], v[108:111]
  s_waitcnt lgkmcnt(0)
  v_mfma_f32_16x16x32_bf16 v[112:115], v[152:155], v[156:159], v[112:115]
  v_mfma_f32_16x16x32_bf16 v[116:119], v[152:155], v[160:163], v[116:119]
  v_mfma_f32_16x16x32_bf16 v[120:123], v[152:155], v[164:167], v[120:123]
  s_waitcnt lgkmcnt(0)
  s_barrier
  ds_read_b128 v[156:159], v11 offset:18432
  ds_read_b128 v[160:163], v11 offset:20480
  ds_read_b128 v[164:167], v11 offset:22528
  ds_read_b64_tr_b16 v[124:125], v2 offset:16384
  ds_read_b64_tr_b16 v[126:127], v2 offset:17408
  ds_read_b64_tr_b16 v[128:129], v3 offset:16384
  ds_read_b64_tr_b16 v[130:131], v3 offset:17408
  ds_read_b64_tr_b16 v[132:133], v4 offset:16384
  ds_read_b64_tr_b16 v[134:135], v4 offset:17408
  ds_read_b64_tr_b16 v[136:137], v5 offset:16384
  ds_read_b64_tr_b16 v[138:139], v5 offset:17408
  ds_read_b64_tr_b16 v[140:141], v6 offset:16384
  ds_read_b64_tr_b16 v[142:143], v6 offset:17408
  ds_read_b64_tr_b16 v[144:145], v7 offset:16384
  ds_read_b64_tr_b16 v[146:147], v7 offset:17408
  s_waitcnt lgkmcnt(14)
  ds_read_b64_tr_b16 v[148:149], v8 offset:16384
  s_waitcnt lgkmcnt(14)
  ds_read_b64_tr_b16 v[150:151], v8 offset:17408
  s_waitcnt lgkmcnt(14)
  ds_read_b64_tr_b16 v[152:153], v9 offset:16384
  s_waitcnt lgkmcnt(14)
  ds_read_b64_tr_b16 v[154:155], v9 offset:17408
  s_waitcnt lgkmcnt(14)
  v_mfma_f32_16x16x32_bf16 v[28:31], v[124:127], v[156:159], v[28:31]
  v_mfma_f32_16x16x32_bf16 v[32:35], v[124:127], v[160:163], v[32:35]
  v_mfma_f32_16x16x32_bf16 v[36:39], v[124:127], v[164:167], v[36:39]
  s_waitcnt lgkmcnt(12)
  v_mfma_f32_16x16x32_bf16 v[40:43], v[128:131], v[156:159], v[40:43]
  v_mfma_f32_16x16x32_bf16 v[44:47], v[128:131], v[160:163], v[44:47]
  v_mfma_f32_16x16x32_bf16 v[48:51], v[128:131], v[164:167], v[48:51]
  s_waitcnt lgkmcnt(10)
  v_mfma_f32_16x16x32_bf16 v[52:55], v[132:135], v[156:159], v[52:55]
  v_mfma_f32_16x16x32_bf16 v[56:59], v[132:135], v[160:163], v[56:59]
  v_mfma_f32_16x16x32_bf16 v[60:63], v[132:135], v[164:167], v[60:63]
  s_waitcnt lgkmcnt(8)
  v_mfma_f32_16x16x32_bf16 v[64:67], v[136:139], v[156:159], v[64:67]
  v_mfma_f32_16x16x32_bf16 v[68:71], v[136:139], v[160:163], v[68:71]
  v_mfma_f32_16x16x32_bf16 v[72:75], v[136:139], v[164:167], v[72:75]
  s_waitcnt lgkmcnt(6)
  v_mfma_f32_16x16x32_bf16 v[76:79], v[140:143], v[156:159], v[76:79]
  v_mfma_f32_16x16x32_bf16 v[80:83], v[140:143], v[160:163], v[80:83]
  v_mfma_f32_16x16x32_bf16 v[84:87], v[140:143], v[164:167], v[84:87]
  s_waitcnt lgkmcnt(4)
  v_mfma_f32_16x16x32_bf16 v[88:91], v[144:147], v[156:159], v[88:91]
  v_mfma_f32_16x16x32_bf16 v[92:95], v[144:147], v[160:163], v[92:95]
  v_mfma_f32_16x16x32_bf16 v[96:99], v[144:147], v[164:167], v[96:99]
  s_waitcnt lgkmcnt(2)
  v_mfma_f32_16x16x32_bf16 v[100:103], v[148:151], v[156:159], v[100:103]
  v_mfma_f32_16x16x32_bf16 v[104:107], v[148:151], v[160:163], v[104:107]
  v_mfma_f32_16x16x32_bf16 v[108:111], v[148:151], v[164:167], v[108:111]
  s_waitcnt lgkmcnt(0)
  v_mfma_f32_16x16x32_bf16 v[112:115], v[152:155], v[156:159], v[112:115]
  v_mfma_f32_16x16x32_bf16 v[116:119], v[152:155], v[160:163], v[116:119]
  v_mfma_f32_16x16x32_bf16 v[120:123], v[152:155], v[164:167], v[120:123]
  s_waitcnt lgkmcnt(0)
  s_barrier
  ds_read_b128 v[156:159], v252
  ds_read_b128 v[160:163], v252 offset:2048
  ds_read_b128 v[164:167], v252 offset:4096
  ds_read_b64_tr_b16 v[124:125], v2 offset:24576
  ds_read_b64_tr_b16 v[126:127], v2 offset:25600
  ds_read_b64_tr_b16 v[128:129], v3 offset:24576
  ds_read_b64_tr_b16 v[130:131], v3 offset:25600
  ds_read_b64_tr_b16 v[132:133], v4 offset:24576
  ds_read_b64_tr_b16 v[134:135], v4 offset:25600
  ds_read_b64_tr_b16 v[136:137], v5 offset:24576
  ds_read_b64_tr_b16 v[138:139], v5 offset:25600
  ds_read_b64_tr_b16 v[140:141], v6 offset:24576
  ds_read_b64_tr_b16 v[142:143], v6 offset:25600
  ds_read_b64_tr_b16 v[144:145], v7 offset:24576
  ds_read_b64_tr_b16 v[146:147], v7 offset:25600
  s_waitcnt lgkmcnt(14)
  ds_read_b64_tr_b16 v[148:149], v8 offset:24576
  s_waitcnt lgkmcnt(14)
  ds_read_b64_tr_b16 v[150:151], v8 offset:25600
  s_waitcnt lgkmcnt(14)
  ds_read_b64_tr_b16 v[152:153], v9 offset:24576
  s_waitcnt lgkmcnt(14)
  ds_read_b64_tr_b16 v[154:155], v9 offset:25600
  s_waitcnt lgkmcnt(14)
  v_mfma_f32_16x16x32_bf16 v[28:31], v[124:127], v[156:159], v[28:31]
  v_mfma_f32_16x16x32_bf16 v[32:35], v[124:127], v[160:163], v[32:35]
  v_mfma_f32_16x16x32_bf16 v[36:39], v[124:127], v[164:167], v[36:39]
  s_waitcnt lgkmcnt(12)
  v_mfma_f32_16x16x32_bf16 v[40:43], v[128:131], v[156:159], v[40:43]
  v_mfma_f32_16x16x32_bf16 v[44:47], v[128:131], v[160:163], v[44:47]
  v_mfma_f32_16x16x32_bf16 v[48:51], v[128:131], v[164:167], v[48:51]
  s_waitcnt lgkmcnt(10)
  v_mfma_f32_16x16x32_bf16 v[52:55], v[132:135], v[156:159], v[52:55]
  v_mfma_f32_16x16x32_bf16 v[56:59], v[132:135], v[160:163], v[56:59]
  v_mfma_f32_16x16x32_bf16 v[60:63], v[132:135], v[164:167], v[60:63]
  s_waitcnt lgkmcnt(8)
  v_mfma_f32_16x16x32_bf16 v[64:67], v[136:139], v[156:159], v[64:67]
  v_mfma_f32_16x16x32_bf16 v[68:71], v[136:139], v[160:163], v[68:71]
  v_mfma_f32_16x16x32_bf16 v[72:75], v[136:139], v[164:167], v[72:75]
  s_waitcnt lgkmcnt(6)
  v_mfma_f32_16x16x32_bf16 v[76:79], v[140:143], v[156:159], v[76:79]
  v_mfma_f32_16x16x32_bf16 v[80:83], v[140:143], v[160:163], v[80:83]
  v_mfma_f32_16x16x32_bf16 v[84:87], v[140:143], v[164:167], v[84:87]
  s_waitcnt lgkmcnt(4)
  v_mfma_f32_16x16x32_bf16 v[88:91], v[144:147], v[156:159], v[88:91]
  v_mfma_f32_16x16x32_bf16 v[92:95], v[144:147], v[160:163], v[92:95]
  v_mfma_f32_16x16x32_bf16 v[96:99], v[144:147], v[164:167], v[96:99]
  s_waitcnt lgkmcnt(2)
  v_mfma_f32_16x16x32_bf16 v[100:103], v[148:151], v[156:159], v[100:103]
  v_mfma_f32_16x16x32_bf16 v[104:107], v[148:151], v[160:163], v[104:107]
  v_mfma_f32_16x16x32_bf16 v[108:111], v[148:151], v[164:167], v[108:111]
  s_waitcnt lgkmcnt(0)
  v_mfma_f32_16x16x32_bf16 v[112:115], v[152:155], v[156:159], v[112:115]
  v_mfma_f32_16x16x32_bf16 v[116:119], v[152:155], v[160:163], v[116:119]
  v_mfma_f32_16x16x32_bf16 v[120:123], v[152:155], v[164:167], v[120:123]
  s_waitcnt lgkmcnt(0)
  s_barrier
  ds_read_b128 v[156:159], v253
  ds_read_b128 v[160:163], v253 offset:2048
  ds_read_b128 v[164:167], v253 offset:4096
  ds_read_b64_tr_b16 v[124:125], v2 offset:32768
  ds_read_b64_tr_b16 v[126:127], v2 offset:33792
  ds_read_b64_tr_b16 v[128:129], v3 offset:32768
  ds_read_b64_tr_b16 v[130:131], v3 offset:33792
  ds_read_b64_tr_b16 v[132:133], v4 offset:32768
  ds_read_b64_tr_b16 v[134:135], v4 offset:33792
  ds_read_b64_tr_b16 v[136:137], v5 offset:32768
  ds_read_b64_tr_b16 v[138:139], v5 offset:33792
  ds_read_b64_tr_b16 v[140:141], v6 offset:32768
  ds_read_b64_tr_b16 v[142:143], v6 offset:33792
  ds_read_b64_tr_b16 v[144:145], v7 offset:32768
  ds_read_b64_tr_b16 v[146:147], v7 offset:33792
  s_waitcnt lgkmcnt(14)
  ds_read_b64_tr_b16 v[148:149], v8 offset:32768
  s_waitcnt lgkmcnt(14)
  ds_read_b64_tr_b16 v[150:151], v8 offset:33792
  s_waitcnt lgkmcnt(14)
  ds_read_b64_tr_b16 v[152:153], v9 offset:32768
  s_waitcnt lgkmcnt(14)
  ds_read_b64_tr_b16 v[154:155], v9 offset:33792
  s_waitcnt lgkmcnt(14)
  v_mfma_f32_16x16x32_bf16 v[28:31], v[124:127], v[156:159], v[28:31]
  v_mfma_f32_16x16x32_bf16 v[32:35], v[124:127], v[160:163], v[32:35]
  v_mfma_f32_16x16x32_bf16 v[36:39], v[124:127], v[164:167], v[36:39]
  s_waitcnt lgkmcnt(12)
  v_mfma_f32_16x16x32_bf16 v[40:43], v[128:131], v[156:159], v[40:43]
  v_mfma_f32_16x16x32_bf16 v[44:47], v[128:131], v[160:163], v[44:47]
  v_mfma_f32_16x16x32_bf16 v[48:51], v[128:131], v[164:167], v[48:51]
  s_waitcnt lgkmcnt(10)
  v_mfma_f32_16x16x32_bf16 v[52:55], v[132:135], v[156:159], v[52:55]
  v_mfma_f32_16x16x32_bf16 v[56:59], v[132:135], v[160:163], v[56:59]
  v_mfma_f32_16x16x32_bf16 v[60:63], v[132:135], v[164:167], v[60:63]
  s_waitcnt lgkmcnt(8)
  v_mfma_f32_16x16x32_bf16 v[64:67], v[136:139], v[156:159], v[64:67]
  v_mfma_f32_16x16x32_bf16 v[68:71], v[136:139], v[160:163], v[68:71]
  v_mfma_f32_16x16x32_bf16 v[72:75], v[136:139], v[164:167], v[72:75]
  s_waitcnt lgkmcnt(6)
  v_mfma_f32_16x16x32_bf16 v[76:79], v[140:143], v[156:159], v[76:79]
  v_mfma_f32_16x16x32_bf16 v[80:83], v[140:143], v[160:163], v[80:83]
  v_mfma_f32_16x16x32_bf16 v[84:87], v[140:143], v[164:167], v[84:87]
  s_waitcnt lgkmcnt(4)
  v_mfma_f32_16x16x32_bf16 v[88:91], v[144:147], v[156:159], v[88:91]
  v_mfma_f32_16x16x32_bf16 v[92:95], v[144:147], v[160:163], v[92:95]
  v_mfma_f32_16x16x32_bf16 v[96:99], v[144:147], v[164:167], v[96:99]
  s_waitcnt lgkmcnt(2)
  v_mfma_f32_16x16x32_bf16 v[100:103], v[148:151], v[156:159], v[100:103]
  v_mfma_f32_16x16x32_bf16 v[104:107], v[148:151], v[160:163], v[104:107]
  v_mfma_f32_16x16x32_bf16 v[108:111], v[148:151], v[164:167], v[108:111]
  s_waitcnt lgkmcnt(0)
  v_mfma_f32_16x16x32_bf16 v[112:115], v[152:155], v[156:159], v[112:115]
  v_mfma_f32_16x16x32_bf16 v[116:119], v[152:155], v[160:163], v[116:119]
  v_mfma_f32_16x16x32_bf16 v[120:123], v[152:155], v[164:167], v[120:123]
  s_waitcnt lgkmcnt(0)
  s_barrier
  s_setprio 3
  ds_read_b64_tr_b16 v[124:125], v2
  ds_read_b64_tr_b16 v[126:127], v2 offset:1024
  ds_read_b64_tr_b16 v[128:129], v3
  ds_read_b64_tr_b16 v[130:131], v3 offset:1024
  ds_read_b64_tr_b16 v[132:133], v4
  ds_read_b64_tr_b16 v[134:135], v4 offset:1024
  ds_read_b64_tr_b16 v[136:137], v5
  ds_read_b64_tr_b16 v[138:139], v5 offset:1024
  ds_read_b64_tr_b16 v[140:141], v6
  ds_read_b64_tr_b16 v[142:143], v6 offset:1024
  ds_read_b64_tr_b16 v[144:145], v7
  ds_read_b64_tr_b16 v[146:147], v7 offset:1024
  ds_read_b64_tr_b16 v[148:149], v8
  ds_read_b64_tr_b16 v[150:151], v8 offset:1024
  ds_read_b64_tr_b16 v[152:153], v9
  s_waitcnt lgkmcnt(14)
  ds_read_b64_tr_b16 v[154:155], v9 offset:1024
  v_pk_mul_f32 v[28:29], v[28:29], s[88:89]
  v_pk_mul_f32 v[30:31], v[30:31], s[88:89]
  v_cvt_pk_bf16_f32 v20, v28, v29
  v_cvt_pk_bf16_f32 v21, v30, v31
  s_waitcnt lgkmcnt(14)
  ds_write_b64 v13, v[20:21]
  v_pk_mul_f32 v[40:41], v[40:41], s[88:89]
  v_pk_mul_f32 v[42:43], v[42:43], s[88:89]
  v_cvt_pk_bf16_f32 v22, v40, v41
  v_cvt_pk_bf16_f32 v23, v42, v43
  s_waitcnt lgkmcnt(14)
  ds_write_b64 v13, v[22:23] offset:512
  v_pk_mul_f32 v[32:33], v[32:33], s[88:89]
  v_pk_mul_f32 v[34:35], v[34:35], s[88:89]
  v_mfma_f32_16x16x32_bf16 v[28:31], v[124:127], v[168:171], 0
  v_cvt_pk_bf16_f32 v24, v32, v33
  v_cvt_pk_bf16_f32 v25, v34, v35
  s_waitcnt lgkmcnt(11)
  ds_write_b64 v13, v[24:25] offset:4096
  v_pk_mul_f32 v[44:45], v[44:45], s[88:89]
  v_pk_mul_f32 v[46:47], v[46:47], s[88:89]
  v_mfma_f32_16x16x32_bf16 v[40:43], v[128:131], v[168:171], 0
  v_cvt_pk_bf16_f32 v26, v44, v45
  v_cvt_pk_bf16_f32 v27, v46, v47
  ds_write_b64 v13, v[26:27] offset:4608
  v_pk_mul_f32 v[36:37], v[36:37], s[88:89]
  v_pk_mul_f32 v[38:39], v[38:39], s[88:89]
  v_mfma_f32_16x16x32_bf16 v[32:35], v[124:127], v[172:175], 0
  v_cvt_pk_bf16_f32 v20, v36, v37
  v_cvt_pk_bf16_f32 v21, v38, v39
  ds_write_b64 v13, v[20:21] offset:8192
  v_pk_mul_f32 v[48:49], v[48:49], s[88:89]
  v_pk_mul_f32 v[50:51], v[50:51], s[88:89]
  v_mfma_f32_16x16x32_bf16 v[44:47], v[128:131], v[172:175], 0
  v_cvt_pk_bf16_f32 v22, v48, v49
  v_cvt_pk_bf16_f32 v23, v50, v51
  ds_write_b64 v13, v[22:23] offset:8704
  v_pk_mul_f32 v[52:53], v[52:53], s[88:89]
  v_pk_mul_f32 v[54:55], v[54:55], s[88:89]
  v_mfma_f32_16x16x32_bf16 v[36:39], v[124:127], v[176:179], 0
  v_cvt_pk_bf16_f32 v24, v52, v53
  v_cvt_pk_bf16_f32 v25, v54, v55
  s_waitcnt lgkmcnt(4)
  ds_write_b64 v13, v[24:25] offset:1024
  v_pk_mul_f32 v[64:65], v[64:65], s[88:89]
  v_pk_mul_f32 v[66:67], v[66:67], s[88:89]
  v_mfma_f32_16x16x32_bf16 v[48:51], v[128:131], v[176:179], 0
  v_cvt_pk_bf16_f32 v26, v64, v65
  v_cvt_pk_bf16_f32 v27, v66, v67
  ds_write_b64 v13, v[26:27] offset:1536
  v_pk_mul_f32 v[56:57], v[56:57], s[88:89]
  v_pk_mul_f32 v[58:59], v[58:59], s[88:89]
  v_mfma_f32_16x16x32_bf16 v[52:55], v[132:135], v[168:171], 0
  v_cvt_pk_bf16_f32 v20, v56, v57
  v_cvt_pk_bf16_f32 v21, v58, v59
  ds_write_b64 v13, v[20:21] offset:5120
  v_pk_mul_f32 v[68:69], v[68:69], s[88:89]
  v_pk_mul_f32 v[70:71], v[70:71], s[88:89]
  v_mfma_f32_16x16x32_bf16 v[64:67], v[136:139], v[168:171], 0
  v_cvt_pk_bf16_f32 v22, v68, v69
  v_cvt_pk_bf16_f32 v23, v70, v71
  ds_write_b64 v13, v[22:23] offset:5632
  v_pk_mul_f32 v[60:61], v[60:61], s[88:89]
  v_pk_mul_f32 v[62:63], v[62:63], s[88:89]
  v_mfma_f32_16x16x32_bf16 v[56:59], v[132:135], v[172:175], 0
  v_cvt_pk_bf16_f32 v24, v60, v61
  v_cvt_pk_bf16_f32 v25, v62, v63
  ds_write_b64 v13, v[24:25] offset:9216
  v_pk_mul_f32 v[72:73], v[72:73], s[88:89]
  v_pk_mul_f32 v[74:75], v[74:75], s[88:89]
  v_mfma_f32_16x16x32_bf16 v[68:71], v[136:139], v[172:175], 0
  v_cvt_pk_bf16_f32 v26, v72, v73
  v_cvt_pk_bf16_f32 v27, v74, v75
  ds_write_b64 v13, v[26:27] offset:9728
  v_pk_mul_f32 v[76:77], v[76:77], s[88:89]
  v_pk_mul_f32 v[78:79], v[78:79], s[88:89]
  v_mfma_f32_16x16x32_bf16 v[60:63], v[132:135], v[176:179], 0
  v_cvt_pk_bf16_f32 v20, v76, v77
  v_cvt_pk_bf16_f32 v21, v78, v79
  ds_write_b64 v13, v[20:21] offset:2048
  v_pk_mul_f32 v[88:89], v[88:89], s[88:89]
  v_pk_mul_f32 v[90:91], v[90:91], s[88:89]
  v_mfma_f32_16x16x32_bf16 v[72:75], v[136:139], v[176:179], 0
  v_cvt_pk_bf16_f32 v22, v88, v89
  v_cvt_pk_bf16_f32 v23, v90, v91
  ds_write_b64 v13, v[22:23] offset:2560
  v_pk_mul_f32 v[80:81], v[80:81], s[88:89]
  v_pk_mul_f32 v[82:83], v[82:83], s[88:89]
  v_mfma_f32_16x16x32_bf16 v[76:79], v[140:143], v[168:171], 0
  v_cvt_pk_bf16_f32 v24, v80, v81
  v_cvt_pk_bf16_f32 v25, v82, v83
  ds_write_b64 v13, v[24:25] offset:6144
  v_pk_mul_f32 v[92:93], v[92:93], s[88:89]
  v_pk_mul_f32 v[94:95], v[94:95], s[88:89]
  v_mfma_f32_16x16x32_bf16 v[88:91], v[144:147], v[168:171], 0
  v_cvt_pk_bf16_f32 v26, v92, v93
  v_cvt_pk_bf16_f32 v27, v94, v95
  ds_write_b64 v13, v[26:27] offset:6656
  v_pk_mul_f32 v[84:85], v[84:85], s[88:89]
  v_pk_mul_f32 v[86:87], v[86:87], s[88:89]
  v_mfma_f32_16x16x32_bf16 v[80:83], v[140:143], v[172:175], 0
  v_cvt_pk_bf16_f32 v20, v84, v85
  v_cvt_pk_bf16_f32 v21, v86, v87
  ds_write_b64 v13, v[20:21] offset:10240
  v_pk_mul_f32 v[96:97], v[96:97], s[88:89]
  v_pk_mul_f32 v[98:99], v[98:99], s[88:89]
  v_mfma_f32_16x16x32_bf16 v[92:95], v[144:147], v[172:175], 0
  v_cvt_pk_bf16_f32 v22, v96, v97
  v_cvt_pk_bf16_f32 v23, v98, v99
  s_waitcnt lgkmcnt(4)
  ds_write_b64 v13, v[22:23] offset:10752
  v_pk_mul_f32 v[100:101], v[100:101], s[88:89]
  v_pk_mul_f32 v[102:103], v[102:103], s[88:89]
  v_mfma_f32_16x16x32_bf16 v[84:87], v[140:143], v[176:179], 0
  v_cvt_pk_bf16_f32 v24, v100, v101
  v_cvt_pk_bf16_f32 v25, v102, v103
  ds_write_b64 v13, v[24:25] offset:3072
  v_pk_mul_f32 v[112:113], v[112:113], s[88:89]
  v_pk_mul_f32 v[114:115], v[114:115], s[88:89]
  v_mfma_f32_16x16x32_bf16 v[96:99], v[144:147], v[176:179], 0
  v_cvt_pk_bf16_f32 v26, v112, v113
  v_cvt_pk_bf16_f32 v27, v114, v115
  ds_write_b64 v13, v[26:27] offset:3584
  v_pk_mul_f32 v[104:105], v[104:105], s[88:89]
  v_pk_mul_f32 v[106:107], v[106:107], s[88:89]
  v_mfma_f32_16x16x32_bf16 v[100:103], v[148:151], v[168:171], 0
  v_cvt_pk_bf16_f32 v20, v104, v105
  v_cvt_pk_bf16_f32 v21, v106, v107
  ds_write_b64 v13, v[20:21] offset:7168
  v_pk_mul_f32 v[116:117], v[116:117], s[88:89]
  v_pk_mul_f32 v[118:119], v[118:119], s[88:89]
  v_mfma_f32_16x16x32_bf16 v[112:115], v[152:155], v[168:171], 0
  v_cvt_pk_bf16_f32 v22, v116, v117
  v_cvt_pk_bf16_f32 v23, v118, v119
  ds_write_b64 v13, v[22:23] offset:7680
  v_pk_mul_f32 v[108:109], v[108:109], s[88:89]
  v_pk_mul_f32 v[110:111], v[110:111], s[88:89]
  v_mfma_f32_16x16x32_bf16 v[104:107], v[148:151], v[172:175], 0
  v_cvt_pk_bf16_f32 v24, v108, v109
  v_cvt_pk_bf16_f32 v25, v110, v111
  ds_write_b64 v13, v[24:25] offset:11264
  v_pk_mul_f32 v[120:121], v[120:121], s[88:89]
  v_pk_mul_f32 v[122:123], v[122:123], s[88:89]
  v_mfma_f32_16x16x32_bf16 v[116:119], v[152:155], v[172:175], 0
  v_cvt_pk_bf16_f32 v26, v120, v121
  v_cvt_pk_bf16_f32 v27, v122, v123
  ds_write_b64 v13, v[26:27] offset:11776
  v_mfma_f32_16x16x32_bf16 v[108:111], v[148:151], v[176:179], 0
  v_mfma_f32_16x16x32_bf16 v[120:123], v[152:155], v[176:179], 0
  s_setprio 0
  s_add_u32 s36, s36, 1
  s_cmp_lt_u32 s36, 3
  s_cbranch_scc1 L_Bx_loop
  s_cmp_eq_u32 s32, 5
  s_cbranch_scc1 L_r3_5
L_r3_4:
  s_waitcnt lgkmcnt(0)
  s_setprio 0
  v_lshlrev_b32 v2, 4, v0
  v_lshrrev_b32 v14, 2, v0
  v_bfe_u32 v15, v0, 3, 2
  v_lshlrev_b32 v14, 7, v14
  v_and_b32 v9, 3, v0
  v_lshl_add_u32 v14, v9, 3, v14
  v_xor_b32 v9, 2, v15
  v_lshl_add_u32 v3, v9, 5, v14
  v_add_u32 v5, 100352, v3
  v_xor_b32 v9, 3, v15
  v_lshl_add_u32 v4, v9, 5, v14
  v_add_u32 v6, 100352, v4
  v_lshrrev_b32 v14, 4, v0
  v_lshlrev_b32 v14, 1, v14
  v_xor_b32 v14, v14, v0
  v_and_b32 v14, 7, v14
  v_lshlrev_b32 v14, 4, v14
  v_lshrrev_b32 v15, 3, v0
  v_mul_u32_u24 v15, 1152, v15
  v_add_u32 v7, v14, v15
  v_add_u32 v8, 8192, v7
  v_add_u32 v9, 59392, v2
  s_mul_i32 s72, s57, 147456
  s_lshl_b32 s73, s33, 3
  s_add_u32 s73, s73, s34
  s_mul_i32 s73, s73, 165888
  s_add_u32 s73, s73, 0x5000000
  s_lshl_b32 s75, s33, 5
  s_add_u32 s75, s75, s34
  s_mul_i32 s75, s75, 36864
  s_waitcnt lgkmcnt(0)
  s_barrier
  s_waitcnt lgkmcnt(0)
  s_barrier
  s_waitcnt lgkmcnt(0)
  s_barrier
  s_waitcnt lgkmcnt(0)
  s_barrier
  v_add_u32 v14, 124928, v2
  ds_read_b128 v[64:67], v14 offset:24576
  ds_read_b128 v[68:71], v14 offset:28672
  ds_read_b128 v[72:75], v14 offset:32768
  ds_read_b128 v[76:79], v14 offset:25600
  ds_read_b128 v[80:83], v14 offset:29696
  ds_read_b128 v[84:87], v14 offset:33792
  ds_read_b128 v[88:91], v14 offset:26624
  ds_read_b128 v[92:95], v14 offset:30720
  ds_read_b128 v[96:99], v14 offset:34816
  ds_read_b128 v[100:103], v14 offset:27648
  ds_read_b128 v[104:107], v14 offset:31744
  ds_read_b128 v[108:111], v14 offset:35840
  s_waitcnt lgkmcnt(0)
  s_barrier
  ds_read_b128 v[160:163], v2 offset:16384
  ds_read_b128 v[164:167], v2 offset:20480
  ds_read_b128 v[168:171], v2 offset:24576
  ds_read_b128 v[172:175], v2 offset:17408
  ds_read_b128 v[176:179], v2 offset:21504
  ds_read_b128 v[180:183], v2 offset:25600
  ds_read_b128 v[184:187], v2 offset:18432
  ds_read_b128 v[188:191], v2 offset:22528
  ds_read_b128 v[192:195], v2 offset:26624
  ds_read_b128 v[196:199], v2 offset:19456
  ds_read_b128 v[200:203], v2 offset:23552
  ds_read_b128 v[204:207], v2 offset:27648
  ds_read_b128 v[208:211], v2 offset:28672
  ds_read_b128 v[212:215], v2 offset:32768
  ds_read_b128 v[216:219], v2 offset:36864
  s_waitcnt lgkmcnt(14)
  ds_read_b128 v[220:223], v2 offset:29696
  s_waitcnt lgkmcnt(14)
  ds_read_b128 v[224:227], v2 offset:33792
  s_waitcnt lgkmcnt(14)
  ds_read_b128 v[228:231], v2 offset:37888
  s_waitcnt lgkmcnt(14)
  ds_read_b128 v[232:235], v2 offset:30720
  s_waitcnt lgkmcnt(14)
  ds_read_b128 v[236:239], v2 offset:34816
  s_waitcnt lgkmcnt(14)
  ds_read_b128 v[240:243], v2 offset:38912
  s_waitcnt lgkmcnt(14)
  ds_read_b128 v[244:247], v2 offset:31744
  s_waitcnt lgkmcnt(14)
  ds_read_b128 v[248:251], v2 offset:35840
  s_waitcnt lgkmcnt(14)
  ds_read_b128 v[252:255], v2 offset:39936
  s_waitcnt lgkmcnt(0)
  s_barrier
  s_waitcnt lgkmcnt(0)
  s_barrier
  s_waitcnt lgkmcnt(0)
  s_barrier
  s_waitcnt lgkmcnt(0)
  s_barrier
  s_waitcnt lgkmcnt(0)
  s_barrier
  s_waitcnt lgkmcnt(0)
  s_barrier
  s_waitcnt lgkmcnt(0)
  s_barrier
  s_waitcnt lgkmcnt(0)
  s_barrier
  s_waitcnt lgkmcnt(0)
  s_barrier
  s_waitcnt lgkmcnt(0)
  s_barrier
  s_waitcnt lgkmcnt(0)
  s_barrier
  s_waitcnt lgkmcnt(0)
  s_barrier
  s_lshl_b32 s38, s34, 4
  s_add_u32 s38, s38, s35
  s_mul_i32 s38, s38, 36864
  s_add_u32 s38, s38, 0
  buffer_load_dwordx4 v[32:35], v2, s[24:27], s38 offen offset:0
  buffer_load_dwordx4 v[36:39], v2, s[24:27], s38 offen offset:1024
  buffer_load_dwordx4 v[40:43], v2, s[24:27], s38 offen offset:2048
  buffer_load_dwordx4 v[44:47], v2, s[24:27], s38 offen offset:3072
  s_add_u32 s38, s38, 4096
  buffer_load_dwordx4 v[32:35], v2, s[24:27], s38 offen offset:0
  buffer_load_dwordx4 v[36:39], v2, s[24:27], s38 offen offset:1024
  buffer_load_dwordx4 v[40:43], v2, s[24:27], s38 offen offset:2048
  buffer_load_dwordx4 v[44:47], v2, s[24:27], s38 offen offset:3072
  s_add_u32 s38, s38, 4096
  buffer_load_dwordx4 v[32:35], v2, s[24:27], s38 offen offset:0
  buffer_load_dwordx4 v[36:39], v2, s[24:27], s38 offen offset:1024
  buffer_load_dwordx4 v[40:43], v2, s[24:27], s38 offen offset:2048
  buffer_load_dwordx4 v[44:47], v2, s[24:27], s38 offen offset:3072
  s_add_u32 s38, s38, 4096
  buffer_load_dwordx4 v[32:35], v2, s[24:27], s38 offen offset:0
  buffer_load_dwordx4 v[36:39], v2, s[24:27], s38 offen offset:1024
  buffer_load_dwordx4 v[40:43], v2, s[24:27], s38 offen offset:2048
  buffer_load_dwordx4 v[44:47], v2, s[24:27], s38 offen offset:3072
  s_add_u32 s38, s38, 4096
  buffer_load_dwordx4 v[32:35], v2, s[24:27], s38 offen offset:0
  buffer_load_dwordx4 v[36:39], v2, s[24:27], s38 offen offset:1024
  s_waitcnt lgkmcnt(0)
  s_barrier
  s_waitcnt lgkmcnt(0)
  s_barrier
  s_waitcnt lgkmcnt(0)
  s_barrier
  s_waitcnt vmcnt(0)
  s_waitcnt lgkmcnt(0)
  s_barrier
  ds_read_b128 v[112:115], v9 offset:24576
  ds_read_b128 v[116:119], v9 offset:28672
  ds_read_b128 v[120:123], v9 offset:32768
  ds_read_b128 v[124:127], v9 offset:25600
  ds_read_b128 v[128:131], v9 offset:29696
  ds_read_b128 v[132:135], v9 offset:33792
  ds_read_b128 v[136:139], v9 offset:26624
  ds_read_b128 v[140:143], v9 offset:30720
  ds_read_b128 v[144:147], v9 offset:34816
  ds_read_b128 v[148:151], v9 offset:27648
  ds_read_b128 v[152:155], v9 offset:31744
  ds_read_b128 v[156:159], v9 offset:35840
  s_mov_b32 m0, 0x2000
  s_add_u32 s39, s72, 0x12000
  buffer_load_dwordx4 v7, s[24:27], s39 offen lds
  buffer_load_dwordx4 v8, s[24:27], s39 offen offset:1024 lds
  s_mov_b32 m0, 0x6000
  s_add_u32 s39, s72, 0x36000
  buffer_load_dwordx4 v7, s[24:27], s39 offen lds
  buffer_load_dwordx4 v8, s[24:27], s39 offen offset:1024 lds
  ds_read_b64_tr_b16 v[16:17], v3 offset:40960
  ds_read_b64_tr_b16 v[18:19], v3 offset:43008
  ds_read_b64_tr_b16 v[20:21], v4 offset:40960
  s_waitcnt lgkmcnt(14)
  ds_read_b64_tr_b16 v[22:23], v4 offset:43008
  s_waitcnt lgkmcnt(14)
  ds_read_b64_tr_b16 v[24:25], v3 offset:45056
  s_waitcnt lgkmcnt(14)
  ds_read_b64_tr_b16 v[26:27], v3 offset:47104
  s_waitcnt lgkmcnt(14)
  ds_read_b64_tr_b16 v[28:29], v4 offset:45056
  s_waitcnt lgkmcnt(14)
  ds_read_b64_tr_b16 v[30:31], v4 offset:47104
  s_setprio 1
  s_add_u32 s76, s34, 144
  s_mov_b32 s77, 0
  s_mov_b32 s78, 0
  s_mov_b32 s80, 0x7ff00000
  s_waitcnt lgkmcnt(9)
  ds_read_b64_tr_b16 v[56:57], v3 offset:49152
  ds_read_b64_tr_b16 v[58:59], v3 offset:51200
  s_waitcnt lgkmcnt(8)
  v_mfma_f32_16x16x32_bf16 v[32:35], v[16:19], v[64:67], 0
  v_mfma_f32_16x16x32_bf16 v[40:43], v[16:19], v[68:71], 0
  v_mfma_f32_16x16x32_bf16 v[48:51], v[16:19], v[72:75], 0
  ds_read_b64_tr_b16 v[16:17], v4 offset:49152
  ds_read_b64_tr_b16 v[18:19], v4 offset:51200
  s_waitcnt lgkmcnt(8)
  v_mfma_f32_16x16x32_bf16 v[36:39], v[20:23], v[64:67], 0
  v_mfma_f32_16x16x32_bf16 v[44:47], v[20:23], v[68:71], 0
  v_mfma_f32_16x16x32_bf16 v[52:55], v[20:23], v[72:75], 0
  ds_read_b64_tr_b16 v[20:21], v3 offset:53248
  ds_read_b64_tr_b16 v[22:23], v3 offset:55296
  s_waitcnt lgkmcnt(8)
  v_mfma_f32_16x16x32_bf16 v[32:35], v[24:27], v[76:79], v[32:35]
  v_mfma_f32_16x16x32_bf16 v[40:43], v[24:27], v[80:83], v[40:43]
  v_mfma_f32_16x16x32_bf16 v[48:51], v[24:27], v[84:87], v[48:51]
  ds_read_b64_tr_b16 v[24:25], v4 offset:53248
  ds_read_b64_tr_b16 v[26:27], v4 offset:55296
  s_waitcnt lgkmcnt(8)
  v_mfma_f32_16x16x32_bf16 v[36:39], v[28:31], v[76:79], v[36:39]
  v_mfma_f32_16x16x32_bf16 v[44:47], v[28:31], v[80:83], v[44:47]
  v_mfma_f32_16x16x32_bf16 v[52:55], v[28:31], v[84:87], v[52:55]
  s_waitcnt lgkmcnt(0)
  s_barrier
  ds_read_b64_tr_b16 v[28:29], v5
  ds_read_b64_tr_b16 v[30:31], v5 offset:2048
  v_mfma_f32_16x16x32_bf16 v[32:35], v[56:59], v[88:91], v[32:35]
  v_mfma_f32_16x16x32_bf16 v[40:43], v[56:59], v[92:95], v[40:43]
  s_mov_b32 m0, 0xc000
  s_add_u32 s39, s72, 0x5a080
  buffer_load_dwordx4 v7, s[24:27], s39 offen lds
  buffer_load_dwordx4 v8, s[24:27], s39 offen offset:1024 lds
  v_mfma_f32_16x16x32_bf16 v[48:51], v[56:59], v[96:99], v[48:51]
  ds_read_b64_tr_b16 v[56:57], v6
  ds_read_b64_tr_b16 v[58:59], v6 offset:2048
  v_mfma_f32_16x16x32_bf16 v[36:39], v[16:19], v[88:91], v[36:39]
  v_mfma_f32_16x16x32_bf16 v[44:47], v[16:19], v[92:95], v[44:47]
  v_mfma_f32_16x16x32_bf16 v[52:55], v[16:19], v[96:99], v[52:55]
  ds_read_b64_tr_b16 v[16:17], v5 offset:4096
  ds_read_b64_tr_b16 v[18:19], v5 offset:6144
  v_mfma_f32_16x16x32_bf16 v[32:35], v[20:23], v[100:103], v[32:35]
  v_mfma_f32_16x16x32_bf16 v[40:43], v[20:23], v[104:107], v[40:43]
  v_mfma_f32_16x16x32_bf16 v[48:51], v[20:23], v[108:111], v[48:51]
  ds_read_b64_tr_b16 v[20:21], v6 offset:4096
  ds_read_b64_tr_b16 v[22:23], v6 offset:6144
  v_mfma_f32_16x16x32_bf16 v[36:39], v[24:27], v[100:103], v[36:39]
  v_mfma_f32_16x16x32_bf16 v[44:47], v[24:27], v[104:107], v[44:47]
  v_mfma_f32_16x16x32_bf16 v[52:55], v[24:27], v[108:111], v[52:55]
  ds_read_b64_tr_b16 v[24:25], v5 offset:8192
  ds_read_b64_tr_b16 v[26:27], v5 offset:10240
  s_waitcnt lgkmcnt(8)
  v_mfma_f32_16x16x32_bf16 v[32:35], v[28:31], v[112:115], v[32:35]
  v_mfma_f32_16x16x32_bf16 v[40:43], v[28:31], v[116:119], v[40:43]
  v_mfma_f32_16x16x32_bf16 v[48:51], v[28:31], v[120:123], v[48:51]
  ds_read_b64_tr_b16 v[28:29], v6 offset:8192
  ds_read_b64_tr_b16 v[30:31], v6 offset:10240
  s_waitcnt lgkmcnt(8)
  v_mfma_f32_16x16x32_bf16 v[36:39], v[56:59], v[112:115], v[36:39]
  v_mfma_f32_16x16x32_bf16 v[44:47], v[56:59], v[116:119], v[44:47]
  v_mfma_f32_16x16x32_bf16 v[52:55], v[56:59], v[120:123], v[52:55]
  ds_read_b64_tr_b16 v[56:57], v5 offset:12288
  ds_read_b64_tr_b16 v[58:59], v5 offset:14336
  s_waitcnt lgkmcnt(8)
  v_mfma_f32_16x16x32_bf16 v[32:35], v[16:19], v[124:127], v[32:35]
  v_mfma_f32_16x16x32_bf16 v[40:43], v[16:19], v[128:131], v[40:43]
  v_mfma_f32_16x16x32_bf16 v[48:51], v[16:19], v[132:135], v[48:51]
  ds_read_b64_tr_b16 v[16:17], v6 offset:12288
  ds_read_b64_tr_b16 v[18:19], v6 offset:14336
  s_waitcnt lgkmcnt(8)
  v_mfma_f32_16x16x32_bf16 v[36:39], v[20:23], v[124:127], v[36:39]
  v_mfma_f32_16x16x32_bf16 v[44:47], v[20:23], v[128:131], v[44:47]
  v_mfma_f32_16x16x32_bf16 v[52:55], v[20:23], v[132:135], v[52:55]
  s_waitcnt vmcnt(4)
  s_waitcnt lgkmcnt(0)
  s_barrier
  ds_read_b64_tr_b16 v[20:21], v3
  ds_read_b64_tr_b16 v[22:23], v3 offset:2048
  v_mfma_f32_16x16x32_bf16 v[32:35], v[24:27], v[136:139], v[32:35]
  v_mfma_f32_16x16x32_bf16 v[40:43], v[24:27], v[140:143], v[40:43]
  s_mov_b32 m0, 0x1a800
  s_add_u32 s39, s72, 0x7e080
  buffer_load_dwordx4 v7, s[24:27], s39 offen lds
  buffer_load_dwordx4 v8, s[24:27], s39 offen offset:1024 lds
  v_mfma_f32_16x16x32_bf16 v[48:51], v[24:27], v[144:147], v[48:51]
  ds_read_b64_tr_b16 v[24:25], v4
  ds_read_b64_tr_b16 v[26:27], v4 offset:2048
  v_mfma_f32_16x16x32_bf16 v[36:39], v[28:31], v[136:139], v[36:39]
  v_mfma_f32_16x16x32_bf16 v[44:47], v[28:31], v[140:143], v[44:47]
  v_mfma_f32_16x16x32_bf16 v[52:55], v[28:31], v[144:147], v[52:55]
  ds_read_b64_tr_b16 v[28:29], v3 offset:4096
  ds_read_b64_tr_b16 v[30:31], v3 offset:6144
  v_mfma_f32_16x16x32_bf16 v[32:35], v[56:59], v[148:151], v[32:35]
  v_mfma_f32_16x16x32_bf16 v[40:43], v[56:59], v[152:155], v[40:43]
  v_mfma_f32_16x16x32_bf16 v[48:51], v[56:59], v[156:159], v[48:51]
  ds_read_b64_tr_b16 v[56:57], v4 offset:4096
  ds_read_b64_tr_b16 v[58:59], v4 offset:6144
  v_mfma_f32_16x16x32_bf16 v[36:39], v[16:19], v[148:151], v[36:39]
  v_mfma_f32_16x16x32_bf16 v[44:47], v[16:19], v[152:155], v[44:47]
  v_mfma_f32_16x16x32_bf16 v[52:55], v[16:19], v[156:159], v[52:55]
  ds_read_b64_tr_b16 v[16:17], v3 offset:8192
  ds_read_b64_tr_b16 v[18:19], v3 offset:10240
  s_waitcnt lgkmcnt(8)
  v_mfma_f32_16x16x32_bf16 v[32:35], v[20:23], v[160:163], v[32:35]
  v_mfma_f32_16x16x32_bf16 v[40:43], v[20:23], v[164:167], v[40:43]
  v_mfma_f32_16x16x32_bf16 v[48:51], v[20:23], v[168:171], v[48:51]
  ds_read_b64_tr_b16 v[20:21], v4 offset:8192
  ds_read_b64_tr_b16 v[22:23], v4 offset:10240
  s_waitcnt lgkmcnt(8)
  v_mfma_f32_16x16x32_bf16 v[36:39], v[24:27], v[160:163], v[36:39]
  v_mfma_f32_16x16x32_bf16 v[44:47], v[24:27], v[164:167], v[44:47]
  v_mfma_f32_16x16x32_bf16 v[52:55], v[24:27], v[168:171], v[52:55]
  ds_read_b64_tr_b16 v[24:25], v3 offset:12288
  ds_read_b64_tr_b16 v[26:27], v3 offset:14336
  s_waitcnt lgkmcnt(8)
  v_mfma_f32_16x16x32_bf16 v[32:35], v[28:31], v[172:175], v[32:35]
  v_mfma_f32_16x16x32_bf16 v[40:43], v[28:31], v[176:179], v[40:43]
  v_mfma_f32_16x16x32_bf16 v[48:51], v[28:31], v[180:183], v[48:51]
  ds_read_b64_tr_b16 v[28:29], v4 offset:12288
  ds_read_b64_tr_b16 v[30:31], v4 offset:14336
  s_waitcnt lgkmcnt(8)
  v_mfma_f32_16x16x32_bf16 v[36:39], v[56:59], v[172:175], v[36:39]
  v_mfma_f32_16x16x32_bf16 v[44:47], v[56:59], v[176:179], v[44:47]
  v_mfma_f32_16x16x32_bf16 v[52:55], v[56:59], v[180:183], v[52:55]
  s_waitcnt vmcnt(4)
  s_waitcnt lgkmcnt(0)
  s_barrier
  ds_read_b64_tr_b16 v[56:57], v3 offset:16384
  ds_read_b64_tr_b16 v[58:59], v3 offset:18432
  v_mfma_f32_16x16x32_bf16 v[32:35], v[16:19], v[184:187], v[32:35]
  v_mfma_f32_16x16x32_bf16 v[40:43], v[16:19], v[188:191], v[40:43]
  s_mov_b32 m0, 0x2000
  s_add_u32 s39, s72, 0x12080
  buffer_load_dwordx4 v7, s[24:27], s39 offen lds
  buffer_load_dwordx4 v8, s[24:27], s39 offen offset:1024 lds
  v_mfma_f32_16x16x32_bf16 v[48:51], v[16:19], v[192:195], v[48:51]
  ds_read_b64_tr_b16 v[60:61], v4 offset:16384
  ds_read_b64_tr_b16 v[62:63], v4 offset:18432
  v_mfma_f32_16x16x32_bf16 v[36:39], v[20:23], v[184:187], v[36:39]
  v_mfma_f32_16x16x32_bf16 v[44:47], v[20:23], v[188:191], v[44:47]
  v_mfma_f32_16x16x32_bf16 v[52:55], v[20:23], v[192:195], v[52:55]
  ds_read_b64_tr_b16 v[16:17], v3 offset:20480
  ds_read_b64_tr_b16 v[18:19], v3 offset:22528
  v_mfma_f32_16x16x32_bf16 v[32:35], v[24:27], v[196:199], v[32:35]
  v_mfma_f32_16x16x32_bf16 v[40:43], v[24:27], v[200:203], v[40:43]
  v_mfma_f32_16x16x32_bf16 v[48:51], v[24:27], v[204:207], v[48:51]
  ds_read_b64_tr_b16 v[20:21], v4 offset:20480
  ds_read_b64_tr_b16 v[22:23], v4 offset:22528
  v_mfma_f32_16x16x32_bf16 v[36:39], v[28:31], v[196:199], v[36:39]
  v_mfma_f32_16x16x32_bf16 v[44:47], v[28:31], v[200:203], v[44:47]
  v_mfma_f32_16x16x32_bf16 v[52:55], v[28:31], v[204:207], v[52:55]
  ds_read_b64_tr_b16 v[24:25], v3 offset:24576
  ds_read_b64_tr_b16 v[26:27], v3 offset:26624
  s_waitcnt lgkmcnt(8)
  v_mfma_f32_16x16x32_bf16 v[32:35], v[56:59], v[208:211], v[32:35]
  v_mfma_f32_16x16x32_bf16 v[40:43], v[56:59], v[212:215], v[40:43]
  v_mfma_f32_16x16x32_bf16 v[48:51], v[56:59], v[216:219], v[48:51]
  ds_read_b64_tr_b16 v[28:29], v4 offset:24576
  ds_read_b64_tr_b16 v[30:31], v4 offset:26624
  s_waitcnt lgkmcnt(8)
  v_mfma_f32_16x16x32_bf16 v[36:39], v[60:63], v[208:211], v[36:39]
  v_mfma_f32_16x16x32_bf16 v[44:47], v[60:63], v[212:215], v[44:47]
  v_mfma_f32_16x16x32_bf16 v[52:55], v[60:63], v[216:219], v[52:55]
  ds_read_b64_tr_b16 v[56:57], v3 offset:28672
  ds_read_b64_tr_b16 v[58:59], v3 offset:30720
  s_waitcnt lgkmcnt(8)
  v_mfma_f32_16x16x32_bf16 v[32:35], v[16:19], v[220:223], v[32:35]
  v_mfma_f32_16x16x32_bf16 v[40:43], v[16:19], v[224:227], v[40:43]
  v_mfma_f32_16x16x32_bf16 v[48:51], v[16:19], v[228:231], v[48:51]
  ds_read_b64_tr_b16 v[60:61], v4 offset:28672
  ds_read_b64_tr_b16 v[62:63], v4 offset:30720
  s_waitcnt lgkmcnt(8)
  v_mfma_f32_16x16x32_bf16 v[36:39], v[20:23], v[220:223], v[36:39]
  v_mfma_f32_16x16x32_bf16 v[44:47], v[20:23], v[224:227], v[44:47]
  v_mfma_f32_16x16x32_bf16 v[52:55], v[20:23], v[228:231], v[52:55]
  s_waitcnt vmcnt(4)
  s_waitcnt lgkmcnt(0)
  s_barrier
  ds_read_b64_tr_b16 v[16:17], v3 offset:40960
  ds_read_b64_tr_b16 v[18:19], v3 offset:43008
  v_mfma_f32_16x16x32_bf16 v[32:35], v[24:27], v[232:235], v[32:35]
  v_mfma_f32_16x16x32_bf16 v[40:43], v[24:27], v[236:239], v[40:43]
  s_mov_b32 m0, 0x6000
  s_add_u32 s39, s72, 0x36080
  buffer_load_dwordx4 v7, s[24:27], s39 offen lds
  buffer_load_dwordx4 v8, s[24:27], s39 offen offset:1024 lds
  v_mfma_f32_16x16x32_bf16 v[48:51], v[24:27], v[240:243], v[48:51]
  ds_read_b64_tr_b16 v[20:21], v4 offset:40960
  ds_read_b64_tr_b16 v[22:23], v4 offset:43008
  v_mfma_f32_16x16x32_bf16 v[36:39], v[28:31], v[232:235], v[36:39]
  v_mfma_f32_16x16x32_bf16 v[44:47], v[28:31], v[236:239], v[44:47]
  v_mfma_f32_16x16x32_bf16 v[52:55], v[28:31], v[240:243], v[52:55]
  ds_read_b64_tr_b16 v[24:25], v3 offset:45056
  ds_read_b64_tr_b16 v[26:27], v3 offset:47104
  v_mfma_f32_16x16x32_bf16 v[32:35], v[56:59], v[244:247], v[32:35]
  v_mfma_f32_16x16x32_bf16 v[40:43], v[56:59], v[248:251], v[40:43]
  v_mfma_f32_16x16x32_bf16 v[48:51], v[56:59], v[252:255], v[48:51]
  ds_read_b64_tr_b16 v[28:29], v4 offset:45056
  ds_read_b64_tr_b16 v[30:31], v4 offset:47104
  v_mfma_f32_16x16x32_bf16 v[36:39], v[60:63], v[244:247], v[36:39]
  v_mfma_f32_16x16x32_bf16 v[44:47], v[60:63], v[248:251], v[44:47]
  v_mfma_f32_16x16x32_bf16 v[52:55], v[60:63], v[252:255], v[52:55]
  s_add_u32 s72, s72, 128
  s_mov_b32 s74, 7
L_op4_loop:
  ds_read_b64_tr_b16 v[56:57], v3 offset:49152
  ds_read_b64_tr_b16 v[58:59], v3 offset:51200
  v_cvt_pk_bf16_f32 v10, v32, v33
  v_cvt_pk_bf16_f32 v11, v34, v35
  v_cvt_pk_bf16_f32 v12, v36, v37
  v_cvt_pk_bf16_f32 v13, v38, v39
  s_add_u32 s40, s73, 0x3400
  buffer_store_dwordx4 v[10:13], v2, s[20:23], s40 offen sc1
  s_waitcnt lgkmcnt(8)
  v_mfma_f32_16x16x32_bf16 v[32:35], v[16:19], v[64:67], 0
  v_cvt_pk_bf16_f32 v10, v40, v41
  v_cvt_pk_bf16_f32 v11, v42, v43
  v_cvt_pk_bf16_f32 v12, v44, v45
  v_cvt_pk_bf16_f32 v13, v46, v47
  s_add_u32 s40, s73, 0x3c00
  buffer_store_dwordx4 v[10:13], v2, s[20:23], s40 offen sc1
  v_mfma_f32_16x16x32_bf16 v[40:43], v[16:19], v[68:71], 0
  s_nop 0
  v_cvt_pk_bf16_f32 v10, v48, v49
  v_cvt_pk_bf16_f32 v11, v50, v51
  v_cvt_pk_bf16_f32 v12, v52, v53
  v_cvt_pk_bf16_f32 v13, v54, v55
  s_add_u32 s40, s73, 0x4400
  buffer_store_dwordx4 v[10:13], v2, s[20:23], s40 offen sc1
  v_mfma_f32_16x16x32_bf16 v[48:51], v[16:19], v[72:75], 0
  ds_read_b64_tr_b16 v[16:17], v4 offset:49152
  ds_read_b64_tr_b16 v[18:19], v4 offset:51200
  s_waitcnt lgkmcnt(4)
  v_mfma_f32_16x16x32_bf16 v[36:39], v[20:23], v[64:67], 0
  v_mfma_f32_16x16x32_bf16 v[44:47], v[20:23], v[68:71], 0
  v_mfma_f32_16x16x32_bf16 v[52:55], v[20:23], v[72:75], 0
  ds_read_b64_tr_b16 v[20:21], v3 offset:53248
  ds_read_b64_tr_b16 v[22:23], v3 offset:55296
  v_mfma_f32_16x16x32_bf16 v[32:35], v[24:27], v[76:79], v[32:35]
  v_mfma_f32_16x16x32_bf16 v[40:43], v[24:27], v[80:83], v[40:43]
  v_mfma_f32_16x16x32_bf16 v[48:51], v[24:27], v[84:87], v[48:51]
  ds_read_b64_tr_b16 v[24:25], v4 offset:53248
  ds_read_b64_tr_b16 v[26:27], v4 offset:55296
  v_mfma_f32_16x16x32_bf16 v[36:39], v[28:31], v[76:79], v[36:39]
  v_mfma_f32_16x16x32_bf16 v[44:47], v[28:31], v[80:83], v[44:47]
  v_mfma_f32_16x16x32_bf16 v[52:55], v[28:31], v[84:87], v[52:55]
  s_waitcnt vmcnt(7)
  s_waitcnt lgkmcnt(0)
  s_barrier
  ds_read_b64_tr_b16 v[28:29], v5
  ds_read_b64_tr_b16 v[30:31], v5 offset:2048
  v_mfma_f32_16x16x32_bf16 v[32:35], v[56:59], v[88:91], v[32:35]
  v_mfma_f32_16x16x32_bf16 v[40:43], v[56:59], v[92:95], v[40:43]
  s_mov_b32 m0, 0xc000
  s_add_u32 s39, s72, 0x5a080
  buffer_load_dwordx4 v7, s[24:27], s39 offen lds
  buffer_load_dwordx4 v8, s[24:27], s39 offen offset:1024 lds
  v_mfma_f32_16x16x32_bf16 v[48:51], v[56:59], v[96:99], v[48:51]
  ds_read_b64_tr_b16 v[56:57], v6
  ds_read_b64_tr_b16 v[58:59], v6 offset:2048
  v_mfma_f32_16x16x32_bf16 v[36:39], v[16:19], v[88:91], v[36:39]
  v_mfma_f32_16x16x32_bf16 v[44:47], v[16:19], v[92:95], v[44:47]
  v_mfma_f32_16x16x32_bf16 v[52:55], v[16:19], v[96:99], v[52:55]
  ds_read_b64_tr_b16 v[16:17], v5 offset:4096
  ds_read_b64_tr_b16 v[18:19], v5 offset:6144
  v_mfma_f32_16x16x32_bf16 v[32:35], v[20:23], v[100:103], v[32:35]
  v_mfma_f32_16x16x32_bf16 v[40:43], v[20:23], v[104:107], v[40:43]
  v_mfma_f32_16x16x32_bf16 v[48:51], v[20:23], v[108:111], v[48:51]
  ds_read_b64_tr_b16 v[20:21], v6 offset:4096
  ds_read_b64_tr_b16 v[22:23], v6 offset:6144
  v_mfma_f32_16x16x32_bf16 v[36:39], v[24:27], v[100:103], v[36:39]
  v_mfma_f32_16x16x32_bf16 v[44:47], v[24:27], v[104:107], v[44:47]
  v_mfma_f32_16x16x32_bf16 v[52:55], v[24:27], v[108:111], v[52:55]
  ds_read_b64_tr_b16 v[24:25], v5 offset:8192
  ds_read_b64_tr_b16 v[26:27], v5 offset:10240
  s_waitcnt lgkmcnt(8)
  v_mfma_f32_16x16x32_bf16 v[32:35], v[28:31], v[112:115], v[32:35]
  v_mfma_f32_16x16x32_bf16 v[40:43], v[28:31], v[116:119], v[40:43]
  v_mfma_f32_16x16x32_bf16 v[48:51], v[28:31], v[120:123], v[48:51]
  ds_read_b64_tr_b16 v[28:29], v6 offset:8192
  ds_read_b64_tr_b16 v[30:31], v6 offset:10240
  s_waitcnt lgkmcnt(8)
  v_mfma_f32_16x16x32_bf16 v[36:39], v[56:59], v[112:115], v[36:39]
  v_mfma_f32_16x16x32_bf16 v[44:47], v[56:59], v[116:119], v[44:47]
  v_mfma_f32_16x16x32_bf16 v[52:55], v[56:59], v[120:123], v[52:55]
  ds_read_b64_tr_b16 v[56:57], v5 offset:12288
  ds_read_b64_tr_b16 v[58:59], v5 offset:14336
  s_waitcnt lgkmcnt(8)
  v_mfma_f32_16x16x32_bf16 v[32:35], v[16:19], v[124:127], v[32:35]
  v_mfma_f32_16x16x32_bf16 v[40:43], v[16:19], v[128:131], v[40:43]
  v_mfma_f32_16x16x32_bf16 v[48:51], v[16:19], v[132:135], v[48:51]
  ds_read_b64_tr_b16 v[16:17], v6 offset:12288
  ds_read_b64_tr_b16 v[18:19], v6 offset:14336
  s_waitcnt lgkmcnt(8)
  v_mfma_f32_16x16x32_bf16 v[36:39], v[20:23], v[124:127], v[36:39]
  v_mfma_f32_16x16x32_bf16 v[44:47], v[20:23], v[128:131], v[44:47]
  v_mfma_f32_16x16x32_bf16 v[52:55], v[20:23], v[132:135], v[52:55]
  s_waitcnt vmcnt(7)
  s_waitcnt lgkmcnt(0)
  s_barrier
  ds_read_b64_tr_b16 v[20:21], v3
  ds_read_b64_tr_b16 v[22:23], v3 offset:2048
  v_mfma_f32_16x16x32_bf16 v[32:35], v[24:27], v[136:139], v[32:35]
  v_mfma_f32_16x16x32_bf16 v[40:43], v[24:27], v[140:143], v[40:43]
  s_mov_b32 m0, 0x1a800
  s_add_u32 s39, s72, 0x7e080
  buffer_load_dwordx4 v7, s[24:27], s39 offen lds
  buffer_load_dwordx4 v8, s[24:27], s39 offen offset:1024 lds
  v_mfma_f32_16x16x32_bf16 v[48:51], v[24:27], v[144:147], v[48:51]
  ds_read_b64_tr_b16 v[24:25], v4
  ds_read_b64_tr_b16 v[26:27], v4 offset:2048
  v_mfma_f32_16x16x32_bf16 v[36:39], v[28:31], v[136:139], v[36:39]
  v_mfma_f32_16x16x32_bf16 v[44:47], v[28:31], v[140:143], v[44:47]
  v_mfma_f32_16x16x32_bf16 v[52:55], v[28:31], v[144:147], v[52:55]
  ds_read_b64_tr_b16 v[28:29], v3 offset:4096
  ds_read_b64_tr_b16 v[30:31], v3 offset:6144
  v_mfma_f32_16x16x32_bf16 v[32:35], v[56:59], v[148:151], v[32:35]
  v_mfma_f32_16x16x32_bf16 v[40:43], v[56:59], v[152:155], v[40:43]
  v_mfma_f32_16x16x32_bf16 v[48:51], v[56:59], v[156:159], v[48:51]
  ds_read_b64_tr_b16 v[56:57], v4 offset:4096
  ds_read_b64_tr_b16 v[58:59], v4 offset:6144
  v_mfma_f32_16x16x32_bf16 v[36:39], v[16:19], v[148:151], v[36:39]
  v_mfma_f32_16x16x32_bf16 v[44:47], v[16:19], v[152:155], v[44:47]
  v_mfma_f32_16x16x32_bf16 v[52:55], v[16:19], v[156:159], v[52:55]
  ds_read_b64_tr_b16 v[16:17], v3 offset:8192
  ds_read_b64_tr_b16 v[18:19], v3 offset:10240
  s_waitcnt lgkmcnt(8)
  v_mfma_f32_16x16x32_bf16 v[32:35], v[20:23], v[160:163], v[32:35]
  v_mfma_f32_16x16x32_bf16 v[40:43], v[20:23], v[164:167], v[40:43]
  v_mfma_f32_16x16x32_bf16 v[48:51], v[20:23], v[168:171], v[48:51]
  ds_read_b64_tr_b16 v[20:21], v4 offset:8192
  ds_read_b64_tr_b16 v[22:23], v4 offset:10240
  s_waitcnt lgkmcnt(8)
  v_mfma_f32_16x16x32_bf16 v[36:39], v[24:27], v[160:163], v[36:39]
  v_mfma_f32_16x16x32_bf16 v[44:47], v[24:27], v[164:167], v[44:47]
  v_mfma_f32_16x16x32_bf16 v[52:55], v[24:27], v[168:171], v[52:55]
  ds_read_b64_tr_b16 v[24:25], v3 offset:12288
  ds_read_b64_tr_b16 v[26:27], v3 offset:14336
  s_waitcnt lgkmcnt(8)
  v_mfma_f32_16x16x32_bf16 v[32:35], v[28:31], v[172:175], v[32:35]
  v_mfma_f32_16x16x32_bf16 v[40:43], v[28:31], v[176:179], v[40:43]
  v_mfma_f32_16x16x32_bf16 v[48:51], v[28:31], v[180:183], v[48:51]
  ds_read_b64_tr_b16 v[28:29], v4 offset:12288
  ds_read_b64_tr_b16 v[30:31], v4 offset:14336
  s_waitcnt lgkmcnt(8)
  v_mfma_f32_16x16x32_bf16 v[36:39], v[56:59], v[172:175], v[36:39]
  v_mfma_f32_16x16x32_bf16 v[44:47], v[56:59], v[176:179], v[44:47]
  v_mfma_f32_16x16x32_bf16 v[52:55], v[56:59], v[180:183], v[52:55]
  s_waitcnt vmcnt(7)
  s_waitcnt lgkmcnt(0)
  s_barrier
  ds_read_b64_tr_b16 v[56:57], v3 offset:16384
  ds_read_b64_tr_b16 v[58:59], v3 offset:18432
  v_mfma_f32_16x16x32_bf16 v[32:35], v[16:19], v[184:187], v[32:35]
  v_mfma_f32_16x16x32_bf16 v[40:43], v[16:19], v[188:191], v[40:43]
  s_mov_b32 m0, 0x2000
  s_add_u32 s39, s72, 0x12080
  buffer_load_dwordx4 v7, s[24:27], s39 offen lds
  buffer_load_dwordx4 v8, s[24:27], s39 offen offset:1024 lds
  v_mfma_f32_16x16x32_bf16 v[48:51], v[16:19], v[192:195], v[48:51]
  ds_read_b64_tr_b16 v[60:61], v4 offset:16384
  ds_read_b64_tr_b16 v[62:63], v4 offset:18432
  v_mfma_f32_16x16x32_bf16 v[36:39], v[20:23], v[184:187], v[36:39]
  v_mfma_f32_16x16x32_bf16 v[44:47], v[20:23], v[188:191], v[44:47]
  v_mfma_f32_16x16x32_bf16 v[52:55], v[20:23], v[192:195], v[52:55]
  ds_read_b64_tr_b16 v[16:17], v3 offset:20480
  ds_read_b64_tr_b16 v[18:19], v3 offset:22528
  v_mfma_f32_16x16x32_bf16 v[32:35], v[24:27], v[196:199], v[32:35]
  v_mfma_f32_16x16x32_bf16 v[40:43], v[24:27], v[200:203], v[40:43]
  v_mfma_f32_16x16x32_bf16 v[48:51], v[24:27], v[204:207], v[48:51]
  ds_read_b64_tr_b16 v[20:21], v4 offset:20480
  ds_read_b64_tr_b16 v[22:23], v4 offset:22528
  v_mfma_f32_16x16x32_bf16 v[36:39], v[28:31], v[196:199], v[36:39]
  v_mfma_f32_16x16x32_bf16 v[44:47], v[28:31], v[200:203], v[44:47]
  v_mfma_f32_16x16x32_bf16 v[52:55], v[28:31], v[204:207], v[52:55]
  ds_read_b64_tr_b16 v[24:25], v3 offset:24576
  ds_read_b64_tr_b16 v[26:27], v3 offset:26624
  s_waitcnt lgkmcnt(8)
  v_mfma_f32_16x16x32_bf16 v[32:35], v[56:59], v[208:211], v[32:35]
  v_mfma_f32_16x16x32_bf16 v[40:43], v[56:59], v[212:215], v[40:43]
  v_mfma_f32_16x16x32_bf16 v[48:51], v[56:59], v[216:219], v[48:51]
  ds_read_b64_tr_b16 v[28:29], v4 offset:24576
  ds_read_b64_tr_b16 v[30:31], v4 offset:26624
  s_waitcnt lgkmcnt(8)
  v_mfma_f32_16x16x32_bf16 v[36:39], v[60:63], v[208:211], v[36:39]
  v_mfma_f32_16x16x32_bf16 v[44:47], v[60:63], v[212:215], v[44:47]
  v_mfma_f32_16x16x32_bf16 v[52:55], v[60:63], v[216:219], v[52:55]
  ds_read_b64_tr_b16 v[56:57], v3 offset:28672
  ds_read_b64_tr_b16 v[58:59], v3 offset:30720
  s_waitcnt lgkmcnt(8)
  v_mfma_f32_16x16x32_bf16 v[32:35], v[16:19], v[220:223], v[32:35]
  v_mfma_f32_16x16x32_bf16 v[40:43], v[16:19], v[224:227], v[40:43]
  v_mfma_f32_16x16x32_bf16 v[48:51], v[16:19], v[228:231], v[48:51]
  ds_read_b64_tr_b16 v[60:61], v4 offset:28672
  ds_read_b64_tr_b16 v[62:63], v4 offset:30720
  s_waitcnt lgkmcnt(8)
  v_mfma_f32_16x16x32_bf16 v[36:39], v[20:23], v[220:223], v[36:39]
  v_mfma_f32_16x16x32_bf16 v[44:47], v[20:23], v[224:227], v[44:47]
  v_mfma_f32_16x16x32_bf16 v[52:55], v[20:23], v[228:231], v[52:55]
  s_waitcnt vmcnt(4)
  s_waitcnt lgkmcnt(0)
  s_barrier
  ds_read_b64_tr_b16 v[16:17], v3 offset:40960
  ds_read_b64_tr_b16 v[18:19], v3 offset:43008
  v_mfma_f32_16x16x32_bf16 v[32:35], v[24:27], v[232:235], v[32:35]
  v_mfma_f32_16x16x32_bf16 v[40:43], v[24:27], v[236:239], v[40:43]
  s_mov_b32 m0, 0x6000
  s_add_u32 s39, s72, 0x36080
  buffer_load_dwordx4 v7, s[24:27], s39 offen lds
  buffer_load_dwordx4 v8, s[24:27], s39 offen offset:1024 lds
  v_mfma_f32_16x16x32_bf16 v[48:51], v[24:27], v[240:243], v[48:51]
  ds_read_b64_tr_b16 v[20:21], v4 offset:40960
  ds_read_b64_tr_b16 v[22:23], v4 offset:43008
  v_mfma_f32_16x16x32_bf16 v[36:39], v[28:31], v[232:235], v[36:39]
  v_mfma_f32_16x16x32_bf16 v[44:47], v[28:31], v[236:239], v[44:47]
  v_mfma_f32_16x16x32_bf16 v[52:55], v[28:31], v[240:243], v[52:55]
  ds_read_b64_tr_b16 v[24:25], v3 offset:45056
  ds_read_b64_tr_b16 v[26:27], v3 offset:47104
  v_mfma_f32_16x16x32_bf16 v[32:35], v[56:59], v[244:247], v[32:35]
  v_mfma_f32_16x16x32_bf16 v[40:43], v[56:59], v[248:251], v[40:43]
  v_mfma_f32_16x16x32_bf16 v[48:51], v[56:59], v[252:255], v[48:51]
  ds_read_b64_tr_b16 v[28:29], v4 offset:45056
  ds_read_b64_tr_b16 v[30:31], v4 offset:47104
  v_mfma_f32_16x16x32_bf16 v[36:39], v[60:63], v[244:247], v[36:39]
  v_mfma_f32_16x16x32_bf16 v[44:47], v[60:63], v[248:251], v[44:47]
  v_mfma_f32_16x16x32_bf16 v[52:55], v[60:63], v[252:255], v[52:55]
  s_add_u32 s72, s72, 128
  s_add_u32 s73, s73, 0x4800
  s_add_u32 s78, s78, 1
  s_sub_u32 s74, s74, 1
  s_cmp_lg_u32 s74, 0
  s_cbranch_scc1 L_op4_loop
  ds_read_b64_tr_b16 v[56:57], v3 offset:49152
  ds_read_b64_tr_b16 v[58:59], v3 offset:51200
  v_cvt_pk_bf16_f32 v10, v32, v33
  v_cvt_pk_bf16_f32 v11, v34, v35
  v_cvt_pk_bf16_f32 v12, v36, v37
  v_cvt_pk_bf16_f32 v13, v38, v39
  s_add_u32 s40, s73, 0x3400
  buffer_store_dwordx4 v[10:13], v2, s[20:23], s40 offen sc1
  s_waitcnt lgkmcnt(6)
  v_mfma_f32_16x16x32_bf16 v[32:35], v[16:19], v[64:67], 0
  v_cvt_pk_bf16_f32 v10, v40, v41
  v_cvt_pk_bf16_f32 v11, v42, v43
  v_cvt_pk_bf16_f32 v12, v44, v45
  v_cvt_pk_bf16_f32 v13, v46, v47
  s_add_u32 s40, s73, 0x3c00
  buffer_store_dwordx4 v[10:13], v2, s[20:23], s40 offen sc1
  v_mfma_f32_16x16x32_bf16 v[40:43], v[16:19], v[68:71], 0
  s_nop 0
  v_cvt_pk_bf16_f32 v10, v48, v49
  v_cvt_pk_bf16_f32 v11, v50, v51
  v_cvt_pk_bf16_f32 v12, v52, v53
  v_cvt_pk_bf16_f32 v13, v54, v55
  s_add_u32 s40, s73, 0x4400
  buffer_store_dwordx4 v[10:13], v2, s[20:23], s40 offen sc1
  v_mfma_f32_16x16x32_bf16 v[48:51], v[16:19], v[72:75], 0
  ds_read_b64_tr_b16 v[16:17], v4 offset:49152
  ds_read_b64_tr_b16 v[18:19], v4 offset:51200
  v_mfma_f32_16x16x32_bf16 v[36:39], v[20:23], v[64:67], 0
  v_mfma_f32_16x16x32_bf16 v[44:47], v[20:23], v[68:71], 0
  v_mfma_f32_16x16x32_bf16 v[52:55], v[20:23], v[72:75], 0
  ds_read_b64_tr_b16 v[20:21], v3 offset:53248
  ds_read_b64_tr_b16 v[22:23], v3 offset:55296
  s_waitcnt lgkmcnt(4)
  v_mfma_f32_16x16x32_bf16 v[32:35], v[24:27], v[76:79], v[32:35]
  v_mfma_f32_16x16x32_bf16 v[40:43], v[24:27], v[80:83], v[40:43]
  v_mfma_f32_16x16x32_bf16 v[48:51], v[24:27], v[84:87], v[48:51]
  ds_read_b64_tr_b16 v[24:25], v4 offset:53248
  ds_read_b64_tr_b16 v[26:27], v4 offset:55296
  v_mfma_f32_16x16x32_bf16 v[36:39], v[28:31], v[76:79], v[36:39]
  v_mfma_f32_16x16x32_bf16 v[44:47], v[28:31], v[80:83], v[44:47]
  v_mfma_f32_16x16x32_bf16 v[52:55], v[28:31], v[84:87], v[52:55]
  s_waitcnt vmcnt(7)
  s_waitcnt lgkmcnt(0)
  s_barrier
  ds_read_b64_tr_b16 v[28:29], v5
  ds_read_b64_tr_b16 v[30:31], v5 offset:2048
  v_mfma_f32_16x16x32_bf16 v[32:35], v[56:59], v[88:91], v[32:35]
  v_mfma_f32_16x16x32_bf16 v[40:43], v[56:59], v[92:95], v[40:43]
  v_mfma_f32_16x16x32_bf16 v[48:51], v[56:59], v[96:99], v[48:51]
  ds_read_b64_tr_b16 v[56:57], v6
  ds_read_b64_tr_b16 v[58:59], v6 offset:2048
  v_mfma_f32_16x16x32_bf16 v[36:39], v[16:19], v[88:91], v[36:39]
  v_mfma_f32_16x16x32_bf16 v[44:47], v[16:19], v[92:95], v[44:47]
  v_mfma_f32_16x16x32_bf16 v[52:55], v[16:19], v[96:99], v[52:55]
  ds_read_b64_tr_b16 v[16:17], v5 offset:4096
  ds_read_b64_tr_b16 v[18:19], v5 offset:6144
  v_mfma_f32_16x16x32_bf16 v[32:35], v[20:23], v[100:103], v[32:35]
  v_mfma_f32_16x16x32_bf16 v[40:43], v[20:23], v[104:107], v[40:43]
  v_mfma_f32_16x16x32_bf16 v[48:51], v[20:23], v[108:111], v[48:51]
  ds_read_b64_tr_b16 v[20:21], v6 offset:4096
  ds_read_b64_tr_b16 v[22:23], v6 offset:6144
  v_mfma_f32_16x16x32_bf16 v[36:39], v[24:27], v[100:103], v[36:39]
  v_mfma_f32_16x16x32_bf16 v[44:47], v[24:27], v[104:107], v[44:47]
  v_mfma_f32_16x16x32_bf16 v[52:55], v[24:27], v[108:111], v[52:55]
  ds_read_b64_tr_b16 v[24:25], v5 offset:8192
  ds_read_b64_tr_b16 v[26:27], v5 offset:10240
  s_waitcnt lgkmcnt(8)
  v_mfma_f32_16x16x32_bf16 v[32:35], v[28:31], v[112:115], v[32:35]
  v_mfma_f32_16x16x32_bf16 v[40:43], v[28:31], v[116:119], v[40:43]
  v_mfma_f32_16x16x32_bf16 v[48:51], v[28:31], v[120:123], v[48:51]
  ds_read_b64_tr_b16 v[28:29], v6 offset:8192
  ds_read_b64_tr_b16 v[30:31], v6 offset:10240
  s_waitcnt lgkmcnt(8)
  v_mfma_f32_16x16x32_bf16 v[36:39], v[56:59], v[112:115], v[36:39]
  v_mfma_f32_16x16x32_bf16 v[44:47], v[56:59], v[116:119], v[44:47]
  v_mfma_f32_16x16x32_bf16 v[52:55], v[56:59], v[120:123], v[52:55]
  ds_read_b64_tr_b16 v[56:57], v5 offset:12288
  ds_read_b64_tr_b16 v[58:59], v5 offset:14336
  s_waitcnt lgkmcnt(8)
  v_mfma_f32_16x16x32_bf16 v[32:35], v[16:19], v[124:127], v[32:35]
  v_mfma_f32_16x16x32_bf16 v[40:43], v[16:19], v[128:131], v[40:43]
  v_mfma_f32_16x16x32_bf16 v[48:51], v[16:19], v[132:135], v[48:51]
  ds_read_b64_tr_b16 v[16:17], v6 offset:12288
  ds_read_b64_tr_b16 v[18:19], v6 offset:14336
  s_waitcnt lgkmcnt(8)
  v_mfma_f32_16x16x32_bf16 v[36:39], v[20:23], v[124:127], v[36:39]
  v_mfma_f32_16x16x32_bf16 v[44:47], v[20:23], v[128:131], v[44:47]
  v_mfma_f32_16x16x32_bf16 v[52:55], v[20:23], v[132:135], v[52:55]
  s_waitcnt vmcnt(5)
  s_waitcnt lgkmcnt(0)
  s_barrier
  ds_read_b64_tr_b16 v[20:21], v3
  ds_read_b64_tr_b16 v[22:23], v3 offset:2048
  v_mfma_f32_16x16x32_bf16 v[32:35], v[24:27], v[136:139], v[32:35]
  v_mfma_f32_16x16x32_bf16 v[40:43], v[24:27], v[140:143], v[40:43]
  v_mfma_f32_16x16x32_bf16 v[48:51], v[24:27], v[144:147], v[48:51]
  ds_read_b64_tr_b16 v[24:25], v4
  ds_read_b64_tr_b16 v[26:27], v4 offset:2048
  v_mfma_f32_16x16x32_bf16 v[36:39], v[28:31], v[136:139], v[36:39]
  v_mfma_f32_16x16x32_bf16 v[44:47], v[28:31], v[140:143], v[44:47]
  v_mfma_f32_16x16x32_bf16 v[52:55], v[28:31], v[144:147], v[52:55]
  ds_read_b64_tr_b16 v[28:29], v3 offset:4096
  ds_read_b64_tr_b16 v[30:31], v3 offset:6144
  v_mfma_f32_16x16x32_bf16 v[32:35], v[56:59], v[148:151], v[32:35]
  v_mfma_f32_16x16x32_bf16 v[40:43], v[56:59], v[152:155], v[40:43]
  v_mfma_f32_16x16x32_bf16 v[48:51], v[56:59], v[156:159], v[48:51]
  ds_read_b64_tr_b16 v[56:57], v4 offset:4096
  ds_read_b64_tr_b16 v[58:59], v4 offset:6144
  v_mfma_f32_16x16x32_bf16 v[36:39], v[16:19], v[148:151], v[36:39]
  v_mfma_f32_16x16x32_bf16 v[44:47], v[16:19], v[152:155], v[44:47]
  v_mfma_f32_16x16x32_bf16 v[52:55], v[16:19], v[156:159], v[52:55]
  ds_read_b64_tr_b16 v[16:17], v3 offset:8192
  ds_read_b64_tr_b16 v[18:19], v3 offset:10240
  s_waitcnt lgkmcnt(8)
  v_mfma_f32_16x16x32_bf16 v[32:35], v[20:23], v[160:163], v[32:35]
  v_mfma_f32_16x16x32_bf16 v[40:43], v[20:23], v[164:167], v[40:43]
  v_mfma_f32_16x16x32_bf16 v[48:51], v[20:23], v[168:171], v[48:51]
  ds_read_b64_tr_b16 v[20:21], v4 offset:8192
  ds_read_b64_tr_b16 v[22:23], v4 offset:10240
  s_waitcnt lgkmcnt(8)
  v_mfma_f32_16x16x32_bf16 v[36:39], v[24:27], v[160:163], v[36:39]
  v_mfma_f32_16x16x32_bf16 v[44:47], v[24:27], v[164:167], v[44:47]
  v_mfma_f32_16x16x32_bf16 v[52:55], v[24:27], v[168:171], v[52:55]
  ds_read_b64_tr_b16 v[24:25], v3 offset:12288
  ds_read_b64_tr_b16 v[26:27], v3 offset:14336
  s_waitcnt lgkmcnt(8)
  v_mfma_f32_16x16x32_bf16 v[32:35], v[28:31], v[172:175], v[32:35]
  v_mfma_f32_16x16x32_bf16 v[40:43], v[28:31], v[176:179], v[40:43]
  v_mfma_f32_16x16x32_bf16 v[48:51], v[28:31], v[180:183], v[48:51]
  ds_read_b64_tr_b16 v[28:29], v4 offset:12288
  ds_read_b64_tr_b16 v[30:31], v4 offset:14336
  s_waitcnt lgkmcnt(8)
  v_mfma_f32_16x16x32_bf16 v[36:39], v[56:59], v[172:175], v[36:39]
  v_mfma_f32_16x16x32_bf16 v[44:47], v[56:59], v[176:179], v[44:47]
  v_mfma_f32_16x16x32_bf16 v[52:55], v[56:59], v[180:183], v[52:55]
  s_waitcnt vmcnt(0)
  s_waitcnt lgkmcnt(0)
  s_barrier
  ds_read_b64_tr_b16 v[56:57], v3 offset:16384
  ds_read_b64_tr_b16 v[58:59], v3 offset:18432
  v_mfma_f32_16x16x32_bf16 v[32:35], v[16:19], v[184:187], v[32:35]
  v_mfma_f32_16x16x32_bf16 v[40:43], v[16:19], v[188:191], v[40:43]
  v_mfma_f32_16x16x32_bf16 v[48:51], v[16:19], v[192:195], v[48:51]
  ds_read_b64_tr_b16 v[60:61], v4 offset:16384
  ds_read_b64_tr_b16 v[62:63], v4 offset:18432
  v_mfma_f32_16x16x32_bf16 v[36:39], v[20:23], v[184:187], v[36:39]
  v_mfma_f32_16x16x32_bf16 v[44:47], v[20:23], v[188:191], v[44:47]
  v_mfma_f32_16x16x32_bf16 v[52:55], v[20:23], v[192:195], v[52:55]
  ds_read_b64_tr_b16 v[16:17], v3 offset:20480
  ds_read_b64_tr_b16 v[18:19], v3 offset:22528
  v_mfma_f32_16x16x32_bf16 v[32:35], v[24:27], v[196:199], v[32:35]
  v_mfma_f32_16x16x32_bf16 v[40:43], v[24:27], v[200:203], v[40:43]
  v_mfma_f32_16x16x32_bf16 v[48:51], v[24:27], v[204:207], v[48:51]
  ds_read_b64_tr_b16 v[20:21], v4 offset:20480
  ds_read_b64_tr_b16 v[22:23], v4 offset:22528
  v_mfma_f32_16x16x32_bf16 v[36:39], v[28:31], v[196:199], v[36:39]
  v_mfma_f32_16x16x32_bf16 v[44:47], v[28:31], v[200:203], v[44:47]
  v_mfma_f32_16x16x32_bf16 v[52:55], v[28:31], v[204:207], v[52:55]
  ds_read_b64_tr_b16 v[24:25], v3 offset:24576
  ds_read_b64_tr_b16 v[26:27], v3 offset:26624
  s_waitcnt lgkmcnt(8)
  v_mfma_f32_16x16x32_bf16 v[32:35], v[56:59], v[208:211], v[32:35]
  v_mfma_f32_16x16x32_bf16 v[40:43], v[56:59], v[212:215], v[40:43]
  v_mfma_f32_16x16x32_bf16 v[48:51], v[56:59], v[216:219], v[48:51]
  ds_read_b64_tr_b16 v[28:29], v4 offset:24576
  ds_read_b64_tr_b16 v[30:31], v4 offset:26624
  s_waitcnt lgkmcnt(8)
  v_mfma_f32_16x16x32_bf16 v[36:39], v[60:63], v[208:211], v[36:39]
  v_mfma_f32_16x16x32_bf16 v[44:47], v[60:63], v[212:215], v[44:47]
  v_mfma_f32_16x16x32_bf16 v[52:55], v[60:63], v[216:219], v[52:55]
  ds_read_b64_tr_b16 v[56:57], v3 offset:28672
  ds_read_b64_tr_b16 v[58:59], v3 offset:30720
  s_waitcnt lgkmcnt(8)
  v_mfma_f32_16x16x32_bf16 v[32:35], v[16:19], v[220:223], v[32:35]
  v_mfma_f32_16x16x32_bf16 v[40:43], v[16:19], v[224:227], v[40:43]
  v_mfma_f32_16x16x32_bf16 v[48:51], v[16:19], v[228:231], v[48:51]
  ds_read_b64_tr_b16 v[60:61], v4 offset:28672
  ds_read_b64_tr_b16 v[62:63], v4 offset:30720
  s_waitcnt lgkmcnt(8)
  v_mfma_f32_16x16x32_bf16 v[36:39], v[20:23], v[220:223], v[36:39]
  v_mfma_f32_16x16x32_bf16 v[44:47], v[20:23], v[224:227], v[44:47]
  v_mfma_f32_16x16x32_bf16 v[52:55], v[20:23], v[228:231], v[52:55]
  s_waitcnt lgkmcnt(6)
  v_mfma_f32_16x16x32_bf16 v[32:35], v[24:27], v[232:235], v[32:35]
  v_mfma_f32_16x16x32_bf16 v[40:43], v[24:27], v[236:239], v[40:43]
  v_mfma_f32_16x16x32_bf16 v[48:51], v[24:27], v[240:243], v[48:51]
  s_waitcnt lgkmcnt(4)
  v_mfma_f32_16x16x32_bf16 v[36:39], v[28:31], v[232:235], v[36:39]
  v_mfma_f32_16x16x32_bf16 v[44:47], v[28:31], v[236:239], v[44:47]
  v_mfma_f32_16x16x32_bf16 v[52:55], v[28:31], v[240:243], v[52:55]
  s_waitcnt lgkmcnt(2)
  v_mfma_f32_16x16x32_bf16 v[32:35], v[56:59], v[244:247], v[32:35]
  v_mfma_f32_16x16x32_bf16 v[40:43], v[56:59], v[248:251], v[40:43]
  v_mfma_f32_16x16x32_bf16 v[48:51], v[56:59], v[252:255], v[48:51]
  s_waitcnt lgkmcnt(0)
  v_mfma_f32_16x16x32_bf16 v[36:39], v[60:63], v[244:247], v[36:39]
  v_mfma_f32_16x16x32_bf16 v[44:47], v[60:63], v[248:251], v[44:47]
  v_mfma_f32_16x16x32_bf16 v[52:55], v[60:63], v[252:255], v[52:55]
  s_nop 1
  v_cvt_pk_bf16_f32 v10, v32, v33
  v_cvt_pk_bf16_f32 v11, v34, v35
  s_nop 1
  v_cvt_pk_bf16_f32 v12, v36, v37
  v_cvt_pk_bf16_f32 v13, v38, v39
  s_add_u32 s40, s73, 0x7c00
  buffer_store_dwordx4 v[10:13], v2, s[20:23], s40 offen sc1
  s_nop 1
  v_cvt_pk_bf16_f32 v10, v40, v41
  v_cvt_pk_bf16_f32 v11, v42, v43
  v_cvt_pk_bf16_f32 v12, v44, v45
  v_cvt_pk_bf16_f32 v13, v46, v47
  s_add_u32 s40, s73, 0x8400
  buffer_store_dwordx4 v[10:13], v2, s[20:23], s40 offen sc1
  s_nop 1
  v_cvt_pk_bf16_f32 v10, v48, v49
  v_cvt_pk_bf16_f32 v11, v50, v51
  v_cvt_pk_bf16_f32 v12, v52, v53
  v_cvt_pk_bf16_f32 v13, v54, v55
  s_add_u32 s40, s73, 0x8c00
  buffer_store_dwordx4 v[10:13], v2, s[20:23], s40 offen sc1
  s_lshl_b32 s41, s33, 8
  s_add_u32 s41, s41, 0x4000000
  v_mov_b32 v238, s41
  v_and_b32 v239, 15, v0
  v_mul_u32_u24 v239, 2304, v239
  v_lshrrev_b32 v232, 4, v0
  v_lshl_add_u32 v239, v232, 4, v239
  buffer_load_dwordx2 v[236:237], v238, s[20:23], 0 offen sc1
  s_waitcnt vmcnt(0)
  s_barrier
  s_branch L_tail
L_r3_5:
  s_waitcnt lgkmcnt(0)
  s_setprio 0
  v_lshlrev_b32 v2, 4, v0
  v_lshrrev_b32 v14, 2, v0
  v_bfe_u32 v15, v0, 3, 2
  v_lshlrev_b32 v14, 7, v14
  v_and_b32 v9, 3, v0
  v_lshl_add_u32 v14, v9, 3, v14
  v_xor_b32 v9, 2, v15
  v_lshl_add_u32 v3, v9, 5, v14
  v_add_u32 v5, 100352, v3
  v_xor_b32 v9, 3, v15
  v_lshl_add_u32 v4, v9, 5, v14
  v_add_u32 v6, 100352, v4
  v_lshrrev_b32 v14, 4, v0
  v_lshlrev_b32 v14, 1, v14
  v_xor_b32 v14, v14, v0
  v_and_b32 v14, 7, v14
  v_lshlrev_b32 v14, 4, v14
  v_lshrrev_b32 v15, 3, v0
  v_mul_u32_u24 v15, 1152, v15
  v_add_u32 v7, v14, v15
  v_add_u32 v8, 8192, v7
  v_add_u32 v9, 59392, v2
  s_mul_i32 s72, s57, 147456
  s_lshl_b32 s73, s33, 3
  s_add_u32 s73, s73, s34
  s_mul_i32 s73, s73, 165888
  s_add_u32 s73, s73, 0x5000000
  s_lshl_b32 s75, s33, 5
  s_add_u32 s75, s75, s34
  s_mul_i32 s75, s75, 36864
  s_waitcnt lgkmcnt(0)
  s_barrier
  s_waitcnt lgkmcnt(0)
  s_barrier
  s_waitcnt lgkmcnt(0)
  s_barrier
  ds_read_b128 v[128:131], v2 offset:16384
  ds_read_b128 v[132:135], v2 offset:20480
  ds_read_b128 v[136:139], v2 offset:17408
  ds_read_b128 v[140:143], v2 offset:21504
  ds_read_b128 v[144:147], v2 offset:18432
  ds_read_b128 v[148:151], v2 offset:22528
  ds_read_b128 v[152:155], v2 offset:19456
  ds_read_b128 v[156:159], v2 offset:23552
  ds_read_b128 v[160:163], v2 offset:24576
  ds_read_b128 v[164:167], v2 offset:28672
  ds_read_b128 v[168:171], v2 offset:25600
  ds_read_b128 v[172:175], v2 offset:29696
  ds_read_b128 v[176:179], v2 offset:26624
  ds_read_b128 v[180:183], v2 offset:30720
  ds_read_b128 v[184:187], v2 offset:27648
  s_waitcnt lgkmcnt(14)
  ds_read_b128 v[188:191], v2 offset:31744
  s_waitcnt lgkmcnt(0)
  s_barrier
  v_add_u32 v14, 124928, v2
  ds_read_b128 v[64:67], v14 offset:8192
  ds_read_b128 v[68:71], v14 offset:12288
  ds_read_b128 v[72:75], v14 offset:9216
  ds_read_b128 v[76:79], v14 offset:13312
  ds_read_b128 v[80:83], v14 offset:10240
  ds_read_b128 v[84:87], v14 offset:14336
  ds_read_b128 v[88:91], v14 offset:11264
  ds_read_b128 v[92:95], v14 offset:15360
  s_waitcnt lgkmcnt(0)
  s_barrier
  s_waitcnt lgkmcnt(0)
  s_barrier
  s_waitcnt lgkmcnt(0)
  s_barrier
  s_lshl_b32 s41, s33, 3
  v_mov_b32 v232, s41
  buffer_load_dwordx2 v[236:237], v232, s[64:67], 0 offen sc1
  s_waitcnt lgkmcnt(0)
  s_barrier
  s_waitcnt lgkmcnt(0)
  s_barrier
  s_waitcnt lgkmcnt(0)
  s_barrier
  s_waitcnt lgkmcnt(0)
  s_barrier
  s_waitcnt lgkmcnt(0)
  s_barrier
  s_waitcnt lgkmcnt(0)
  s_barrier
  s_waitcnt lgkmcnt(0)
  s_barrier
  s_waitcnt lgkmcnt(0)
  s_barrier
  s_mov_b32 s83, 0x100000
L_hs:
  s_waitcnt vmcnt(0)
  v_readfirstlane_b32 s81, v236
  v_readfirstlane_b32 s82, v237
  s_nop 3
  s_and_b32 s81, s81, s82
  s_cmp_eq_u32 s81, 0x01010101
  s_cbranch_scc1 L_hs_ok
  s_sleep 8
  buffer_load_dwordx2 v[236:237], v232, s[64:67], 0 offen sc1
  s_sub_u32 s83, s83, 1
  s_cmp_lg_u32 s83, 0
  s_cbranch_scc1 L_hs
L_hs_ok:
  s_waitcnt lgkmcnt(0)
  s_barrier
  s_waitcnt lgkmcnt(0)
  s_barrier
  s_lshl_b32 s38, s34, 4
  s_add_u32 s38, s38, s35
  s_mul_i32 s38, s38, 36864
  s_add_u32 s38, s38, 18432
  buffer_load_dwordx4 v[32:35], v2, s[24:27], s38 offen offset:0
  buffer_load_dwordx4 v[36:39], v2, s[24:27], s38 offen offset:1024
  buffer_load_dwordx4 v[40:43], v2, s[24:27], s38 offen offset:2048
  buffer_load_dwordx4 v[44:47], v2, s[24:27], s38 offen offset:3072
  s_add_u32 s38, s38, 4096
  buffer_load_dwordx4 v[32:35], v2, s[24:27], s38 offen offset:0
  buffer_load_dwordx4 v[36:39], v2, s[24:27], s38 offen offset:1024
  buffer_load_dwordx4 v[40:43], v2, s[24:27], s38 offen offset:2048
  buffer_load_dwordx4 v[44:47], v2, s[24:27], s38 offen offset:3072
  s_add_u32 s38, s38, 4096
  buffer_load_dwordx4 v[32:35], v2, s[24:27], s38 offen offset:0
  buffer_load_dwordx4 v[36:39], v2, s[24:27], s38 offen offset:1024
  buffer_load_dwordx4 v[40:43], v2, s[24:27], s38 offen offset:2048
  buffer_load_dwordx4 v[44:47], v2, s[24:27], s38 offen offset:3072
  s_add_u32 s38, s38, 4096
  buffer_load_dwordx4 v[32:35], v2, s[24:27], s38 offen offset:0
  buffer_load_dwordx4 v[36:39], v2, s[24:27], s38 offen offset:1024
  buffer_load_dwordx4 v[40:43], v2, s[24:27], s38 offen offset:2048
  buffer_load_dwordx4 v[44:47], v2, s[24:27], s38 offen offset:3072
  s_add_u32 s38, s38, 4096
  buffer_load_dwordx4 v[32:35], v2, s[24:27], s38 offen offset:0
  buffer_load_dwordx4 v[36:39], v2, s[24:27], s38 offen offset:1024
  s_waitcnt lgkmcnt(0)
  s_barrier
  s_waitcnt lgkmcnt(0)
  s_barrier
  s_waitcnt lgkmcnt(0)
  s_barrier
  s_waitcnt vmcnt(0)
  s_waitcnt lgkmcnt(0)
  s_barrier
  ds_read_b128 v[96:99], v9 offset:8192
  ds_read_b128 v[100:103], v9 offset:12288
  ds_read_b128 v[104:107], v9 offset:9216
  ds_read_b128 v[108:111], v9 offset:13312
  ds_read_b128 v[112:115], v9 offset:10240
  ds_read_b128 v[116:119], v9 offset:14336
  ds_read_b128 v[120:123], v9 offset:11264
  ds_read_b128 v[124:127], v9 offset:15360
  s_mov_b32 m0, 0x2800
  s_add_u32 s39, s72, 0x16800
  buffer_load_dwordx4 v7, s[24:27], s39 offen lds
  buffer_load_dwordx4 v8, s[24:27], s39 offen offset:1024 lds
  s_mov_b32 m0, 0x6800
  s_add_u32 s39, s72, 0x3a800
  buffer_load_dwordx4 v7, s[24:27], s39 offen lds
  buffer_load_dwordx4 v8, s[24:27], s39 offen offset:1024 lds
  ds_read_b64_tr_b16 v[16:17], v3 offset:40960
  ds_read_b64_tr_b16 v[18:19], v3 offset:43008
  ds_read_b64_tr_b16 v[20:21], v4 offset:40960
  ds_read_b64_tr_b16 v[22:23], v4 offset:43008
  ds_read_b64_tr_b16 v[24:25], v3 offset:45056
  ds_read_b64_tr_b16 v[26:27], v3 offset:47104
  ds_read_b64_tr_b16 v[28:29], v4 offset:45056
  s_waitcnt lgkmcnt(14)
  ds_read_b64_tr_b16 v[30:31], v4 offset:47104
  s_add_u32 s76, s34, 152
  s_mov_b32 s77, 0
  s_mov_b32 s78, 0
  s_mov_b32 s80, 0x7ff00000
  s_waitcnt lgkmcnt(14)
  ds_read_b64_tr_b16 v[48:49], v3 offset:49152
  s_waitcnt lgkmcnt(13)
  ds_read_b64_tr_b16 v[50:51], v3 offset:51200
  s_waitcnt lgkmcnt(8)
  v_mfma_f32_16x16x32_bf16 v[32:35], v[16:19], v[64:67], 0
  v_mfma_f32_16x16x32_bf16 v[40:43], v[16:19], v[68:71], 0
  ds_read_b64_tr_b16 v[52:53], v4 offset:49152
  ds_read_b64_tr_b16 v[54:55], v4 offset:51200
  s_waitcnt lgkmcnt(8)
  v_mfma_f32_16x16x32_bf16 v[36:39], v[20:23], v[64:67], 0
  v_mfma_f32_16x16x32_bf16 v[44:47], v[20:23], v[68:71], 0
  ds_read_b64_tr_b16 v[56:57], v3 offset:53248
  ds_read_b64_tr_b16 v[58:59], v3 offset:55296
  s_waitcnt lgkmcnt(8)
  v_mfma_f32_16x16x32_bf16 v[32:35], v[24:27], v[72:75], v[32:35]
  v_mfma_f32_16x16x32_bf16 v[40:43], v[24:27], v[76:79], v[40:43]
  ds_read_b64_tr_b16 v[60:61], v4 offset:53248
  ds_read_b64_tr_b16 v[62:63], v4 offset:55296
  s_waitcnt lgkmcnt(8)
  v_mfma_f32_16x16x32_bf16 v[36:39], v[28:31], v[72:75], v[36:39]
  v_mfma_f32_16x16x32_bf16 v[44:47], v[28:31], v[76:79], v[44:47]
  s_waitcnt lgkmcnt(0)
  s_barrier
  ds_read_b64_tr_b16 v[16:17], v5
  ds_read_b64_tr_b16 v[18:19], v5 offset:2048
  v_mfma_f32_16x16x32_bf16 v[32:35], v[48:51], v[80:83], v[32:35]
  v_mfma_f32_16x16x32_bf16 v[40:43], v[48:51], v[84:87], v[40:43]
  ds_read_b64_tr_b16 v[20:21], v6
  ds_read_b64_tr_b16 v[22:23], v6 offset:2048
  s_mov_b32 m0, 0xc800
  s_add_u32 s39, s72, 0x5e880
  buffer_load_dwordx4 v7, s[24:27], s39 offen lds
  buffer_load_dwordx4 v8, s[24:27], s39 offen offset:1024 lds
  v_mfma_f32_16x16x32_bf16 v[36:39], v[52:55], v[80:83], v[36:39]
  v_mfma_f32_16x16x32_bf16 v[44:47], v[52:55], v[84:87], v[44:47]
  ds_read_b64_tr_b16 v[24:25], v5 offset:4096
  ds_read_b64_tr_b16 v[26:27], v5 offset:6144
  v_mfma_f32_16x16x32_bf16 v[32:35], v[56:59], v[88:91], v[32:35]
  v_mfma_f32_16x16x32_bf16 v[40:43], v[56:59], v[92:95], v[40:43]
  ds_read_b64_tr_b16 v[28:29], v6 offset:4096
  ds_read_b64_tr_b16 v[30:31], v6 offset:6144
  v_mfma_f32_16x16x32_bf16 v[36:39], v[60:63], v[88:91], v[36:39]
  v_mfma_f32_16x16x32_bf16 v[44:47], v[60:63], v[92:95], v[44:47]
  ds_read_b64_tr_b16 v[48:49], v5 offset:8192
  ds_read_b64_tr_b16 v[50:51], v5 offset:10240
  s_waitcnt lgkmcnt(8)
  v_mfma_f32_16x16x32_bf16 v[32:35], v[16:19], v[96:99], v[32:35]
  v_mfma_f32_16x16x32_bf16 v[40:43], v[16:19], v[100:103], v[40:43]
  ds_read_b64_tr_b16 v[52:53], v6 offset:8192
  ds_read_b64_tr_b16 v[54:55], v6 offset:10240
  s_waitcnt lgkmcnt(8)
  v_mfma_f32_16x16x32_bf16 v[36:39], v[20:23], v[96:99], v[36:39]
  v_mfma_f32_16x16x32_bf16 v[44:47], v[20:23], v[100:103], v[44:47]
  ds_read_b64_tr_b16 v[56:57], v5 offset:12288
  ds_read_b64_tr_b16 v[58:59], v5 offset:14336
  s_waitcnt lgkmcnt(8)
  v_mfma_f32_16x16x32_bf16 v[32:35], v[24:27], v[104:107], v[32:35]
  v_mfma_f32_16x16x32_bf16 v[40:43], v[24:27], v[108:111], v[40:43]
  ds_read_b64_tr_b16 v[60:61], v6 offset:12288
  ds_read_b64_tr_b16 v[62:63], v6 offset:14336
  s_waitcnt lgkmcnt(8)
  v_mfma_f32_16x16x32_bf16 v[36:39], v[28:31], v[104:107], v[36:39]
  v_mfma_f32_16x16x32_bf16 v[44:47], v[28:31], v[108:111], v[44:47]
  s_waitcnt vmcnt(4)
  s_waitcnt lgkmcnt(0)
  s_barrier
  ds_read_b64_tr_b16 v[16:17], v3
  ds_read_b64_tr_b16 v[18:19], v3 offset:2048
  v_mfma_f32_16x16x32_bf16 v[32:35], v[48:51], v[112:115], v[32:35]
  v_mfma_f32_16x16x32_bf16 v[40:43], v[48:51], v[116:119], v[40:43]
  ds_read_b64_tr_b16 v[20:21], v4
  ds_read_b64_tr_b16 v[22:23], v4 offset:2048
  s_mov_b32 m0, 0x1b000
  s_add_u32 s39, s72, 0x82880
  buffer_load_dwordx4 v7, s[24:27], s39 offen lds
  buffer_load_dwordx4 v8, s[24:27], s39 offen offset:1024 lds
  v_mfma_f32_16x16x32_bf16 v[36:39], v[52:55], v[112:115], v[36:39]
  v_mfma_f32_16x16x32_bf16 v[44:47], v[52:55], v[116:119], v[44:47]
  ds_read_b64_tr_b16 v[24:25], v3 offset:4096
  ds_read_b64_tr_b16 v[26:27], v3 offset:6144
  v_mfma_f32_16x16x32_bf16 v[32:35], v[56:59], v[120:123], v[32:35]
  v_mfma_f32_16x16x32_bf16 v[40:43], v[56:59], v[124:127], v[40:43]
  ds_read_b64_tr_b16 v[28:29], v4 offset:4096
  ds_read_b64_tr_b16 v[30:31], v4 offset:6144
  v_mfma_f32_16x16x32_bf16 v[36:39], v[60:63], v[120:123], v[36:39]
  v_mfma_f32_16x16x32_bf16 v[44:47], v[60:63], v[124:127], v[44:47]
  ds_read_b64_tr_b16 v[48:49], v3 offset:8192
  ds_read_b64_tr_b16 v[50:51], v3 offset:10240
  s_waitcnt lgkmcnt(8)
  v_mfma_f32_16x16x32_bf16 v[32:35], v[16:19], v[128:131], v[32:35]
  v_mfma_f32_16x16x32_bf16 v[40:43], v[16:19], v[132:135], v[40:43]
  ds_read_b64_tr_b16 v[52:53], v4 offset:8192
  ds_read_b64_tr_b16 v[54:55], v4 offset:10240
  s_waitcnt lgkmcnt(8)
  v_mfma_f32_16x16x32_bf16 v[36:39], v[20:23], v[128:131], v[36:39]
  v_mfma_f32_16x16x32_bf16 v[44:47], v[20:23], v[132:135], v[44:47]
  ds_read_b64_tr_b16 v[56:57], v3 offset:12288
  ds_read_b64_tr_b16 v[58:59], v3 offset:14336
  s_waitcnt lgkmcnt(8)
  v_mfma_f32_16x16x32_bf16 v[32:35], v[24:27], v[136:139], v[32:35]
  v_mfma_f32_16x16x32_bf16 v[40:43], v[24:27], v[140:143], v[40:43]
  ds_read_b64_tr_b16 v[60:61], v4 offset:12288
  ds_read_b64_tr_b16 v[62:63], v4 offset:14336
  s_waitcnt lgkmcnt(8)
  v_mfma_f32_16x16x32_bf16 v[36:39], v[28:31], v[136:139], v[36:39]
  v_mfma_f32_16x16x32_bf16 v[44:47], v[28:31], v[140:143], v[44:47]
  s_waitcnt vmcnt(4)
  s_waitcnt lgkmcnt(0)
  s_barrier
  ds_read_b64_tr_b16 v[16:17], v3 offset:16384
  ds_read_b64_tr_b16 v[18:19], v3 offset:18432
  v_mfma_f32_16x16x32_bf16 v[32:35], v[48:51], v[144:147], v[32:35]
  v_mfma_f32_16x16x32_bf16 v[40:43], v[48:51], v[148:151], v[40:43]
  ds_read_b64_tr_b16 v[20:21], v4 offset:16384
  ds_read_b64_tr_b16 v[22:23], v4 offset:18432
  s_mov_b32 m0, 0x2800
  s_add_u32 s39, s72, 0x16880
  buffer_load_dwordx4 v7, s[24:27], s39 offen lds
  buffer_load_dwordx4 v8, s[24:27], s39 offen offset:1024 lds
  v_mfma_f32_16x16x32_bf16 v[36:39], v[52:55], v[144:147], v[36:39]
  v_mfma_f32_16x16x32_bf16 v[44:47], v[52:55], v[148:151], v[44:47]
  ds_read_b64_tr_b16 v[24:25], v3 offset:20480
  ds_read_b64_tr_b16 v[26:27], v3 offset:22528
  v_mfma_f32_16x16x32_bf16 v[32:35], v[56:59], v[152:155], v[32:35]
  v_mfma_f32_16x16x32_bf16 v[40:43], v[56:59], v[156:159], v[40:43]
  ds_read_b64_tr_b16 v[28:29], v4 offset:20480
  ds_read_b64_tr_b16 v[30:31], v4 offset:22528
  v_mfma_f32_16x16x32_bf16 v[36:39], v[60:63], v[152:155], v[36:39]
  v_mfma_f32_16x16x32_bf16 v[44:47], v[60:63], v[156:159], v[44:47]
  ds_read_b64_tr_b16 v[48:49], v3 offset:24576
  ds_read_b64_tr_b16 v[50:51], v3 offset:26624
  s_waitcnt lgkmcnt(8)
  v_mfma_f32_16x16x32_bf16 v[32:35], v[16:19], v[160:163], v[32:35]
  v_mfma_f32_16x16x32_bf16 v[40:43], v[16:19], v[164:167], v[40:43]
  ds_read_b64_tr_b16 v[52:53], v4 offset:24576
  ds_read_b64_tr_b16 v[54:55], v4 offset:26624
  s_waitcnt lgkmcnt(8)
  v_mfma_f32_16x16x32_bf16 v[36:39], v[20:23], v[160:163], v[36:39]
  v_mfma_f32_16x16x32_bf16 v[44:47], v[20:23], v[164:167], v[44:47]
  ds_read_b64_tr_b16 v[56:57], v3 offset:28672
  ds_read_b64_tr_b16 v[58:59], v3 offset:30720
  s_waitcnt lgkmcnt(8)
  v_mfma_f32_16x16x32_bf16 v[32:35], v[24:27], v[168:171], v[32:35]
  v_mfma_f32_16x16x32_bf16 v[40:43], v[24:27], v[172:175], v[40:43]
  ds_read_b64_tr_b16 v[60:61], v4 offset:28672
  ds_read_b64_tr_b16 v[62:63], v4 offset:30720
  s_waitcnt lgkmcnt(8)
  v_mfma_f32_16x16x32_bf16 v[36:39], v[28:31], v[168:171], v[36:39]
  v_mfma_f32_16x16x32_bf16 v[44:47], v[28:31], v[172:175], v[44:47]
  s_waitcnt vmcnt(4)
  s_waitcnt lgkmcnt(0)
  s_barrier
  ds_read_b64_tr_b16 v[16:17], v3 offset:40960
  ds_read_b64_tr_b16 v[18:19], v3 offset:43008
  v_mfma_f32_16x16x32_bf16 v[32:35], v[48:51], v[176:179], v[32:35]
  v_mfma_f32_16x16x32_bf16 v[40:43], v[48:51], v[180:183], v[40:43]
  ds_read_b64_tr_b16 v[20:21], v4 offset:40960
  ds_read_b64_tr_b16 v[22:23], v4 offset:43008
  s_mov_b32 m0, 0x6800
  s_add_u32 s39, s72, 0x3a880
  buffer_load_dwordx4 v7, s[24:27], s39 offen lds
  buffer_load_dwordx4 v8, s[24:27], s39 offen offset:1024 lds
  v_mfma_f32_16x16x32_bf16 v[36:39], v[52:55], v[176:179], v[36:39]
  v_mfma_f32_16x16x32_bf16 v[44:47], v[52:55], v[180:183], v[44:47]
  ds_read_b64_tr_b16 v[24:25], v3 offset:45056
  ds_read_b64_tr_b16 v[26:27], v3 offset:47104
  v_mfma_f32_16x16x32_bf16 v[32:35], v[56:59], v[184:187], v[32:35]
  v_mfma_f32_16x16x32_bf16 v[40:43], v[56:59], v[188:191], v[40:43]
  ds_read_b64_tr_b16 v[28:29], v4 offset:45056
  ds_read_b64_tr_b16 v[30:31], v4 offset:47104
  v_mfma_f32_16x16x32_bf16 v[36:39], v[60:63], v[184:187], v[36:39]
  v_mfma_f32_16x16x32_bf16 v[44:47], v[60:63], v[188:191], v[44:47]
  s_add_u32 s72, s72, 128
  s_mov_b32 s74, 7
L_op5_loop:
  ds_read_b64_tr_b16 v[48:49], v3 offset:49152
  ds_read_b64_tr_b16 v[50:51], v3 offset:51200
  v_cvt_pk_bf16_f32 v10, v32, v33
  v_cvt_pk_bf16_f32 v11, v34, v35
  s_nop 0
  v_cvt_pk_bf16_f32 v12, v36, v37
  v_cvt_pk_bf16_f32 v13, v38, v39
  s_add_u32 s40, s73, 0x1400
  buffer_store_dwordx4 v[10:13], v2, s[20:23], s40 offen sc1
  s_waitcnt lgkmcnt(8)
  v_mfma_f32_16x16x32_bf16 v[32:35], v[16:19], v[64:67], 0
  v_cvt_pk_bf16_f32 v10, v40, v41
  v_cvt_pk_bf16_f32 v11, v42, v43
  v_cvt_pk_bf16_f32 v12, v44, v45
  v_cvt_pk_bf16_f32 v13, v46, v47
  s_add_u32 s40, s73, 0x1c00
  buffer_store_dwordx4 v[10:13], v2, s[20:23], s40 offen sc1
  v_mfma_f32_16x16x32_bf16 v[40:43], v[16:19], v[68:71], 0
  ds_read_b64_tr_b16 v[52:53], v4 offset:49152
  ds_read_b64_tr_b16 v[54:55], v4 offset:51200
  s_waitcnt lgkmcnt(6)
  v_mfma_f32_16x16x32_bf16 v[36:39], v[20:23], v[64:67], 0
  v_mfma_f32_16x16x32_bf16 v[44:47], v[20:23], v[68:71], 0
  ds_read_b64_tr_b16 v[56:57], v3 offset:53248
  ds_read_b64_tr_b16 v[58:59], v3 offset:55296
  v_mfma_f32_16x16x32_bf16 v[32:35], v[24:27], v[72:75], v[32:35]
  v_mfma_f32_16x16x32_bf16 v[40:43], v[24:27], v[76:79], v[40:43]
  ds_read_b64_tr_b16 v[60:61], v4 offset:53248
  ds_read_b64_tr_b16 v[62:63], v4 offset:55296
  s_waitcnt lgkmcnt(7)
  v_mfma_f32_16x16x32_bf16 v[36:39], v[28:31], v[72:75], v[36:39]
  v_mfma_f32_16x16x32_bf16 v[44:47], v[28:31], v[76:79], v[44:47]
  s_waitcnt vmcnt(6)
  s_waitcnt lgkmcnt(0)
  s_barrier
  ds_read_b64_tr_b16 v[16:17], v5
  ds_read_b64_tr_b16 v[18:19], v5 offset:2048
  v_mfma_f32_16x16x32_bf16 v[32:35], v[48:51], v[80:83], v[32:35]
  v_mfma_f32_16x16x32_bf16 v[40:43], v[48:51], v[84:87], v[40:43]
  ds_read_b64_tr_b16 v[20:21], v6
  ds_read_b64_tr_b16 v[22:23], v6 offset:2048
  s_mov_b32 m0, 0xc800
  s_add_u32 s39, s72, 0x5e880
  buffer_load_dwordx4 v7, s[24:27], s39 offen lds
  buffer_load_dwordx4 v8, s[24:27], s39 offen offset:1024 lds
  v_mfma_f32_16x16x32_bf16 v[36:39], v[52:55], v[80:83], v[36:39]
  v_mfma_f32_16x16x32_bf16 v[44:47], v[52:55], v[84:87], v[44:47]
  ds_read_b64_tr_b16 v[24:25], v5 offset:4096
  ds_read_b64_tr_b16 v[26:27], v5 offset:6144
  v_mfma_f32_16x16x32_bf16 v[32:35], v[56:59], v[88:91], v[32:35]
  v_mfma_f32_16x16x32_bf16 v[40:43], v[56:59], v[92:95], v[40:43]
  ds_read_b64_tr_b16 v[28:29], v6 offset:4096
  ds_read_b64_tr_b16 v[30:31], v6 offset:6144
  v_mfma_f32_16x16x32_bf16 v[36:39], v[60:63], v[88:91], v[36:39]
  v_mfma_f32_16x16x32_bf16 v[44:47], v[60:63], v[92:95], v[44:47]
  ds_read_b64_tr_b16 v[48:49], v5 offset:8192
  ds_read_b64_tr_b16 v[50:51], v5 offset:10240
  s_waitcnt lgkmcnt(8)
  v_mfma_f32_16x16x32_bf16 v[32:35], v[16:19], v[96:99], v[32:35]
  v_mfma_f32_16x16x32_bf16 v[40:43], v[16:19], v[100:103], v[40:43]
  ds_read_b64_tr_b16 v[52:53], v6 offset:8192
  ds_read_b64_tr_b16 v[54:55], v6 offset:10240
  s_waitcnt lgkmcnt(8)
  v_mfma_f32_16x16x32_bf16 v[36:39], v[20:23], v[96:99], v[36:39]
  v_mfma_f32_16x16x32_bf16 v[44:47], v[20:23], v[100:103], v[44:47]
  ds_read_b64_tr_b16 v[56:57], v5 offset:12288
  ds_read_b64_tr_b16 v[58:59], v5 offset:14336
  s_waitcnt lgkmcnt(8)
  v_mfma_f32_16x16x32_bf16 v[32:35], v[24:27], v[104:107], v[32:35]
  v_mfma_f32_16x16x32_bf16 v[40:43], v[24:27], v[108:111], v[40:43]
  ds_read_b64_tr_b16 v[60:61], v6 offset:12288
  ds_read_b64_tr_b16 v[62:63], v6 offset:14336
  s_waitcnt lgkmcnt(8)
  v_mfma_f32_16x16x32_bf16 v[36:39], v[28:31], v[104:107], v[36:39]
  v_mfma_f32_16x16x32_bf16 v[44:47], v[28:31], v[108:111], v[44:47]
  s_waitcnt vmcnt(6)
  s_waitcnt lgkmcnt(0)
  s_barrier
  ds_read_b64_tr_b16 v[16:17], v3
  ds_read_b64_tr_b16 v[18:19], v3 offset:2048
  v_mfma_f32_16x16x32_bf16 v[32:35], v[48:51], v[112:115], v[32:35]
  v_mfma_f32_16x16x32_bf16 v[40:43], v[48:51], v[116:119], v[40:43]
  ds_read_b64_tr_b16 v[20:21], v4
  ds_read_b64_tr_b16 v[22:23], v4 offset:2048
  s_mov_b32 m0, 0x1b000
  s_add_u32 s39, s72, 0x82880
  buffer_load_dwordx4 v7, s[24:27], s39 offen lds
  buffer_load_dwordx4 v8, s[24:27], s39 offen offset:1024 lds
  v_mfma_f32_16x16x32_bf16 v[36:39], v[52:55], v[112:115], v[36:39]
  v_mfma_f32_16x16x32_bf16 v[44:47], v[52:55], v[116:119], v[44:47]
  ds_read_b64_tr_b16 v[24:25], v3 offset:4096
  ds_read_b64_tr_b16 v[26:27], v3 offset:6144
  v_mfma_f32_16x16x32_bf16 v[32:35], v[56:59], v[120:123], v[32:35]
  v_mfma_f32_16x16x32_bf16 v[40:43], v[56:59], v[124:127], v[40:43]
  ds_read_b64_tr_b16 v[28:29], v4 offset:4096
  ds_read_b64_tr_b16 v[30:31], v4 offset:6144
  v_mfma_f32_16x16x32_bf16 v[36:39], v[60:63], v[120:123], v[36:39]
  v_mfma_f32_16x16x32_bf16 v[44:47], v[60:63], v[124:127], v[44:47]
  ds_read_b64_tr_b16 v[48:49], v3 offset:8192
  ds_read_b64_tr_b16 v[50:51], v3 offset:10240
  s_waitcnt lgkmcnt(8)
  v_mfma_f32_16x16x32_bf16 v[32:35], v[16:19], v[128:131], v[32:35]
  v_mfma_f32_16x16x32_bf16 v[40:43], v[16:19], v[132:135], v[40:43]
  ds_read_b64_tr_b16 v[52:53], v4 offset:8192
  ds_read_b64_tr_b16 v[54:55], v4 offset:10240
  s_waitcnt lgkmcnt(8)
  v_mfma_f32_16x16x32_bf16 v[36:39], v[20:23], v[128:131], v[36:39]
  v_mfma_f32_16x16x32_bf16 v[44:47], v[20:23], v[132:135], v[44:47]
  ds_read_b64_tr_b16 v[56:57], v3 offset:12288
  ds_read_b64_tr_b16 v[58:59], v3 offset:14336
  s_waitcnt lgkmcnt(8)
  v_mfma_f32_16x16x32_bf16 v[32:35], v[24:27], v[136:139], v[32:35]
  v_mfma_f32_16x16x32_bf16 v[40:43], v[24:27], v[140:143], v[40:43]
  ds_read_b64_tr_b16 v[60:61], v4 offset:12288
  ds_read_b64_tr_b16 v[62:63], v4 offset:14336
  s_waitcnt lgkmcnt(8)
  v_mfma_f32_16x16x32_bf16 v[36:39], v[28:31], v[136:139], v[36:39]
  v_mfma_f32_16x16x32_bf16 v[44:47], v[28:31], v[140:143], v[44:47]
  s_waitcnt vmcnt(6)
  s_waitcnt lgkmcnt(0)
  s_barrier
  ds_read_b64_tr_b16 v[16:17], v3 offset:16384
  ds_read_b64_tr_b16 v[18:19], v3 offset:18432
  v_mfma_f32_16x16x32_bf16 v[32:35], v[48:51], v[144:147], v[32:35]
  v_mfma_f32_16x16x32_bf16 v[40:43], v[48:51], v[148:151], v[40:43]
  ds_read_b64_tr_b16 v[20:21], v4 offset:16384
  ds_read_b64_tr_b16 v[22:23], v4 offset:18432
  s_mov_b32 m0, 0x2800
  s_add_u32 s39, s72, 0x16880
  buffer_load_dwordx4 v7, s[24:27], s39 offen lds
  buffer_load_dwordx4 v8, s[24:27], s39 offen offset:1024 lds
  v_mfma_f32_16x16x32_bf16 v[36:39], v[52:55], v[144:147], v[36:39]
  v_mfma_f32_16x16x32_bf16 v[44:47], v[52:55], v[148:151], v[44:47]
  ds_read_b64_tr_b16 v[24:25], v3 offset:20480
  ds_read_b64_tr_b16 v[26:27], v3 offset:22528
  v_mfma_f32_16x16x32_bf16 v[32:35], v[56:59], v[152:155], v[32:35]
  v_mfma_f32_16x16x32_bf16 v[40:43], v[56:59], v[156:159], v[40:43]
  ds_read_b64_tr_b16 v[28:29], v4 offset:20480
  ds_read_b64_tr_b16 v[30:31], v4 offset:22528
  v_mfma_f32_16x16x32_bf16 v[36:39], v[60:63], v[152:155], v[36:39]
  v_mfma_f32_16x16x32_bf16 v[44:47], v[60:63], v[156:159], v[44:47]
  ds_read_b64_tr_b16 v[48:49], v3 offset:24576
  ds_read_b64_tr_b16 v[50:51], v3 offset:26624
  s_waitcnt lgkmcnt(8)
  v_mfma_f32_16x16x32_bf16 v[32:35], v[16:19], v[160:163], v[32:35]
  v_mfma_f32_16x16x32_bf16 v[40:43], v[16:19], v[164:167], v[40:43]
  ds_read_b64_tr_b16 v[52:53], v4 offset:24576
  ds_read_b64_tr_b16 v[54:55], v4 offset:26624
  s_waitcnt lgkmcnt(8)
  v_mfma_f32_16x16x32_bf16 v[36:39], v[20:23], v[160:163], v[36:39]
  v_mfma_f32_16x16x32_bf16 v[44:47], v[20:23], v[164:167], v[44:47]
  ds_read_b64_tr_b16 v[56:57], v3 offset:28672
  ds_read_b64_tr_b16 v[58:59], v3 offset:30720
  s_waitcnt lgkmcnt(8)
  v_mfma_f32_16x16x32_bf16 v[32:35], v[24:27], v[168:171], v[32:35]
  v_mfma_f32_16x16x32_bf16 v[40:43], v[24:27], v[172:175], v[40:43]
  ds_read_b64_tr_b16 v[60:61], v4 offset:28672
  ds_read_b64_tr_b16 v[62:63], v4 offset:30720
  s_waitcnt lgkmcnt(8)
  v_mfma_f32_16x16x32_bf16 v[36:39], v[28:31], v[168:171], v[36:39]
  v_mfma_f32_16x16x32_bf16 v[44:47], v[28:31], v[172:175], v[44:47]
  s_waitcnt vmcnt(4)
  s_waitcnt lgkmcnt(0)
  s_barrier
  ds_read_b64_tr_b16 v[16:17], v3 offset:40960
  ds_read_b64_tr_b16 v[18:19], v3 offset:43008
  v_mfma_f32_16x16x32_bf16 v[32:35], v[48:51], v[176:179], v[32:35]
  v_mfma_f32_16x16x32_bf16 v[40:43], v[48:51], v[180:183], v[40:43]
  ds_read_b64_tr_b16 v[20:21], v4 offset:40960
  ds_read_b64_tr_b16 v[22:23], v4 offset:43008
  s_mov_b32 m0, 0x6800
  s_add_u32 s39, s72, 0x3a880
  buffer_load_dwordx4 v7, s[24:27], s39 offen lds
  buffer_load_dwordx4 v8, s[24:27], s39 offen offset:1024 lds
  v_mfma_f32_16x16x32_bf16 v[36:39], v[52:55], v[176:179], v[36:39]
  v_mfma_f32_16x16x32_bf16 v[44:47], v[52:55], v[180:183], v[44:47]
  ds_read_b64_tr_b16 v[24:25], v3 offset:45056
  ds_read_b64_tr_b16 v[26:27], v3 offset:47104
  v_mfma_f32_16x16x32_bf16 v[32:35], v[56:59], v[184:187], v[32:35]
  v_mfma_f32_16x16x32_bf16 v[40:43], v[56:59], v[188:191], v[40:43]
  ds_read_b64_tr_b16 v[28:29], v4 offset:45056
  ds_read_b64_tr_b16 v[30:31], v4 offset:47104
  v_mfma_f32_16x16x32_bf16 v[36:39], v[60:63], v[184:187], v[36:39]
  v_mfma_f32_16x16x32_bf16 v[44:47], v[60:63], v[188:191], v[44:47]
  s_add_u32 s72, s72, 128
  s_add_u32 s73, s73, 0x4800
  s_add_u32 s78, s78, 1
  s_sub_u32 s74, s74, 1
  s_cmp_lg_u32 s74, 0
  s_cbranch_scc1 L_op5_loop
  ds_read_b64_tr_b16 v[48:49], v3 offset:49152
  ds_read_b64_tr_b16 v[50:51], v3 offset:51200
  v_cvt_pk_bf16_f32 v10, v32, v33
  v_cvt_pk_bf16_f32 v11, v34, v35
  v_cvt_pk_bf16_f32 v12, v36, v37
  v_cvt_pk_bf16_f32 v13, v38, v39
  s_add_u32 s40, s73, 0x1400
  buffer_store_dwordx4 v[10:13], v2, s[20:23], s40 offen sc1
  s_waitcnt lgkmcnt(6)
  v_mfma_f32_16x16x32_bf16 v[32:35], v[16:19], v[64:67], 0
  v_cvt_pk_bf16_f32 v10, v40, v41
  v_cvt_pk_bf16_f32 v11, v42, v43
  v_cvt_pk_bf16_f32 v12, v44, v45
  v_cvt_pk_bf16_f32 v13, v46, v47
  s_add_u32 s40, s73, 0x1c00
  buffer_store_dwordx4 v[10:13], v2, s[20:23], s40 offen sc1
  v_mfma_f32_16x16x32_bf16 v[40:43], v[16:19], v[68:71], 0
  ds_read_b64_tr_b16 v[52:53], v4 offset:49152
  ds_read_b64_tr_b16 v[54:55], v4 offset:51200
  v_mfma_f32_16x16x32_bf16 v[36:39], v[20:23], v[64:67], 0
  v_mfma_f32_16x16x32_bf16 v[44:47], v[20:23], v[68:71], 0
  ds_read_b64_tr_b16 v[56:57], v3 offset:53248
  ds_read_b64_tr_b16 v[58:59], v3 offset:55296
  s_waitcnt lgkmcnt(6)
  v_mfma_f32_16x16x32_bf16 v[32:35], v[24:27], v[72:75], v[32:35]
  v_mfma_f32_16x16x32_bf16 v[40:43], v[24:27], v[76:79], v[40:43]
  ds_read_b64_tr_b16 v[60:61], v4 offset:53248
  ds_read_b64_tr_b16 v[62:63], v4 offset:55296
  v_mfma_f32_16x16x32_bf16 v[36:39], v[28:31], v[72:75], v[36:39]
  v_mfma_f32_16x16x32_bf16 v[44:47], v[28:31], v[76:79], v[44:47]
  s_waitcnt vmcnt(6)
  s_waitcnt lgkmcnt(0)
  s_barrier
  ds_read_b64_tr_b16 v[16:17], v5
  ds_read_b64_tr_b16 v[18:19], v5 offset:2048
  v_mfma_f32_16x16x32_bf16 v[32:35], v[48:51], v[80:83], v[32:35]
  v_mfma_f32_16x16x32_bf16 v[40:43], v[48:51], v[84:87], v[40:43]
  ds_read_b64_tr_b16 v[20:21], v6
  ds_read_b64_tr_b16 v[22:23], v6 offset:2048
  v_mfma_f32_16x16x32_bf16 v[36:39], v[52:55], v[80:83], v[36:39]
  v_mfma_f32_16x16x32_bf16 v[44:47], v[52:55], v[84:87], v[44:47]
  ds_read_b64_tr_b16 v[24:25], v5 offset:4096
  ds_read_b64_tr_b16 v[26:27], v5 offset:6144
  v_mfma_f32_16x16x32_bf16 v[32:35], v[56:59], v[88:91], v[32:35]
  v_mfma_f32_16x16x32_bf16 v[40:43], v[56:59], v[92:95], v[40:43]
  ds_read_b64_tr_b16 v[28:29], v6 offset:4096
  ds_read_b64_tr_b16 v[30:31], v6 offset:6144
  v_mfma_f32_16x16x32_bf16 v[36:39], v[60:63], v[88:91], v[36:39]
  v_mfma_f32_16x16x32_bf16 v[44:47], v[60:63], v[92:95], v[44:47]
  ds_read_b64_tr_b16 v[48:49], v5 offset:8192
  ds_read_b64_tr_b16 v[50:51], v5 offset:10240
  s_waitcnt lgkmcnt(8)
  v_mfma_f32_16x16x32_bf16 v[32:35], v[16:19], v[96:99], v[32:35]
  v_mfma_f32_16x16x32_bf16 v[40:43], v[16:19], v[100:103], v[40:43]
  ds_read_b64_tr_b16 v[52:53], v6 offset:8192
  ds_read_b64_tr_b16 v[54:55], v6 offset:10240
  s_waitcnt lgkmcnt(8)
  v_mfma_f32_16x16x32_bf16 v[36:39], v[20:23], v[96:99], v[36:39]
  v_mfma_f32_16x16x32_bf16 v[44:47], v[20:23], v[100:103], v[44:47]
  ds_read_b64_tr_b16 v[56:57], v5 offset:12288
  ds_read_b64_tr_b16 v[58:59], v5 offset:14336
  s_waitcnt lgkmcnt(8)
  v_mfma_f32_16x16x32_bf16 v[32:35], v[24:27], v[104:107], v[32:35]
  v_mfma_f32_16x16x32_bf16 v[40:43], v[24:27], v[108:111], v[40:43]
  ds_read_b64_tr_b16 v[60:61], v6 offset:12288
  ds_read_b64_tr_b16 v[62:63], v6 offset:14336
  s_waitcnt lgkmcnt(8)
  v_mfma_f32_16x16x32_bf16 v[36:39], v[28:31], v[104:107], v[36:39]
  v_mfma_f32_16x16x32_bf16 v[44:47], v[28:31], v[108:111], v[44:47]
  s_waitcnt vmcnt(4)
  s_waitcnt lgkmcnt(0)
  s_barrier
  ds_read_b64_tr_b16 v[16:17], v3
  ds_read_b64_tr_b16 v[18:19], v3 offset:2048
  v_mfma_f32_16x16x32_bf16 v[32:35], v[48:51], v[112:115], v[32:35]
  v_mfma_f32_16x16x32_bf16 v[40:43], v[48:51], v[116:119], v[40:43]
  ds_read_b64_tr_b16 v[20:21], v4
  ds_read_b64_tr_b16 v[22:23], v4 offset:2048
  v_mfma_f32_16x16x32_bf16 v[36:39], v[52:55], v[112:115], v[36:39]
  v_mfma_f32_16x16x32_bf16 v[44:47], v[52:55], v[116:119], v[44:47]
  ds_read_b64_tr_b16 v[24:25], v3 offset:4096
  ds_read_b64_tr_b16 v[26:27], v3 offset:6144
  v_mfma_f32_16x16x32_bf16 v[32:35], v[56:59], v[120:123], v[32:35]
  v_mfma_f32_16x16x32_bf16 v[40:43], v[56:59], v[124:127], v[40:43]
  ds_read_b64_tr_b16 v[28:29], v4 offset:4096
  ds_read_b64_tr_b16 v[30:31], v4 offset:6144
  v_mfma_f32_16x16x32_bf16 v[36:39], v[60:63], v[120:123], v[36:39]
  v_mfma_f32_16x16x32_bf16 v[44:47], v[60:63], v[124:127], v[44:47]
  ds_read_b64_tr_b16 v[48:49], v3 offset:8192
  ds_read_b64_tr_b16 v[50:51], v3 offset:10240
  s_waitcnt lgkmcnt(8)
  v_mfma_f32_16x16x32_bf16 v[32:35], v[16:19], v[128:131], v[32:35]
  v_mfma_f32_16x16x32_bf16 v[40:43], v[16:19], v[132:135], v[40:43]
  ds_read_b64_tr_b16 v[52:53], v4 offset:8192
  ds_read_b64_tr_b16 v[54:55], v4 offset:10240
  s_waitcnt lgkmcnt(8)
  v_mfma_f32_16x16x32_bf16 v[36:39], v[20:23], v[128:131], v[36:39]
  v_mfma_f32_16x16x32_bf16 v[44:47], v[20:23], v[132:135], v[44:47]
  ds_read_b64_tr_b16 v[56:57], v3 offset:12288
  ds_read_b64_tr_b16 v[58:59], v3 offset:14336
  s_waitcnt lgkmcnt(8)
  v_mfma_f32_16x16x32_bf16 v[32:35], v[24:27], v[136:139], v[32:35]
  v_mfma_f32_16x16x32_bf16 v[40:43], v[24:27], v[140:143], v[40:43]
  ds_read_b64_tr_b16 v[60:61], v4 offset:12288
  ds_read_b64_tr_b16 v[62:63], v4 offset:14336
  s_waitcnt lgkmcnt(8)
  v_mfma_f32_16x16x32_bf16 v[36:39], v[28:31], v[136:139], v[36:39]
  v_mfma_f32_16x16x32_bf16 v[44:47], v[28:31], v[140:143], v[44:47]
  s_waitcnt vmcnt(0)
  s_waitcnt lgkmcnt(0)
  s_barrier
  ds_read_b64_tr_b16 v[16:17], v3 offset:16384
  ds_read_b64_tr_b16 v[18:19], v3 offset:18432
  v_mfma_f32_16x16x32_bf16 v[32:35], v[48:51], v[144:147], v[32:35]
  v_mfma_f32_16x16x32_bf16 v[40:43], v[48:51], v[148:151], v[40:43]
  ds_read_b64_tr_b16 v[20:21], v4 offset:16384
  ds_read_b64_tr_b16 v[22:23], v4 offset:18432
  v_mfma_f32_16x16x32_bf16 v[36:39], v[52:55], v[144:147], v[36:39]
  v_mfma_f32_16x16x32_bf16 v[44:47], v[52:55], v[148:151], v[44:47]
  ds_read_b64_tr_b16 v[24:25], v3 offset:20480
  ds_read_b64_tr_b16 v[26:27], v3 offset:22528
  v_mfma_f32_16x16x32_bf16 v[32:35], v[56:59], v[152:155], v[32:35]
  v_mfma_f32_16x16x32_bf16 v[40:43], v[56:59], v[156:159], v[40:43]
  ds_read_b64_tr_b16 v[28:29], v4 offset:20480
  ds_read_b64_tr_b16 v[30:31], v4 offset:22528
  v_mfma_f32_16x16x32_bf16 v[36:39], v[60:63], v[152:155], v[36:39]
  v_mfma_f32_16x16x32_bf16 v[44:47], v[60:63], v[156:159], v[44:47]
  ds_read_b64_tr_b16 v[48:49], v3 offset:24576
  ds_read_b64_tr_b16 v[50:51], v3 offset:26624
  s_waitcnt lgkmcnt(8)
  v_mfma_f32_16x16x32_bf16 v[32:35], v[16:19], v[160:163], v[32:35]
  v_mfma_f32_16x16x32_bf16 v[40:43], v[16:19], v[164:167], v[40:43]
  ds_read_b64_tr_b16 v[52:53], v4 offset:24576
  ds_read_b64_tr_b16 v[54:55], v4 offset:26624
  s_waitcnt lgkmcnt(8)
  v_mfma_f32_16x16x32_bf16 v[36:39], v[20:23], v[160:163], v[36:39]
  v_mfma_f32_16x16x32_bf16 v[44:47], v[20:23], v[164:167], v[44:47]
  ds_read_b64_tr_b16 v[56:57], v3 offset:28672
  ds_read_b64_tr_b16 v[58:59], v3 offset:30720
  s_waitcnt lgkmcnt(8)
  v_mfma_f32_16x16x32_bf16 v[32:35], v[24:27], v[168:171], v[32:35]
  v_mfma_f32_16x16x32_bf16 v[40:43], v[24:27], v[172:175], v[40:43]
  ds_read_b64_tr_b16 v[60:61], v4 offset:28672
  ds_read_b64_tr_b16 v[62:63], v4 offset:30720
  s_waitcnt lgkmcnt(8)
  v_mfma_f32_16x16x32_bf16 v[36:39], v[28:31], v[168:171], v[36:39]
  v_mfma_f32_16x16x32_bf16 v[44:47], v[28:31], v[172:175], v[44:47]
  s_waitcnt lgkmcnt(6)
  v_mfma_f32_16x16x32_bf16 v[32:35], v[48:51], v[176:179], v[32:35]
  v_mfma_f32_16x16x32_bf16 v[40:43], v[48:51], v[180:183], v[40:43]
  s_waitcnt lgkmcnt(4)
  v_mfma_f32_16x16x32_bf16 v[36:39], v[52:55], v[176:179], v[36:39]
  v_mfma_f32_16x16x32_bf16 v[44:47], v[52:55], v[180:183], v[44:47]
  s_waitcnt lgkmcnt(2)
  v_mfma_f32_16x16x32_bf16 v[32:35], v[56:59], v[184:187], v[32:35]
  v_mfma_f32_16x16x32_bf16 v[40:43], v[56:59], v[188:191], v[40:43]
  s_waitcnt lgkmcnt(0)
  v_mfma_f32_16x16x32_bf16 v[36:39], v[60:63], v[184:187], v[36:39]
  v_mfma_f32_16x16x32_bf16 v[44:47], v[60:63], v[188:191], v[44:47]
  s_nop 3
  v_cvt_pk_bf16_f32 v10, v32, v33
  v_cvt_pk_bf16_f32 v11, v34, v35
  s_nop 0
  v_cvt_pk_bf16_f32 v12, v36, v37
  v_cvt_pk_bf16_f32 v13, v38, v39
  s_add_u32 s40, s73, 0x5c00
  buffer_store_dwordx4 v[10:13], v2, s[20:23], s40 offen sc1
  s_nop 1
  v_cvt_pk_bf16_f32 v10, v40, v41
  v_cvt_pk_bf16_f32 v11, v42, v43
  v_cvt_pk_bf16_f32 v12, v44, v45
  v_cvt_pk_bf16_f32 v13, v46, v47
  s_add_u32 s40, s73, 0x6400
  buffer_store_dwordx4 v[10:13], v2, s[20:23], s40 offen sc1
  s_lshl_b32 s41, s33, 8
  s_add_u32 s41, s41, 0x4000000
  v_mov_b32 v238, s41
  v_and_b32 v239, 15, v0
  v_mul_u32_u24 v239, 2304, v239
  v_lshrrev_b32 v232, 4, v0
  v_lshl_add_u32 v239, v232, 4, v239
  buffer_load_dwordx2 v[236:237], v238, s[20:23], 0 offen sc1
  s_waitcnt vmcnt(0)
  s_barrier
  s_branch L_tail
L_Bw:
  s_sub_u32 s37, s32, 4
  s_mov_b32 s36, 0
  s_mov_b32 s88, 0x3e0293ee
  s_mov_b32 s89, 0x3e0293ee
  v_lshrrev_b32 v18, 4, v0
  v_bfe_u32 v19, v0, 2, 2
  v_lshl_add_u32 v28, v18, 3, v19
  v_lshlrev_b32 v28, 8, v28
  v_and_b32 v18, 1, v18
  v_lshl_add_u32 v19, v18, 2, v19
  v_and_b32 v18, 3, v0
  v_lshl_add_u32 v28, v18, 3, v28
  v_xor_b32 v18, 0, v19
  v_lshl_add_u32 v2, v18, 5, v28
  v_xor_b32 v18, 1, v19
  v_lshl_add_u32 v3, v18, 5, v28
  v_xor_b32 v18, 2, v19
  v_lshl_add_u32 v4, v18, 5, v28
  v_xor_b32 v18, 3, v19
  v_lshl_add_u32 v5, v18, 5, v28
  v_xor_b32 v18, 4, v19
  v_lshl_add_u32 v6, v18, 5, v28
  v_xor_b32 v18, 5, v19
  v_lshl_add_u32 v7, v18, 5, v28
  v_xor_b32 v18, 6, v19
  v_lshl_add_u32 v8, v18, 5, v28
  v_xor_b32 v18, 7, v19
  v_lshl_add_u32 v9, v18, 5, v28
  v_bfe_u32 v18, v0, 1, 3
  v_lshrrev_b32 v19, 4, v0
  v_xor_b32 v18, v18, v19
  v_lshlrev_b32 v18, 4, v18
  v_and_b32 v19, 15, v0
  v_lshl_add_u32 v10, v19, 7, v18
  v_lshlrev_b32 v12, 4, v0
  v_lshrrev_b32 v18, 5, v0
  v_lshl_add_u32 v18, v18, 4, v19
  v_lshlrev_b32 v18, 4, v18
  v_bfe_u32 v19, v0, 4, 1
  v_lshl_add_u32 v18, v19, 3, v18
  v_add_u32 v13, 0x1e800, v18
  s_mul_i32 s38, s37, 3072
  s_mul_i32 s39, s37, 12288
  s_mul_i32 s40, s37, 6144
  v_add_u32 v10, s40, v10
  v_add_u32 v12, s38, v12
  v_add_u32 v13, s39, v13
  v_xor_b32 v11, 64, v10
  s_setprio 0
  s_mul_i32 s38, s35, 2
  s_mul_i32 s39, s34, 1
  s_add_u32 s38, s38, s39
  s_mul_i32 s39, s38, 57
  s_lshr_b32 s39, s39, 9
  s_mul_i32 s39, s39, 9
  s_sub_u32 s91, s38, s39
  s_lshl_b32 s90, s91, 1
  s_mov_b32 s92, 0
  s_lshl_b32 s48, s57, 8
  s_add_u32 s48, s48, 256
  s_add_u32 s49, s48, 256
  v_lshrrev_b32 v18, 4, v0
  v_or_b32 v19, 0, v18
  v_lshlrev_b32 v19, 1, v19
  v_xor_b32 v19, v19, v0
  v_and_b32 v19, 15, v19
  v_lshlrev_b32 v19, 4, v19
  v_mul_u32_u24 v18, 8192, v18
  v_add_u32 v18, v18, v19
  v_add_u32 v14, 0, v18
  v_lshrrev_b32 v18, 4, v0
  v_or_b32 v19, 0, v18
  v_lshlrev_b32 v19, 1, v19
  v_xor_b32 v19, v19, v0
  v_and_b32 v19, 15, v19
  v_lshlrev_b32 v19, 4, v19
  v_mul_u32_u24 v18, 8192, v18
  v_add_u32 v18, v18, v19
  v_add_u32 v15, 31744, v18
  v_lshrrev_b32 v18, 4, v0
  v_or_b32 v19, 4, v18
  v_lshlrev_b32 v19, 1, v19
  v_xor_b32 v19, v19, v0
  v_and_b32 v19, 15, v19
  v_lshlrev_b32 v19, 4, v19
  v_mul_u32_u24 v18, 8192, v18
  v_add_u32 v18, v18, v19
  v_add_u32 v16, 63488, v18
  v_lshrrev_b32 v18, 4, v0
  v_or_b32 v19, 4, v18
  v_lshlrev_b32 v19, 1, v19
  v_xor_b32 v19, v19, v0
  v_and_b32 v19, 15, v19
  v_lshlrev_b32 v19, 4, v19
  v_mul_u32_u24 v18, 8192, v18
  v_add_u32 v18, v18, v19
  v_add_u32 v17, 95232, v18
  s_waitcnt lgkmcnt(0)
  s_barrier
  v_add_u32 v10, 0xa000, v10
  v_add_u32 v11, 0xa000, v11
  ds_read_b64_tr_b16 v[124:125], v2
  ds_read_b64_tr_b16 v[126:127], v2 offset:1024
  ds_read_b64_tr_b16 v[128:129], v3
  ds_read_b64_tr_b16 v[130:131], v3 offset:1024
  ds_read_b64_tr_b16 v[132:133], v4
  ds_read_b64_tr_b16 v[134:135], v4 offset:1024
  ds_read_b64_tr_b16 v[136:137], v5
  ds_read_b64_tr_b16 v[138:139], v5 offset:1024
  ds_read_b128 v[168:171], v10
  ds_read_b128 v[172:175], v10 offset:2048
  ds_read_b128 v[176:179], v10 offset:4096
  s_waitcnt lgkmcnt(2)
  v_mfma_f32_16x16x32_bf16 v[28:31], v[124:127], v[168:171], 0
  ds_read_b64_tr_b16 v[140:141], v2 offset:8192
  ds_read_b64_tr_b16 v[142:143], v2 offset:9216
  v_mfma_f32_16x16x32_bf16 v[40:43], v[128:131], v[168:171], 0
  ds_read_b64_tr_b16 v[144:145], v3 offset:8192
  v_mfma_f32_16x16x32_bf16 v[52:55], v[132:135], v[168:171], 0
  ds_read_b64_tr_b16 v[146:147], v3 offset:9216
  v_mfma_f32_16x16x32_bf16 v[64:67], v[136:139], v[168:171], 0
  ds_read_b64_tr_b16 v[148:149], v4 offset:8192
  s_waitcnt lgkmcnt(6)
  v_mfma_f32_16x16x32_bf16 v[32:35], v[124:127], v[172:175], 0
  ds_read_b64_tr_b16 v[150:151], v4 offset:9216
  v_mfma_f32_16x16x32_bf16 v[44:47], v[128:131], v[172:175], 0
  ds_read_b64_tr_b16 v[152:153], v5 offset:8192
  v_mfma_f32_16x16x32_bf16 v[56:59], v[132:135], v[172:175], 0
  ds_read_b64_tr_b16 v[154:155], v5 offset:9216
  v_mfma_f32_16x16x32_bf16 v[68:71], v[136:139], v[172:175], 0
  ds_read_b128 v[180:183], v11
  s_waitcnt lgkmcnt(9)
  v_mfma_f32_16x16x32_bf16 v[36:39], v[124:127], v[176:179], 0
  ds_read_b128 v[184:187], v11 offset:2048
  v_mfma_f32_16x16x32_bf16 v[48:51], v[128:131], v[176:179], 0
  ds_read_b128 v[188:191], v11 offset:4096
  v_mfma_f32_16x16x32_bf16 v[60:63], v[132:135], v[176:179], 0
  v_mfma_f32_16x16x32_bf16 v[72:75], v[136:139], v[176:179], 0
  s_waitcnt lgkmcnt(2)
  v_mfma_f32_16x16x32_bf16 v[28:31], v[140:143], v[180:183], v[28:31]
  v_mfma_f32_16x16x32_bf16 v[40:43], v[144:147], v[180:183], v[40:43]
  v_mfma_f32_16x16x32_bf16 v[52:55], v[148:151], v[180:183], v[52:55]
  v_mfma_f32_16x16x32_bf16 v[64:67], v[152:155], v[180:183], v[64:67]
  s_waitcnt lgkmcnt(1)
  v_mfma_f32_16x16x32_bf16 v[32:35], v[140:143], v[184:187], v[32:35]
  v_mfma_f32_16x16x32_bf16 v[44:47], v[144:147], v[184:187], v[44:47]
  v_mfma_f32_16x16x32_bf16 v[56:59], v[148:151], v[184:187], v[56:59]
  v_mfma_f32_16x16x32_bf16 v[68:71], v[152:155], v[184:187], v[68:71]
  s_waitcnt lgkmcnt(0)
  v_mfma_f32_16x16x32_bf16 v[36:39], v[140:143], v[188:191], v[36:39]
  v_mfma_f32_16x16x32_bf16 v[48:51], v[144:147], v[188:191], v[48:51]
  v_mfma_f32_16x16x32_bf16 v[60:63], v[148:151], v[188:191], v[60:63]
  v_mfma_f32_16x16x32_bf16 v[72:75], v[152:155], v[188:191], v[72:75]
  s_waitcnt lgkmcnt(0)
  s_barrier
  ds_read_b64_tr_b16 v[124:125], v2 offset:16384
  ds_read_b64_tr_b16 v[126:127], v2 offset:17408
  ds_read_b64_tr_b16 v[128:129], v3 offset:16384
  ds_read_b64_tr_b16 v[130:131], v3 offset:17408
  ds_read_b64_tr_b16 v[132:133], v4 offset:16384
  ds_read_b64_tr_b16 v[134:135], v4 offset:17408
  ds_read_b64_tr_b16 v[136:137], v5 offset:16384
  ds_read_b64_tr_b16 v[138:139], v5 offset:17408
  ds_read_b128 v[192:195], v10 offset:26624
  ds_read_b128 v[196:199], v10 offset:28672
  ds_read_b128 v[200:203], v10 offset:30720
  s_waitcnt lgkmcnt(2)
  v_mfma_f32_16x16x32_bf16 v[28:31], v[124:127], v[192:195], v[28:31]
  ds_read_b64_tr_b16 v[140:141], v2 offset:24576
  ds_read_b64_tr_b16 v[142:143], v2 offset:25600
  v_mfma_f32_16x16x32_bf16 v[40:43], v[128:131], v[192:195], v[40:43]
  ds_read_b64_tr_b16 v[144:145], v3 offset:24576
  v_mfma_f32_16x16x32_bf16 v[52:55], v[132:135], v[192:195], v[52:55]
  ds_read_b64_tr_b16 v[146:147], v3 offset:25600
  v_mfma_f32_16x16x32_bf16 v[64:67], v[136:139], v[192:195], v[64:67]
  ds_read_b64_tr_b16 v[148:149], v4 offset:24576
  s_waitcnt lgkmcnt(6)
  v_mfma_f32_16x16x32_bf16 v[32:35], v[124:127], v[196:199], v[32:35]
  ds_read_b64_tr_b16 v[150:151], v4 offset:25600
  v_mfma_f32_16x16x32_bf16 v[44:47], v[128:131], v[196:199], v[44:47]
  ds_read_b64_tr_b16 v[152:153], v5 offset:24576
  v_mfma_f32_16x16x32_bf16 v[56:59], v[132:135], v[196:199], v[56:59]
  ds_read_b64_tr_b16 v[154:155], v5 offset:25600
  v_mfma_f32_16x16x32_bf16 v[68:71], v[136:139], v[196:199], v[68:71]
  ds_read_b128 v[204:207], v11 offset:26624
  s_waitcnt lgkmcnt(9)
  v_mfma_f32_16x16x32_bf16 v[36:39], v[124:127], v[200:203], v[36:39]
  ds_read_b128 v[208:211], v11 offset:28672
  v_mfma_f32_16x16x32_bf16 v[48:51], v[128:131], v[200:203], v[48:51]
  ds_read_b128 v[212:215], v11 offset:30720
  v_mfma_f32_16x16x32_bf16 v[60:63], v[132:135], v[200:203], v[60:63]
  v_mfma_f32_16x16x32_bf16 v[72:75], v[136:139], v[200:203], v[72:75]
  s_waitcnt lgkmcnt(2)
  v_mfma_f32_16x16x32_bf16 v[28:31], v[140:143], v[204:207], v[28:31]
  v_mfma_f32_16x16x32_bf16 v[40:43], v[144:147], v[204:207], v[40:43]
  v_mfma_f32_16x16x32_bf16 v[52:55], v[148:151], v[204:207], v[52:55]
  v_mfma_f32_16x16x32_bf16 v[64:67], v[152:155], v[204:207], v[64:67]
  s_waitcnt lgkmcnt(1)
  v_mfma_f32_16x16x32_bf16 v[32:35], v[140:143], v[208:211], v[32:35]
  v_mfma_f32_16x16x32_bf16 v[44:47], v[144:147], v[208:211], v[44:47]
  v_mfma_f32_16x16x32_bf16 v[56:59], v[148:151], v[208:211], v[56:59]
  v_mfma_f32_16x16x32_bf16 v[68:71], v[152:155], v[208:211], v[68:71]
  s_waitcnt lgkmcnt(0)
  v_mfma_f32_16x16x32_bf16 v[36:39], v[140:143], v[212:215], v[36:39]
  v_mfma_f32_16x16x32_bf16 v[48:51], v[144:147], v[212:215], v[48:51]
  v_mfma_f32_16x16x32_bf16 v[60:63], v[148:151], v[212:215], v[60:63]
  v_mfma_f32_16x16x32_bf16 v[72:75], v[152:155], v[212:215], v[72:75]
  s_waitcnt lgkmcnt(0)
  s_barrier
  v_add_u32 v2, 0x1e800, v2
  v_add_u32 v3, 0x1e800, v3
  v_add_u32 v4, 0x1e800, v4
  v_add_u32 v5, 0x1e800, v5
  v_add_u32 v10, 0x14800, v10
  v_add_u32 v11, 0x14800, v11
  ds_read_b64_tr_b16 v[124:125], v2
  ds_read_b64_tr_b16 v[126:127], v2 offset:1024
  ds_read_b64_tr_b16 v[128:129], v3
  ds_read_b64_tr_b16 v[130:131], v3 offset:1024
  ds_read_b64_tr_b16 v[132:133], v4
  ds_read_b64_tr_b16 v[134:135], v4 offset:1024
  ds_read_b64_tr_b16 v[136:137], v5
  ds_read_b64_tr_b16 v[138:139], v5 offset:1024
  ds_read_b128 v[216:219], v10 offset:16384
  ds_read_b128 v[220:223], v10 offset:18432
  ds_read_b128 v[224:227], v10 offset:20480
  s_waitcnt lgkmcnt(2)
  v_mfma_f32_16x16x32_bf16 v[28:31], v[124:127], v[216:219], v[28:31]
  ds_read_b64_tr_b16 v[140:141], v2 offset:8192
  ds_read_b64_tr_b16 v[142:143], v2 offset:9216
  v_mfma_f32_16x16x32_bf16 v[40:43], v[128:131], v[216:219], v[40:43]
  ds_read_b64_tr_b16 v[144:145], v3 offset:8192
  v_mfma_f32_16x16x32_bf16 v[52:55], v[132:135], v[216:219], v[52:55]
  ds_read_b64_tr_b16 v[146:147], v3 offset:9216
  v_mfma_f32_16x16x32_bf16 v[64:67], v[136:139], v[216:219], v[64:67]
  ds_read_b64_tr_b16 v[148:149], v4 offset:8192
  s_waitcnt lgkmcnt(6)
  v_mfma_f32_16x16x32_bf16 v[32:35], v[124:127], v[220:223], v[32:35]
  ds_read_b64_tr_b16 v[150:151], v4 offset:9216
  v_mfma_f32_16x16x32_bf16 v[44:47], v[128:131], v[220:223], v[44:47]
  ds_read_b64_tr_b16 v[152:153], v5 offset:8192
  v_mfma_f32_16x16x32_bf16 v[56:59], v[132:135], v[220:223], v[56:59]
  ds_read_b64_tr_b16 v[154:155], v5 offset:9216
  v_mfma_f32_16x16x32_bf16 v[68:71], v[136:139], v[220:223], v[68:71]
  ds_read_b128 v[228:231], v11 offset:16384
  s_waitcnt lgkmcnt(9)
  v_mfma_f32_16x16x32_bf16 v[36:39], v[124:127], v[224:227], v[36:39]
  ds_read_b128 v[232:235], v11 offset:18432
  v_mfma_f32_16x16x32_bf16 v[48:51], v[128:131], v[224:227], v[48:51]
  ds_read_b128 v[236:239], v11 offset:20480
  v_mfma_f32_16x16x32_bf16 v[60:63], v[132:135], v[224:227], v[60:63]
  v_mfma_f32_16x16x32_bf16 v[72:75], v[136:139], v[224:227], v[72:75]
  s_waitcnt lgkmcnt(2)
  v_mfma_f32_16x16x32_bf16 v[28:31], v[140:143], v[228:231], v[28:31]
  v_mfma_f32_16x16x32_bf16 v[40:43], v[144:147], v[228:231], v[40:43]
  v_mfma_f32_16x16x32_bf16 v[52:55], v[148:151], v[228:231], v[52:55]
  v_mfma_f32_16x16x32_bf16 v[64:67], v[152:155], v[228:231], v[64:67]
  s_waitcnt lgkmcnt(1)
  v_mfma_f32_16x16x32_bf16 v[32:35], v[140:143], v[232:235], v[32:35]
  v_mfma_f32_16x16x32_bf16 v[44:47], v[144:147], v[232:235], v[44:47]
  v_mfma_f32_16x16x32_bf16 v[56:59], v[148:151], v[232:235], v[56:59]
  v_mfma_f32_16x16x32_bf16 v[68:71], v[152:155], v[232:235], v[68:71]
  s_waitcnt lgkmcnt(0)
  v_mfma_f32_16x16x32_bf16 v[36:39], v[140:143], v[236:239], v[36:39]
  v_mfma_f32_16x16x32_bf16 v[48:51], v[144:147], v[236:239], v[48:51]
  v_mfma_f32_16x16x32_bf16 v[60:63], v[148:151], v[236:239], v[60:63]
  v_mfma_f32_16x16x32_bf16 v[72:75], v[152:155], v[236:239], v[72:75]
  s_waitcnt lgkmcnt(0)
  s_barrier
  v_subrev_u32 v2, 0x1e800, v2
  v_subrev_u32 v3, 0x1e800, v3
  v_subrev_u32 v4, 0x1e800, v4
  v_subrev_u32 v5, 0x1e800, v5
  v_subrev_u32 v10, 0x14800, v10
  v_subrev_u32 v11, 0x14800, v11
  ds_read_b64_tr_b16 v[124:125], v2
  ds_read_b64_tr_b16 v[126:127], v2 offset:1024
  ds_read_b64_tr_b16 v[128:129], v3
  ds_read_b64_tr_b16 v[130:131], v3 offset:1024
  ds_read_b64_tr_b16 v[132:133], v4
  ds_read_b64_tr_b16 v[134:135], v4 offset:1024
  ds_read_b64_tr_b16 v[136:137], v5
  ds_read_b64_tr_b16 v[138:139], v5 offset:1024
  ds_read_b128 v[156:159], v10
  ds_read_b128 v[160:163], v10 offset:2048
  ds_read_b128 v[164:167], v10 offset:4096
  s_waitcnt lgkmcnt(2)
  v_mfma_f32_16x16x32_bf16 v[28:31], v[124:127], v[156:159], v[28:31]
  ds_read_b64_tr_b16 v[140:141], v2 offset:8192
  ds_read_b64_tr_b16 v[142:143], v2 offset:9216
  v_mfma_f32_16x16x32_bf16 v[40:43], v[128:131], v[156:159], v[40:43]
  ds_read_b64_tr_b16 v[144:145], v3 offset:8192
  v_mfma_f32_16x16x32_bf16 v[52:55], v[132:135], v[156:159], v[52:55]
  ds_read_b64_tr_b16 v[146:147], v3 offset:9216
  v_mfma_f32_16x16x32_bf16 v[64:67], v[136:139], v[156:159], v[64:67]
  ds_read_b64_tr_b16 v[148:149], v4 offset:8192
  s_waitcnt lgkmcnt(6)
  v_mfma_f32_16x16x32_bf16 v[32:35], v[124:127], v[160:163], v[32:35]
  ds_read_b64_tr_b16 v[150:151], v4 offset:9216
  v_mfma_f32_16x16x32_bf16 v[44:47], v[128:131], v[160:163], v[44:47]
  ds_read_b64_tr_b16 v[152:153], v5 offset:8192
  v_mfma_f32_16x16x32_bf16 v[56:59], v[132:135], v[160:163], v[56:59]
  ds_read_b64_tr_b16 v[154:155], v5 offset:9216
  v_mfma_f32_16x16x32_bf16 v[68:71], v[136:139], v[160:163], v[68:71]
  ds_read_b128 v[76:79], v11
  s_waitcnt lgkmcnt(9)
  v_mfma_f32_16x16x32_bf16 v[36:39], v[124:127], v[164:167], v[36:39]
  ds_read_b128 v[80:83], v11 offset:2048
  v_mfma_f32_16x16x32_bf16 v[48:51], v[128:131], v[164:167], v[48:51]
  ds_read_b128 v[84:87], v11 offset:4096
  v_mfma_f32_16x16x32_bf16 v[60:63], v[132:135], v[164:167], v[60:63]
  v_mfma_f32_16x16x32_bf16 v[72:75], v[136:139], v[164:167], v[72:75]
  s_waitcnt lgkmcnt(2)
  v_mfma_f32_16x16x32_bf16 v[28:31], v[140:143], v[76:79], v[28:31]
  v_mfma_f32_16x16x32_bf16 v[40:43], v[144:147], v[76:79], v[40:43]
  v_mfma_f32_16x16x32_bf16 v[52:55], v[148:151], v[76:79], v[52:55]
  v_mfma_f32_16x16x32_bf16 v[64:67], v[152:155], v[76:79], v[64:67]
  s_waitcnt lgkmcnt(1)
  v_mfma_f32_16x16x32_bf16 v[32:35], v[140:143], v[80:83], v[32:35]
  v_mfma_f32_16x16x32_bf16 v[44:47], v[144:147], v[80:83], v[44:47]
  v_mfma_f32_16x16x32_bf16 v[56:59], v[148:151], v[80:83], v[56:59]
  v_mfma_f32_16x16x32_bf16 v[68:71], v[152:155], v[80:83], v[68:71]
  s_waitcnt lgkmcnt(0)
  v_mfma_f32_16x16x32_bf16 v[36:39], v[140:143], v[84:87], v[36:39]
  v_mfma_f32_16x16x32_bf16 v[48:51], v[144:147], v[84:87], v[48:51]
  v_mfma_f32_16x16x32_bf16 v[60:63], v[148:151], v[84:87], v[60:63]
  v_mfma_f32_16x16x32_bf16 v[72:75], v[152:155], v[84:87], v[72:75]
  s_waitcnt lgkmcnt(0)
  s_barrier
  ds_read_b64_tr_b16 v[124:125], v2 offset:16384
  ds_read_b64_tr_b16 v[126:127], v2 offset:17408
  ds_read_b64_tr_b16 v[128:129], v3 offset:16384
  ds_read_b64_tr_b16 v[130:131], v3 offset:17408
  ds_read_b64_tr_b16 v[132:133], v4 offset:16384
  ds_read_b64_tr_b16 v[134:135], v4 offset:17408
  ds_read_b64_tr_b16 v[136:137], v5 offset:16384
  ds_read_b64_tr_b16 v[138:139], v5 offset:17408
  ds_read_b128 v[156:159], v10 offset:26624
  ds_read_b128 v[160:163], v10 offset:28672
  ds_read_b128 v[164:167], v10 offset:30720
  s_waitcnt lgkmcnt(2)
  v_mfma_f32_16x16x32_bf16 v[28:31], v[124:127], v[156:159], v[28:31]
  ds_read_b64_tr_b16 v[140:141], v2 offset:24576
  ds_read_b64_tr_b16 v[142:143], v2 offset:25600
  v_mfma_f32_16x16x32_bf16 v[40:43], v[128:131], v[156:159], v[40:43]
  ds_read_b64_tr_b16 v[144:145], v3 offset:24576
  v_mfma_f32_16x16x32_bf16 v[52:55], v[132:135], v[156:159], v[52:55]
  ds_read_b64_tr_b16 v[146:147], v3 offset:25600
  v_mfma_f32_16x16x32_bf16 v[64:67], v[136:139], v[156:159], v[64:67]
  ds_read_b64_tr_b16 v[148:149], v4 offset:24576
  s_waitcnt lgkmcnt(6)
  v_mfma_f32_16x16x32_bf16 v[32:35], v[124:127], v[160:163], v[32:35]
  ds_read_b64_tr_b16 v[150:151], v4 offset:25600
  v_mfma_f32_16x16x32_bf16 v[44:47], v[128:131], v[160:163], v[44:47]
  ds_read_b64_tr_b16 v[152:153], v5 offset:24576
  v_mfma_f32_16x16x32_bf16 v[56:59], v[132:135], v[160:163], v[56:59]
  ds_read_b64_tr_b16 v[154:155], v5 offset:25600
  v_mfma_f32_16x16x32_bf16 v[68:71], v[136:139], v[160:163], v[68:71]
  ds_read_b128 v[76:79], v11 offset:26624
  s_waitcnt lgkmcnt(9)
  v_mfma_f32_16x16x32_bf16 v[36:39], v[124:127], v[164:167], v[36:39]
  ds_read_b128 v[80:83], v11 offset:28672
  v_mfma_f32_16x16x32_bf16 v[48:51], v[128:131], v[164:167], v[48:51]
  ds_read_b128 v[84:87], v11 offset:30720
  v_mfma_f32_16x16x32_bf16 v[60:63], v[132:135], v[164:167], v[60:63]
  v_mfma_f32_16x16x32_bf16 v[72:75], v[136:139], v[164:167], v[72:75]
  s_waitcnt lgkmcnt(2)
  v_mfma_f32_16x16x32_bf16 v[28:31], v[140:143], v[76:79], v[28:31]
  v_mfma_f32_16x16x32_bf16 v[40:43], v[144:147], v[76:79], v[40:43]
  v_mfma_f32_16x16x32_bf16 v[52:55], v[148:151], v[76:79], v[52:55]
  v_mfma_f32_16x16x32_bf16 v[64:67], v[152:155], v[76:79], v[64:67]
  s_waitcnt lgkmcnt(1)
  v_mfma_f32_16x16x32_bf16 v[32:35], v[140:143], v[80:83], v[32:35]
  v_mfma_f32_16x16x32_bf16 v[44:47], v[144:147], v[80:83], v[44:47]
  v_mfma_f32_16x16x32_bf16 v[56:59], v[148:151], v[80:83], v[56:59]
  v_mfma_f32_16x16x32_bf16 v[68:71], v[152:155], v[80:83], v[68:71]
  s_waitcnt lgkmcnt(0)
  v_mfma_f32_16x16x32_bf16 v[36:39], v[140:143], v[84:87], v[36:39]
  v_mfma_f32_16x16x32_bf16 v[48:51], v[144:147], v[84:87], v[48:51]
  v_mfma_f32_16x16x32_bf16 v[60:63], v[148:151], v[84:87], v[60:63]
  v_mfma_f32_16x16x32_bf16 v[72:75], v[152:155], v[84:87], v[72:75]
  s_waitcnt lgkmcnt(0)
  s_barrier
  v_add_u32 v2, 0x1e800, v2
  v_add_u32 v3, 0x1e800, v3
  v_add_u32 v4, 0x1e800, v4
  v_add_u32 v5, 0x1e800, v5
  v_add_u32 v10, 0x14800, v10
  v_add_u32 v11, 0x14800, v11
  ds_read_b64_tr_b16 v[124:125], v2
  ds_read_b64_tr_b16 v[126:127], v2 offset:1024
  ds_read_b64_tr_b16 v[128:129], v3
  ds_read_b64_tr_b16 v[130:131], v3 offset:1024
  ds_read_b64_tr_b16 v[132:133], v4
  ds_read_b64_tr_b16 v[134:135], v4 offset:1024
  ds_read_b64_tr_b16 v[136:137], v5
  ds_read_b64_tr_b16 v[138:139], v5 offset:1024
  ds_read_b128 v[156:159], v10 offset:16384
  ds_read_b128 v[160:163], v10 offset:18432
  ds_read_b128 v[164:167], v10 offset:20480
  s_waitcnt lgkmcnt(2)
  v_mfma_f32_16x16x32_bf16 v[28:31], v[124:127], v[156:159], v[28:31]
  ds_read_b64_tr_b16 v[140:141], v2 offset:8192
  ds_read_b64_tr_b16 v[142:143], v2 offset:9216
  v_mfma_f32_16x16x32_bf16 v[40:43], v[128:131], v[156:159], v[40:43]
  ds_read_b64_tr_b16 v[144:145], v3 offset:8192
  v_mfma_f32_16x16x32_bf16 v[52:55], v[132:135], v[156:159], v[52:55]
  ds_read_b64_tr_b16 v[146:147], v3 offset:9216
  v_mfma_f32_16x16x32_bf16 v[64:67], v[136:139], v[156:159], v[64:67]
  ds_read_b64_tr_b16 v[148:149], v4 offset:8192
  s_waitcnt lgkmcnt(6)
  v_mfma_f32_16x16x32_bf16 v[32:35], v[124:127], v[160:163], v[32:35]
  ds_read_b64_tr_b16 v[150:151], v4 offset:9216
  v_mfma_f32_16x16x32_bf16 v[44:47], v[128:131], v[160:163], v[44:47]
  ds_read_b64_tr_b16 v[152:153], v5 offset:8192
  v_mfma_f32_16x16x32_bf16 v[56:59], v[132:135], v[160:163], v[56:59]
  ds_read_b64_tr_b16 v[154:155], v5 offset:9216
  v_mfma_f32_16x16x32_bf16 v[68:71], v[136:139], v[160:163], v[68:71]
  ds_read_b128 v[76:79], v11 offset:16384
  s_waitcnt lgkmcnt(9)
  v_mfma_f32_16x16x32_bf16 v[36:39], v[124:127], v[164:167], v[36:39]
  ds_read_b128 v[80:83], v11 offset:18432
  v_mfma_f32_16x16x32_bf16 v[48:51], v[128:131], v[164:167], v[48:51]
  ds_read_b128 v[84:87], v11 offset:20480
  v_mfma_f32_16x16x32_bf16 v[60:63], v[132:135], v[164:167], v[60:63]
  v_mfma_f32_16x16x32_bf16 v[72:75], v[136:139], v[164:167], v[72:75]
  s_waitcnt lgkmcnt(2)
  v_mfma_f32_16x16x32_bf16 v[28:31], v[140:143], v[76:79], v[28:31]
  v_mfma_f32_16x16x32_bf16 v[40:43], v[144:147], v[76:79], v[40:43]
  v_mfma_f32_16x16x32_bf16 v[52:55], v[148:151], v[76:79], v[52:55]
  v_mfma_f32_16x16x32_bf16 v[64:67], v[152:155], v[76:79], v[64:67]
  s_waitcnt lgkmcnt(1)
  v_mfma_f32_16x16x32_bf16 v[32:35], v[140:143], v[80:83], v[32:35]
  v_mfma_f32_16x16x32_bf16 v[44:47], v[144:147], v[80:83], v[44:47]
  v_mfma_f32_16x16x32_bf16 v[56:59], v[148:151], v[80:83], v[56:59]
  v_mfma_f32_16x16x32_bf16 v[68:71], v[152:155], v[80:83], v[68:71]
  s_waitcnt lgkmcnt(0)
  v_mfma_f32_16x16x32_bf16 v[36:39], v[140:143], v[84:87], v[36:39]
  v_mfma_f32_16x16x32_bf16 v[48:51], v[144:147], v[84:87], v[48:51]
  v_mfma_f32_16x16x32_bf16 v[60:63], v[148:151], v[84:87], v[60:63]
  v_mfma_f32_16x16x32_bf16 v[72:75], v[152:155], v[84:87], v[72:75]
  s_waitcnt lgkmcnt(0)
  s_barrier
  v_subrev_u32 v2, 0x1e800, v2
  v_subrev_u32 v3, 0x1e800, v3
  v_subrev_u32 v4, 0x1e800, v4
  v_subrev_u32 v5, 0x1e800, v5
  v_subrev_u32 v10, 0x14800, v10
  v_subrev_u32 v11, 0x14800, v11
  ds_read_b64_tr_b16 v[124:125], v2
  ds_read_b64_tr_b16 v[126:127], v2 offset:1024
  ds_read_b64_tr_b16 v[128:129], v3
  ds_read_b64_tr_b16 v[130:131], v3 offset:1024
  ds_read_b64_tr_b16 v[132:133], v4
  ds_read_b64_tr_b16 v[134:135], v4 offset:1024
  ds_read_b64_tr_b16 v[136:137], v5
  ds_read_b64_tr_b16 v[138:139], v5 offset:1024
  ds_read_b128 v[156:159], v10
  ds_read_b128 v[160:163], v10 offset:2048
  ds_read_b128 v[164:167], v10 offset:4096
  s_waitcnt lgkmcnt(2)
  v_mfma_f32_16x16x32_bf16 v[28:31], v[124:127], v[156:159], v[28:31]
  ds_read_b64_tr_b16 v[140:141], v2 offset:8192
  ds_read_b64_tr_b16 v[142:143], v2 offset:9216
  v_mfma_f32_16x16x32_bf16 v[40:43], v[128:131], v[156:159], v[40:43]
  ds_read_b64_tr_b16 v[144:145], v3 offset:8192
  v_mfma_f32_16x16x32_bf16 v[52:55], v[132:135], v[156:159], v[52:55]
  ds_read_b64_tr_b16 v[146:147], v3 offset:9216
  v_mfma_f32_16x16x32_bf16 v[64:67], v[136:139], v[156:159], v[64:67]
  ds_read_b64_tr_b16 v[148:149], v4 offset:8192
  s_waitcnt lgkmcnt(6)
  v_mfma_f32_16x16x32_bf16 v[32:35], v[124:127], v[160:163], v[32:35]
  ds_read_b64_tr_b16 v[150:151], v4 offset:9216
  v_mfma_f32_16x16x32_bf16 v[44:47], v[128:131], v[160:163], v[44:47]
  ds_read_b64_tr_b16 v[152:153], v5 offset:8192
  v_mfma_f32_16x16x32_bf16 v[56:59], v[132:135], v[160:163], v[56:59]
  ds_read_b64_tr_b16 v[154:155], v5 offset:9216
  v_mfma_f32_16x16x32_bf16 v[68:71], v[136:139], v[160:163], v[68:71]
  ds_read_b128 v[76:79], v11
  s_waitcnt lgkmcnt(9)
  v_mfma_f32_16x16x32_bf16 v[36:39], v[124:127], v[164:167], v[36:39]
  ds_read_b128 v[80:83], v11 offset:2048
  v_mfma_f32_16x16x32_bf16 v[48:51], v[128:131], v[164:167], v[48:51]
  ds_read_b128 v[84:87], v11 offset:4096
  v_mfma_f32_16x16x32_bf16 v[60:63], v[132:135], v[164:167], v[60:63]
  v_mfma_f32_16x16x32_bf16 v[72:75], v[136:139], v[164:167], v[72:75]
  s_waitcnt lgkmcnt(2)
  v_mfma_f32_16x16x32_bf16 v[28:31], v[140:143], v[76:79], v[28:31]
  v_mfma_f32_16x16x32_bf16 v[40:43], v[144:147], v[76:79], v[40:43]
  v_mfma_f32_16x16x32_bf16 v[52:55], v[148:151], v[76:79], v[52:55]
  v_mfma_f32_16x16x32_bf16 v[64:67], v[152:155], v[76:79], v[64:67]
  s_waitcnt lgkmcnt(1)
  v_mfma_f32_16x16x32_bf16 v[32:35], v[140:143], v[80:83], v[32:35]
  v_mfma_f32_16x16x32_bf16 v[44:47], v[144:147], v[80:83], v[44:47]
  v_mfma_f32_16x16x32_bf16 v[56:59], v[148:151], v[80:83], v[56:59]
  v_mfma_f32_16x16x32_bf16 v[68:71], v[152:155], v[80:83], v[68:71]
  s_waitcnt lgkmcnt(0)
  v_mfma_f32_16x16x32_bf16 v[36:39], v[140:143], v[84:87], v[36:39]
  v_mfma_f32_16x16x32_bf16 v[48:51], v[144:147], v[84:87], v[48:51]
  v_mfma_f32_16x16x32_bf16 v[60:63], v[148:151], v[84:87], v[60:63]
  v_mfma_f32_16x16x32_bf16 v[72:75], v[152:155], v[84:87], v[72:75]
  s_waitcnt lgkmcnt(0)
  s_barrier
  ds_read_b64_tr_b16 v[124:125], v2 offset:16384
  ds_read_b64_tr_b16 v[126:127], v2 offset:17408
  ds_read_b64_tr_b16 v[128:129], v3 offset:16384
  ds_read_b64_tr_b16 v[130:131], v3 offset:17408
  ds_read_b64_tr_b16 v[132:133], v4 offset:16384
  ds_read_b64_tr_b16 v[134:135], v4 offset:17408
  ds_read_b64_tr_b16 v[136:137], v5 offset:16384
  ds_read_b64_tr_b16 v[138:139], v5 offset:17408
  ds_read_b128 v[156:159], v10 offset:26624
  ds_read_b128 v[160:163], v10 offset:28672
  ds_read_b128 v[164:167], v10 offset:30720
  s_lshl_b32 s39, s90, 18
  s_add_u32 s39, s39, s48
  s_mov_b32 m0, 0x0
  s_nop 0
  buffer_load_dwordx4 v14, s[12:15], s39 offen lds
  buffer_load_dwordx4 v15, s[12:15], s39 offen offset:1024 lds
  buffer_load_dwordx4 v16, s[12:15], s39 offen offset:2048 lds
  buffer_load_dwordx4 v17, s[12:15], s39 offen offset:3072 lds
  s_add_u32 s39, s39, 131072
  s_mov_b32 m0, 0x1000
  s_nop 0
  buffer_load_dwordx4 v14, s[12:15], s39 offen lds
  buffer_load_dwordx4 v15, s[12:15], s39 offen offset:1024 lds
  buffer_load_dwordx4 v16, s[12:15], s39 offen offset:2048 lds
  buffer_load_dwordx4 v17, s[12:15], s39 offen offset:3072 lds
  s_add_u32 s90, s90, 1
  s_cmp_eq_u32 s90, 18
  s_cselect_b32 s90, 0, s90
  s_waitcnt lgkmcnt(2)
  v_mfma_f32_16x16x32_bf16 v[28:31], v[124:127], v[156:159], v[28:31]
  ds_read_b64_tr_b16 v[140:141], v2 offset:24576
  ds_read_b64_tr_b16 v[142:143], v2 offset:25600
  v_mfma_f32_16x16x32_bf16 v[40:43], v[128:131], v[156:159], v[40:43]
  ds_read_b64_tr_b16 v[144:145], v3 offset:24576
  v_mfma_f32_16x16x32_bf16 v[52:55], v[132:135], v[156:159], v[52:55]
  ds_read_b64_tr_b16 v[146:147], v3 offset:25600
  v_mfma_f32_16x16x32_bf16 v[64:67], v[136:139], v[156:159], v[64:67]
  ds_read_b64_tr_b16 v[148:149], v4 offset:24576
  s_waitcnt lgkmcnt(6)
  v_mfma_f32_16x16x32_bf16 v[32:35], v[124:127], v[160:163], v[32:35]
  ds_read_b64_tr_b16 v[150:151], v4 offset:25600
  v_mfma_f32_16x16x32_bf16 v[44:47], v[128:131], v[160:163], v[44:47]
  ds_read_b64_tr_b16 v[152:153], v5 offset:24576
  v_mfma_f32_16x16x32_bf16 v[56:59], v[132:135], v[160:163], v[56:59]
  ds_read_b64_tr_b16 v[154:155], v5 offset:25600
  v_mfma_f32_16x16x32_bf16 v[68:71], v[136:139], v[160:163], v[68:71]
  ds_read_b128 v[76:79], v11 offset:26624
  s_waitcnt lgkmcnt(9)
  v_mfma_f32_16x16x32_bf16 v[36:39], v[124:127], v[164:167], v[36:39]
  ds_read_b128 v[80:83], v11 offset:28672
  v_mfma_f32_16x16x32_bf16 v[48:51], v[128:131], v[164:167], v[48:51]
  ds_read_b128 v[84:87], v11 offset:30720
  v_mfma_f32_16x16x32_bf16 v[60:63], v[132:135], v[164:167], v[60:63]
  v_mfma_f32_16x16x32_bf16 v[72:75], v[136:139], v[164:167], v[72:75]
  s_lshl_b32 s39, s90, 18
  s_add_u32 s39, s39, s48
  s_mov_b32 m0, 0x2000
  s_nop 0
  buffer_load_dwordx4 v14, s[12:15], s39 offen lds
  buffer_load_dwordx4 v15, s[12:15], s39 offen offset:1024 lds
  buffer_load_dwordx4 v16, s[12:15], s39 offen offset:2048 lds
  buffer_load_dwordx4 v17, s[12:15], s39 offen offset:3072 lds
  s_add_u32 s39, s39, 131072
  s_mov_b32 m0, 0x3000
  s_nop 0
  buffer_load_dwordx4 v14, s[12:15], s39 offen lds
  buffer_load_dwordx4 v15, s[12:15], s39 offen offset:1024 lds
  buffer_load_dwordx4 v16, s[12:15], s39 offen offset:2048 lds
  buffer_load_dwordx4 v17, s[12:15], s39 offen offset:3072 lds
  s_add_u32 s90, s90, 1
  s_cmp_eq_u32 s90, 18
  s_cselect_b32 s90, 0, s90
  s_waitcnt lgkmcnt(2)
  v_mfma_f32_16x16x32_bf16 v[28:31], v[140:143], v[76:79], v[28:31]
  v_mfma_f32_16x16x32_bf16 v[40:43], v[144:147], v[76:79], v[40:43]
  v_mfma_f32_16x16x32_bf16 v[52:55], v[148:151], v[76:79], v[52:55]
  v_mfma_f32_16x16x32_bf16 v[64:67], v[152:155], v[76:79], v[64:67]
  s_waitcnt lgkmcnt(1)
  v_mfma_f32_16x16x32_bf16 v[32:35], v[140:143], v[80:83], v[32:35]
  v_mfma_f32_16x16x32_bf16 v[44:47], v[144:147], v[80:83], v[44:47]
  v_mfma_f32_16x16x32_bf16 v[56:59], v[148:151], v[80:83], v[56:59]
  v_mfma_f32_16x16x32_bf16 v[68:71], v[152:155], v[80:83], v[68:71]
  s_waitcnt lgkmcnt(0)
  v_mfma_f32_16x16x32_bf16 v[36:39], v[140:143], v[84:87], v[36:39]
  v_mfma_f32_16x16x32_bf16 v[48:51], v[144:147], v[84:87], v[48:51]
  v_mfma_f32_16x16x32_bf16 v[60:63], v[148:151], v[84:87], v[60:63]
  v_mfma_f32_16x16x32_bf16 v[72:75], v[152:155], v[84:87], v[72:75]
  s_waitcnt lgkmcnt(0)
  s_barrier
  v_add_u32 v2, 0x1e800, v2
  v_add_u32 v3, 0x1e800, v3
  v_add_u32 v4, 0x1e800, v4
  v_add_u32 v5, 0x1e800, v5
  v_add_u32 v10, 0x14800, v10
  v_add_u32 v11, 0x14800, v11
  ds_read_b64_tr_b16 v[124:125], v2
  ds_read_b64_tr_b16 v[126:127], v2 offset:1024
  ds_read_b64_tr_b16 v[128:129], v3
  ds_read_b64_tr_b16 v[130:131], v3 offset:1024
  ds_read_b64_tr_b16 v[132:133], v4
  ds_read_b64_tr_b16 v[134:135], v4 offset:1024
  ds_read_b64_tr_b16 v[136:137], v5
  ds_read_b64_tr_b16 v[138:139], v5 offset:1024
  ds_read_b128 v[156:159], v10 offset:16384
  ds_read_b128 v[160:163], v10 offset:18432
  ds_read_b128 v[164:167], v10 offset:20480
  s_lshl_b32 s39, s90, 18
  s_add_u32 s39, s39, s48
  s_mov_b32 m0, 0x4000
  s_nop 0
  buffer_load_dwordx4 v14, s[12:15], s39 offen lds
  buffer_load_dwordx4 v15, s[12:15], s39 offen offset:1024 lds
  buffer_load_dwordx4 v16, s[12:15], s39 offen offset:2048 lds
  buffer_load_dwordx4 v17, s[12:15], s39 offen offset:3072 lds
  s_add_u32 s39, s39, 131072
  s_mov_b32 m0, 0x5000
  s_nop 0
  buffer_load_dwordx4 v14, s[12:15], s39 offen lds
  buffer_load_dwordx4 v15, s[12:15], s39 offen offset:1024 lds
  buffer_load_dwordx4 v16, s[12:15], s39 offen offset:2048 lds
  buffer_load_dwordx4 v17, s[12:15], s39 offen offset:3072 lds
  s_add_u32 s90, s90, 1
  s_cmp_eq_u32 s90, 18
  s_cselect_b32 s90, 0, s90
  s_waitcnt lgkmcnt(2)
  v_mfma_f32_16x16x32_bf16 v[28:31], v[124:127], v[156:159], v[28:31]
  ds_read_b64_tr_b16 v[140:141], v2 offset:8192
  ds_read_b64_tr_b16 v[142:143], v2 offset:9216
  v_mfma_f32_16x16x32_bf16 v[40:43], v[128:131], v[156:159], v[40:43]
  ds_read_b64_tr_b16 v[144:145], v3 offset:8192
  v_mfma_f32_16x16x32_bf16 v[52:55], v[132:135], v[156:159], v[52:55]
  ds_read_b64_tr_b16 v[146:147], v3 offset:9216
  v_mfma_f32_16x16x32_bf16 v[64:67], v[136:139], v[156:159], v[64:67]
  ds_read_b64_tr_b16 v[148:149], v4 offset:8192
  s_waitcnt lgkmcnt(6)
  v_mfma_f32_16x16x32_bf16 v[32:35], v[124:127], v[160:163], v[32:35]
  ds_read_b64_tr_b16 v[150:151], v4 offset:9216
  v_mfma_f32_16x16x32_bf16 v[44:47], v[128:131], v[160:163], v[44:47]
  ds_read_b64_tr_b16 v[152:153], v5 offset:8192
  v_mfma_f32_16x16x32_bf16 v[56:59], v[132:135], v[160:163], v[56:59]
  ds_read_b64_tr_b16 v[154:155], v5 offset:9216
  v_mfma_f32_16x16x32_bf16 v[68:71], v[136:139], v[160:163], v[68:71]
  ds_read_b128 v[76:79], v11 offset:16384
  s_waitcnt lgkmcnt(9)
  v_mfma_f32_16x16x32_bf16 v[36:39], v[124:127], v[164:167], v[36:39]
  ds_read_b128 v[80:83], v11 offset:18432
  v_mfma_f32_16x16x32_bf16 v[48:51], v[128:131], v[164:167], v[48:51]
  ds_read_b128 v[84:87], v11 offset:20480
  v_mfma_f32_16x16x32_bf16 v[60:63], v[132:135], v[164:167], v[60:63]
  v_mfma_f32_16x16x32_bf16 v[72:75], v[136:139], v[164:167], v[72:75]
  s_waitcnt lgkmcnt(2)
  v_mfma_f32_16x16x32_bf16 v[28:31], v[140:143], v[76:79], v[28:31]
  v_mfma_f32_16x16x32_bf16 v[40:43], v[144:147], v[76:79], v[40:43]
  v_mfma_f32_16x16x32_bf16 v[52:55], v[148:151], v[76:79], v[52:55]
  v_mfma_f32_16x16x32_bf16 v[64:67], v[152:155], v[76:79], v[64:67]
  s_waitcnt lgkmcnt(1)
  v_mfma_f32_16x16x32_bf16 v[32:35], v[140:143], v[80:83], v[32:35]
  v_mfma_f32_16x16x32_bf16 v[44:47], v[144:147], v[80:83], v[44:47]
  v_mfma_f32_16x16x32_bf16 v[56:59], v[148:151], v[80:83], v[56:59]
  v_mfma_f32_16x16x32_bf16 v[68:71], v[152:155], v[80:83], v[68:71]
  s_waitcnt lgkmcnt(0)
  v_mfma_f32_16x16x32_bf16 v[36:39], v[140:143], v[84:87], v[36:39]
  v_mfma_f32_16x16x32_bf16 v[48:51], v[144:147], v[84:87], v[48:51]
  v_mfma_f32_16x16x32_bf16 v[60:63], v[148:151], v[84:87], v[60:63]
  v_mfma_f32_16x16x32_bf16 v[72:75], v[152:155], v[84:87], v[72:75]
  v_subrev_u32 v2, 0x1e800, v2
  v_subrev_u32 v3, 0x1e800, v3
  v_subrev_u32 v4, 0x1e800, v4
  v_subrev_u32 v5, 0x1e800, v5
  v_subrev_u32 v252, 0x14800, v10
  v_subrev_u32 v253, 0x14800, v11
  s_waitcnt vmcnt(16)
  s_waitcnt lgkmcnt(0)
  s_barrier
  ds_read_b64_tr_b16 v[124:125], v2
  ds_read_b64_tr_b16 v[126:127], v2 offset:1024
  ds_read_b64_tr_b16 v[128:129], v3
  ds_read_b64_tr_b16 v[130:131], v3 offset:1024
  ds_read_b64_tr_b16 v[132:133], v4
  ds_read_b64_tr_b16 v[134:135], v4 offset:1024
  ds_read_b64_tr_b16 v[136:137], v5
  ds_read_b64_tr_b16 v[138:139], v5 offset:1024
  ds_read_b64_tr_b16 v[140:141], v6
  ds_read_b64_tr_b16 v[142:143], v6 offset:1024
  ds_read_b64_tr_b16 v[144:145], v7
  ds_read_b64_tr_b16 v[146:147], v7 offset:1024
  ds_read_b64_tr_b16 v[148:149], v8
  ds_read_b64_tr_b16 v[150:151], v8 offset:1024
  ds_read_b64_tr_b16 v[152:153], v9
  s_waitcnt lgkmcnt(14)
  ds_read_b64_tr_b16 v[154:155], v9 offset:1024
  s_lshl_b32 s39, s90, 18
  s_add_u32 s39, s39, s48
  s_mov_b32 m0, 0x6000
  s_nop 0
  buffer_load_dwordx4 v14, s[12:15], s39 offen lds
  buffer_load_dwordx4 v15, s[12:15], s39 offen offset:1024 lds
  buffer_load_dwordx4 v16, s[12:15], s39 offen offset:2048 lds
  buffer_load_dwordx4 v17, s[12:15], s39 offen offset:3072 lds
  v_pk_mul_f32 v[28:29], v[28:29], s[88:89]
  v_pk_mul_f32 v[30:31], v[30:31], s[88:89]
  v_cvt_pk_bf16_f32 v20, v28, v29
  v_cvt_pk_bf16_f32 v21, v30, v31
  s_waitcnt lgkmcnt(14)
  ds_write_b64 v13, v[20:21]
  v_pk_mul_f32 v[40:41], v[40:41], s[88:89]
  v_pk_mul_f32 v[42:43], v[42:43], s[88:89]
  v_cvt_pk_bf16_f32 v22, v40, v41
  v_cvt_pk_bf16_f32 v23, v42, v43
  s_waitcnt lgkmcnt(10)
  ds_write_b64 v13, v[22:23] offset:512
  v_pk_mul_f32 v[32:33], v[32:33], s[88:89]
  v_pk_mul_f32 v[34:35], v[34:35], s[88:89]
  v_mfma_f32_16x16x32_bf16 v[28:31], v[124:127], v[168:171], 0
  v_cvt_pk_bf16_f32 v24, v32, v33
  v_cvt_pk_bf16_f32 v25, v34, v35
  ds_write_b64 v13, v[24:25] offset:4096
  v_pk_mul_f32 v[44:45], v[44:45], s[88:89]
  v_pk_mul_f32 v[46:47], v[46:47], s[88:89]
  v_mfma_f32_16x16x32_bf16 v[40:43], v[128:131], v[168:171], 0
  v_cvt_pk_bf16_f32 v26, v44, v45
  v_cvt_pk_bf16_f32 v27, v46, v47
  ds_write_b64 v13, v[26:27] offset:4608
  v_pk_mul_f32 v[36:37], v[36:37], s[88:89]
  v_pk_mul_f32 v[38:39], v[38:39], s[88:89]
  v_mfma_f32_16x16x32_bf16 v[32:35], v[124:127], v[172:175], 0
  v_cvt_pk_bf16_f32 v20, v36, v37
  v_cvt_pk_bf16_f32 v21, v38, v39
  ds_write_b64 v13, v[20:21] offset:8192
  v_pk_mul_f32 v[48:49], v[48:49], s[88:89]
  v_pk_mul_f32 v[50:51], v[50:51], s[88:89]
  v_mfma_f32_16x16x32_bf16 v[44:47], v[128:131], v[172:175], 0
  v_cvt_pk_bf16_f32 v22, v48, v49
  v_cvt_pk_bf16_f32 v23, v50, v51
  ds_write_b64 v13, v[22:23] offset:8704
  s_add_u32 s39, s39, 131072
  s_mov_b32 m0, 0x7000
  s_nop 0
  buffer_load_dwordx4 v14, s[12:15], s39 offen lds
  buffer_load_dwordx4 v15, s[12:15], s39 offen offset:1024 lds
  buffer_load_dwordx4 v16, s[12:15], s39 offen offset:2048 lds
  buffer_load_dwordx4 v17, s[12:15], s39 offen offset:3072 lds
  s_add_u32 s90, s90, 1
  s_cmp_eq_u32 s90, 18
  s_cselect_b32 s90, 0, s90
  v_pk_mul_f32 v[52:53], v[52:53], s[88:89]
  v_pk_mul_f32 v[54:55], v[54:55], s[88:89]
  v_mfma_f32_16x16x32_bf16 v[36:39], v[124:127], v[176:179], 0
  v_cvt_pk_bf16_f32 v24, v52, v53
  v_cvt_pk_bf16_f32 v25, v54, v55
  s_waitcnt lgkmcnt(4)
  ds_write_b64 v13, v[24:25] offset:1024
  v_pk_mul_f32 v[64:65], v[64:65], s[88:89]
  v_pk_mul_f32 v[66:67], v[66:67], s[88:89]
  v_mfma_f32_16x16x32_bf16 v[48:51], v[128:131], v[176:179], 0
  v_cvt_pk_bf16_f32 v26, v64, v65
  v_cvt_pk_bf16_f32 v27, v66, v67
  ds_write_b64 v13, v[26:27] offset:1536
  v_pk_mul_f32 v[56:57], v[56:57], s[88:89]
  v_pk_mul_f32 v[58:59], v[58:59], s[88:89]
  v_mfma_f32_16x16x32_bf16 v[52:55], v[132:135], v[168:171], 0
  v_cvt_pk_bf16_f32 v20, v56, v57
  v_cvt_pk_bf16_f32 v21, v58, v59
  ds_write_b64 v13, v[20:21] offset:5120
  v_pk_mul_f32 v[68:69], v[68:69], s[88:89]
  v_pk_mul_f32 v[70:71], v[70:71], s[88:89]
  v_mfma_f32_16x16x32_bf16 v[64:67], v[136:139], v[168:171], 0
  v_cvt_pk_bf16_f32 v22, v68, v69
  v_cvt_pk_bf16_f32 v23, v70, v71
  ds_write_b64 v13, v[22:23] offset:5632
  v_pk_mul_f32 v[60:61], v[60:61], s[88:89]
  v_pk_mul_f32 v[62:63], v[62:63], s[88:89]
  v_mfma_f32_16x16x32_bf16 v[56:59], v[132:135], v[172:175], 0
  v_cvt_pk_bf16_f32 v24, v60, v61
  v_cvt_pk_bf16_f32 v25, v62, v63
  ds_write_b64 v13, v[24:25] offset:9216
  v_pk_mul_f32 v[72:73], v[72:73], s[88:89]
  v_pk_mul_f32 v[74:75], v[74:75], s[88:89]
  v_mfma_f32_16x16x32_bf16 v[68:71], v[136:139], v[172:175], 0
  v_cvt_pk_bf16_f32 v26, v72, v73
  v_cvt_pk_bf16_f32 v27, v74, v75
  ds_write_b64 v13, v[26:27] offset:9728
  v_mfma_f32_16x16x32_bf16 v[60:63], v[132:135], v[176:179], 0
  v_mfma_f32_16x16x32_bf16 v[72:75], v[136:139], v[176:179], 0
  v_mfma_f32_16x16x32_bf16 v[76:79], v[140:143], v[168:171], 0
  v_mfma_f32_16x16x32_bf16 v[88:91], v[144:147], v[168:171], 0
  v_mfma_f32_16x16x32_bf16 v[80:83], v[140:143], v[172:175], 0
  v_mfma_f32_16x16x32_bf16 v[92:95], v[144:147], v[172:175], 0
  v_mfma_f32_16x16x32_bf16 v[84:87], v[140:143], v[176:179], 0
  v_mfma_f32_16x16x32_bf16 v[96:99], v[144:147], v[176:179], 0
  v_mfma_f32_16x16x32_bf16 v[100:103], v[148:151], v[168:171], 0
  v_mfma_f32_16x16x32_bf16 v[112:115], v[152:155], v[168:171], 0
  v_mfma_f32_16x16x32_bf16 v[104:107], v[148:151], v[172:175], 0
  v_mfma_f32_16x16x32_bf16 v[116:119], v[152:155], v[172:175], 0
  v_mfma_f32_16x16x32_bf16 v[108:111], v[148:151], v[176:179], 0
  v_mfma_f32_16x16x32_bf16 v[120:123], v[152:155], v[176:179], 0
L_Bw_loop:
  s_waitcnt vmcnt(16)
  s_waitcnt lgkmcnt(0)
  s_barrier
  s_setprio 3
  ds_read_b64_tr_b16 v[124:125], v2 offset:8192
  ds_read_b64_tr_b16 v[126:127], v2 offset:9216
  ds_read_b64_tr_b16 v[128:129], v3 offset:8192
  ds_read_b64_tr_b16 v[130:131], v3 offset:9216
  ds_read_b64_tr_b16 v[132:133], v4 offset:8192
  ds_read_b64_tr_b16 v[134:135], v4 offset:9216
  ds_read_b64_tr_b16 v[136:137], v5 offset:8192
  ds_read_b64_tr_b16 v[138:139], v5 offset:9216
  ds_read_b64_tr_b16 v[140:141], v6 offset:8192
  ds_read_b64_tr_b16 v[142:143], v6 offset:9216
  ds_read_b64_tr_b16 v[144:145], v7 offset:8192
  ds_read_b64_tr_b16 v[146:147], v7 offset:9216
  ds_read_b64_tr_b16 v[148:149], v8 offset:8192
  ds_read_b64_tr_b16 v[150:151], v8 offset:9216
  ds_read_b64_tr_b16 v[152:153], v9 offset:8192
  s_waitcnt lgkmcnt(14)
  ds_read_b64_tr_b16 v[154:155], v9 offset:9216
  s_lshl_b32 s39, s90, 18
  s_add_u32 s39, s39, s48
  s_mov_b32 m0, 0x0
  s_nop 0
  buffer_load_dwordx4 v14, s[12:15], s39 offen lds
  buffer_load_dwordx4 v15, s[12:15], s39 offen offset:1024 lds
  buffer_load_dwordx4 v16, s[12:15], s39 offen offset:2048 lds
  buffer_load_dwordx4 v17, s[12:15], s39 offen offset:3072 lds
  s_waitcnt lgkmcnt(14)
  v_mfma_f32_16x16x32_bf16 v[28:31], v[124:127], v[180:183], v[28:31]
  v_mfma_f32_16x16x32_bf16 v[32:35], v[124:127], v[184:187], v[32:35]
  v_mfma_f32_16x16x32_bf16 v[36:39], v[124:127], v[188:191], v[36:39]
  s_waitcnt lgkmcnt(12)
  v_mfma_f32_16x16x32_bf16 v[40:43], v[128:131], v[180:183], v[40:43]
  v_mfma_f32_16x16x32_bf16 v[44:47], v[128:131], v[184:187], v[44:47]
  v_mfma_f32_16x16x32_bf16 v[48:51], v[128:131], v[188:191], v[48:51]
  s_add_u32 s39, s39, 131072
  s_mov_b32 m0, 0x1000
  s_nop 0
  buffer_load_dwordx4 v14, s[12:15], s39 offen lds
  buffer_load_dwordx4 v15, s[12:15], s39 offen offset:1024 lds
  buffer_load_dwordx4 v16, s[12:15], s39 offen offset:2048 lds
  buffer_load_dwordx4 v17, s[12:15], s39 offen offset:3072 lds
  s_add_u32 s90, s90, 1
  s_cmp_eq_u32 s90, 18
  s_cselect_b32 s90, 0, s90
  s_waitcnt lgkmcnt(2)
  v_mfma_f32_16x16x32_bf16 v[52:55], v[132:135], v[180:183], v[52:55]
  v_mfma_f32_16x16x32_bf16 v[56:59], v[132:135], v[184:187], v[56:59]
  v_mfma_f32_16x16x32_bf16 v[60:63], v[132:135], v[188:191], v[60:63]
  v_mfma_f32_16x16x32_bf16 v[64:67], v[136:139], v[180:183], v[64:67]
  v_mfma_f32_16x16x32_bf16 v[68:71], v[136:139], v[184:187], v[68:71]
  v_mfma_f32_16x16x32_bf16 v[72:75], v[136:139], v[188:191], v[72:75]
  v_mfma_f32_16x16x32_bf16 v[76:79], v[140:143], v[180:183], v[76:79]
  v_mfma_f32_16x16x32_bf16 v[80:83], v[140:143], v[184:187], v[80:83]
  v_mfma_f32_16x16x32_bf16 v[84:87], v[140:143], v[188:191], v[84:87]
  v_mfma_f32_16x16x32_bf16 v[88:91], v[144:147], v[180:183], v[88:91]
  v_mfma_f32_16x16x32_bf16 v[92:95], v[144:147], v[184:187], v[92:95]
  v_mfma_f32_16x16x32_bf16 v[96:99], v[144:147], v[188:191], v[96:99]
  v_mfma_f32_16x16x32_bf16 v[100:103], v[148:151], v[180:183], v[100:103]
  v_mfma_f32_16x16x32_bf16 v[104:107], v[148:151], v[184:187], v[104:107]
  v_mfma_f32_16x16x32_bf16 v[108:111], v[148:151], v[188:191], v[108:111]
  s_waitcnt lgkmcnt(0)
  v_mfma_f32_16x16x32_bf16 v[112:115], v[152:155], v[180:183], v[112:115]
  v_mfma_f32_16x16x32_bf16 v[116:119], v[152:155], v[184:187], v[116:119]
  v_mfma_f32_16x16x32_bf16 v[120:123], v[152:155], v[188:191], v[120:123]
  s_setprio 0
  s_waitcnt vmcnt(16)
  s_waitcnt lgkmcnt(0)
  s_barrier
  s_setprio 3
  ds_read_b64_tr_b16 v[124:125], v2 offset:16384
  ds_read_b64_tr_b16 v[126:127], v2 offset:17408
  ds_read_b64_tr_b16 v[128:129], v3 offset:16384
  ds_read_b64_tr_b16 v[130:131], v3 offset:17408
  ds_read_b64_tr_b16 v[132:133], v4 offset:16384
  ds_read_b64_tr_b16 v[134:135], v4 offset:17408
  ds_read_b64_tr_b16 v[136:137], v5 offset:16384
  ds_read_b64_tr_b16 v[138:139], v5 offset:17408
  ds_read_b64_tr_b16 v[140:141], v6 offset:16384
  ds_read_b64_tr_b16 v[142:143], v6 offset:17408
  ds_read_b64_tr_b16 v[144:145], v7 offset:16384
  ds_read_b64_tr_b16 v[146:147], v7 offset:17408
  ds_read_b64_tr_b16 v[148:149], v8 offset:16384
  ds_read_b64_tr_b16 v[150:151], v8 offset:17408
  ds_read_b64_tr_b16 v[152:153], v9 offset:16384
  s_waitcnt lgkmcnt(14)
  ds_read_b64_tr_b16 v[154:155], v9 offset:17408
  s_lshl_b32 s39, s90, 18
  s_add_u32 s39, s39, s48
  s_mov_b32 m0, 0x2000
  s_nop 0
  buffer_load_dwordx4 v14, s[12:15], s39 offen lds
  buffer_load_dwordx4 v15, s[12:15], s39 offen offset:1024 lds
  buffer_load_dwordx4 v16, s[12:15], s39 offen offset:2048 lds
  buffer_load_dwordx4 v17, s[12:15], s39 offen offset:3072 lds
  s_waitcnt lgkmcnt(14)
  v_mfma_f32_16x16x32_bf16 v[28:31], v[124:127], v[192:195], v[28:31]
  v_mfma_f32_16x16x32_bf16 v[32:35], v[124:127], v[196:199], v[32:35]
  v_mfma_f32_16x16x32_bf16 v[36:39], v[124:127], v[200:203], v[36:39]
  s_waitcnt lgkmcnt(12)
  v_mfma_f32_16x16x32_bf16 v[40:43], v[128:131], v[192:195], v[40:43]
  v_mfma_f32_16x16x32_bf16 v[44:47], v[128:131], v[196:199], v[44:47]
  v_mfma_f32_16x16x32_bf16 v[48:51], v[128:131], v[200:203], v[48:51]
  s_add_u32 s39, s39, 131072
  s_mov_b32 m0, 0x3000
  s_nop 0
  buffer_load_dwordx4 v14, s[12:15], s39 offen lds
  buffer_load_dwordx4 v15, s[12:15], s39 offen offset:1024 lds
  buffer_load_dwordx4 v16, s[12:15], s39 offen offset:2048 lds
  buffer_load_dwordx4 v17, s[12:15], s39 offen offset:3072 lds
  s_add_u32 s90, s90, 1
  s_cmp_eq_u32 s90, 18
  s_cselect_b32 s90, 0, s90
  s_waitcnt lgkmcnt(2)
  v_mfma_f32_16x16x32_bf16 v[52:55], v[132:135], v[192:195], v[52:55]
  v_mfma_f32_16x16x32_bf16 v[56:59], v[132:135], v[196:199], v[56:59]
  v_mfma_f32_16x16x32_bf16 v[60:63], v[132:135], v[200:203], v[60:63]
  v_mfma_f32_16x16x32_bf16 v[64:67], v[136:139], v[192:195], v[64:67]
  v_mfma_f32_16x16x32_bf16 v[68:71], v[136:139], v[196:199], v[68:71]
  v_mfma_f32_16x16x32_bf16 v[72:75], v[136:139], v[200:203], v[72:75]
  v_mfma_f32_16x16x32_bf16 v[76:79], v[140:143], v[192:195], v[76:79]
  v_mfma_f32_16x16x32_bf16 v[80:83], v[140:143], v[196:199], v[80:83]
  v_mfma_f32_16x16x32_bf16 v[84:87], v[140:143], v[200:203], v[84:87]
  v_mfma_f32_16x16x32_bf16 v[88:91], v[144:147], v[192:195], v[88:91]
  v_mfma_f32_16x16x32_bf16 v[92:95], v[144:147], v[196:199], v[92:95]
  v_mfma_f32_16x16x32_bf16 v[96:99], v[144:147], v[200:203], v[96:99]
  v_mfma_f32_16x16x32_bf16 v[100:103], v[148:151], v[192:195], v[100:103]
  v_mfma_f32_16x16x32_bf16 v[104:107], v[148:151], v[196:199], v[104:107]
  v_mfma_f32_16x16x32_bf16 v[108:111], v[148:151], v[200:203], v[108:111]
  s_waitcnt lgkmcnt(0)
  v_mfma_f32_16x16x32_bf16 v[112:115], v[152:155], v[192:195], v[112:115]
  v_mfma_f32_16x16x32_bf16 v[116:119], v[152:155], v[196:199], v[116:119]
  v_mfma_f32_16x16x32_bf16 v[120:123], v[152:155], v[200:203], v[120:123]
  s_setprio 0
  s_waitcnt vmcnt(16)
  s_waitcnt lgkmcnt(0)
  s_barrier
  s_setprio 3
  ds_read_b64_tr_b16 v[124:125], v2 offset:24576
  ds_read_b64_tr_b16 v[126:127], v2 offset:25600
  ds_read_b64_tr_b16 v[128:129], v3 offset:24576
  ds_read_b64_tr_b16 v[130:131], v3 offset:25600
  ds_read_b64_tr_b16 v[132:133], v4 offset:24576
  ds_read_b64_tr_b16 v[134:135], v4 offset:25600
  ds_read_b64_tr_b16 v[136:137], v5 offset:24576
  ds_read_b64_tr_b16 v[138:139], v5 offset:25600
  ds_read_b64_tr_b16 v[140:141], v6 offset:24576
  ds_read_b64_tr_b16 v[142:143], v6 offset:25600
  ds_read_b64_tr_b16 v[144:145], v7 offset:24576
  ds_read_b64_tr_b16 v[146:147], v7 offset:25600
  ds_read_b64_tr_b16 v[148:149], v8 offset:24576
  ds_read_b64_tr_b16 v[150:151], v8 offset:25600
  ds_read_b64_tr_b16 v[152:153], v9 offset:24576
  s_waitcnt lgkmcnt(14)
  ds_read_b64_tr_b16 v[154:155], v9 offset:25600
  s_lshl_b32 s39, s90, 18
  s_add_u32 s39, s39, s48
  s_mov_b32 m0, 0x4000
  s_nop 0
  buffer_load_dwordx4 v14, s[12:15], s39 offen lds
  buffer_load_dwordx4 v15, s[12:15], s39 offen offset:1024 lds
  buffer_load_dwordx4 v16, s[12:15], s39 offen offset:2048 lds
  buffer_load_dwordx4 v17, s[12:15], s39 offen offset:3072 lds
  s_waitcnt lgkmcnt(14)
  v_mfma_f32_16x16x32_bf16 v[28:31], v[124:127], v[204:207], v[28:31]
  v_mfma_f32_16x16x32_bf16 v[32:35], v[124:127], v[208:211], v[32:35]
  v_mfma_f32_16x16x32_bf16 v[36:39], v[124:127], v[212:215], v[36:39]
  s_waitcnt lgkmcnt(12)
  v_mfma_f32_16x16x32_bf16 v[40:43], v[128:131], v[204:207], v[40:43]
  v_mfma_f32_16x16x32_bf16 v[44:47], v[128:131], v[208:211], v[44:47]
  v_mfma_f32_16x16x32_bf16 v[48:51], v[128:131], v[212:215], v[48:51]
  s_add_u32 s39, s39, 131072
  s_mov_b32 m0, 0x5000
  s_nop 0
  buffer_load_dwordx4 v14, s[12:15], s39 offen lds
  buffer_load_dwordx4 v15, s[12:15], s39 offen offset:1024 lds
  buffer_load_dwordx4 v16, s[12:15], s39 offen offset:2048 lds
  buffer_load_dwordx4 v17, s[12:15], s39 offen offset:3072 lds
  s_add_u32 s90, s90, 1
  s_cmp_eq_u32 s90, 18
  s_cselect_b32 s90, 0, s90
  s_waitcnt lgkmcnt(2)
  v_mfma_f32_16x16x32_bf16 v[52:55], v[132:135], v[204:207], v[52:55]
  v_mfma_f32_16x16x32_bf16 v[56:59], v[132:135], v[208:211], v[56:59]
  v_mfma_f32_16x16x32_bf16 v[60:63], v[132:135], v[212:215], v[60:63]
  v_mfma_f32_16x16x32_bf16 v[64:67], v[136:139], v[204:207], v[64:67]
  v_mfma_f32_16x16x32_bf16 v[68:71], v[136:139], v[208:211], v[68:71]
  v_mfma_f32_16x16x32_bf16 v[72:75], v[136:139], v[212:215], v[72:75]
  v_mfma_f32_16x16x32_bf16 v[76:79], v[140:143], v[204:207], v[76:79]
  v_mfma_f32_16x16x32_bf16 v[80:83], v[140:143], v[208:211], v[80:83]
  v_mfma_f32_16x16x32_bf16 v[84:87], v[140:143], v[212:215], v[84:87]
  v_mfma_f32_16x16x32_bf16 v[88:91], v[144:147], v[204:207], v[88:91]
  v_mfma_f32_16x16x32_bf16 v[92:95], v[144:147], v[208:211], v[92:95]
  v_mfma_f32_16x16x32_bf16 v[96:99], v[144:147], v[212:215], v[96:99]
  v_mfma_f32_16x16x32_bf16 v[100:103], v[148:151], v[204:207], v[100:103]
  v_mfma_f32_16x16x32_bf16 v[104:107], v[148:151], v[208:211], v[104:107]
  v_mfma_f32_16x16x32_bf16 v[108:111], v[148:151], v[212:215], v[108:111]
  s_waitcnt lgkmcnt(0)
  v_mfma_f32_16x16x32_bf16 v[112:115], v[152:155], v[204:207], v[112:115]
  v_mfma_f32_16x16x32_bf16 v[116:119], v[152:155], v[208:211], v[116:119]
  v_mfma_f32_16x16x32_bf16 v[120:123], v[152:155], v[212:215], v[120:123]
  s_setprio 0
  s_waitcnt vmcnt(16)
  s_waitcnt lgkmcnt(0)
  s_barrier
  ds_read_b64_tr_b16 v[124:125], v2
  ds_read_b64_tr_b16 v[126:127], v2 offset:1024
  ds_read_b64_tr_b16 v[128:129], v3
  ds_read_b64_tr_b16 v[130:131], v3 offset:1024
  ds_read_b64_tr_b16 v[132:133], v4
  ds_read_b64_tr_b16 v[134:135], v4 offset:1024
  ds_read_b64_tr_b16 v[136:137], v5
  ds_read_b64_tr_b16 v[138:139], v5 offset:1024
  ds_read_b64_tr_b16 v[140:141], v6
  ds_read_b64_tr_b16 v[142:143], v6 offset:1024
  ds_read_b64_tr_b16 v[144:145], v7
  ds_read_b64_tr_b16 v[146:147], v7 offset:1024
  ds_read_b64_tr_b16 v[148:149], v8
  ds_read_b64_tr_b16 v[150:151], v8 offset:1024
  ds_read_b64_tr_b16 v[152:153], v9
  s_waitcnt lgkmcnt(14)
  ds_read_b64_tr_b16 v[154:155], v9 offset:1024
  s_lshl_b32 s39, s90, 18
  s_add_u32 s39, s39, s48
  s_mov_b32 m0, 0x6000
  s_nop 0
  buffer_load_dwordx4 v14, s[12:15], s39 offen lds
  buffer_load_dwordx4 v15, s[12:15], s39 offen offset:1024 lds
  buffer_load_dwordx4 v16, s[12:15], s39 offen offset:2048 lds
  buffer_load_dwordx4 v17, s[12:15], s39 offen offset:3072 lds
  s_waitcnt lgkmcnt(14)
  v_mfma_f32_16x16x32_bf16 v[28:31], v[124:127], v[216:219], v[28:31]
  v_mfma_f32_16x16x32_bf16 v[32:35], v[124:127], v[220:223], v[32:35]
  v_mfma_f32_16x16x32_bf16 v[36:39], v[124:127], v[224:227], v[36:39]
  s_waitcnt lgkmcnt(12)
  v_mfma_f32_16x16x32_bf16 v[40:43], v[128:131], v[216:219], v[40:43]
  v_mfma_f32_16x16x32_bf16 v[44:47], v[128:131], v[220:223], v[44:47]
  v_mfma_f32_16x16x32_bf16 v[48:51], v[128:131], v[224:227], v[48:51]
  s_add_u32 s39, s39, 131072
  s_mov_b32 m0, 0x7000
  s_nop 0
  buffer_load_dwordx4 v14, s[12:15], s39 offen lds
  buffer_load_dwordx4 v15, s[12:15], s39 offen offset:1024 lds
  buffer_load_dwordx4 v16, s[12:15], s39 offen offset:2048 lds
  buffer_load_dwordx4 v17, s[12:15], s39 offen offset:3072 lds
  s_add_u32 s90, s90, 1
  s_cmp_eq_u32 s90, 18
  s_cselect_b32 s90, 0, s90
  s_waitcnt lgkmcnt(2)
  v_mfma_f32_16x16x32_bf16 v[52:55], v[132:135], v[216:219], v[52:55]
  v_mfma_f32_16x16x32_bf16 v[56:59], v[132:135], v[220:223], v[56:59]
  v_mfma_f32_16x16x32_bf16 v[60:63], v[132:135], v[224:227], v[60:63]
  v_mfma_f32_16x16x32_bf16 v[64:67], v[136:139], v[216:219], v[64:67]
  v_mfma_f32_16x16x32_bf16 v[68:71], v[136:139], v[220:223], v[68:71]
  v_mfma_f32_16x16x32_bf16 v[72:75], v[136:139], v[224:227], v[72:75]
  v_mfma_f32_16x16x32_bf16 v[76:79], v[140:143], v[216:219], v[76:79]
  v_mfma_f32_16x16x32_bf16 v[80:83], v[140:143], v[220:223], v[80:83]
  v_mfma_f32_16x16x32_bf16 v[84:87], v[140:143], v[224:227], v[84:87]
  v_mfma_f32_16x16x32_bf16 v[88:91], v[144:147], v[216:219], v[88:91]
  v_mfma_f32_16x16x32_bf16 v[92:95], v[144:147], v[220:223], v[92:95]
  v_mfma_f32_16x16x32_bf16 v[96:99], v[144:147], v[224:227], v[96:99]
  v_mfma_f32_16x16x32_bf16 v[100:103], v[148:151], v[216:219], v[100:103]
  v_mfma_f32_16x16x32_bf16 v[104:107], v[148:151], v[220:223], v[104:107]
  v_mfma_f32_16x16x32_bf16 v[108:111], v[148:151], v[224:227], v[108:111]
  s_waitcnt lgkmcnt(0)
  v_mfma_f32_16x16x32_bf16 v[112:115], v[152:155], v[216:219], v[112:115]
  v_mfma_f32_16x16x32_bf16 v[116:119], v[152:155], v[220:223], v[116:119]
  v_mfma_f32_16x16x32_bf16 v[120:123], v[152:155], v[224:227], v[120:123]
  s_waitcnt vmcnt(16)
  s_waitcnt lgkmcnt(0)
  s_barrier
  ds_read_b64_tr_b16 v[124:125], v2 offset:8192
  ds_read_b64_tr_b16 v[126:127], v2 offset:9216
  ds_read_b64_tr_b16 v[128:129], v3 offset:8192
  ds_read_b64_tr_b16 v[130:131], v3 offset:9216
  ds_read_b64_tr_b16 v[132:133], v4 offset:8192
  ds_read_b64_tr_b16 v[134:135], v4 offset:9216
  ds_read_b64_tr_b16 v[136:137], v5 offset:8192
  ds_read_b64_tr_b16 v[138:139], v5 offset:9216
  ds_read_b64_tr_b16 v[140:141], v6 offset:8192
  ds_read_b64_tr_b16 v[142:143], v6 offset:9216
  ds_read_b64_tr_b16 v[144:145], v7 offset:8192
  ds_read_b64_tr_b16 v[146:147], v7 offset:9216
  ds_read_b64_tr_b16 v[148:149], v8 offset:8192
  ds_read_b64_tr_b16 v[150:151], v8 offset:9216
  ds_read_b64_tr_b16 v[152:153], v9 offset:8192
  s_waitcnt lgkmcnt(14)
  ds_read_b64_tr_b16 v[154:155], v9 offset:9216
  s_lshl_b32 s39, s90, 18
  s_add_u32 s39, s39, s48
  s_mov_b32 m0, 0x0
  s_nop 0
  buffer_load_dwordx4 v14, s[12:15], s39 offen lds
  buffer_load_dwordx4 v15, s[12:15], s39 offen offset:1024 lds
  buffer_load_dwordx4 v16, s[12:15], s39 offen offset:2048 lds
  buffer_load_dwordx4 v17, s[12:15], s39 offen offset:3072 lds
  s_waitcnt lgkmcnt(14)
  v_mfma_f32_16x16x32_bf16 v[28:31], v[124:127], v[228:231], v[28:31]
  v_mfma_f32_16x16x32_bf16 v[32:35], v[124:127], v[232:235], v[32:35]
  v_mfma_f32_16x16x32_bf16 v[36:39], v[124:127], v[236:239], v[36:39]
  s_waitcnt lgkmcnt(12)
  v_mfma_f32_16x16x32_bf16 v[40:43], v[128:131], v[228:231], v[40:43]
  v_mfma_f32_16x16x32_bf16 v[44:47], v[128:131], v[232:235], v[44:47]
  v_mfma_f32_16x16x32_bf16 v[48:51], v[128:131], v[236:239], v[48:51]
  s_add_u32 s39, s39, 131072
  s_mov_b32 m0, 0x1000
  s_nop 0
  buffer_load_dwordx4 v14, s[12:15], s39 offen lds
  buffer_load_dwordx4 v15, s[12:15], s39 offen offset:1024 lds
  buffer_load_dwordx4 v16, s[12:15], s39 offen offset:2048 lds
  buffer_load_dwordx4 v17, s[12:15], s39 offen offset:3072 lds
  s_add_u32 s90, s90, 1
  s_cmp_eq_u32 s90, 18
  s_cselect_b32 s90, 0, s90
  s_waitcnt lgkmcnt(2)
  v_mfma_f32_16x16x32_bf16 v[52:55], v[132:135], v[228:231], v[52:55]
  v_mfma_f32_16x16x32_bf16 v[56:59], v[132:135], v[232:235], v[56:59]
  v_mfma_f32_16x16x32_bf16 v[60:63], v[132:135], v[236:239], v[60:63]
  v_mfma_f32_16x16x32_bf16 v[64:67], v[136:139], v[228:231], v[64:67]
  v_mfma_f32_16x16x32_bf16 v[68:71], v[136:139], v[232:235], v[68:71]
  v_mfma_f32_16x16x32_bf16 v[72:75], v[136:139], v[236:239], v[72:75]
  v_mfma_f32_16x16x32_bf16 v[76:79], v[140:143], v[228:231], v[76:79]
  v_mfma_f32_16x16x32_bf16 v[80:83], v[140:143], v[232:235], v[80:83]
  v_mfma_f32_16x16x32_bf16 v[84:87], v[140:143], v[236:239], v[84:87]
  v_mfma_f32_16x16x32_bf16 v[88:91], v[144:147], v[228:231], v[88:91]
  v_mfma_f32_16x16x32_bf16 v[92:95], v[144:147], v[232:235], v[92:95]
  v_mfma_f32_16x16x32_bf16 v[96:99], v[144:147], v[236:239], v[96:99]
  v_mfma_f32_16x16x32_bf16 v[100:103], v[148:151], v[228:231], v[100:103]
  v_mfma_f32_16x16x32_bf16 v[104:107], v[148:151], v[232:235], v[104:107]
  v_mfma_f32_16x16x32_bf16 v[108:111], v[148:151], v[236:239], v[108:111]
  s_waitcnt lgkmcnt(0)
  v_mfma_f32_16x16x32_bf16 v[112:115], v[152:155], v[228:231], v[112:115]
  v_mfma_f32_16x16x32_bf16 v[116:119], v[152:155], v[232:235], v[116:119]
  v_mfma_f32_16x16x32_bf16 v[120:123], v[152:155], v[236:239], v[120:123]
  s_waitcnt vmcnt(16)
  s_waitcnt lgkmcnt(0)
  s_barrier
  ds_read_b128 v[156:159], v252
  ds_read_b128 v[160:163], v252 offset:2048
  ds_read_b128 v[164:167], v252 offset:4096
  ds_read_b64_tr_b16 v[124:125], v2 offset:16384
  ds_read_b64_tr_b16 v[126:127], v2 offset:17408
  ds_read_b64_tr_b16 v[128:129], v3 offset:16384
  ds_read_b64_tr_b16 v[130:131], v3 offset:17408
  ds_read_b64_tr_b16 v[132:133], v4 offset:16384
  ds_read_b64_tr_b16 v[134:135], v4 offset:17408
  ds_read_b64_tr_b16 v[136:137], v5 offset:16384
  ds_read_b64_tr_b16 v[138:139], v5 offset:17408
  ds_read_b64_tr_b16 v[140:141], v6 offset:16384
  ds_read_b64_tr_b16 v[142:143], v6 offset:17408
  ds_read_b64_tr_b16 v[144:145], v7 offset:16384
  ds_read_b64_tr_b16 v[146:147], v7 offset:17408
  s_waitcnt lgkmcnt(14)
  ds_read_b64_tr_b16 v[148:149], v8 offset:16384
  s_waitcnt lgkmcnt(14)
  ds_read_b64_tr_b16 v[150:151], v8 offset:17408
  s_waitcnt lgkmcnt(14)
  ds_read_b64_tr_b16 v[152:153], v9 offset:16384
  s_waitcnt lgkmcnt(14)
  ds_read_b64_tr_b16 v[154:155], v9 offset:17408
  s_lshl_b32 s39, s90, 18
  s_add_u32 s39, s39, s48
  s_mov_b32 m0, 0x2000
  s_nop 0
  buffer_load_dwordx4 v14, s[12:15], s39 offen lds
  buffer_load_dwordx4 v15, s[12:15], s39 offen offset:1024 lds
  buffer_load_dwordx4 v16, s[12:15], s39 offen offset:2048 lds
  buffer_load_dwordx4 v17, s[12:15], s39 offen offset:3072 lds
  s_waitcnt lgkmcnt(14)
  v_mfma_f32_16x16x32_bf16 v[28:31], v[124:127], v[156:159], v[28:31]
  v_mfma_f32_16x16x32_bf16 v[32:35], v[124:127], v[160:163], v[32:35]
  v_mfma_f32_16x16x32_bf16 v[36:39], v[124:127], v[164:167], v[36:39]
  s_waitcnt lgkmcnt(12)
  v_mfma_f32_16x16x32_bf16 v[40:43], v[128:131], v[156:159], v[40:43]
  v_mfma_f32_16x16x32_bf16 v[44:47], v[128:131], v[160:163], v[44:47]
  v_mfma_f32_16x16x32_bf16 v[48:51], v[128:131], v[164:167], v[48:51]
  s_add_u32 s39, s39, 131072
  s_mov_b32 m0, 0x3000
  s_nop 0
  buffer_load_dwordx4 v14, s[12:15], s39 offen lds
  buffer_load_dwordx4 v15, s[12:15], s39 offen offset:1024 lds
  buffer_load_dwordx4 v16, s[12:15], s39 offen offset:2048 lds
  buffer_load_dwordx4 v17, s[12:15], s39 offen offset:3072 lds
  s_add_u32 s90, s90, 1
  s_cmp_eq_u32 s90, 18
  s_cselect_b32 s90, 0, s90
  s_waitcnt lgkmcnt(2)
  v_mfma_f32_16x16x32_bf16 v[52:55], v[132:135], v[156:159], v[52:55]
  v_mfma_f32_16x16x32_bf16 v[56:59], v[132:135], v[160:163], v[56:59]
  v_mfma_f32_16x16x32_bf16 v[60:63], v[132:135], v[164:167], v[60:63]
  v_mfma_f32_16x16x32_bf16 v[64:67], v[136:139], v[156:159], v[64:67]
  v_mfma_f32_16x16x32_bf16 v[68:71], v[136:139], v[160:163], v[68:71]
  v_mfma_f32_16x16x32_bf16 v[72:75], v[136:139], v[164:167], v[72:75]
  v_mfma_f32_16x16x32_bf16 v[76:79], v[140:143], v[156:159], v[76:79]
  v_mfma_f32_16x16x32_bf16 v[80:83], v[140:143], v[160:163], v[80:83]
  v_mfma_f32_16x16x32_bf16 v[84:87], v[140:143], v[164:167], v[84:87]
  v_mfma_f32_16x16x32_bf16 v[88:91], v[144:147], v[156:159], v[88:91]
  v_mfma_f32_16x16x32_bf16 v[92:95], v[144:147], v[160:163], v[92:95]
  v_mfma_f32_16x16x32_bf16 v[96:99], v[144:147], v[164:167], v[96:99]
  v_mfma_f32_16x16x32_bf16 v[100:103], v[148:151], v[156:159], v[100:103]
  v_mfma_f32_16x16x32_bf16 v[104:107], v[148:151], v[160:163], v[104:107]
  v_mfma_f32_16x16x32_bf16 v[108:111], v[148:151], v[164:167], v[108:111]
  s_waitcnt lgkmcnt(0)
  v_mfma_f32_16x16x32_bf16 v[112:115], v[152:155], v[156:159], v[112:115]
  v_mfma_f32_16x16x32_bf16 v[116:119], v[152:155], v[160:163], v[116:119]
  v_mfma_f32_16x16x32_bf16 v[120:123], v[152:155], v[164:167], v[120:123]
  s_waitcnt vmcnt(16)
  s_waitcnt lgkmcnt(0)
  s_barrier
  ds_read_b128 v[156:159], v253
  ds_read_b128 v[160:163], v253 offset:2048
  ds_read_b128 v[164:167], v253 offset:4096
  ds_read_b64_tr_b16 v[124:125], v2 offset:24576
  ds_read_b64_tr_b16 v[126:127], v2 offset:25600
  ds_read_b64_tr_b16 v[128:129], v3 offset:24576
  ds_read_b64_tr_b16 v[130:131], v3 offset:25600
  ds_read_b64_tr_b16 v[132:133], v4 offset:24576
  ds_read_b64_tr_b16 v[134:135], v4 offset:25600
  ds_read_b64_tr_b16 v[136:137], v5 offset:24576
  ds_read_b64_tr_b16 v[138:139], v5 offset:25600
  ds_read_b64_tr_b16 v[140:141], v6 offset:24576
  ds_read_b64_tr_b16 v[142:143], v6 offset:25600
  ds_read_b64_tr_b16 v[144:145], v7 offset:24576
  ds_read_b64_tr_b16 v[146:147], v7 offset:25600
  s_waitcnt lgkmcnt(14)
  ds_read_b64_tr_b16 v[148:149], v8 offset:24576
  s_waitcnt lgkmcnt(14)
  ds_read_b64_tr_b16 v[150:151], v8 offset:25600
  s_waitcnt lgkmcnt(14)
  ds_read_b64_tr_b16 v[152:153], v9 offset:24576
  s_waitcnt lgkmcnt(14)
  ds_read_b64_tr_b16 v[154:155], v9 offset:25600
  s_lshl_b32 s39, s90, 18
  s_add_u32 s39, s39, s48
  s_mov_b32 m0, 0x4000
  s_nop 0
  buffer_load_dwordx4 v14, s[12:15], s39 offen lds
  buffer_load_dwordx4 v15, s[12:15], s39 offen offset:1024 lds
  buffer_load_dwordx4 v16, s[12:15], s39 offen offset:2048 lds
  buffer_load_dwordx4 v17, s[12:15], s39 offen offset:3072 lds
  s_waitcnt lgkmcnt(14)
  v_mfma_f32_16x16x32_bf16 v[28:31], v[124:127], v[156:159], v[28:31]
  v_mfma_f32_16x16x32_bf16 v[32:35], v[124:127], v[160:163], v[32:35]
  v_mfma_f32_16x16x32_bf16 v[36:39], v[124:127], v[164:167], v[36:39]
  s_waitcnt lgkmcnt(12)
  v_mfma_f32_16x16x32_bf16 v[40:43], v[128:131], v[156:159], v[40:43]
  v_mfma_f32_16x16x32_bf16 v[44:47], v[128:131], v[160:163], v[44:47]
  v_mfma_f32_16x16x32_bf16 v[48:51], v[128:131], v[164:167], v[48:51]
  s_add_u32 s39, s39, 131072
  s_mov_b32 m0, 0x5000
  s_nop 0
  buffer_load_dwordx4 v14, s[12:15], s39 offen lds
  buffer_load_dwordx4 v15, s[12:15], s39 offen offset:1024 lds
  buffer_load_dwordx4 v16, s[12:15], s39 offen offset:2048 lds
  buffer_load_dwordx4 v17, s[12:15], s39 offen offset:3072 lds
  s_add_u32 s90, s90, 1
  s_cmp_eq_u32 s90, 18
  s_cselect_b32 s90, 0, s90
  s_waitcnt lgkmcnt(2)
  v_mfma_f32_16x16x32_bf16 v[52:55], v[132:135], v[156:159], v[52:55]
  v_mfma_f32_16x16x32_bf16 v[56:59], v[132:135], v[160:163], v[56:59]
  v_mfma_f32_16x16x32_bf16 v[60:63], v[132:135], v[164:167], v[60:63]
  v_mfma_f32_16x16x32_bf16 v[64:67], v[136:139], v[156:159], v[64:67]
  v_mfma_f32_16x16x32_bf16 v[68:71], v[136:139], v[160:163], v[68:71]
  v_mfma_f32_16x16x32_bf16 v[72:75], v[136:139], v[164:167], v[72:75]
  v_mfma_f32_16x16x32_bf16 v[76:79], v[140:143], v[156:159], v[76:79]
  v_mfma_f32_16x16x32_bf16 v[80:83], v[140:143], v[160:163], v[80:83]
  v_mfma_f32_16x16x32_bf16 v[84:87], v[140:143], v[164:167], v[84:87]
  v_mfma_f32_16x16x32_bf16 v[88:91], v[144:147], v[156:159], v[88:91]
  v_mfma_f32_16x16x32_bf16 v[92:95], v[144:147], v[160:163], v[92:95]
  v_mfma_f32_16x16x32_bf16 v[96:99], v[144:147], v[164:167], v[96:99]
  v_mfma_f32_16x16x32_bf16 v[100:103], v[148:151], v[156:159], v[100:103]
  v_mfma_f32_16x16x32_bf16 v[104:107], v[148:151], v[160:163], v[104:107]
  v_mfma_f32_16x16x32_bf16 v[108:111], v[148:151], v[164:167], v[108:111]
  s_waitcnt lgkmcnt(0)
  v_mfma_f32_16x16x32_bf16 v[112:115], v[152:155], v[156:159], v[112:115]
  v_mfma_f32_16x16x32_bf16 v[116:119], v[152:155], v[160:163], v[116:119]
  v_mfma_f32_16x16x32_bf16 v[120:123], v[152:155], v[164:167], v[120:123]
  s_waitcnt vmcnt(16)
  s_waitcnt lgkmcnt(0)
  s_barrier
  ds_read_b128 v[156:159], v10
  ds_read_b128 v[160:163], v10 offset:2048
  ds_read_b128 v[164:167], v10 offset:4096
  ds_read_b64_tr_b16 v[124:125], v2
  ds_read_b64_tr_b16 v[126:127], v2 offset:1024
  ds_read_b64_tr_b16 v[128:129], v3
  ds_read_b64_tr_b16 v[130:131], v3 offset:1024
  ds_read_b64_tr_b16 v[132:133], v4
  ds_read_b64_tr_b16 v[134:135], v4 offset:1024
  ds_read_b64_tr_b16 v[136:137], v5
  ds_read_b64_tr_b16 v[138:139], v5 offset:1024
  ds_read_b64_tr_b16 v[140:141], v6
  ds_read_b64_tr_b16 v[142:143], v6 offset:1024
  ds_read_b64_tr_b16 v[144:145], v7
  ds_read_b64_tr_b16 v[146:147], v7 offset:1024
  s_waitcnt lgkmcnt(14)
  ds_read_b64_tr_b16 v[148:149], v8
  s_waitcnt lgkmcnt(14)
  ds_read_b64_tr_b16 v[150:151], v8 offset:1024
  s_waitcnt lgkmcnt(14)
  ds_read_b64_tr_b16 v[152:153], v9
  s_waitcnt lgkmcnt(14)
  ds_read_b64_tr_b16 v[154:155], v9 offset:1024
  s_lshl_b32 s39, s90, 18
  s_add_u32 s39, s39, s48
  s_mov_b32 m0, 0x6000
  s_nop 0
  buffer_load_dwordx4 v14, s[12:15], s39 offen lds
  buffer_load_dwordx4 v15, s[12:15], s39 offen offset:1024 lds
  buffer_load_dwordx4 v16, s[12:15], s39 offen offset:2048 lds
  buffer_load_dwordx4 v17, s[12:15], s39 offen offset:3072 lds
  s_waitcnt lgkmcnt(14)
  v_mfma_f32_16x16x32_bf16 v[28:31], v[124:127], v[156:159], v[28:31]
  v_mfma_f32_16x16x32_bf16 v[32:35], v[124:127], v[160:163], v[32:35]
  v_mfma_f32_16x16x32_bf16 v[36:39], v[124:127], v[164:167], v[36:39]
  s_waitcnt lgkmcnt(12)
  v_mfma_f32_16x16x32_bf16 v[40:43], v[128:131], v[156:159], v[40:43]
  v_mfma_f32_16x16x32_bf16 v[44:47], v[128:131], v[160:163], v[44:47]
  v_mfma_f32_16x16x32_bf16 v[48:51], v[128:131], v[164:167], v[48:51]
  s_add_u32 s39, s39, 131072
  s_mov_b32 m0, 0x7000
  s_nop 0
  buffer_load_dwordx4 v14, s[12:15], s39 offen lds
  buffer_load_dwordx4 v15, s[12:15], s39 offen offset:1024 lds
  buffer_load_dwordx4 v16, s[12:15], s39 offen offset:2048 lds
  buffer_load_dwordx4 v17, s[12:15], s39 offen offset:3072 lds
  s_add_u32 s90, s90, 1
  s_cmp_eq_u32 s90, 18
  s_cselect_b32 s90, 0, s90
  s_waitcnt lgkmcnt(2)
  v_mfma_f32_16x16x32_bf16 v[52:55], v[132:135], v[156:159], v[52:55]
  v_mfma_f32_16x16x32_bf16 v[56:59], v[132:135], v[160:163], v[56:59]
  v_mfma_f32_16x16x32_bf16 v[60:63], v[132:135], v[164:167], v[60:63]
  v_mfma_f32_16x16x32_bf16 v[64:67], v[136:139], v[156:159], v[64:67]
  v_mfma_f32_16x16x32_bf16 v[68:71], v[136:139], v[160:163], v[68:71]
  v_mfma_f32_16x16x32_bf16 v[72:75], v[136:139], v[164:167], v[72:75]
  v_mfma_f32_16x16x32_bf16 v[76:79], v[140:143], v[156:159], v[76:79]
  v_mfma_f32_16x16x32_bf16 v[80:83], v[140:143], v[160:163], v[80:83]
  v_mfma_f32_16x16x32_bf16 v[84:87], v[140:143], v[164:167], v[84:87]
  v_mfma_f32_16x16x32_bf16 v[88:91], v[144:147], v[156:159], v[88:91]
  v_mfma_f32_16x16x32_bf16 v[92:95], v[144:147], v[160:163], v[92:95]
  v_mfma_f32_16x16x32_bf16 v[96:99], v[144:147], v[164:167], v[96:99]
  v_mfma_f32_16x16x32_bf16 v[100:103], v[148:151], v[156:159], v[100:103]
  v_mfma_f32_16x16x32_bf16 v[104:107], v[148:151], v[160:163], v[104:107]
  v_mfma_f32_16x16x32_bf16 v[108:111], v[148:151], v[164:167], v[108:111]
  s_waitcnt lgkmcnt(0)
  v_mfma_f32_16x16x32_bf16 v[112:115], v[152:155], v[156:159], v[112:115]
  v_mfma_f32_16x16x32_bf16 v[116:119], v[152:155], v[160:163], v[116:119]
  v_mfma_f32_16x16x32_bf16 v[120:123], v[152:155], v[164:167], v[120:123]
  s_waitcnt vmcnt(16)
  s_waitcnt lgkmcnt(0)
  s_barrier
  ds_read_b128 v[156:159], v11
  ds_read_b128 v[160:163], v11 offset:2048
  ds_read_b128 v[164:167], v11 offset:4096
  ds_read_b64_tr_b16 v[124:125], v2 offset:8192
  ds_read_b64_tr_b16 v[126:127], v2 offset:9216
  ds_read_b64_tr_b16 v[128:129], v3 offset:8192
  ds_read_b64_tr_b16 v[130:131], v3 offset:9216
  ds_read_b64_tr_b16 v[132:133], v4 offset:8192
  ds_read_b64_tr_b16 v[134:135], v4 offset:9216
  ds_read_b64_tr_b16 v[136:137], v5 offset:8192
  ds_read_b64_tr_b16 v[138:139], v5 offset:9216
  ds_read_b64_tr_b16 v[140:141], v6 offset:8192
  ds_read_b64_tr_b16 v[142:143], v6 offset:9216
  ds_read_b64_tr_b16 v[144:145], v7 offset:8192
  ds_read_b64_tr_b16 v[146:147], v7 offset:9216
  s_waitcnt lgkmcnt(14)
  ds_read_b64_tr_b16 v[148:149], v8 offset:8192
  s_waitcnt lgkmcnt(14)
  ds_read_b64_tr_b16 v[150:151], v8 offset:9216
  s_waitcnt lgkmcnt(14)
  ds_read_b64_tr_b16 v[152:153], v9 offset:8192
  s_waitcnt lgkmcnt(14)
  ds_read_b64_tr_b16 v[154:155], v9 offset:9216
  s_lshl_b32 s39, s90, 18
  s_add_u32 s39, s39, s48
  s_mov_b32 m0, 0x8000
  s_nop 0
  buffer_load_dwordx4 v14, s[12:15], s39 offen lds
  buffer_load_dwordx4 v15, s[12:15], s39 offen offset:1024 lds
  buffer_load_dwordx4 v16, s[12:15], s39 offen offset:2048 lds
  buffer_load_dwordx4 v17, s[12:15], s39 offen offset:3072 lds
  s_waitcnt lgkmcnt(14)
  v_mfma_f32_16x16x32_bf16 v[28:31], v[124:127], v[156:159], v[28:31]
  v_mfma_f32_16x16x32_bf16 v[32:35], v[124:127], v[160:163], v[32:35]
  v_mfma_f32_16x16x32_bf16 v[36:39], v[124:127], v[164:167], v[36:39]
  s_waitcnt lgkmcnt(12)
  v_mfma_f32_16x16x32_bf16 v[40:43], v[128:131], v[156:159], v[40:43]
  v_mfma_f32_16x16x32_bf16 v[44:47], v[128:131], v[160:163], v[44:47]
  v_mfma_f32_16x16x32_bf16 v[48:51], v[128:131], v[164:167], v[48:51]
  s_add_u32 s39, s39, 131072
  s_mov_b32 m0, 0x9000
  s_nop 0
  buffer_load_dwordx4 v14, s[12:15], s39 offen lds
  buffer_load_dwordx4 v15, s[12:15], s39 offen offset:1024 lds
  buffer_load_dwordx4 v16, s[12:15], s39 offen offset:2048 lds
  buffer_load_dwordx4 v17, s[12:15], s39 offen offset:3072 lds
  s_add_u32 s90, s90, 1
  s_cmp_eq_u32 s90, 18
  s_cselect_b32 s90, 0, s90
  s_waitcnt lgkmcnt(2)
  v_mfma_f32_16x16x32_bf16 v[52:55], v[132:135], v[156:159], v[52:55]
  v_mfma_f32_16x16x32_bf16 v[56:59], v[132:135], v[160:163], v[56:59]
  v_mfma_f32_16x16x32_bf16 v[60:63], v[132:135], v[164:167], v[60:63]
  v_mfma_f32_16x16x32_bf16 v[64:67], v[136:139], v[156:159], v[64:67]
  v_mfma_f32_16x16x32_bf16 v[68:71], v[136:139], v[160:163], v[68:71]
  v_mfma_f32_16x16x32_bf16 v[72:75], v[136:139], v[164:167], v[72:75]
  v_mfma_f32_16x16x32_bf16 v[76:79], v[140:143], v[156:159], v[76:79]
  v_mfma_f32_16x16x32_bf16 v[80:83], v[140:143], v[160:163], v[80:83]
  v_mfma_f32_16x16x32_bf16 v[84:87], v[140:143], v[164:167], v[84:87]
  v_mfma_f32_16x16x32_bf16 v[88:91], v[144:147], v[156:159], v[88:91]
  v_mfma_f32_16x16x32_bf16 v[92:95], v[144:147], v[160:163], v[92:95]
  v_mfma_f32_16x16x32_bf16 v[96:99], v[144:147], v[164:167], v[96:99]
  v_mfma_f32_16x16x32_bf16 v[100:103], v[148:151], v[156:159], v[100:103]
  v_mfma_f32_16x16x32_bf16 v[104:107], v[148:151], v[160:163], v[104:107]
  v_mfma_f32_16x16x32_bf16 v[108:111], v[148:151], v[164:167], v[108:111]
  s_waitcnt lgkmcnt(0)
  v_mfma_f32_16x16x32_bf16 v[112:115], v[152:155], v[156:159], v[112:115]
  v_mfma_f32_16x16x32_bf16 v[116:119], v[152:155], v[160:163], v[116:119]
  v_mfma_f32_16x16x32_bf16 v[120:123], v[152:155], v[164:167], v[120:123]
  s_waitcnt vmcnt(16)
  s_waitcnt lgkmcnt(0)
  s_barrier
  ds_read_b128 v[156:159], v10 offset:18432
  ds_read_b128 v[160:163], v10 offset:20480
  ds_read_b128 v[164:167], v10 offset:22528
  ds_read_b64_tr_b16 v[124:125], v2 offset:16384
  ds_read_b64_tr_b16 v[126:127], v2 offset:17408
  ds_read_b64_tr_b16 v[128:129], v3 offset:16384
  ds_read_b64_tr_b16 v[130:131], v3 offset:17408
  ds_read_b64_tr_b16 v[132:133], v4 offset:16384
  ds_read_b64_tr_b16 v[134:135], v4 offset:17408
  ds_read_b64_tr_b16 v[136:137], v5 offset:16384
  ds_read_b64_tr_b16 v[138:139], v5 offset:17408
  ds_read_b64_tr_b16 v[140:141], v6 offset:16384
  ds_read_b64_tr_b16 v[142:143], v6 offset:17408
  ds_read_b64_tr_b16 v[144:145], v7 offset:16384
  ds_read_b64_tr_b16 v[146:147], v7 offset:17408
  s_waitcnt lgkmcnt(14)
  ds_read_b64_tr_b16 v[148:149], v8 offset:16384
  s_waitcnt lgkmcnt(14)
  ds_read_b64_tr_b16 v[150:151], v8 offset:17408
  s_waitcnt lgkmcnt(14)
  ds_read_b64_tr_b16 v[152:153], v9 offset:16384
  s_waitcnt lgkmcnt(14)
  ds_read_b64_tr_b16 v[154:155], v9 offset:17408
  s_lshl_b32 s39, s90, 18
  s_add_u32 s39, s39, s48
  s_mov_b32 m0, 0x0
  s_nop 0
  buffer_load_dwordx4 v14, s[12:15], s39 offen lds
  buffer_load_dwordx4 v15, s[12:15], s39 offen offset:1024 lds
  buffer_load_dwordx4 v16, s[12:15], s39 offen offset:2048 lds
  buffer_load_dwordx4 v17, s[12:15], s39 offen offset:3072 lds
  s_waitcnt lgkmcnt(14)
  v_mfma_f32_16x16x32_bf16 v[28:31], v[124:127], v[156:159], v[28:31]
  v_mfma_f32_16x16x32_bf16 v[32:35], v[124:127], v[160:163], v[32:35]
  v_mfma_f32_16x16x32_bf16 v[36:39], v[124:127], v[164:167], v[36:39]
  s_waitcnt lgkmcnt(12)
  v_mfma_f32_16x16x32_bf16 v[40:43], v[128:131], v[156:159], v[40:43]
  v_mfma_f32_16x16x32_bf16 v[44:47], v[128:131], v[160:163], v[44:47]
  v_mfma_f32_16x16x32_bf16 v[48:51], v[128:131], v[164:167], v[48:51]
  s_add_u32 s39, s39, 131072
  s_mov_b32 m0, 0x1000
  s_nop 0
  buffer_load_dwordx4 v14, s[12:15], s39 offen lds
  buffer_load_dwordx4 v15, s[12:15], s39 offen offset:1024 lds
  buffer_load_dwordx4 v16, s[12:15], s39 offen offset:2048 lds
  buffer_load_dwordx4 v17, s[12:15], s39 offen offset:3072 lds
  s_add_u32 s90, s90, 1
  s_cmp_eq_u32 s90, 18
  s_cselect_b32 s90, 0, s90
  s_waitcnt lgkmcnt(2)
  v_mfma_f32_16x16x32_bf16 v[52:55], v[132:135], v[156:159], v[52:55]
  v_mfma_f32_16x16x32_bf16 v[56:59], v[132:135], v[160:163], v[56:59]
  v_mfma_f32_16x16x32_bf16 v[60:63], v[132:135], v[164:167], v[60:63]
  v_mfma_f32_16x16x32_bf16 v[64:67], v[136:139], v[156:159], v[64:67]
  v_mfma_f32_16x16x32_bf16 v[68:71], v[136:139], v[160:163], v[68:71]
  v_mfma_f32_16x16x32_bf16 v[72:75], v[136:139], v[164:167], v[72:75]
  v_mfma_f32_16x16x32_bf16 v[76:79], v[140:143], v[156:159], v[76:79]
  v_mfma_f32_16x16x32_bf16 v[80:83], v[140:143], v[160:163], v[80:83]
  v_mfma_f32_16x16x32_bf16 v[84:87], v[140:143], v[164:167], v[84:87]
  v_mfma_f32_16x16x32_bf16 v[88:91], v[144:147], v[156:159], v[88:91]
  v_mfma_f32_16x16x32_bf16 v[92:95], v[144:147], v[160:163], v[92:95]
  v_mfma_f32_16x16x32_bf16 v[96:99], v[144:147], v[164:167], v[96:99]
  v_mfma_f32_16x16x32_bf16 v[100:103], v[148:151], v[156:159], v[100:103]
  v_mfma_f32_16x16x32_bf16 v[104:107], v[148:151], v[160:163], v[104:107]
  v_mfma_f32_16x16x32_bf16 v[108:111], v[148:151], v[164:167], v[108:111]
  s_waitcnt lgkmcnt(0)
  v_mfma_f32_16x16x32_bf16 v[112:115], v[152:155], v[156:159], v[112:115]
  v_mfma_f32_16x16x32_bf16 v[116:119], v[152:155], v[160:163], v[116:119]
  v_mfma_f32_16x16x32_bf16 v[120:123], v[152:155], v[164:167], v[120:123]
  s_waitcnt vmcnt(16)
  s_waitcnt lgkmcnt(0)
  s_barrier
  ds_read_b128 v[156:159], v11 offset:18432
  ds_read_b128 v[160:163], v11 offset:20480
  ds_read_b128 v[164:167], v11 offset:22528
  ds_read_b64_tr_b16 v[124:125], v2 offset:24576
  ds_read_b64_tr_b16 v[126:127], v2 offset:25600
  ds_read_b64_tr_b16 v[128:129], v3 offset:24576
  ds_read_b64_tr_b16 v[130:131], v3 offset:25600
  ds_read_b64_tr_b16 v[132:133], v4 offset:24576
  ds_read_b64_tr_b16 v[134:135], v4 offset:25600
  ds_read_b64_tr_b16 v[136:137], v5 offset:24576
  ds_read_b64_tr_b16 v[138:139], v5 offset:25600
  ds_read_b64_tr_b16 v[140:141], v6 offset:24576
  ds_read_b64_tr_b16 v[142:143], v6 offset:25600
  ds_read_b64_tr_b16 v[144:145], v7 offset:24576
  ds_read_b64_tr_b16 v[146:147], v7 offset:25600
  s_waitcnt lgkmcnt(14)
  ds_read_b64_tr_b16 v[148:149], v8 offset:24576
  s_waitcnt lgkmcnt(14)
  ds_read_b64_tr_b16 v[150:151], v8 offset:25600
  s_waitcnt lgkmcnt(14)
  ds_read_b64_tr_b16 v[152:153], v9 offset:24576
  s_waitcnt lgkmcnt(14)
  ds_read_b64_tr_b16 v[154:155], v9 offset:25600
  s_lshl_b32 s39, s90, 18
  s_add_u32 s39, s39, s48
  s_mov_b32 m0, 0x2000
  s_nop 0
  buffer_load_dwordx4 v14, s[12:15], s39 offen lds
  buffer_load_dwordx4 v15, s[12:15], s39 offen offset:1024 lds
  buffer_load_dwordx4 v16, s[12:15], s39 offen offset:2048 lds
  buffer_load_dwordx4 v17, s[12:15], s39 offen offset:3072 lds
  s_waitcnt lgkmcnt(14)
  v_mfma_f32_16x16x32_bf16 v[28:31], v[124:127], v[156:159], v[28:31]
  v_mfma_f32_16x16x32_bf16 v[32:35], v[124:127], v[160:163], v[32:35]
  v_mfma_f32_16x16x32_bf16 v[36:39], v[124:127], v[164:167], v[36:39]
  s_waitcnt lgkmcnt(12)
  v_mfma_f32_16x16x32_bf16 v[40:43], v[128:131], v[156:159], v[40:43]
  v_mfma_f32_16x16x32_bf16 v[44:47], v[128:131], v[160:163], v[44:47]
  v_mfma_f32_16x16x32_bf16 v[48:51], v[128:131], v[164:167], v[48:51]
  s_add_u32 s39, s39, 131072
  s_mov_b32 m0, 0x3000
  s_nop 0
  buffer_load_dwordx4 v14, s[12:15], s39 offen lds
  buffer_load_dwordx4 v15, s[12:15], s39 offen offset:1024 lds
  buffer_load_dwordx4 v16, s[12:15], s39 offen offset:2048 lds
  buffer_load_dwordx4 v17, s[12:15], s39 offen offset:3072 lds
  s_add_u32 s90, s90, 1
  s_cmp_eq_u32 s90, 18
  s_cselect_b32 s90, 0, s90
  s_waitcnt lgkmcnt(2)
  v_mfma_f32_16x16x32_bf16 v[52:55], v[132:135], v[156:159], v[52:55]
  v_mfma_f32_16x16x32_bf16 v[56:59], v[132:135], v[160:163], v[56:59]
  v_mfma_f32_16x16x32_bf16 v[60:63], v[132:135], v[164:167], v[60:63]
  v_mfma_f32_16x16x32_bf16 v[64:67], v[136:139], v[156:159], v[64:67]
  v_mfma_f32_16x16x32_bf16 v[68:71], v[136:139], v[160:163], v[68:71]
  v_mfma_f32_16x16x32_bf16 v[72:75], v[136:139], v[164:167], v[72:75]
  v_mfma_f32_16x16x32_bf16 v[76:79], v[140:143], v[156:159], v[76:79]
  v_mfma_f32_16x16x32_bf16 v[80:83], v[140:143], v[160:163], v[80:83]
  v_mfma_f32_16x16x32_bf16 v[84:87], v[140:143], v[164:167], v[84:87]
  v_mfma_f32_16x16x32_bf16 v[88:91], v[144:147], v[156:159], v[88:91]
  v_mfma_f32_16x16x32_bf16 v[92:95], v[144:147], v[160:163], v[92:95]
  v_mfma_f32_16x16x32_bf16 v[96:99], v[144:147], v[164:167], v[96:99]
  v_mfma_f32_16x16x32_bf16 v[100:103], v[148:151], v[156:159], v[100:103]
  v_mfma_f32_16x16x32_bf16 v[104:107], v[148:151], v[160:163], v[104:107]
  v_mfma_f32_16x16x32_bf16 v[108:111], v[148:151], v[164:167], v[108:111]
  s_waitcnt lgkmcnt(0)
  v_mfma_f32_16x16x32_bf16 v[112:115], v[152:155], v[156:159], v[112:115]
  v_mfma_f32_16x16x32_bf16 v[116:119], v[152:155], v[160:163], v[116:119]
  v_mfma_f32_16x16x32_bf16 v[120:123], v[152:155], v[164:167], v[120:123]
  s_waitcnt vmcnt(16)
  s_waitcnt lgkmcnt(0)
  s_barrier
  ds_read_b128 v[156:159], v10
  ds_read_b128 v[160:163], v10 offset:2048
  ds_read_b128 v[164:167], v10 offset:4096
  ds_read_b64_tr_b16 v[124:125], v2 offset:32768
  ds_read_b64_tr_b16 v[126:127], v2 offset:33792
  ds_read_b64_tr_b16 v[128:129], v3 offset:32768
  ds_read_b64_tr_b16 v[130:131], v3 offset:33792
  ds_read_b64_tr_b16 v[132:133], v4 offset:32768
  ds_read_b64_tr_b16 v[134:135], v4 offset:33792
  ds_read_b64_tr_b16 v[136:137], v5 offset:32768
  ds_read_b64_tr_b16 v[138:139], v5 offset:33792
  ds_read_b64_tr_b16 v[140:141], v6 offset:32768
  ds_read_b64_tr_b16 v[142:143], v6 offset:33792
  ds_read_b64_tr_b16 v[144:145], v7 offset:32768
  ds_read_b64_tr_b16 v[146:147], v7 offset:33792
  s_waitcnt lgkmcnt(14)
  ds_read_b64_tr_b16 v[148:149], v8 offset:32768
  s_waitcnt lgkmcnt(14)
  ds_read_b64_tr_b16 v[150:151], v8 offset:33792
  s_waitcnt lgkmcnt(14)
  ds_read_b64_tr_b16 v[152:153], v9 offset:32768
  s_waitcnt lgkmcnt(14)
  ds_read_b64_tr_b16 v[154:155], v9 offset:33792
  s_lshl_b32 s39, s90, 18
  s_add_u32 s39, s39, s48
  s_mov_b32 m0, 0x4000
  s_nop 0
  buffer_load_dwordx4 v14, s[12:15], s39 offen lds
  buffer_load_dwordx4 v15, s[12:15], s39 offen offset:1024 lds
  buffer_load_dwordx4 v16, s[12:15], s39 offen offset:2048 lds
  buffer_load_dwordx4 v17, s[12:15], s39 offen offset:3072 lds
  s_waitcnt lgkmcnt(14)
  v_mfma_f32_16x16x32_bf16 v[28:31], v[124:127], v[156:159], v[28:31]
  v_mfma_f32_16x16x32_bf16 v[32:35], v[124:127], v[160:163], v[32:35]
  v_mfma_f32_16x16x32_bf16 v[36:39], v[124:127], v[164:167], v[36:39]
  s_waitcnt lgkmcnt(12)
  v_mfma_f32_16x16x32_bf16 v[40:43], v[128:131], v[156:159], v[40:43]
  v_mfma_f32_16x16x32_bf16 v[44:47], v[128:131], v[160:163], v[44:47]
  v_mfma_f32_16x16x32_bf16 v[48:51], v[128:131], v[164:167], v[48:51]
  s_add_u32 s39, s39, 131072
  s_mov_b32 m0, 0x5000
  s_nop 0
  buffer_load_dwordx4 v14, s[12:15], s39 offen lds
  buffer_load_dwordx4 v15, s[12:15], s39 offen offset:1024 lds
  buffer_load_dwordx4 v16, s[12:15], s39 offen offset:2048 lds
  buffer_load_dwordx4 v17, s[12:15], s39 offen offset:3072 lds
  s_add_u32 s90, s90, 1
  s_cmp_eq_u32 s90, 18
  s_cselect_b32 s90, 0, s90
  s_waitcnt lgkmcnt(2)
  v_mfma_f32_16x16x32_bf16 v[52:55], v[132:135], v[156:159], v[52:55]
  v_mfma_f32_16x16x32_bf16 v[56:59], v[132:135], v[160:163], v[56:59]
  v_mfma_f32_16x16x32_bf16 v[60:63], v[132:135], v[164:167], v[60:63]
  v_mfma_f32_16x16x32_bf16 v[64:67], v[136:139], v[156:159], v[64:67]
  v_mfma_f32_16x16x32_bf16 v[68:71], v[136:139], v[160:163], v[68:71]
  v_mfma_f32_16x16x32_bf16 v[72:75], v[136:139], v[164:167], v[72:75]
  v_mfma_f32_16x16x32_bf16 v[76:79], v[140:143], v[156:159], v[76:79]
  v_mfma_f32_16x16x32_bf16 v[80:83], v[140:143], v[160:163], v[80:83]
  v_mfma_f32_16x16x32_bf16 v[84:87], v[140:143], v[164:167], v[84:87]
  v_mfma_f32_16x16x32_bf16 v[88:91], v[144:147], v[156:159], v[88:91]
  v_mfma_f32_16x16x32_bf16 v[92:95], v[144:147], v[160:163], v[92:95]
  v_mfma_f32_16x16x32_bf16 v[96:99], v[144:147], v[164:167], v[96:99]
  v_mfma_f32_16x16x32_bf16 v[100:103], v[148:151], v[156:159], v[100:103]
  v_mfma_f32_16x16x32_bf16 v[104:107], v[148:151], v[160:163], v[104:107]
  v_mfma_f32_16x16x32_bf16 v[108:111], v[148:151], v[164:167], v[108:111]
  s_waitcnt lgkmcnt(0)
  v_mfma_f32_16x16x32_bf16 v[112:115], v[152:155], v[156:159], v[112:115]
  v_mfma_f32_16x16x32_bf16 v[116:119], v[152:155], v[160:163], v[116:119]
  v_mfma_f32_16x16x32_bf16 v[120:123], v[152:155], v[164:167], v[120:123]
  s_waitcnt vmcnt(16)
  s_waitcnt lgkmcnt(0)
  s_barrier
  ds_read_b128 v[156:159], v11
  ds_read_b128 v[160:163], v11 offset:2048
  ds_read_b128 v[164:167], v11 offset:4096
  ds_read_b64_tr_b16 v[124:125], v2
  ds_read_b64_tr_b16 v[126:127], v2 offset:1024
  ds_read_b64_tr_b16 v[128:129], v3
  ds_read_b64_tr_b16 v[130:131], v3 offset:1024
  ds_read_b64_tr_b16 v[132:133], v4
  ds_read_b64_tr_b16 v[134:135], v4 offset:1024
  ds_read_b64_tr_b16 v[136:137], v5
  ds_read_b64_tr_b16 v[138:139], v5 offset:1024
  ds_read_b64_tr_b16 v[140:141], v6
  ds_read_b64_tr_b16 v[142:143], v6 offset:1024
  ds_read_b64_tr_b16 v[144:145], v7
  ds_read_b64_tr_b16 v[146:147], v7 offset:1024
  s_waitcnt lgkmcnt(14)
  ds_read_b64_tr_b16 v[148:149], v8
  s_waitcnt lgkmcnt(14)
  ds_read_b64_tr_b16 v[150:151], v8 offset:1024
  s_waitcnt lgkmcnt(14)
  ds_read_b64_tr_b16 v[152:153], v9
  s_waitcnt lgkmcnt(14)
  ds_read_b64_tr_b16 v[154:155], v9 offset:1024
  s_lshl_b32 s39, s90, 18
  s_add_u32 s39, s39, s48
  s_mov_b32 m0, 0x6000
  s_nop 0
  buffer_load_dwordx4 v14, s[12:15], s39 offen lds
  buffer_load_dwordx4 v15, s[12:15], s39 offen offset:1024 lds
  buffer_load_dwordx4 v16, s[12:15], s39 offen offset:2048 lds
  buffer_load_dwordx4 v17, s[12:15], s39 offen offset:3072 lds
  s_waitcnt lgkmcnt(14)
  v_mfma_f32_16x16x32_bf16 v[28:31], v[124:127], v[156:159], v[28:31]
  v_mfma_f32_16x16x32_bf16 v[32:35], v[124:127], v[160:163], v[32:35]
  v_mfma_f32_16x16x32_bf16 v[36:39], v[124:127], v[164:167], v[36:39]
  s_waitcnt lgkmcnt(12)
  v_mfma_f32_16x16x32_bf16 v[40:43], v[128:131], v[156:159], v[40:43]
  v_mfma_f32_16x16x32_bf16 v[44:47], v[128:131], v[160:163], v[44:47]
  v_mfma_f32_16x16x32_bf16 v[48:51], v[128:131], v[164:167], v[48:51]
  s_add_u32 s39, s39, 131072
  s_mov_b32 m0, 0x7000
  s_nop 0
  buffer_load_dwordx4 v14, s[12:15], s39 offen lds
  buffer_load_dwordx4 v15, s[12:15], s39 offen offset:1024 lds
  buffer_load_dwordx4 v16, s[12:15], s39 offen offset:2048 lds
  buffer_load_dwordx4 v17, s[12:15], s39 offen offset:3072 lds
  s_add_u32 s90, s90, 1
  s_cmp_eq_u32 s90, 18
  s_cselect_b32 s90, 0, s90
  s_waitcnt lgkmcnt(2)
  v_mfma_f32_16x16x32_bf16 v[52:55], v[132:135], v[156:159], v[52:55]
  v_mfma_f32_16x16x32_bf16 v[56:59], v[132:135], v[160:163], v[56:59]
  v_mfma_f32_16x16x32_bf16 v[60:63], v[132:135], v[164:167], v[60:63]
  v_mfma_f32_16x16x32_bf16 v[64:67], v[136:139], v[156:159], v[64:67]
  v_mfma_f32_16x16x32_bf16 v[68:71], v[136:139], v[160:163], v[68:71]
  v_mfma_f32_16x16x32_bf16 v[72:75], v[136:139], v[164:167], v[72:75]
  v_mfma_f32_16x16x32_bf16 v[76:79], v[140:143], v[156:159], v[76:79]
  v_mfma_f32_16x16x32_bf16 v[80:83], v[140:143], v[160:163], v[80:83]
  v_mfma_f32_16x16x32_bf16 v[84:87], v[140:143], v[164:167], v[84:87]
  v_mfma_f32_16x16x32_bf16 v[88:91], v[144:147], v[156:159], v[88:91]
  v_mfma_f32_16x16x32_bf16 v[92:95], v[144:147], v[160:163], v[92:95]
  v_mfma_f32_16x16x32_bf16 v[96:99], v[144:147], v[164:167], v[96:99]
  v_mfma_f32_16x16x32_bf16 v[100:103], v[148:151], v[156:159], v[100:103]
  v_mfma_f32_16x16x32_bf16 v[104:107], v[148:151], v[160:163], v[104:107]
  v_mfma_f32_16x16x32_bf16 v[108:111], v[148:151], v[164:167], v[108:111]
  s_waitcnt lgkmcnt(0)
  v_mfma_f32_16x16x32_bf16 v[112:115], v[152:155], v[156:159], v[112:115]
  v_mfma_f32_16x16x32_bf16 v[116:119], v[152:155], v[160:163], v[116:119]
  v_mfma_f32_16x16x32_bf16 v[120:123], v[152:155], v[164:167], v[120:123]
  s_waitcnt vmcnt(16)
  s_waitcnt lgkmcnt(0)
  s_barrier
  ds_read_b128 v[156:159], v10 offset:18432
  ds_read_b128 v[160:163], v10 offset:20480
  ds_read_b128 v[164:167], v10 offset:22528
  ds_read_b64_tr_b16 v[124:125], v2 offset:8192
  ds_read_b64_tr_b16 v[126:127], v2 offset:9216
  ds_read_b64_tr_b16 v[128:129], v3 offset:8192
  ds_read_b64_tr_b16 v[130:131], v3 offset:9216
  ds_read_b64_tr_b16 v[132:133], v4 offset:8192
  ds_read_b64_tr_b16 v[134:135], v4 offset:9216
  ds_read_b64_tr_b16 v[136:137], v5 offset:8192
  ds_read_b64_tr_b16 v[138:139], v5 offset:9216
  ds_read_b64_tr_b16 v[140:141], v6 offset:8192
  ds_read_b64_tr_b16 v[142:143], v6 offset:9216
  ds_read_b64_tr_b16 v[144:145], v7 offset:8192
  ds_read_b64_tr_b16 v[146:147], v7 offset:9216
  s_waitcnt lgkmcnt(14)
  ds_read_b64_tr_b16 v[148:149], v8 offset:8192
  s_waitcnt lgkmcnt(14)
  ds_read_b64_tr_b16 v[150:151], v8 offset:9216
  s_waitcnt lgkmcnt(14)
  ds_read_b64_tr_b16 v[152:153], v9 offset:8192
  s_waitcnt lgkmcnt(14)
  ds_read_b64_tr_b16 v[154:155], v9 offset:9216
  s_lshl_b32 s39, s90, 18
  s_add_u32 s39, s39, s48
  s_mov_b32 m0, 0x8000
  s_nop 0
  buffer_load_dwordx4 v14, s[12:15], s39 offen lds
  buffer_load_dwordx4 v15, s[12:15], s39 offen offset:1024 lds
  buffer_load_dwordx4 v16, s[12:15], s39 offen offset:2048 lds
  buffer_load_dwordx4 v17, s[12:15], s39 offen offset:3072 lds
  s_waitcnt lgkmcnt(14)
  v_mfma_f32_16x16x32_bf16 v[28:31], v[124:127], v[156:159], v[28:31]
  v_mfma_f32_16x16x32_bf16 v[32:35], v[124:127], v[160:163], v[32:35]
  v_mfma_f32_16x16x32_bf16 v[36:39], v[124:127], v[164:167], v[36:39]
  s_waitcnt lgkmcnt(12)
  v_mfma_f32_16x16x32_bf16 v[40:43], v[128:131], v[156:159], v[40:43]
  v_mfma_f32_16x16x32_bf16 v[44:47], v[128:131], v[160:163], v[44:47]
  v_mfma_f32_16x16x32_bf16 v[48:51], v[128:131], v[164:167], v[48:51]
  s_add_u32 s39, s39, 131072
  s_mov_b32 m0, 0x9000
  s_nop 0
  buffer_load_dwordx4 v14, s[12:15], s39 offen lds
  buffer_load_dwordx4 v15, s[12:15], s39 offen offset:1024 lds
  buffer_load_dwordx4 v16, s[12:15], s39 offen offset:2048 lds
  buffer_load_dwordx4 v17, s[12:15], s39 offen offset:3072 lds
  s_add_u32 s90, s90, 1
  s_cmp_eq_u32 s90, 18
  s_cselect_b32 s90, 0, s90
  s_waitcnt lgkmcnt(2)
  v_mfma_f32_16x16x32_bf16 v[52:55], v[132:135], v[156:159], v[52:55]
  v_mfma_f32_16x16x32_bf16 v[56:59], v[132:135], v[160:163], v[56:59]
  v_mfma_f32_16x16x32_bf16 v[60:63], v[132:135], v[164:167], v[60:63]
  v_mfma_f32_16x16x32_bf16 v[64:67], v[136:139], v[156:159], v[64:67]
  v_mfma_f32_16x16x32_bf16 v[68:71], v[136:139], v[160:163], v[68:71]
  v_mfma_f32_16x16x32_bf16 v[72:75], v[136:139], v[164:167], v[72:75]
  v_mfma_f32_16x16x32_bf16 v[76:79], v[140:143], v[156:159], v[76:79]
  v_mfma_f32_16x16x32_bf16 v[80:83], v[140:143], v[160:163], v[80:83]
  v_mfma_f32_16x16x32_bf16 v[84:87], v[140:143], v[164:167], v[84:87]
  v_mfma_f32_16x16x32_bf16 v[88:91], v[144:147], v[156:159], v[88:91]
  v_mfma_f32_16x16x32_bf16 v[92:95], v[144:147], v[160:163], v[92:95]
  v_mfma_f32_16x16x32_bf16 v[96:99], v[144:147], v[164:167], v[96:99]
  v_mfma_f32_16x16x32_bf16 v[100:103], v[148:151], v[156:159], v[100:103]
  v_mfma_f32_16x16x32_bf16 v[104:107], v[148:151], v[160:163], v[104:107]
  v_mfma_f32_16x16x32_bf16 v[108:111], v[148:151], v[164:167], v[108:111]
  s_waitcnt lgkmcnt(0)
  v_mfma_f32_16x16x32_bf16 v[112:115], v[152:155], v[156:159], v[112:115]
  v_mfma_f32_16x16x32_bf16 v[116:119], v[152:155], v[160:163], v[116:119]
  v_mfma_f32_16x16x32_bf16 v[120:123], v[152:155], v[164:167], v[120:123]
  s_waitcnt vmcnt(16)
  s_waitcnt lgkmcnt(0)
  s_barrier
  ds_read_b128 v[156:159], v11 offset:18432
  ds_read_b128 v[160:163], v11 offset:20480
  ds_read_b128 v[164:167], v11 offset:22528
  ds_read_b64_tr_b16 v[124:125], v2 offset:16384
  ds_read_b64_tr_b16 v[126:127], v2 offset:17408
  ds_read_b64_tr_b16 v[128:129], v3 offset:16384
  ds_read_b64_tr_b16 v[130:131], v3 offset:17408
  ds_read_b64_tr_b16 v[132:133], v4 offset:16384
  ds_read_b64_tr_b16 v[134:135], v4 offset:17408
  ds_read_b64_tr_b16 v[136:137], v5 offset:16384
  ds_read_b64_tr_b16 v[138:139], v5 offset:17408
  ds_read_b64_tr_b16 v[140:141], v6 offset:16384
  ds_read_b64_tr_b16 v[142:143], v6 offset:17408
  ds_read_b64_tr_b16 v[144:145], v7 offset:16384
  ds_read_b64_tr_b16 v[146:147], v7 offset:17408
  s_waitcnt lgkmcnt(14)
  ds_read_b64_tr_b16 v[148:149], v8 offset:16384
  s_waitcnt lgkmcnt(14)
  ds_read_b64_tr_b16 v[150:151], v8 offset:17408
  s_waitcnt lgkmcnt(14)
  ds_read_b64_tr_b16 v[152:153], v9 offset:16384
  s_waitcnt lgkmcnt(14)
  ds_read_b64_tr_b16 v[154:155], v9 offset:17408
  s_lshl_b32 s39, s90, 18
  s_add_u32 s39, s39, s49
  s_add_u32 m0, s92, 0x0
  s_nop 0
  buffer_load_dwordx4 v14, s[12:15], s39 offen lds
  buffer_load_dwordx4 v15, s[12:15], s39 offen offset:1024 lds
  buffer_load_dwordx4 v16, s[12:15], s39 offen offset:2048 lds
  buffer_load_dwordx4 v17, s[12:15], s39 offen offset:3072 lds
  s_waitcnt lgkmcnt(14)
  v_mfma_f32_16x16x32_bf16 v[28:31], v[124:127], v[156:159], v[28:31]
  v_mfma_f32_16x16x32_bf16 v[32:35], v[124:127], v[160:163], v[32:35]
  v_mfma_f32_16x16x32_bf16 v[36:39], v[124:127], v[164:167], v[36:39]
  s_waitcnt lgkmcnt(12)
  v_mfma_f32_16x16x32_bf16 v[40:43], v[128:131], v[156:159], v[40:43]
  v_mfma_f32_16x16x32_bf16 v[44:47], v[128:131], v[160:163], v[44:47]
  v_mfma_f32_16x16x32_bf16 v[48:51], v[128:131], v[164:167], v[48:51]
  s_add_u32 s39, s39, 131072
  s_add_u32 m0, s92, 0x1000
  s_nop 0
  buffer_load_dwordx4 v14, s[12:15], s39 offen lds
  buffer_load_dwordx4 v15, s[12:15], s39 offen offset:1024 lds
  buffer_load_dwordx4 v16, s[12:15], s39 offen offset:2048 lds
  buffer_load_dwordx4 v17, s[12:15], s39 offen offset:3072 lds
  s_add_u32 s90, s90, 1
  s_cmp_eq_u32 s90, 18
  s_cselect_b32 s90, 0, s90
  s_waitcnt lgkmcnt(2)
  v_mfma_f32_16x16x32_bf16 v[52:55], v[132:135], v[156:159], v[52:55]
  v_mfma_f32_16x16x32_bf16 v[56:59], v[132:135], v[160:163], v[56:59]
  v_mfma_f32_16x16x32_bf16 v[60:63], v[132:135], v[164:167], v[60:63]
  v_mfma_f32_16x16x32_bf16 v[64:67], v[136:139], v[156:159], v[64:67]
  v_mfma_f32_16x16x32_bf16 v[68:71], v[136:139], v[160:163], v[68:71]
  v_mfma_f32_16x16x32_bf16 v[72:75], v[136:139], v[164:167], v[72:75]
  v_mfma_f32_16x16x32_bf16 v[76:79], v[140:143], v[156:159], v[76:79]
  v_mfma_f32_16x16x32_bf16 v[80:83], v[140:143], v[160:163], v[80:83]
  v_mfma_f32_16x16x32_bf16 v[84:87], v[140:143], v[164:167], v[84:87]
  v_mfma_f32_16x16x32_bf16 v[88:91], v[144:147], v[156:159], v[88:91]
  v_mfma_f32_16x16x32_bf16 v[92:95], v[144:147], v[160:163], v[92:95]
  v_mfma_f32_16x16x32_bf16 v[96:99], v[144:147], v[164:167], v[96:99]
  v_mfma_f32_16x16x32_bf16 v[100:103], v[148:151], v[156:159], v[100:103]
  v_mfma_f32_16x16x32_bf16 v[104:107], v[148:151], v[160:163], v[104:107]
  v_mfma_f32_16x16x32_bf16 v[108:111], v[148:151], v[164:167], v[108:111]
  s_waitcnt lgkmcnt(0)
  v_mfma_f32_16x16x32_bf16 v[112:115], v[152:155], v[156:159], v[112:115]
  v_mfma_f32_16x16x32_bf16 v[116:119], v[152:155], v[160:163], v[116:119]
  v_mfma_f32_16x16x32_bf16 v[120:123], v[152:155], v[164:167], v[120:123]
  s_waitcnt vmcnt(16)
  s_waitcnt lgkmcnt(0)
  s_barrier
  ds_read_b128 v[156:159], v252
  ds_read_b128 v[160:163], v252 offset:2048
  ds_read_b128 v[164:167], v252 offset:4096
  ds_read_b64_tr_b16 v[124:125], v2 offset:24576
  ds_read_b64_tr_b16 v[126:127], v2 offset:25600
  ds_read_b64_tr_b16 v[128:129], v3 offset:24576
  ds_read_b64_tr_b16 v[130:131], v3 offset:25600
  ds_read_b64_tr_b16 v[132:133], v4 offset:24576
  ds_read_b64_tr_b16 v[134:135], v4 offset:25600
  ds_read_b64_tr_b16 v[136:137], v5 offset:24576
  ds_read_b64_tr_b16 v[138:139], v5 offset:25600
  ds_read_b64_tr_b16 v[140:141], v6 offset:24576
  ds_read_b64_tr_b16 v[142:143], v6 offset:25600
  ds_read_b64_tr_b16 v[144:145], v7 offset:24576
  ds_read_b64_tr_b16 v[146:147], v7 offset:25600
  s_waitcnt lgkmcnt(14)
  ds_read_b64_tr_b16 v[148:149], v8 offset:24576
  s_waitcnt lgkmcnt(14)
  ds_read_b64_tr_b16 v[150:151], v8 offset:25600
  s_waitcnt lgkmcnt(14)
  ds_read_b64_tr_b16 v[152:153], v9 offset:24576
  s_waitcnt lgkmcnt(14)
  ds_read_b64_tr_b16 v[154:155], v9 offset:25600
  s_lshl_b32 s39, s90, 18
  s_add_u32 s39, s39, s49
  s_add_u32 m0, s92, 0x2000
  s_nop 0
  buffer_load_dwordx4 v14, s[12:15], s39 offen lds
  buffer_load_dwordx4 v15, s[12:15], s39 offen offset:1024 lds
  buffer_load_dwordx4 v16, s[12:15], s39 offen offset:2048 lds
  buffer_load_dwordx4 v17, s[12:15], s39 offen offset:3072 lds
  s_waitcnt lgkmcnt(14)
  v_mfma_f32_16x16x32_bf16 v[28:31], v[124:127], v[156:159], v[28:31]
  v_mfma_f32_16x16x32_bf16 v[32:35], v[124:127], v[160:163], v[32:35]
  v_mfma_f32_16x16x32_bf16 v[36:39], v[124:127], v[164:167], v[36:39]
  s_waitcnt lgkmcnt(12)
  v_mfma_f32_16x16x32_bf16 v[40:43], v[128:131], v[156:159], v[40:43]
  v_mfma_f32_16x16x32_bf16 v[44:47], v[128:131], v[160:163], v[44:47]
  v_mfma_f32_16x16x32_bf16 v[48:51], v[128:131], v[164:167], v[48:51]
  s_add_u32 s39, s39, 131072
  s_add_u32 m0, s92, 0x3000
  s_nop 0
  buffer_load_dwordx4 v14, s[12:15], s39 offen lds
  buffer_load_dwordx4 v15, s[12:15], s39 offen offset:1024 lds
  buffer_load_dwordx4 v16, s[12:15], s39 offen offset:2048 lds
  buffer_load_dwordx4 v17, s[12:15], s39 offen offset:3072 lds
  s_add_u32 s90, s90, 1
  s_cmp_eq_u32 s90, 18
  s_cselect_b32 s90, 0, s90
  s_waitcnt lgkmcnt(2)
  v_mfma_f32_16x16x32_bf16 v[52:55], v[132:135], v[156:159], v[52:55]
  v_mfma_f32_16x16x32_bf16 v[56:59], v[132:135], v[160:163], v[56:59]
  v_mfma_f32_16x16x32_bf16 v[60:63], v[132:135], v[164:167], v[60:63]
  v_mfma_f32_16x16x32_bf16 v[64:67], v[136:139], v[156:159], v[64:67]
  v_mfma_f32_16x16x32_bf16 v[68:71], v[136:139], v[160:163], v[68:71]
  v_mfma_f32_16x16x32_bf16 v[72:75], v[136:139], v[164:167], v[72:75]
  v_mfma_f32_16x16x32_bf16 v[76:79], v[140:143], v[156:159], v[76:79]
  v_mfma_f32_16x16x32_bf16 v[80:83], v[140:143], v[160:163], v[80:83]
  v_mfma_f32_16x16x32_bf16 v[84:87], v[140:143], v[164:167], v[84:87]
  v_mfma_f32_16x16x32_bf16 v[88:91], v[144:147], v[156:159], v[88:91]
  v_mfma_f32_16x16x32_bf16 v[92:95], v[144:147], v[160:163], v[92:95]
  v_mfma_f32_16x16x32_bf16 v[96:99], v[144:147], v[164:167], v[96:99]
  v_mfma_f32_16x16x32_bf16 v[100:103], v[148:151], v[156:159], v[100:103]
  v_mfma_f32_16x16x32_bf16 v[104:107], v[148:151], v[160:163], v[104:107]
  v_mfma_f32_16x16x32_bf16 v[108:111], v[148:151], v[164:167], v[108:111]
  s_waitcnt lgkmcnt(0)
  v_mfma_f32_16x16x32_bf16 v[112:115], v[152:155], v[156:159], v[112:115]
  v_mfma_f32_16x16x32_bf16 v[116:119], v[152:155], v[160:163], v[116:119]
  v_mfma_f32_16x16x32_bf16 v[120:123], v[152:155], v[164:167], v[120:123]
  s_waitcnt vmcnt(16)
  s_waitcnt lgkmcnt(0)
  s_barrier
  ds_read_b128 v[156:159], v253
  ds_read_b128 v[160:163], v253 offset:2048
  ds_read_b128 v[164:167], v253 offset:4096
  ds_read_b64_tr_b16 v[124:125], v2 offset:32768
  ds_read_b64_tr_b16 v[126:127], v2 offset:33792
  ds_read_b64_tr_b16 v[128:129], v3 offset:32768
  ds_read_b64_tr_b16 v[130:131], v3 offset:33792
  ds_read_b64_tr_b16 v[132:133], v4 offset:32768
  ds_read_b64_tr_b16 v[134:135], v4 offset:33792
  ds_read_b64_tr_b16 v[136:137], v5 offset:32768
  ds_read_b64_tr_b16 v[138:139], v5 offset:33792
  ds_read_b64_tr_b16 v[140:141], v6 offset:32768
  ds_read_b64_tr_b16 v[142:143], v6 offset:33792
  ds_read_b64_tr_b16 v[144:145], v7 offset:32768
  ds_read_b64_tr_b16 v[146:147], v7 offset:33792
  s_waitcnt lgkmcnt(14)
  ds_read_b64_tr_b16 v[148:149], v8 offset:32768
  s_waitcnt lgkmcnt(14)
  ds_read_b64_tr_b16 v[150:151], v8 offset:33792
  s_waitcnt lgkmcnt(14)
  ds_read_b64_tr_b16 v[152:153], v9 offset:32768
  s_waitcnt lgkmcnt(14)
  ds_read_b64_tr_b16 v[154:155], v9 offset:33792
  s_lshl_b32 s39, s90, 18
  s_add_u32 s39, s39, s49
  s_add_u32 m0, s92, 0x4000
  s_nop 0
  buffer_load_dwordx4 v14, s[12:15], s39 offen lds
  buffer_load_dwordx4 v15, s[12:15], s39 offen offset:1024 lds
  buffer_load_dwordx4 v16, s[12:15], s39 offen offset:2048 lds
  buffer_load_dwordx4 v17, s[12:15], s39 offen offset:3072 lds
  s_waitcnt lgkmcnt(14)
  v_mfma_f32_16x16x32_bf16 v[28:31], v[124:127], v[156:159], v[28:31]
  v_mfma_f32_16x16x32_bf16 v[32:35], v[124:127], v[160:163], v[32:35]
  v_mfma_f32_16x16x32_bf16 v[36:39], v[124:127], v[164:167], v[36:39]
  s_waitcnt lgkmcnt(12)
  v_mfma_f32_16x16x32_bf16 v[40:43], v[128:131], v[156:159], v[40:43]
  v_mfma_f32_16x16x32_bf16 v[44:47], v[128:131], v[160:163], v[44:47]
  v_mfma_f32_16x16x32_bf16 v[48:51], v[128:131], v[164:167], v[48:51]
  s_add_u32 s39, s39, 131072
  s_add_u32 m0, s92, 0x5000
  s_nop 0
  buffer_load_dwordx4 v14, s[12:15], s39 offen lds
  buffer_load_dwordx4 v15, s[12:15], s39 offen offset:1024 lds
  buffer_load_dwordx4 v16, s[12:15], s39 offen offset:2048 lds
  buffer_load_dwordx4 v17, s[12:15], s39 offen offset:3072 lds
  s_add_u32 s90, s90, 1
  s_cmp_eq_u32 s90, 18
  s_cselect_b32 s90, 0, s90
  s_waitcnt lgkmcnt(2)
  v_mfma_f32_16x16x32_bf16 v[52:55], v[132:135], v[156:159], v[52:55]
  v_mfma_f32_16x16x32_bf16 v[56:59], v[132:135], v[160:163], v[56:59]
  v_mfma_f32_16x16x32_bf16 v[60:63], v[132:135], v[164:167], v[60:63]
  v_mfma_f32_16x16x32_bf16 v[64:67], v[136:139], v[156:159], v[64:67]
  v_mfma_f32_16x16x32_bf16 v[68:71], v[136:139], v[160:163], v[68:71]
  v_mfma_f32_16x16x32_bf16 v[72:75], v[136:139], v[164:167], v[72:75]
  v_mfma_f32_16x16x32_bf16 v[76:79], v[140:143], v[156:159], v[76:79]
  v_mfma_f32_16x16x32_bf16 v[80:83], v[140:143], v[160:163], v[80:83]
  v_mfma_f32_16x16x32_bf16 v[84:87], v[140:143], v[164:167], v[84:87]
  v_mfma_f32_16x16x32_bf16 v[88:91], v[144:147], v[156:159], v[88:91]
  v_mfma_f32_16x16x32_bf16 v[92:95], v[144:147], v[160:163], v[92:95]
  v_mfma_f32_16x16x32_bf16 v[96:99], v[144:147], v[164:167], v[96:99]
  v_mfma_f32_16x16x32_bf16 v[100:103], v[148:151], v[156:159], v[100:103]
  v_mfma_f32_16x16x32_bf16 v[104:107], v[148:151], v[160:163], v[104:107]
  v_mfma_f32_16x16x32_bf16 v[108:111], v[148:151], v[164:167], v[108:111]
  s_waitcnt lgkmcnt(0)
  v_mfma_f32_16x16x32_bf16 v[112:115], v[152:155], v[156:159], v[112:115]
  v_mfma_f32_16x16x32_bf16 v[116:119], v[152:155], v[160:163], v[116:119]
  v_mfma_f32_16x16x32_bf16 v[120:123], v[152:155], v[164:167], v[120:123]
  s_waitcnt vmcnt(16)
  s_waitcnt lgkmcnt(0)
  s_barrier
  s_setprio 3
  ds_read_b64_tr_b16 v[124:125], v2
  ds_read_b64_tr_b16 v[126:127], v2 offset:1024
  ds_read_b64_tr_b16 v[128:129], v3
  ds_read_b64_tr_b16 v[130:131], v3 offset:1024
  ds_read_b64_tr_b16 v[132:133], v4
  ds_read_b64_tr_b16 v[134:135], v4 offset:1024
  ds_read_b64_tr_b16 v[136:137], v5
  ds_read_b64_tr_b16 v[138:139], v5 offset:1024
  ds_read_b64_tr_b16 v[140:141], v6
  ds_read_b64_tr_b16 v[142:143], v6 offset:1024
  ds_read_b64_tr_b16 v[144:145], v7
  ds_read_b64_tr_b16 v[146:147], v7 offset:1024
  ds_read_b64_tr_b16 v[148:149], v8
  ds_read_b64_tr_b16 v[150:151], v8 offset:1024
  ds_read_b64_tr_b16 v[152:153], v9
  s_waitcnt lgkmcnt(14)
  ds_read_b64_tr_b16 v[154:155], v9 offset:1024
  s_lshl_b32 s39, s90, 18
  s_add_u32 s39, s39, s49
  s_add_u32 m0, s92, 0x6000
  s_nop 0
  buffer_load_dwordx4 v14, s[12:15], s39 offen lds
  buffer_load_dwordx4 v15, s[12:15], s39 offen offset:1024 lds
  buffer_load_dwordx4 v16, s[12:15], s39 offen offset:2048 lds
  buffer_load_dwordx4 v17, s[12:15], s39 offen offset:3072 lds
  v_pk_mul_f32 v[28:29], v[28:29], s[88:89]
  v_pk_mul_f32 v[30:31], v[30:31], s[88:89]
  v_cvt_pk_bf16_f32 v20, v28, v29
  v_cvt_pk_bf16_f32 v21, v30, v31
  s_waitcnt lgkmcnt(14)
  ds_write_b64 v13, v[20:21]
  v_pk_mul_f32 v[40:41], v[40:41], s[88:89]
  v_pk_mul_f32 v[42:43], v[42:43], s[88:89]
  v_cvt_pk_bf16_f32 v22, v40, v41
  v_cvt_pk_bf16_f32 v23, v42, v43
  s_waitcnt lgkmcnt(10)
  ds_write_b64 v13, v[22:23] offset:512
  v_pk_mul_f32 v[32:33], v[32:33], s[88:89]
  v_pk_mul_f32 v[34:35], v[34:35], s[88:89]
  v_mfma_f32_16x16x32_bf16 v[28:31], v[124:127], v[168:171], 0
  v_cvt_pk_bf16_f32 v24, v32, v33
  v_cvt_pk_bf16_f32 v25, v34, v35
  ds_write_b64 v13, v[24:25] offset:4096
  v_pk_mul_f32 v[44:45], v[44:45], s[88:89]
  v_pk_mul_f32 v[46:47], v[46:47], s[88:89]
  v_mfma_f32_16x16x32_bf16 v[40:43], v[128:131], v[168:171], 0
  v_cvt_pk_bf16_f32 v26, v44, v45
  v_cvt_pk_bf16_f32 v27, v46, v47
  ds_write_b64 v13, v[26:27] offset:4608
  v_pk_mul_f32 v[36:37], v[36:37], s[88:89]
  v_pk_mul_f32 v[38:39], v[38:39], s[88:89]
  v_mfma_f32_16x16x32_bf16 v[32:35], v[124:127], v[172:175], 0
  v_cvt_pk_bf16_f32 v20, v36, v37
  v_cvt_pk_bf16_f32 v21, v38, v39
  ds_write_b64 v13, v[20:21] offset:8192
  v_pk_mul_f32 v[48:49], v[48:49], s[88:89]
  v_pk_mul_f32 v[50:51], v[50:51], s[88:89]
  v_mfma_f32_16x16x32_bf16 v[44:47], v[128:131], v[172:175], 0
  v_cvt_pk_bf16_f32 v22, v48, v49
  v_cvt_pk_bf16_f32 v23, v50, v51
  ds_write_b64 v13, v[22:23] offset:8704
  s_add_u32 s39, s39, 131072
  s_add_u32 m0, s92, 0x7000
  s_nop 0
  buffer_load_dwordx4 v14, s[12:15], s39 offen lds
  buffer_load_dwordx4 v15, s[12:15], s39 offen offset:1024 lds
  buffer_load_dwordx4 v16, s[12:15], s39 offen offset:2048 lds
  buffer_load_dwordx4 v17, s[12:15], s39 offen offset:3072 lds
  s_add_u32 s90, s90, 1
  s_cmp_eq_u32 s90, 18
  s_cselect_b32 s90, 0, s90
  v_pk_mul_f32 v[52:53], v[52:53], s[88:89]
  v_pk_mul_f32 v[54:55], v[54:55], s[88:89]
  v_mfma_f32_16x16x32_bf16 v[36:39], v[124:127], v[176:179], 0
  v_cvt_pk_bf16_f32 v24, v52, v53
  v_cvt_pk_bf16_f32 v25, v54, v55
  s_waitcnt lgkmcnt(4)
  ds_write_b64 v13, v[24:25] offset:1024
  v_pk_mul_f32 v[64:65], v[64:65], s[88:89]
  v_pk_mul_f32 v[66:67], v[66:67], s[88:89]
  v_mfma_f32_16x16x32_bf16 v[48:51], v[128:131], v[176:179], 0
  v_cvt_pk_bf16_f32 v26, v64, v65
  v_cvt_pk_bf16_f32 v27, v66, v67
  ds_write_b64 v13, v[26:27] offset:1536
  v_pk_mul_f32 v[56:57], v[56:57], s[88:89]
  v_pk_mul_f32 v[58:59], v[58:59], s[88:89]
  v_mfma_f32_16x16x32_bf16 v[52:55], v[132:135], v[168:171], 0
  v_cvt_pk_bf16_f32 v20, v56, v57
  v_cvt_pk_bf16_f32 v21, v58, v59
  ds_write_b64 v13, v[20:21] offset:5120
  v_pk_mul_f32 v[68:69], v[68:69], s[88:89]
  v_pk_mul_f32 v[70:71], v[70:71], s[88:89]
  v_mfma_f32_16x16x32_bf16 v[64:67], v[136:139], v[168:171], 0
  v_cvt_pk_bf16_f32 v22, v68, v69
  v_cvt_pk_bf16_f32 v23, v70, v71
  ds_write_b64 v13, v[22:23] offset:5632
  v_pk_mul_f32 v[60:61], v[60:61], s[88:89]
  v_pk_mul_f32 v[62:63], v[62:63], s[88:89]
  v_mfma_f32_16x16x32_bf16 v[56:59], v[132:135], v[172:175], 0
  v_cvt_pk_bf16_f32 v24, v60, v61
  v_cvt_pk_bf16_f32 v25, v62, v63
  ds_write_b64 v13, v[24:25] offset:9216
  v_pk_mul_f32 v[72:73], v[72:73], s[88:89]
  v_pk_mul_f32 v[74:75], v[74:75], s[88:89]
  v_mfma_f32_16x16x32_bf16 v[68:71], v[136:139], v[172:175], 0
  v_cvt_pk_bf16_f32 v26, v72, v73
  v_cvt_pk_bf16_f32 v27, v74, v75
  ds_write_b64 v13, v[26:27] offset:9728
  v_pk_mul_f32 v[76:77], v[76:77], s[88:89]
  v_pk_mul_f32 v[78:79], v[78:79], s[88:89]
  v_mfma_f32_16x16x32_bf16 v[60:63], v[132:135], v[176:179], 0
  v_cvt_pk_bf16_f32 v20, v76, v77
  v_cvt_pk_bf16_f32 v21, v78, v79
  ds_write_b64 v13, v[20:21] offset:2048
  v_pk_mul_f32 v[88:89], v[88:89], s[88:89]
  v_pk_mul_f32 v[90:91], v[90:91], s[88:89]
  v_mfma_f32_16x16x32_bf16 v[72:75], v[136:139], v[176:179], 0
  v_cvt_pk_bf16_f32 v22, v88, v89
  v_cvt_pk_bf16_f32 v23, v90, v91
  ds_write_b64 v13, v[22:23] offset:2560
  v_pk_mul_f32 v[80:81], v[80:81], s[88:89]
  v_pk_mul_f32 v[82:83], v[82:83], s[88:89]
  v_mfma_f32_16x16x32_bf16 v[76:79], v[140:143], v[168:171], 0
  v_cvt_pk_bf16_f32 v24, v80, v81
  v_cvt_pk_bf16_f32 v25, v82, v83
  ds_write_b64 v13, v[24:25] offset:6144
  v_pk_mul_f32 v[92:93], v[92:93], s[88:89]
  v_pk_mul_f32 v[94:95], v[94:95], s[88:89]
  v_mfma_f32_16x16x32_bf16 v[88:91], v[144:147], v[168:171], 0
  v_cvt_pk_bf16_f32 v26, v92, v93
  v_cvt_pk_bf16_f32 v27, v94, v95
  ds_write_b64 v13, v[26:27] offset:6656
  v_pk_mul_f32 v[84:85], v[84:85], s[88:89]
  v_pk_mul_f32 v[86:87], v[86:87], s[88:89]
  v_mfma_f32_16x16x32_bf16 v[80:83], v[140:143], v[172:175], 0
  v_cvt_pk_bf16_f32 v20, v84, v85
  v_cvt_pk_bf16_f32 v21, v86, v87
  ds_write_b64 v13, v[20:21] offset:10240
  v_pk_mul_f32 v[96:97], v[96:97], s[88:89]
  v_pk_mul_f32 v[98:99], v[98:99], s[88:89]
  v_mfma_f32_16x16x32_bf16 v[92:95], v[144:147], v[172:175], 0
  v_cvt_pk_bf16_f32 v22, v96, v97
  v_cvt_pk_bf16_f32 v23, v98, v99
  s_waitcnt lgkmcnt(4)
  ds_write_b64 v13, v[22:23] offset:10752
  v_pk_mul_f32 v[100:101], v[100:101], s[88:89]
  v_pk_mul_f32 v[102:103], v[102:103], s[88:89]
  v_mfma_f32_16x16x32_bf16 v[84:87], v[140:143], v[176:179], 0
  v_cvt_pk_bf16_f32 v24, v100, v101
  v_cvt_pk_bf16_f32 v25, v102, v103
  ds_write_b64 v13, v[24:25] offset:3072
  v_pk_mul_f32 v[112:113], v[112:113], s[88:89]
  v_pk_mul_f32 v[114:115], v[114:115], s[88:89]
  v_mfma_f32_16x16x32_bf16 v[96:99], v[144:147], v[176:179], 0
  v_cvt_pk_bf16_f32 v26, v112, v113
  v_cvt_pk_bf16_f32 v27, v114, v115
  ds_write_b64 v13, v[26:27] offset:3584
  v_pk_mul_f32 v[104:105], v[104:105], s[88:89]
  v_pk_mul_f32 v[106:107], v[106:107], s[88:89]
  v_mfma_f32_16x16x32_bf16 v[100:103], v[148:151], v[168:171], 0
  v_cvt_pk_bf16_f32 v20, v104, v105
  v_cvt_pk_bf16_f32 v21, v106, v107
  ds_write_b64 v13, v[20:21] offset:7168
  v_pk_mul_f32 v[116:117], v[116:117], s[88:89]
  v_pk_mul_f32 v[118:119], v[118:119], s[88:89]
  v_mfma_f32_16x16x32_bf16 v[112:115], v[152:155], v[168:171], 0
  v_cvt_pk_bf16_f32 v22, v116, v117
  v_cvt_pk_bf16_f32 v23, v118, v119
  ds_write_b64 v13, v[22:23] offset:7680
  v_pk_mul_f32 v[108:109], v[108:109], s[88:89]
  v_pk_mul_f32 v[110:111], v[110:111], s[88:89]
  v_mfma_f32_16x16x32_bf16 v[104:107], v[148:151], v[172:175], 0
  v_cvt_pk_bf16_f32 v24, v108, v109
  v_cvt_pk_bf16_f32 v25, v110, v111
  ds_write_b64 v13, v[24:25] offset:11264
  v_pk_mul_f32 v[120:121], v[120:121], s[88:89]
  v_pk_mul_f32 v[122:123], v[122:123], s[88:89]
  v_mfma_f32_16x16x32_bf16 v[116:119], v[152:155], v[172:175], 0
  v_cvt_pk_bf16_f32 v26, v120, v121
  v_cvt_pk_bf16_f32 v27, v122, v123
  ds_write_b64 v13, v[26:27] offset:11776
  v_mfma_f32_16x16x32_bf16 v[108:111], v[148:151], v[176:179], 0
  v_mfma_f32_16x16x32_bf16 v[120:123], v[152:155], v[176:179], 0
  s_setprio 0
  s_add_u32 s36, s36, 1
  s_mov_b32 s48, s49
  s_add_u32 s49, s48, 256
  s_cmp_eq_u32 s36, 2
  s_cselect_b32 s92, 0x28000, 0
  s_cmp_lt_u32 s36, 3
  s_cbranch_scc1 L_Bw_loop
L_r3_6:
  s_waitcnt lgkmcnt(0)
  s_setprio 0
  v_lshlrev_b32 v2, 4, v0
  v_lshrrev_b32 v14, 2, v0
  v_bfe_u32 v15, v0, 3, 2
  v_lshlrev_b32 v14, 7, v14
  v_and_b32 v9, 3, v0
  v_lshl_add_u32 v14, v9, 3, v14
  v_xor_b32 v9, 2, v15
  v_lshl_add_u32 v3, v9, 5, v14
  v_add_u32 v5, 100352, v3
  v_xor_b32 v9, 3, v15
  v_lshl_add_u32 v4, v9, 5, v14
  v_add_u32 v6, 100352, v4
  v_lshrrev_b32 v14, 4, v0
  v_lshlrev_b32 v14, 1, v14
  v_xor_b32 v14, v14, v0
  v_and_b32 v14, 7, v14
  v_lshlrev_b32 v14, 4, v14
  v_lshrrev_b32 v15, 3, v0
  v_mul_u32_u24 v15, 1152, v15
  v_add_u32 v7, v14, v15
  v_add_u32 v8, 8192, v7
  v_add_u32 v9, 59392, v2
  s_mul_i32 s72, s57, 147456
  s_lshl_b32 s73, s33, 3
  s_add_u32 s73, s73, s34
  s_mul_i32 s73, s73, 165888
  s_add_u32 s73, s73, 0x5000000
  s_lshl_b32 s75, s33, 5
  s_add_u32 s75, s75, s34
  s_mul_i32 s75, s75, 36864
  s_waitcnt lgkmcnt(0)
  s_barrier
  s_waitcnt lgkmcnt(0)
  s_barrier
  s_waitcnt lgkmcnt(0)
  s_barrier
  ds_read_b128 v[128:131], v2 offset:32768
  ds_read_b128 v[132:135], v2 offset:36864
  ds_read_b128 v[136:139], v2 offset:33792
  ds_read_b128 v[140:143], v2 offset:37888
  ds_read_b128 v[144:147], v2 offset:34816
  ds_read_b128 v[148:151], v2 offset:38912
  ds_read_b128 v[152:155], v2 offset:35840
  ds_read_b128 v[156:159], v2 offset:39936
  ds_read_b128 v[160:163], v2 offset:40960
  ds_read_b128 v[164:167], v2 offset:45056
  ds_read_b128 v[168:171], v2 offset:41984
  ds_read_b128 v[172:175], v2 offset:46080
  ds_read_b128 v[176:179], v2 offset:43008
  ds_read_b128 v[180:183], v2 offset:47104
  ds_read_b128 v[184:187], v2 offset:44032
  s_waitcnt lgkmcnt(14)
  ds_read_b128 v[188:191], v2 offset:48128
  s_waitcnt lgkmcnt(0)
  s_barrier
  v_add_u32 v14, 124928, v2
  ds_read_b128 v[64:67], v14 offset:16384
  ds_read_b128 v[68:71], v14 offset:20480
  ds_read_b128 v[72:75], v14 offset:17408
  ds_read_b128 v[76:79], v14 offset:21504
  ds_read_b128 v[80:83], v14 offset:18432
  ds_read_b128 v[84:87], v14 offset:22528
  ds_read_b128 v[88:91], v14 offset:19456
  ds_read_b128 v[92:95], v14 offset:23552
  s_waitcnt lgkmcnt(0)
  s_barrier
  s_waitcnt lgkmcnt(0)
  s_barrier
  s_waitcnt lgkmcnt(0)
  s_barrier
  s_waitcnt lgkmcnt(0)
  s_barrier
  s_waitcnt lgkmcnt(0)
  s_barrier
  s_waitcnt lgkmcnt(0)
  s_barrier
  s_waitcnt lgkmcnt(0)
  s_barrier
  s_getpc_b64 s[42:43]
L_cpfb:
  s_sub_u32 s42, s42, L_cpfb-concat_heads__mha_block_cached__gqa_block_cached__near_ridge_kernel
  s_subb_u32 s43, s43, 0
  s_lshr_b32 s38, s2, 3
  s_mul_i32 s38, s38, 4096
  s_min_u32 s38, s38, L_end1-concat_heads__mha_block_cached__gqa_block_cached__near_ridge_kernel-4096
  v_lshlrev_b32 v200, 4, v0
  v_add_u32 v200, s38, v200
  global_load_dwordx4 v[202:205], v200, s[42:43] offset:0
  global_load_dwordx4 v[202:205], v200, s[42:43] offset:1024
  global_load_dwordx4 v[202:205], v200, s[42:43] offset:2048
  global_load_dwordx4 v[202:205], v200, s[42:43] offset:3072
  v_add_u32 v200, 4096, v200
  s_waitcnt lgkmcnt(0)
  s_barrier
  s_waitcnt lgkmcnt(0)
  s_barrier
  s_waitcnt lgkmcnt(0)
  s_barrier
  s_waitcnt lgkmcnt(0)
  s_barrier
  s_waitcnt lgkmcnt(0)
  s_barrier
  s_mov_b32 m0, 0xa000
  s_add_u32 s39, s72, 0x48000
  buffer_load_dwordx4 v7, s[24:27], s39 offen lds
  buffer_load_dwordx4 v8, s[24:27], s39 offen offset:1024 lds
  s_mov_b32 m0, 0xa800
  s_add_u32 s39, s72, 0x4c800
  buffer_load_dwordx4 v7, s[24:27], s39 offen lds
  buffer_load_dwordx4 v8, s[24:27], s39 offen offset:1024 lds
  s_mov_b32 m0, 0xb000
  s_add_u32 s39, s72, 0x51000
  buffer_load_dwordx4 v7, s[24:27], s39 offen lds
  buffer_load_dwordx4 v8, s[24:27], s39 offen offset:1024 lds
  s_mov_b32 m0, 0xb800
  s_add_u32 s39, s72, 0x55800
  buffer_load_dwordx4 v7, s[24:27], s39 offen lds
  buffer_load_dwordx4 v8, s[24:27], s39 offen offset:1024 lds
  s_waitcnt lgkmcnt(0)
  s_barrier
  s_mov_b32 m0, 0xc000
  s_add_u32 s39, s72, 0x5a000
  buffer_load_dwordx4 v7, s[24:27], s39 offen lds
  buffer_load_dwordx4 v8, s[24:27], s39 offen offset:1024 lds
  s_mov_b32 m0, 0xc800
  s_add_u32 s39, s72, 0x5e800
  buffer_load_dwordx4 v7, s[24:27], s39 offen lds
  buffer_load_dwordx4 v8, s[24:27], s39 offen offset:1024 lds
  s_mov_b32 m0, 0xd000
  s_add_u32 s39, s72, 0x63000
  buffer_load_dwordx4 v7, s[24:27], s39 offen lds
  buffer_load_dwordx4 v8, s[24:27], s39 offen offset:1024 lds
  s_mov_b32 m0, 0xd800
  s_add_u32 s39, s72, 0x67800
  buffer_load_dwordx4 v7, s[24:27], s39 offen lds
  buffer_load_dwordx4 v8, s[24:27], s39 offen offset:1024 lds
  s_waitcnt lgkmcnt(0)
  s_barrier
  s_waitcnt lgkmcnt(0)
  s_barrier
  s_mov_b32 m0, 0x18800
  s_add_u32 s39, s72, 0x6c000
  buffer_load_dwordx4 v7, s[24:27], s39 offen lds
  buffer_load_dwordx4 v8, s[24:27], s39 offen offset:1024 lds
  s_mov_b32 m0, 0x19000
  s_add_u32 s39, s72, 0x70800
  buffer_load_dwordx4 v7, s[24:27], s39 offen lds
  buffer_load_dwordx4 v8, s[24:27], s39 offen offset:1024 lds
  s_mov_b32 m0, 0x19800
  s_add_u32 s39, s72, 0x75000
  buffer_load_dwordx4 v7, s[24:27], s39 offen lds
  buffer_load_dwordx4 v8, s[24:27], s39 offen offset:1024 lds
  s_mov_b32 m0, 0x1a000
  s_add_u32 s39, s72, 0x79800
  buffer_load_dwordx4 v7, s[24:27], s39 offen lds
  buffer_load_dwordx4 v8, s[24:27], s39 offen offset:1024 lds
  s_mov_b32 m0, 0x1a800
  s_add_u32 s39, s72, 0x7e000
  buffer_load_dwordx4 v7, s[24:27], s39 offen lds
  buffer_load_dwordx4 v8, s[24:27], s39 offen offset:1024 lds
  s_mov_b32 m0, 0x1b000
  s_add_u32 s39, s72, 0x82800
  buffer_load_dwordx4 v7, s[24:27], s39 offen lds
  buffer_load_dwordx4 v8, s[24:27], s39 offen offset:1024 lds
  s_mov_b32 m0, 0x1b800
  s_add_u32 s39, s72, 0x87000
  buffer_load_dwordx4 v7, s[24:27], s39 offen lds
  buffer_load_dwordx4 v8, s[24:27], s39 offen offset:1024 lds
  s_mov_b32 m0, 0x1c000
  s_add_u32 s39, s72, 0x8b800
  buffer_load_dwordx4 v7, s[24:27], s39 offen lds
  buffer_load_dwordx4 v8, s[24:27], s39 offen offset:1024 lds
  s_waitcnt lgkmcnt(0)
  s_barrier
  s_waitcnt vmcnt(0)
  s_waitcnt lgkmcnt(0)
  s_barrier
  ds_read_b128 v[96:99], v9 offset:16384
  ds_read_b128 v[100:103], v9 offset:20480
  ds_read_b128 v[104:107], v9 offset:17408
  ds_read_b128 v[108:111], v9 offset:21504
  ds_read_b128 v[112:115], v9 offset:18432
  ds_read_b128 v[116:119], v9 offset:22528
  ds_read_b128 v[120:123], v9 offset:19456
  ds_read_b128 v[124:127], v9 offset:23552
  s_mov_b32 m0, 0x3000
  s_add_u32 s39, s72, 0x1b000
  buffer_load_dwordx4 v7, s[24:27], s39 offen lds
  buffer_load_dwordx4 v8, s[24:27], s39 offen offset:1024 lds
  s_mov_b32 m0, 0x7000
  s_add_u32 s39, s72, 0x3f000
  buffer_load_dwordx4 v7, s[24:27], s39 offen lds
  buffer_load_dwordx4 v8, s[24:27], s39 offen offset:1024 lds
  ds_read_b64_tr_b16 v[16:17], v3 offset:40960
  ds_read_b64_tr_b16 v[18:19], v3 offset:43008
  ds_read_b64_tr_b16 v[20:21], v4 offset:40960
  ds_read_b64_tr_b16 v[22:23], v4 offset:43008
  ds_read_b64_tr_b16 v[24:25], v3 offset:45056
  ds_read_b64_tr_b16 v[26:27], v3 offset:47104
  ds_read_b64_tr_b16 v[28:29], v4 offset:45056
  s_waitcnt lgkmcnt(14)
  ds_read_b64_tr_b16 v[30:31], v4 offset:47104
  s_add_u32 s76, s34, 8
  s_mov_b32 s77, 0
  s_mov_b32 s78, 0
  s_mov_b32 s80, 0x7ff00000
  s_waitcnt lgkmcnt(14)
  ds_read_b64_tr_b16 v[48:49], v3 offset:49152
  s_waitcnt lgkmcnt(13)
  ds_read_b64_tr_b16 v[50:51], v3 offset:51200
  s_waitcnt lgkmcnt(8)
  v_mfma_f32_16x16x32_bf16 v[32:35], v[16:19], v[64:67], 0
  v_mfma_f32_16x16x32_bf16 v[40:43], v[16:19], v[68:71], 0
  ds_read_b64_tr_b16 v[52:53], v4 offset:49152
  ds_read_b64_tr_b16 v[54:55], v4 offset:51200
  s_waitcnt lgkmcnt(8)
  v_mfma_f32_16x16x32_bf16 v[36:39], v[20:23], v[64:67], 0
  v_mfma_f32_16x16x32_bf16 v[44:47], v[20:23], v[68:71], 0
  ds_read_b64_tr_b16 v[56:57], v3 offset:53248
  ds_read_b64_tr_b16 v[58:59], v3 offset:55296
  s_waitcnt lgkmcnt(8)
  v_mfma_f32_16x16x32_bf16 v[32:35], v[24:27], v[72:75], v[32:35]
  v_mfma_f32_16x16x32_bf16 v[40:43], v[24:27], v[76:79], v[40:43]
  ds_read_b64_tr_b16 v[60:61], v4 offset:53248
  ds_read_b64_tr_b16 v[62:63], v4 offset:55296
  s_waitcnt lgkmcnt(8)
  v_mfma_f32_16x16x32_bf16 v[36:39], v[28:31], v[72:75], v[36:39]
  v_mfma_f32_16x16x32_bf16 v[44:47], v[28:31], v[76:79], v[44:47]
  s_waitcnt lgkmcnt(0)
  s_barrier
  ds_read_b64_tr_b16 v[16:17], v5
  ds_read_b64_tr_b16 v[18:19], v5 offset:2048
  v_mfma_f32_16x16x32_bf16 v[32:35], v[48:51], v[80:83], v[32:35]
  v_mfma_f32_16x16x32_bf16 v[40:43], v[48:51], v[84:87], v[40:43]
  ds_read_b64_tr_b16 v[20:21], v6
  ds_read_b64_tr_b16 v[22:23], v6 offset:2048
  s_mov_b32 m0, 0xd000
  s_add_u32 s39, s72, 0x63080
  buffer_load_dwordx4 v7, s[24:27], s39 offen lds
  buffer_load_dwordx4 v8, s[24:27], s39 offen offset:1024 lds
  v_mfma_f32_16x16x32_bf16 v[36:39], v[52:55], v[80:83], v[36:39]
  v_mfma_f32_16x16x32_bf16 v[44:47], v[52:55], v[84:87], v[44:47]
  ds_read_b64_tr_b16 v[24:25], v5 offset:4096
  ds_read_b64_tr_b16 v[26:27], v5 offset:6144
  v_mfma_f32_16x16x32_bf16 v[32:35], v[56:59], v[88:91], v[32:35]
  v_mfma_f32_16x16x32_bf16 v[40:43], v[56:59], v[92:95], v[40:43]
  ds_read_b64_tr_b16 v[28:29], v6 offset:4096
  ds_read_b64_tr_b16 v[30:31], v6 offset:6144
  v_mfma_f32_16x16x32_bf16 v[36:39], v[60:63], v[88:91], v[36:39]
  v_mfma_f32_16x16x32_bf16 v[44:47], v[60:63], v[92:95], v[44:47]
  ds_read_b64_tr_b16 v[48:49], v5 offset:8192
  ds_read_b64_tr_b16 v[50:51], v5 offset:10240
  s_waitcnt lgkmcnt(8)
  v_mfma_f32_16x16x32_bf16 v[32:35], v[16:19], v[96:99], v[32:35]
  v_mfma_f32_16x16x32_bf16 v[40:43], v[16:19], v[100:103], v[40:43]
  ds_read_b64_tr_b16 v[52:53], v6 offset:8192
  ds_read_b64_tr_b16 v[54:55], v6 offset:10240
  s_waitcnt lgkmcnt(8)
  v_mfma_f32_16x16x32_bf16 v[36:39], v[20:23], v[96:99], v[36:39]
  v_mfma_f32_16x16x32_bf16 v[44:47], v[20:23], v[100:103], v[44:47]
  ds_read_b64_tr_b16 v[56:57], v5 offset:12288
  ds_read_b64_tr_b16 v[58:59], v5 offset:14336
  s_waitcnt lgkmcnt(8)
  v_mfma_f32_16x16x32_bf16 v[32:35], v[24:27], v[104:107], v[32:35]
  v_mfma_f32_16x16x32_bf16 v[40:43], v[24:27], v[108:111], v[40:43]
  ds_read_b64_tr_b16 v[60:61], v6 offset:12288
  ds_read_b64_tr_b16 v[62:63], v6 offset:14336
  s_waitcnt lgkmcnt(8)
  v_mfma_f32_16x16x32_bf16 v[36:39], v[28:31], v[104:107], v[36:39]
  v_mfma_f32_16x16x32_bf16 v[44:47], v[28:31], v[108:111], v[44:47]
  s_waitcnt vmcnt(4)
  s_waitcnt lgkmcnt(0)
  s_barrier
  ds_read_b64_tr_b16 v[16:17], v3
  ds_read_b64_tr_b16 v[18:19], v3 offset:2048
  v_mfma_f32_16x16x32_bf16 v[32:35], v[48:51], v[112:115], v[32:35]
  v_mfma_f32_16x16x32_bf16 v[40:43], v[48:51], v[116:119], v[40:43]
  ds_read_b64_tr_b16 v[20:21], v4
  ds_read_b64_tr_b16 v[22:23], v4 offset:2048
  s_mov_b32 m0, 0x1b800
  s_add_u32 s39, s72, 0x87080
  buffer_load_dwordx4 v7, s[24:27], s39 offen lds
  buffer_load_dwordx4 v8, s[24:27], s39 offen offset:1024 lds
  v_mfma_f32_16x16x32_bf16 v[36:39], v[52:55], v[112:115], v[36:39]
  v_mfma_f32_16x16x32_bf16 v[44:47], v[52:55], v[116:119], v[44:47]
  ds_read_b64_tr_b16 v[24:25], v3 offset:4096
  ds_read_b64_tr_b16 v[26:27], v3 offset:6144
  v_mfma_f32_16x16x32_bf16 v[32:35], v[56:59], v[120:123], v[32:35]
  v_mfma_f32_16x16x32_bf16 v[40:43], v[56:59], v[124:127], v[40:43]
  ds_read_b64_tr_b16 v[28:29], v4 offset:4096
  ds_read_b64_tr_b16 v[30:31], v4 offset:6144
  v_mfma_f32_16x16x32_bf16 v[36:39], v[60:63], v[120:123], v[36:39]
  v_mfma_f32_16x16x32_bf16 v[44:47], v[60:63], v[124:127], v[44:47]
  ds_read_b64_tr_b16 v[48:49], v3 offset:8192
  ds_read_b64_tr_b16 v[50:51], v3 offset:10240
  s_waitcnt lgkmcnt(8)
  v_mfma_f32_16x16x32_bf16 v[32:35], v[16:19], v[128:131], v[32:35]
  v_mfma_f32_16x16x32_bf16 v[40:43], v[16:19], v[132:135], v[40:43]
  ds_read_b64_tr_b16 v[52:53], v4 offset:8192
  ds_read_b64_tr_b16 v[54:55], v4 offset:10240
  s_waitcnt lgkmcnt(8)
  v_mfma_f32_16x16x32_bf16 v[36:39], v[20:23], v[128:131], v[36:39]
  v_mfma_f32_16x16x32_bf16 v[44:47], v[20:23], v[132:135], v[44:47]
  ds_read_b64_tr_b16 v[56:57], v3 offset:12288
  ds_read_b64_tr_b16 v[58:59], v3 offset:14336
  s_waitcnt lgkmcnt(8)
  v_mfma_f32_16x16x32_bf16 v[32:35], v[24:27], v[136:139], v[32:35]
  v_mfma_f32_16x16x32_bf16 v[40:43], v[24:27], v[140:143], v[40:43]
  ds_read_b64_tr_b16 v[60:61], v4 offset:12288
  ds_read_b64_tr_b16 v[62:63], v4 offset:14336
  s_waitcnt lgkmcnt(8)
  v_mfma_f32_16x16x32_bf16 v[36:39], v[28:31], v[136:139], v[36:39]
  v_mfma_f32_16x16x32_bf16 v[44:47], v[28:31], v[140:143], v[44:47]
  s_waitcnt vmcnt(4)
  s_waitcnt lgkmcnt(0)
  s_barrier
  ds_read_b64_tr_b16 v[16:17], v3 offset:16384
  ds_read_b64_tr_b16 v[18:19], v3 offset:18432
  v_mfma_f32_16x16x32_bf16 v[32:35], v[48:51], v[144:147], v[32:35]
  v_mfma_f32_16x16x32_bf16 v[40:43], v[48:51], v[148:151], v[40:43]
  ds_read_b64_tr_b16 v[20:21], v4 offset:16384
  ds_read_b64_tr_b16 v[22:23], v4 offset:18432
  s_mov_b32 m0, 0x3000
  s_add_u32 s39, s72, 0x1b080
  buffer_load_dwordx4 v7, s[24:27], s39 offen lds
  buffer_load_dwordx4 v8, s[24:27], s39 offen offset:1024 lds
  v_mfma_f32_16x16x32_bf16 v[36:39], v[52:55], v[144:147], v[36:39]
  v_mfma_f32_16x16x32_bf16 v[44:47], v[52:55], v[148:151], v[44:47]
  ds_read_b64_tr_b16 v[24:25], v3 offset:20480
  ds_read_b64_tr_b16 v[26:27], v3 offset:22528
  v_mfma_f32_16x16x32_bf16 v[32:35], v[56:59], v[152:155], v[32:35]
  v_mfma_f32_16x16x32_bf16 v[40:43], v[56:59], v[156:159], v[40:43]
  ds_read_b64_tr_b16 v[28:29], v4 offset:20480
  ds_read_b64_tr_b16 v[30:31], v4 offset:22528
  v_mfma_f32_16x16x32_bf16 v[36:39], v[60:63], v[152:155], v[36:39]
  v_mfma_f32_16x16x32_bf16 v[44:47], v[60:63], v[156:159], v[44:47]
  ds_read_b64_tr_b16 v[48:49], v3 offset:24576
  ds_read_b64_tr_b16 v[50:51], v3 offset:26624
  s_waitcnt lgkmcnt(8)
  v_mfma_f32_16x16x32_bf16 v[32:35], v[16:19], v[160:163], v[32:35]
  v_mfma_f32_16x16x32_bf16 v[40:43], v[16:19], v[164:167], v[40:43]
  ds_read_b64_tr_b16 v[52:53], v4 offset:24576
  ds_read_b64_tr_b16 v[54:55], v4 offset:26624
  s_waitcnt lgkmcnt(8)
  v_mfma_f32_16x16x32_bf16 v[36:39], v[20:23], v[160:163], v[36:39]
  v_mfma_f32_16x16x32_bf16 v[44:47], v[20:23], v[164:167], v[44:47]
  ds_read_b64_tr_b16 v[56:57], v3 offset:28672
  ds_read_b64_tr_b16 v[58:59], v3 offset:30720
  s_waitcnt lgkmcnt(8)
  v_mfma_f32_16x16x32_bf16 v[32:35], v[24:27], v[168:171], v[32:35]
  v_mfma_f32_16x16x32_bf16 v[40:43], v[24:27], v[172:175], v[40:43]
  ds_read_b64_tr_b16 v[60:61], v4 offset:28672
  ds_read_b64_tr_b16 v[62:63], v4 offset:30720
  s_waitcnt lgkmcnt(8)
  v_mfma_f32_16x16x32_bf16 v[36:39], v[28:31], v[168:171], v[36:39]
  v_mfma_f32_16x16x32_bf16 v[44:47], v[28:31], v[172:175], v[44:47]
  s_waitcnt vmcnt(4)
  s_waitcnt lgkmcnt(0)
  s_barrier
  ds_read_b64_tr_b16 v[16:17], v3 offset:40960
  ds_read_b64_tr_b16 v[18:19], v3 offset:43008
  v_mfma_f32_16x16x32_bf16 v[32:35], v[48:51], v[176:179], v[32:35]
  v_mfma_f32_16x16x32_bf16 v[40:43], v[48:51], v[180:183], v[40:43]
  ds_read_b64_tr_b16 v[20:21], v4 offset:40960
  ds_read_b64_tr_b16 v[22:23], v4 offset:43008
  s_mov_b32 m0, 0x7000
  s_add_u32 s39, s72, 0x3f080
  buffer_load_dwordx4 v7, s[24:27], s39 offen lds
  buffer_load_dwordx4 v8, s[24:27], s39 offen offset:1024 lds
  v_mfma_f32_16x16x32_bf16 v[36:39], v[52:55], v[176:179], v[36:39]
  v_mfma_f32_16x16x32_bf16 v[44:47], v[52:55], v[180:183], v[44:47]
  ds_read_b64_tr_b16 v[24:25], v3 offset:45056
  ds_read_b64_tr_b16 v[26:27], v3 offset:47104
  v_mfma_f32_16x16x32_bf16 v[32:35], v[56:59], v[184:187], v[32:35]
  v_mfma_f32_16x16x32_bf16 v[40:43], v[56:59], v[188:191], v[40:43]
  ds_read_b64_tr_b16 v[28:29], v4 offset:45056
  ds_read_b64_tr_b16 v[30:31], v4 offset:47104
  v_mfma_f32_16x16x32_bf16 v[36:39], v[60:63], v[184:187], v[36:39]
  v_mfma_f32_16x16x32_bf16 v[44:47], v[60:63], v[188:191], v[44:47]
  s_add_u32 s72, s72, 128
  s_mov_b32 s74, 7
L_op6_loop:
  ds_read_b64_tr_b16 v[48:49], v3 offset:49152
  ds_read_b64_tr_b16 v[50:51], v3 offset:51200
  v_cvt_pk_bf16_f32 v10, v32, v33
  v_cvt_pk_bf16_f32 v11, v34, v35
  s_nop 0
  v_cvt_pk_bf16_f32 v12, v36, v37
  v_cvt_pk_bf16_f32 v13, v38, v39
  s_add_u32 s40, s73, 0x2400
  buffer_store_dwordx4 v[10:13], v2, s[20:23], s40 offen sc1
  s_waitcnt lgkmcnt(8)
  v_mfma_f32_16x16x32_bf16 v[32:35], v[16:19], v[64:67], 0
  v_cvt_pk_bf16_f32 v10, v40, v41
  v_cvt_pk_bf16_f32 v11, v42, v43
  v_cvt_pk_bf16_f32 v12, v44, v45
  v_cvt_pk_bf16_f32 v13, v46, v47
  s_add_u32 s40, s73, 0x2c00
  buffer_store_dwordx4 v[10:13], v2, s[20:23], s40 offen sc1
  v_mfma_f32_16x16x32_bf16 v[40:43], v[16:19], v[68:71], 0
  ds_read_b64_tr_b16 v[52:53], v4 offset:49152
  ds_read_b64_tr_b16 v[54:55], v4 offset:51200
  s_waitcnt lgkmcnt(6)
  v_mfma_f32_16x16x32_bf16 v[36:39], v[20:23], v[64:67], 0
  v_mfma_f32_16x16x32_bf16 v[44:47], v[20:23], v[68:71], 0
  ds_read_b64_tr_b16 v[56:57], v3 offset:53248
  ds_read_b64_tr_b16 v[58:59], v3 offset:55296
  v_mfma_f32_16x16x32_bf16 v[32:35], v[24:27], v[72:75], v[32:35]
  v_mfma_f32_16x16x32_bf16 v[40:43], v[24:27], v[76:79], v[40:43]
  ds_read_b64_tr_b16 v[60:61], v4 offset:53248
  ds_read_b64_tr_b16 v[62:63], v4 offset:55296
  s_waitcnt lgkmcnt(7)
  v_mfma_f32_16x16x32_bf16 v[36:39], v[28:31], v[72:75], v[36:39]
  v_mfma_f32_16x16x32_bf16 v[44:47], v[28:31], v[76:79], v[44:47]
  s_waitcnt vmcnt(6)
  s_waitcnt lgkmcnt(0)
  s_barrier
  ds_read_b64_tr_b16 v[16:17], v5
  ds_read_b64_tr_b16 v[18:19], v5 offset:2048
  v_mfma_f32_16x16x32_bf16 v[32:35], v[48:51], v[80:83], v[32:35]
  v_mfma_f32_16x16x32_bf16 v[40:43], v[48:51], v[84:87], v[40:43]
  ds_read_b64_tr_b16 v[20:21], v6
  ds_read_b64_tr_b16 v[22:23], v6 offset:2048
  s_mov_b32 m0, 0xd000
  s_add_u32 s39, s72, 0x63080
  buffer_load_dwordx4 v7, s[24:27], s39 offen lds
  buffer_load_dwordx4 v8, s[24:27], s39 offen offset:1024 lds
  v_mfma_f32_16x16x32_bf16 v[36:39], v[52:55], v[80:83], v[36:39]
  v_mfma_f32_16x16x32_bf16 v[44:47], v[52:55], v[84:87], v[44:47]
  ds_read_b64_tr_b16 v[24:25], v5 offset:4096
  ds_read_b64_tr_b16 v[26:27], v5 offset:6144
  v_mfma_f32_16x16x32_bf16 v[32:35], v[56:59], v[88:91], v[32:35]
  v_mfma_f32_16x16x32_bf16 v[40:43], v[56:59], v[92:95], v[40:43]
  ds_read_b64_tr_b16 v[28:29], v6 offset:4096
  ds_read_b64_tr_b16 v[30:31], v6 offset:6144
  v_mfma_f32_16x16x32_bf16 v[36:39], v[60:63], v[88:91], v[36:39]
  v_mfma_f32_16x16x32_bf16 v[44:47], v[60:63], v[92:95], v[44:47]
  ds_read_b64_tr_b16 v[48:49], v5 offset:8192
  ds_read_b64_tr_b16 v[50:51], v5 offset:10240
  s_waitcnt lgkmcnt(8)
  v_mfma_f32_16x16x32_bf16 v[32:35], v[16:19], v[96:99], v[32:35]
  v_mfma_f32_16x16x32_bf16 v[40:43], v[16:19], v[100:103], v[40:43]
  ds_read_b64_tr_b16 v[52:53], v6 offset:8192
  ds_read_b64_tr_b16 v[54:55], v6 offset:10240
  s_waitcnt lgkmcnt(8)
  v_mfma_f32_16x16x32_bf16 v[36:39], v[20:23], v[96:99], v[36:39]
  v_mfma_f32_16x16x32_bf16 v[44:47], v[20:23], v[100:103], v[44:47]
  ds_read_b64_tr_b16 v[56:57], v5 offset:12288
  ds_read_b64_tr_b16 v[58:59], v5 offset:14336
  s_waitcnt lgkmcnt(8)
  v_mfma_f32_16x16x32_bf16 v[32:35], v[24:27], v[104:107], v[32:35]
  v_mfma_f32_16x16x32_bf16 v[40:43], v[24:27], v[108:111], v[40:43]
  ds_read_b64_tr_b16 v[60:61], v6 offset:12288
  ds_read_b64_tr_b16 v[62:63], v6 offset:14336
  s_waitcnt lgkmcnt(8)
  v_mfma_f32_16x16x32_bf16 v[36:39], v[28:31], v[104:107], v[36:39]
  v_mfma_f32_16x16x32_bf16 v[44:47], v[28:31], v[108:111], v[44:47]
  s_waitcnt vmcnt(6)
  s_waitcnt lgkmcnt(0)
  s_barrier
  ds_read_b64_tr_b16 v[16:17], v3
  ds_read_b64_tr_b16 v[18:19], v3 offset:2048
  v_mfma_f32_16x16x32_bf16 v[32:35], v[48:51], v[112:115], v[32:35]
  v_mfma_f32_16x16x32_bf16 v[40:43], v[48:51], v[116:119], v[40:43]
  ds_read_b64_tr_b16 v[20:21], v4
  ds_read_b64_tr_b16 v[22:23], v4 offset:2048
  s_mov_b32 m0, 0x1b800
  s_add_u32 s39, s72, 0x87080
  buffer_load_dwordx4 v7, s[24:27], s39 offen lds
  buffer_load_dwordx4 v8, s[24:27], s39 offen offset:1024 lds
  v_mfma_f32_16x16x32_bf16 v[36:39], v[52:55], v[112:115], v[36:39]
  v_mfma_f32_16x16x32_bf16 v[44:47], v[52:55], v[116:119], v[44:47]
  ds_read_b64_tr_b16 v[24:25], v3 offset:4096
  ds_read_b64_tr_b16 v[26:27], v3 offset:6144
  v_mfma_f32_16x16x32_bf16 v[32:35], v[56:59], v[120:123], v[32:35]
  v_mfma_f32_16x16x32_bf16 v[40:43], v[56:59], v[124:127], v[40:43]
  ds_read_b64_tr_b16 v[28:29], v4 offset:4096
  ds_read_b64_tr_b16 v[30:31], v4 offset:6144
  v_mfma_f32_16x16x32_bf16 v[36:39], v[60:63], v[120:123], v[36:39]
  v_mfma_f32_16x16x32_bf16 v[44:47], v[60:63], v[124:127], v[44:47]
  ds_read_b64_tr_b16 v[48:49], v3 offset:8192
  ds_read_b64_tr_b16 v[50:51], v3 offset:10240
  s_waitcnt lgkmcnt(8)
  v_mfma_f32_16x16x32_bf16 v[32:35], v[16:19], v[128:131], v[32:35]
  v_mfma_f32_16x16x32_bf16 v[40:43], v[16:19], v[132:135], v[40:43]
  ds_read_b64_tr_b16 v[52:53], v4 offset:8192
  ds_read_b64_tr_b16 v[54:55], v4 offset:10240
  s_waitcnt lgkmcnt(8)
  v_mfma_f32_16x16x32_bf16 v[36:39], v[20:23], v[128:131], v[36:39]
  v_mfma_f32_16x16x32_bf16 v[44:47], v[20:23], v[132:135], v[44:47]
  ds_read_b64_tr_b16 v[56:57], v3 offset:12288
  ds_read_b64_tr_b16 v[58:59], v3 offset:14336
  s_waitcnt lgkmcnt(8)
  v_mfma_f32_16x16x32_bf16 v[32:35], v[24:27], v[136:139], v[32:35]
  v_mfma_f32_16x16x32_bf16 v[40:43], v[24:27], v[140:143], v[40:43]
  ds_read_b64_tr_b16 v[60:61], v4 offset:12288
  ds_read_b64_tr_b16 v[62:63], v4 offset:14336
  s_waitcnt lgkmcnt(8)
  v_mfma_f32_16x16x32_bf16 v[36:39], v[28:31], v[136:139], v[36:39]
  v_mfma_f32_16x16x32_bf16 v[44:47], v[28:31], v[140:143], v[44:47]
  s_waitcnt vmcnt(6)
  s_waitcnt lgkmcnt(0)
  s_barrier
  ds_read_b64_tr_b16 v[16:17], v3 offset:16384
  ds_read_b64_tr_b16 v[18:19], v3 offset:18432
  v_mfma_f32_16x16x32_bf16 v[32:35], v[48:51], v[144:147], v[32:35]
  v_mfma_f32_16x16x32_bf16 v[40:43], v[48:51], v[148:151], v[40:43]
  ds_read_b64_tr_b16 v[20:21], v4 offset:16384
  ds_read_b64_tr_b16 v[22:23], v4 offset:18432
  s_mov_b32 m0, 0x3000
  s_add_u32 s39, s72, 0x1b080
  buffer_load_dwordx4 v7, s[24:27], s39 offen lds
  buffer_load_dwordx4 v8, s[24:27], s39 offen offset:1024 lds
  v_mfma_f32_16x16x32_bf16 v[36:39], v[52:55], v[144:147], v[36:39]
  v_mfma_f32_16x16x32_bf16 v[44:47], v[52:55], v[148:151], v[44:47]
  ds_read_b64_tr_b16 v[24:25], v3 offset:20480
  ds_read_b64_tr_b16 v[26:27], v3 offset:22528
  v_mfma_f32_16x16x32_bf16 v[32:35], v[56:59], v[152:155], v[32:35]
  v_mfma_f32_16x16x32_bf16 v[40:43], v[56:59], v[156:159], v[40:43]
  ds_read_b64_tr_b16 v[28:29], v4 offset:20480
  ds_read_b64_tr_b16 v[30:31], v4 offset:22528
  v_mfma_f32_16x16x32_bf16 v[36:39], v[60:63], v[152:155], v[36:39]
  v_mfma_f32_16x16x32_bf16 v[44:47], v[60:63], v[156:159], v[44:47]
  ds_read_b64_tr_b16 v[48:49], v3 offset:24576
  ds_read_b64_tr_b16 v[50:51], v3 offset:26624
  s_waitcnt lgkmcnt(8)
  v_mfma_f32_16x16x32_bf16 v[32:35], v[16:19], v[160:163], v[32:35]
  v_mfma_f32_16x16x32_bf16 v[40:43], v[16:19], v[164:167], v[40:43]
  ds_read_b64_tr_b16 v[52:53], v4 offset:24576
  ds_read_b64_tr_b16 v[54:55], v4 offset:26624
  s_waitcnt lgkmcnt(8)
  v_mfma_f32_16x16x32_bf16 v[36:39], v[20:23], v[160:163], v[36:39]
  v_mfma_f32_16x16x32_bf16 v[44:47], v[20:23], v[164:167], v[44:47]
  ds_read_b64_tr_b16 v[56:57], v3 offset:28672
  ds_read_b64_tr_b16 v[58:59], v3 offset:30720
  s_waitcnt lgkmcnt(8)
  v_mfma_f32_16x16x32_bf16 v[32:35], v[24:27], v[168:171], v[32:35]
  v_mfma_f32_16x16x32_bf16 v[40:43], v[24:27], v[172:175], v[40:43]
  ds_read_b64_tr_b16 v[60:61], v4 offset:28672
  ds_read_b64_tr_b16 v[62:63], v4 offset:30720
  s_waitcnt lgkmcnt(8)
  v_mfma_f32_16x16x32_bf16 v[36:39], v[28:31], v[168:171], v[36:39]
  v_mfma_f32_16x16x32_bf16 v[44:47], v[28:31], v[172:175], v[44:47]
  s_waitcnt vmcnt(4)
  s_waitcnt lgkmcnt(0)
  s_barrier
  ds_read_b64_tr_b16 v[16:17], v3 offset:40960
  ds_read_b64_tr_b16 v[18:19], v3 offset:43008
  v_mfma_f32_16x16x32_bf16 v[32:35], v[48:51], v[176:179], v[32:35]
  v_mfma_f32_16x16x32_bf16 v[40:43], v[48:51], v[180:183], v[40:43]
  ds_read_b64_tr_b16 v[20:21], v4 offset:40960
  ds_read_b64_tr_b16 v[22:23], v4 offset:43008
  s_mov_b32 m0, 0x7000
  s_add_u32 s39, s72, 0x3f080
  buffer_load_dwordx4 v7, s[24:27], s39 offen lds
  buffer_load_dwordx4 v8, s[24:27], s39 offen offset:1024 lds
  v_mfma_f32_16x16x32_bf16 v[36:39], v[52:55], v[176:179], v[36:39]
  v_mfma_f32_16x16x32_bf16 v[44:47], v[52:55], v[180:183], v[44:47]
  ds_read_b64_tr_b16 v[24:25], v3 offset:45056
  ds_read_b64_tr_b16 v[26:27], v3 offset:47104
  v_mfma_f32_16x16x32_bf16 v[32:35], v[56:59], v[184:187], v[32:35]
  v_mfma_f32_16x16x32_bf16 v[40:43], v[56:59], v[188:191], v[40:43]
  ds_read_b64_tr_b16 v[28:29], v4 offset:45056
  ds_read_b64_tr_b16 v[30:31], v4 offset:47104
  v_mfma_f32_16x16x32_bf16 v[36:39], v[60:63], v[184:187], v[36:39]
  v_mfma_f32_16x16x32_bf16 v[44:47], v[60:63], v[188:191], v[44:47]
  s_add_u32 s72, s72, 128
  s_add_u32 s73, s73, 0x4800
  s_add_u32 s78, s78, 1
  s_sub_u32 s74, s74, 1
  s_cmp_lg_u32 s74, 0
  s_cbranch_scc1 L_op6_loop
  ds_read_b64_tr_b16 v[48:49], v3 offset:49152
  ds_read_b64_tr_b16 v[50:51], v3 offset:51200
  v_cvt_pk_bf16_f32 v10, v32, v33
  v_cvt_pk_bf16_f32 v11, v34, v35
  v_cvt_pk_bf16_f32 v12, v36, v37
  v_cvt_pk_bf16_f32 v13, v38, v39
  s_add_u32 s40, s73, 0x2400
  buffer_store_dwordx4 v[10:13], v2, s[20:23], s40 offen sc1
  s_waitcnt lgkmcnt(6)
  v_mfma_f32_16x16x32_bf16 v[32:35], v[16:19], v[64:67], 0
  v_cvt_pk_bf16_f32 v10, v40, v41
  v_cvt_pk_bf16_f32 v11, v42, v43
  v_cvt_pk_bf16_f32 v12, v44, v45
  v_cvt_pk_bf16_f32 v13, v46, v47
  s_add_u32 s40, s73, 0x2c00
  buffer_store_dwordx4 v[10:13], v2, s[20:23], s40 offen sc1
  v_mfma_f32_16x16x32_bf16 v[40:43], v[16:19], v[68:71], 0
  ds_read_b64_tr_b16 v[52:53], v4 offset:49152
  ds_read_b64_tr_b16 v[54:55], v4 offset:51200
  v_mfma_f32_16x16x32_bf16 v[36:39], v[20:23], v[64:67], 0
  v_mfma_f32_16x16x32_bf16 v[44:47], v[20:23], v[68:71], 0
  ds_read_b64_tr_b16 v[56:57], v3 offset:53248
  ds_read_b64_tr_b16 v[58:59], v3 offset:55296
  s_waitcnt lgkmcnt(6)
  v_mfma_f32_16x16x32_bf16 v[32:35], v[24:27], v[72:75], v[32:35]
  v_mfma_f32_16x16x32_bf16 v[40:43], v[24:27], v[76:79], v[40:43]
  ds_read_b64_tr_b16 v[60:61], v4 offset:53248
  ds_read_b64_tr_b16 v[62:63], v4 offset:55296
  v_mfma_f32_16x16x32_bf16 v[36:39], v[28:31], v[72:75], v[36:39]
  v_mfma_f32_16x16x32_bf16 v[44:47], v[28:31], v[76:79], v[44:47]
  s_waitcnt vmcnt(6)
  s_waitcnt lgkmcnt(0)
  s_barrier
  ds_read_b64_tr_b16 v[16:17], v5
  ds_read_b64_tr_b16 v[18:19], v5 offset:2048
  v_mfma_f32_16x16x32_bf16 v[32:35], v[48:51], v[80:83], v[32:35]
  v_mfma_f32_16x16x32_bf16 v[40:43], v[48:51], v[84:87], v[40:43]
  ds_read_b64_tr_b16 v[20:21], v6
  ds_read_b64_tr_b16 v[22:23], v6 offset:2048
  v_mfma_f32_16x16x32_bf16 v[36:39], v[52:55], v[80:83], v[36:39]
  v_mfma_f32_16x16x32_bf16 v[44:47], v[52:55], v[84:87], v[44:47]
  ds_read_b64_tr_b16 v[24:25], v5 offset:4096
  ds_read_b64_tr_b16 v[26:27], v5 offset:6144
  v_mfma_f32_16x16x32_bf16 v[32:35], v[56:59], v[88:91], v[32:35]
  v_mfma_f32_16x16x32_bf16 v[40:43], v[56:59], v[92:95], v[40:43]
  ds_read_b64_tr_b16 v[28:29], v6 offset:4096
  ds_read_b64_tr_b16 v[30:31], v6 offset:6144
  v_mfma_f32_16x16x32_bf16 v[36:39], v[60:63], v[88:91], v[36:39]
  v_mfma_f32_16x16x32_bf16 v[44:47], v[60:63], v[92:95], v[44:47]
  ds_read_b64_tr_b16 v[48:49], v5 offset:8192
  ds_read_b64_tr_b16 v[50:51], v5 offset:10240
  s_waitcnt lgkmcnt(8)
  v_mfma_f32_16x16x32_bf16 v[32:35], v[16:19], v[96:99], v[32:35]
  v_mfma_f32_16x16x32_bf16 v[40:43], v[16:19], v[100:103], v[40:43]
  ds_read_b64_tr_b16 v[52:53], v6 offset:8192
  ds_read_b64_tr_b16 v[54:55], v6 offset:10240
  s_waitcnt lgkmcnt(8)
  v_mfma_f32_16x16x32_bf16 v[36:39], v[20:23], v[96:99], v[36:39]
  v_mfma_f32_16x16x32_bf16 v[44:47], v[20:23], v[100:103], v[44:47]
  ds_read_b64_tr_b16 v[56:57], v5 offset:12288
  ds_read_b64_tr_b16 v[58:59], v5 offset:14336
  s_waitcnt lgkmcnt(8)
  v_mfma_f32_16x16x32_bf16 v[32:35], v[24:27], v[104:107], v[32:35]
  v_mfma_f32_16x16x32_bf16 v[40:43], v[24:27], v[108:111], v[40:43]
  ds_read_b64_tr_b16 v[60:61], v6 offset:12288
  ds_read_b64_tr_b16 v[62:63], v6 offset:14336
  s_waitcnt lgkmcnt(8)
  v_mfma_f32_16x16x32_bf16 v[36:39], v[28:31], v[104:107], v[36:39]
  v_mfma_f32_16x16x32_bf16 v[44:47], v[28:31], v[108:111], v[44:47]
  s_waitcnt vmcnt(4)
  s_waitcnt lgkmcnt(0)
  s_barrier
  ds_read_b64_tr_b16 v[16:17], v3
  ds_read_b64_tr_b16 v[18:19], v3 offset:2048
  v_mfma_f32_16x16x32_bf16 v[32:35], v[48:51], v[112:115], v[32:35]
  v_mfma_f32_16x16x32_bf16 v[40:43], v[48:51], v[116:119], v[40:43]
  ds_read_b64_tr_b16 v[20:21], v4
  ds_read_b64_tr_b16 v[22:23], v4 offset:2048
  v_mfma_f32_16x16x32_bf16 v[36:39], v[52:55], v[112:115], v[36:39]
  v_mfma_f32_16x16x32_bf16 v[44:47], v[52:55], v[116:119], v[44:47]
  ds_read_b64_tr_b16 v[24:25], v3 offset:4096
  ds_read_b64_tr_b16 v[26:27], v3 offset:6144
  v_mfma_f32_16x16x32_bf16 v[32:35], v[56:59], v[120:123], v[32:35]
  v_mfma_f32_16x16x32_bf16 v[40:43], v[56:59], v[124:127], v[40:43]
  ds_read_b64_tr_b16 v[28:29], v4 offset:4096
  ds_read_b64_tr_b16 v[30:31], v4 offset:6144
  v_mfma_f32_16x16x32_bf16 v[36:39], v[60:63], v[120:123], v[36:39]
  v_mfma_f32_16x16x32_bf16 v[44:47], v[60:63], v[124:127], v[44:47]
  ds_read_b64_tr_b16 v[48:49], v3 offset:8192
  ds_read_b64_tr_b16 v[50:51], v3 offset:10240
  s_waitcnt lgkmcnt(8)
  v_mfma_f32_16x16x32_bf16 v[32:35], v[16:19], v[128:131], v[32:35]
  v_mfma_f32_16x16x32_bf16 v[40:43], v[16:19], v[132:135], v[40:43]
  ds_read_b64_tr_b16 v[52:53], v4 offset:8192
  ds_read_b64_tr_b16 v[54:55], v4 offset:10240
  s_waitcnt lgkmcnt(8)
  v_mfma_f32_16x16x32_bf16 v[36:39], v[20:23], v[128:131], v[36:39]
  v_mfma_f32_16x16x32_bf16 v[44:47], v[20:23], v[132:135], v[44:47]
  ds_read_b64_tr_b16 v[56:57], v3 offset:12288
  ds_read_b64_tr_b16 v[58:59], v3 offset:14336
  s_waitcnt lgkmcnt(8)
  v_mfma_f32_16x16x32_bf16 v[32:35], v[24:27], v[136:139], v[32:35]
  v_mfma_f32_16x16x32_bf16 v[40:43], v[24:27], v[140:143], v[40:43]
  ds_read_b64_tr_b16 v[60:61], v4 offset:12288
  ds_read_b64_tr_b16 v[62:63], v4 offset:14336
  s_waitcnt lgkmcnt(8)
  v_mfma_f32_16x16x32_bf16 v[36:39], v[28:31], v[136:139], v[36:39]
  v_mfma_f32_16x16x32_bf16 v[44:47], v[28:31], v[140:143], v[44:47]
  s_waitcnt vmcnt(0)
  s_waitcnt lgkmcnt(0)
  s_barrier
  ds_read_b64_tr_b16 v[16:17], v3 offset:16384
  ds_read_b64_tr_b16 v[18:19], v3 offset:18432
  v_mfma_f32_16x16x32_bf16 v[32:35], v[48:51], v[144:147], v[32:35]
  v_mfma_f32_16x16x32_bf16 v[40:43], v[48:51], v[148:151], v[40:43]
  ds_read_b64_tr_b16 v[20:21], v4 offset:16384
  ds_read_b64_tr_b16 v[22:23], v4 offset:18432
  v_mfma_f32_16x16x32_bf16 v[36:39], v[52:55], v[144:147], v[36:39]
  v_mfma_f32_16x16x32_bf16 v[44:47], v[52:55], v[148:151], v[44:47]
  ds_read_b64_tr_b16 v[24:25], v3 offset:20480
  ds_read_b64_tr_b16 v[26:27], v3 offset:22528
  v_mfma_f32_16x16x32_bf16 v[32:35], v[56:59], v[152:155], v[32:35]
  v_mfma_f32_16x16x32_bf16 v[40:43], v[56:59], v[156:159], v[40:43]
  ds_read_b64_tr_b16 v[28:29], v4 offset:20480
  ds_read_b64_tr_b16 v[30:31], v4 offset:22528
  v_mfma_f32_16x16x32_bf16 v[36:39], v[60:63], v[152:155], v[36:39]
  v_mfma_f32_16x16x32_bf16 v[44:47], v[60:63], v[156:159], v[44:47]
  ds_read_b64_tr_b16 v[48:49], v3 offset:24576
  ds_read_b64_tr_b16 v[50:51], v3 offset:26624
  s_waitcnt lgkmcnt(8)
  v_mfma_f32_16x16x32_bf16 v[32:35], v[16:19], v[160:163], v[32:35]
  v_mfma_f32_16x16x32_bf16 v[40:43], v[16:19], v[164:167], v[40:43]
  ds_read_b64_tr_b16 v[52:53], v4 offset:24576
  ds_read_b64_tr_b16 v[54:55], v4 offset:26624
  s_waitcnt lgkmcnt(8)
  v_mfma_f32_16x16x32_bf16 v[36:39], v[20:23], v[160:163], v[36:39]
  v_mfma_f32_16x16x32_bf16 v[44:47], v[20:23], v[164:167], v[44:47]
  ds_read_b64_tr_b16 v[56:57], v3 offset:28672
  ds_read_b64_tr_b16 v[58:59], v3 offset:30720
  s_waitcnt lgkmcnt(8)
  v_mfma_f32_16x16x32_bf16 v[32:35], v[24:27], v[168:171], v[32:35]
  v_mfma_f32_16x16x32_bf16 v[40:43], v[24:27], v[172:175], v[40:43]
  ds_read_b64_tr_b16 v[60:61], v4 offset:28672
  ds_read_b64_tr_b16 v[62:63], v4 offset:30720
  s_waitcnt lgkmcnt(8)
  v_mfma_f32_16x16x32_bf16 v[36:39], v[28:31], v[168:171], v[36:39]
  v_mfma_f32_16x16x32_bf16 v[44:47], v[28:31], v[172:175], v[44:47]
  s_waitcnt lgkmcnt(6)
  v_mfma_f32_16x16x32_bf16 v[32:35], v[48:51], v[176:179], v[32:35]
  v_mfma_f32_16x16x32_bf16 v[40:43], v[48:51], v[180:183], v[40:43]
  s_waitcnt lgkmcnt(4)
  v_mfma_f32_16x16x32_bf16 v[36:39], v[52:55], v[176:179], v[36:39]
  v_mfma_f32_16x16x32_bf16 v[44:47], v[52:55], v[180:183], v[44:47]
  s_waitcnt lgkmcnt(2)
  v_mfma_f32_16x16x32_bf16 v[32:35], v[56:59], v[184:187], v[32:35]
  v_mfma_f32_16x16x32_bf16 v[40:43], v[56:59], v[188:191], v[40:43]
  s_waitcnt lgkmcnt(0)
  v_mfma_f32_16x16x32_bf16 v[36:39], v[60:63], v[184:187], v[36:39]
  v_mfma_f32_16x16x32_bf16 v[44:47], v[60:63], v[188:191], v[44:47]
  s_nop 3
  v_cvt_pk_bf16_f32 v10, v32, v33
  v_cvt_pk_bf16_f32 v11, v34, v35
  s_nop 0
  v_cvt_pk_bf16_f32 v12, v36, v37
  v_cvt_pk_bf16_f32 v13, v38, v39
  s_add_u32 s40, s73, 0x6c00
  buffer_store_dwordx4 v[10:13], v2, s[20:23], s40 offen sc1
  s_nop 1
  v_cvt_pk_bf16_f32 v10, v40, v41
  v_cvt_pk_bf16_f32 v11, v42, v43
  v_cvt_pk_bf16_f32 v12, v44, v45
  v_cvt_pk_bf16_f32 v13, v46, v47
  s_add_u32 s40, s73, 0x7400
  buffer_store_dwordx4 v[10:13], v2, s[20:23], s40 offen sc1
  s_lshl_b32 s41, s33, 8
  s_add_u32 s41, s41, 0x4000000
  v_mov_b32 v238, s41
  v_and_b32 v239, 15, v0
  v_mul_u32_u24 v239, 2304, v239
  v_lshrrev_b32 v232, 4, v0
  v_lshl_add_u32 v239, v232, 4, v239
  buffer_load_dwordx2 v[236:237], v238, s[20:23], 0 offen sc1
  s_waitcnt vmcnt(0)
  s_barrier
  s_branch L_tail
L_end1:
  s_endpgm
.section .rodata,"a"
.p2align 6
.amdhsa_kernel concat_heads__mha_block_cached__gqa_block_cached__near_ridge_kernel
  .amdhsa_next_free_vgpr 256
  .amdhsa_next_free_sgpr 102
  .amdhsa_accum_offset 256
  .amdhsa_group_segment_fixed_size 0
  .amdhsa_kernarg_size 104
  .amdhsa_user_sgpr_count 2
  .amdhsa_user_sgpr_kernarg_segment_ptr 1
  .amdhsa_system_sgpr_workgroup_id_x 1
.end_amdhsa_kernel
```
